```python
import torch

def _softmax(x, axis=-1):
    return torch.softmax(x, dim=axis)
def _gelu(x):
    return torch.nn.functional.gelu(x, approximate="tanh")
def _silu(x):
    return torch.nn.functional.silu(x)
def _sigmoid(x):
    return torch.sigmoid(x)
def _layernorm(x, axis=-1, eps=1e-5):
    m = x.mean(dim=axis, keepdim=True)
    v = x.var(dim=axis, keepdim=True, unbiased=False)
    return (x - m) / torch.sqrt(v + eps)
def _scatter_add(tgt, idx, src, axis=0):
    return tgt.clone().index_add_(axis, idx, src)
def _segment_sum(src, seg, n):
    out = torch.zeros((n,) + src.shape[1:], dtype=src.dtype)
    return out.index_add_(0, seg, src)
def _pad(x, pw):
    flat = tuple(v for pair in reversed(pw) for v in pair)
    return torch.nn.functional.pad(x, flat)

kernel_name = 'concat_heads__sliding_block__softmax_full_mha__prompt'

def setup_inputs():

    _w = (lambda a: (lambda t: t.to(torch.bfloat16) if t.is_floating_point() else t)(torch.as_tensor(a)))
    def _A_setup():
        B, S, D = 1, 2048, 1024
        return {
            "x": _w((lambda *s: torch.randn(*s, dtype=torch.bfloat16) * 0.2)(B, S, D)),
            "wqkv": _w((lambda *s: torch.randn(*s, dtype=torch.bfloat16) * 0.8)(D, 3 * D)),
            "wo": _w((lambda *s: torch.randn(*s, dtype=torch.bfloat16) * 0.8)(D, D)),
        }
    _A_in = _A_setup()

    def _B_setup():
        B, S, D = 1, 2048, 1024
        return {
            "x": _w((lambda *s: torch.randn(*s, dtype=torch.bfloat16) * 0.2)(B, S, D)),
            "wqkv": _w((lambda *s: torch.randn(*s, dtype=torch.bfloat16) * 0.8)(D, 3 * D)),
            "wo": _w((lambda *s: torch.randn(*s, dtype=torch.bfloat16) * 0.8)(D, D)),
        }
    _B_in = _B_setup()

    return {
        "A_x": _A_in["x"],
        "A_wqkv": _A_in["wqkv"],
        "A_wo": _A_in["wo"],
        "B_x": _B_in["x"],
        "B_wqkv": _B_in["wqkv"],
        "B_wo": _B_in["wo"],
    }

def reference(A_x, A_wqkv, A_wo, B_x, B_wqkv, B_wo):
    def _A_ref(x, wqkv, wo):
        B, S, D = x.shape
        H = 32; Dh = D // H; W = 256
        qkv = (lambda x, *d: x.permute(*d))((x @ wqkv).reshape(B, S, 3, H, Dh), 2, 0, 3, 1, 4)
        q, k, v = qkv[0], qkv[1], qkv[2]
        scores = torch.einsum("bhqd,bhkd->bhqk", q, k) * (Dh ** -0.5)
        idx = torch.arange(S)
        mask = (idx[:, None] - idx[None, :] >= 0) & (idx[:, None] - idx[None, :] < W)
        scores = torch.where(mask[None, None], scores, -1e9)
        p = _softmax(scores, axis=-1)
        o = torch.einsum("bhqk,bhkd->bhqd", p, v)
        return (lambda x, *d: x.permute(*d))(o, 0, 2, 1, 3).reshape(B, S, D) @ wo

    def _B_ref(x, wqkv, wo):
        B, S, D = x.shape
        H = 32; Dh = D // H
        qkv = (lambda x, *d: x.permute(*d))((x @ wqkv).reshape(B, S, 3, H, Dh), 2, 0, 3, 1, 4)
        q, k, v = qkv[0], qkv[1], qkv[2]
        scale = Dh ** -0.5
        scores = torch.einsum("bhqd,bhkd->bhqk", q, k) * scale
        p = _softmax(scores, axis=-1)
        o = torch.einsum("bhqk,bhkd->bhqd", p, v)
        return (lambda x, *d: x.permute(*d))(o, 0, 2, 1, 3).reshape(B, S, D) @ wo

    a = _A_ref(A_x, A_wqkv, A_wo)
    b = _B_ref(B_x, B_wqkv, B_wo)
    return torch.concatenate([a, b], axis=-1)
```

```asm
; @launch grid=(256,1,1) block=(512,1,1) lds=163840
.amdgcn_target "amdgcn-amd-amdhsa--gfx950"
.text
.globl concat_heads__sliding_block__softmax_full_mha__prompt_kernel
.p2align 8
.type concat_heads__sliding_block__softmax_full_mha__prompt_kernel,@function
concat_heads__sliding_block__softmax_full_mha__prompt_kernel:
    s_cmp_ge_u32 s2, 256
    s_cbranch_scc1 END
    s_andn2_b32 s23, 1, s2
    s_mul_i32 s25, s23, 24
    s_add_u32 s4, s0, s25
    s_addc_u32 s5, s1, 0
    s_load_dwordx2 s[8:9], s[4:5], 0
    s_load_dwordx2 s[12:13], s[4:5], 8
    s_load_dwordx2 s[36:37], s[4:5], 16
    s_load_dwordx2 s[40:41], s[0:1], 48
    s_load_dwordx2 s[6:7], s[0:1], 56
    s_load_dwordx2 s[16:17], s[0:1], 64
    v_lshrrev_b32 v27, 6, v0
    v_and_b32 v2, 63, v0
    v_readfirstlane_b32 s20, v27
    s_bfe_u32 s21, s2, 0x20003
    s_and_b32 s25, s2, 2
    s_lshl_b32 s25, s25, 1
    s_add_u32 s21, s21, s25
    s_lshr_b32 s22, s2, 5
    s_and_b32 s25, s2, 4
    s_lshl_b32 s25, s25, 1
    s_add_u32 s22, s22, s25
    s_and_b32 s28, s20, 3
    s_lshr_b32 s29, s20, 2
    s_mov_b32 s10, 0x400000
    s_mov_b32 s11, 0x20000
    s_mov_b32 s14, 0x600000
    s_mov_b32 s15, 0x20000
    s_cmp_ge_u32 s20, 4
    s_cbranch_scc1 G1Y
    v_lshrrev_b32 v24, 3, v2
    v_and_b32 v25, 7, v2
    v_lshrrev_b32 v26, 4, v2
    s_lshl_b32 s25, s21, 8
    s_lshl_b32 s26, s20, 6
    s_add_u32 s25, s25, s26
    v_add_u32 v27, s25, v24
    v_lshlrev_b32 v27, 11, v27
    v_xor_b32 v22, v25, v26
    v_lshl_add_u32 v22, v22, 4, v27
    v_xor_b32 v23, 64, v22
    v_add_u32 v23, 15360, v23
    s_and_b32 s26, s22, 3
    s_mul_i32 s27, s20, 24576
    s_xor_b32 s25, s26, 0
    s_lshl_b32 s46, s25, 11
    s_add_u32 s46, s46, s27
    s_lshl_b32 s25, s25, 15
    v_add_u32 v68, s25, v22
    v_add_u32 v69, s25, v23
    s_xor_b32 s25, s26, 1
    s_lshl_b32 s47, s25, 11
    s_add_u32 s47, s47, s27
    s_lshl_b32 s25, s25, 15
    v_add_u32 v70, s25, v22
    v_add_u32 v71, s25, v23
    s_xor_b32 s25, s26, 2
    s_lshl_b32 s48, s25, 11
    s_add_u32 s48, s48, s27
    s_lshl_b32 s25, s25, 15
    v_add_u32 v72, s25, v22
    v_add_u32 v73, s25, v23
    s_xor_b32 s25, s26, 3
    s_lshl_b32 s49, s25, 11
    s_add_u32 s49, s49, s27
    s_lshl_b32 s25, s25, 15
    v_add_u32 v74, s25, v22
    v_add_u32 v75, s25, v23
    s_and_b32 s26, s21, 1
    s_lshl_b32 s25, s20, 1
    s_add_u32 s25, s25, s26
    s_lshl_b32 s50, s25, 10
    s_add_u32 s50, s50, 98304
    s_xor_b32 s51, s50, 1024
    s_lshl_b32 s25, s25, 3
    v_add_u32 v27, s25, v24
    v_xor_b32 v22, 8, v27
    v_mul_u32_u24 v27, 6144, v27
    v_mul_u32_u24 v22, 6144, v22
    s_lshl_b32 s26, s26, 2
    v_and_b32 v26, 1, v26
    v_lshl_add_u32 v26, v26, 1, s26
    v_xor_b32 v26, v26, v25
    s_lshl_b32 s25, s22, 7
    v_lshl_add_u32 v26, v26, 4, s25
    v_add_u32 v76, v26, v27
    v_xor_b32 v26, 64, v26
    v_add_u32 v77, v26, v22
    s_waitcnt lgkmcnt(0)
    s_add_u32 m0, s46, 0
    s_movk_i32 s52, 0
    buffer_load_dwordx4 v68, s[8:11], s52 offen lds
    buffer_load_dwordx4 v69, s[8:11], s52 offen offset:1024 lds
    s_add_u32 m0, s50, 0
    s_mov_b32 s53, 0
    buffer_load_dwordx4 v76, s[12:15], s53 offen lds
    s_add_u32 m0, s50, 8192
    s_mov_b32 s53, 2048
    buffer_load_dwordx4 v76, s[12:15], s53 offen lds
    s_add_u32 m0, s50, 16384
    s_mov_b32 s53, 4096
    buffer_load_dwordx4 v76, s[12:15], s53 offen lds
    s_add_u32 m0, s47, 0
    s_movk_i32 s52, 0
    buffer_load_dwordx4 v70, s[8:11], s52 offen lds
    buffer_load_dwordx4 v71, s[8:11], s52 offen offset:1024 lds
    s_mul_i32 s25, s28, 24576
    v_and_b32 v24, 15, v2
    v_lshrrev_b32 v25, 4, v2
    v_bfe_u32 v26, v2, 1, 3
    v_xor_b32 v26, v26, v25
    v_lshlrev_b32 v26, 4, v26
    v_lshl_add_u32 v26, v24, 7, v26
    v_add_u32 v64, s25, v26
    v_xor_b32 v65, 64, v64
    v_lshlrev_b32 v4, 4, v24
    v_lshl_add_u32 v4, v25, 9, v4
    v_bfe_u32 v24, v2, 2, 2
    v_lshl_add_u32 v26, v25, 3, v24
    v_lshlrev_b32 v26, 7, v26
    v_and_b32 v23, 3, v2
    v_lshl_add_u32 v26, v23, 3, v26
    v_lshrrev_b32 v24, 1, v24
    v_lshl_add_u32 v26, v24, 5, v26
    s_xor_b32 s25, s29, s23
    s_xor_b32 s25, s25, 1
    v_and_b32 v25, 1, v25
    v_xor_b32 v25, s25, v25
    v_lshl_add_u32 v26, v25, 6, v26
    v_add_u32 v66, 98304, v26
    v_xor_b32 v67, 32, v66
    s_add_u32 m0, s51, 0
    s_mov_b32 s53, 0
    buffer_load_dwordx4 v77, s[12:15], s53 offen lds
    s_add_u32 m0, s51, 8192
    s_mov_b32 s53, 2048
    buffer_load_dwordx4 v77, s[12:15], s53 offen lds
    s_add_u32 m0, s51, 16384
    s_mov_b32 s53, 4096
    buffer_load_dwordx4 v77, s[12:15], s53 offen lds
    s_add_u32 m0, s48, 0
    s_movk_i32 s52, 0
    buffer_load_dwordx4 v72, s[8:11], s52 offen lds
    buffer_load_dwordx4 v73, s[8:11], s52 offen offset:1024 lds
    s_add_u32 m0, s49, 0
    s_movk_i32 s52, 0
    buffer_load_dwordx4 v74, s[8:11], s52 offen lds
    buffer_load_dwordx4 v75, s[8:11], s52 offen offset:1024 lds
    s_add_u32 m0, s46, 8192
    s_movk_i32 s52, 128
    buffer_load_dwordx4 v68, s[8:11], s52 offen lds
    buffer_load_dwordx4 v69, s[8:11], s52 offen offset:1024 lds
    s_add_u32 m0, s50, 24576
    s_mov_b32 s53, 393216
    buffer_load_dwordx4 v76, s[12:15], s53 offen lds
    s_add_u32 m0, s50, 32768
    s_mov_b32 s53, 395264
    buffer_load_dwordx4 v76, s[12:15], s53 offen lds
    s_add_u32 m0, s50, 40960
    s_mov_b32 s53, 397312
    buffer_load_dwordx4 v76, s[12:15], s53 offen lds
    s_add_u32 m0, s47, 8192
    s_movk_i32 s52, 128
    buffer_load_dwordx4 v70, s[8:11], s52 offen lds
    buffer_load_dwordx4 v71, s[8:11], s52 offen offset:1024 lds
    s_add_u32 m0, s51, 24576
    s_mov_b32 s53, 393216
    buffer_load_dwordx4 v77, s[12:15], s53 offen lds
    s_add_u32 m0, s51, 32768
    s_mov_b32 s53, 395264
    buffer_load_dwordx4 v77, s[12:15], s53 offen lds
    s_add_u32 m0, s51, 40960
    s_mov_b32 s53, 397312
    buffer_load_dwordx4 v77, s[12:15], s53 offen lds
    s_add_u32 m0, s48, 8192
    s_movk_i32 s52, 128
    buffer_load_dwordx4 v72, s[8:11], s52 offen lds
    buffer_load_dwordx4 v73, s[8:11], s52 offen offset:1024 lds
    s_add_u32 m0, s49, 8192
    s_movk_i32 s52, 128
    buffer_load_dwordx4 v74, s[8:11], s52 offen lds
    buffer_load_dwordx4 v75, s[8:11], s52 offen offset:1024 lds
G1O:
    s_waitcnt vmcnt(14)
    s_barrier
    ds_read_b128 v[216:219], v64 offset:0
    ds_read_b64_tr_b16 v[232:233], v66 offset:0
    ds_read_b64_tr_b16 v[234:235], v66 offset:512
    ds_read_b64_tr_b16 v[236:237], v67 offset:0
    ds_read_b64_tr_b16 v[238:239], v67 offset:512
    ds_read_b64_tr_b16 v[240:241], v66 offset:8192
    ds_read_b64_tr_b16 v[242:243], v66 offset:8704
    ds_read_b64_tr_b16 v[244:245], v67 offset:8192
    ds_read_b64_tr_b16 v[246:247], v67 offset:8704
    ds_read_b64_tr_b16 v[248:249], v66 offset:16384
    ds_read_b64_tr_b16 v[250:251], v66 offset:16896
    ds_read_b64_tr_b16 v[252:253], v67 offset:16384
    ds_read_b64_tr_b16 v[254:255], v67 offset:16896
    ds_read_b128 v[220:223], v64 offset:2048
    ds_read_b128 v[224:227], v64 offset:4096
    ds_read_b128 v[228:231], v64 offset:6144
    s_waitcnt lgkmcnt(0)
    v_mfma_f32_16x16x32_bf16 v[80:83], v[232:235], v[216:219], 0
    ds_read_b128 v[176:179], v65 offset:0
    s_add_u32 m0, s50, 49152
    s_mov_b32 s53, 786432
    v_mfma_f32_16x16x32_bf16 v[96:99], v[232:235], v[220:223], 0
    ds_read_b64_tr_b16 v[192:193], v66 offset:4096
    buffer_load_dwordx4 v76, s[12:15], s53 offen lds
    v_mfma_f32_16x16x32_bf16 v[100:103], v[236:239], v[220:223], 0
    ds_read_b64_tr_b16 v[194:195], v66 offset:4608
    s_add_u32 m0, s50, 57344
    s_mov_b32 s53, 788480
    v_mfma_f32_16x16x32_bf16 v[84:87], v[236:239], v[216:219], 0
    ds_read_b64_tr_b16 v[196:197], v67 offset:4096
    buffer_load_dwordx4 v76, s[12:15], s53 offen lds
    v_mfma_f32_16x16x32_bf16 v[88:91], v[240:243], v[216:219], 0
    ds_read_b64_tr_b16 v[198:199], v67 offset:4608
    s_add_u32 m0, s46, 16384
    s_movk_i32 s52, 256
    v_mfma_f32_16x16x32_bf16 v[104:107], v[240:243], v[220:223], 0
    ds_read_b64_tr_b16 v[200:201], v66 offset:12288
    buffer_load_dwordx4 v68, s[8:11], s52 offen lds
    v_mfma_f32_16x16x32_bf16 v[108:111], v[244:247], v[220:223], 0
    ds_read_b64_tr_b16 v[202:203], v66 offset:12800
    buffer_load_dwordx4 v69, s[8:11], s52 offen offset:1024 lds
    v_mfma_f32_16x16x32_bf16 v[92:95], v[244:247], v[216:219], 0
    ds_read_b64_tr_b16 v[204:205], v67 offset:12288
    s_add_u32 m0, s51, 49152
    s_mov_b32 s53, 786432
    v_mfma_f32_16x16x32_bf16 v[144:147], v[216:219], v[248:251], 0
    ds_read_b64_tr_b16 v[206:207], v67 offset:12800
    buffer_load_dwordx4 v77, s[12:15], s53 offen lds
    v_mfma_f32_16x16x32_bf16 v[148:151], v[220:223], v[248:251], 0
    ds_read_b64_tr_b16 v[208:209], v66 offset:20480
    s_add_u32 m0, s51, 57344
    s_mov_b32 s53, 788480
    v_mfma_f32_16x16x32_bf16 v[156:159], v[220:223], v[252:255], 0
    ds_read_b64_tr_b16 v[210:211], v66 offset:20992
    buffer_load_dwordx4 v77, s[12:15], s53 offen lds
    v_mfma_f32_16x16x32_bf16 v[152:155], v[216:219], v[252:255], 0
    ds_read_b64_tr_b16 v[212:213], v67 offset:20480
    s_add_u32 m0, s47, 16384
    s_movk_i32 s52, 256
    v_mfma_f32_16x16x32_bf16 v[160:163], v[224:227], v[248:251], 0
    ds_read_b64_tr_b16 v[214:215], v67 offset:20992
    buffer_load_dwordx4 v70, s[8:11], s52 offen lds
    v_mfma_f32_16x16x32_bf16 v[164:167], v[228:231], v[248:251], 0
    ds_read_b128 v[180:183], v65 offset:2048
    buffer_load_dwordx4 v71, s[8:11], s52 offen offset:1024 lds
    v_mfma_f32_16x16x32_bf16 v[172:175], v[228:231], v[252:255], 0
    ds_read_b128 v[184:187], v65 offset:4096
    s_add_u32 m0, s48, 16384
    s_movk_i32 s52, 256
    v_mfma_f32_16x16x32_bf16 v[168:171], v[224:227], v[252:255], 0
    ds_read_b128 v[188:191], v65 offset:6144
    buffer_load_dwordx4 v72, s[8:11], s52 offen lds
    v_mfma_f32_16x16x32_bf16 v[120:123], v[240:243], v[224:227], 0
    buffer_load_dwordx4 v73, s[8:11], s52 offen offset:1024 lds
    v_mfma_f32_16x16x32_bf16 v[136:139], v[240:243], v[228:231], 0
    s_add_u32 m0, s49, 16384
    s_movk_i32 s52, 256
    v_mfma_f32_16x16x32_bf16 v[140:143], v[244:247], v[228:231], 0
    buffer_load_dwordx4 v74, s[8:11], s52 offen lds
    v_mfma_f32_16x16x32_bf16 v[124:127], v[244:247], v[224:227], 0
    buffer_load_dwordx4 v75, s[8:11], s52 offen offset:1024 lds
    v_mfma_f32_16x16x32_bf16 v[112:115], v[232:235], v[224:227], 0
    v_mfma_f32_16x16x32_bf16 v[128:131], v[232:235], v[228:231], 0
    v_mfma_f32_16x16x32_bf16 v[132:135], v[236:239], v[228:231], 0
    v_mfma_f32_16x16x32_bf16 v[116:119], v[236:239], v[224:227], 0
    s_waitcnt vmcnt(12) lgkmcnt(0)
    s_barrier
    v_lshlrev_b32 v3, 4, v2
    v_and_b32 v5, 31, v2
    v_lshlrev_b32 v5, 7, v5
    v_lshrrev_b32 v22, 5, v2
    v_mul_u32_u24 v22, 786432, v22
    v_add_u32 v5, v5, v22
    s_lshl_b32 s24, s22, 1
    s_add_u32 s24, s24, 1
    s_sub_u32 s24, s24, s23
    s_mov_b32 s18, 35127424
    s_mov_b32 s19, 0x20000
    s_mov_b32 s38, 0x200000
    s_mov_b32 s39, 0x20000
    s_mov_b32 s42, 0x800000
    s_mov_b32 s43, 0x20000
    s_mov_b32 s32, 1048744942
    s_xor_b32 s25, s24, s29
    s_lshl_b32 s26, s23, 5
    s_add_u32 s25, s25, s26
    s_lshl_b32 s26, s21, 2
    s_add_u32 s26, s26, s28
    s_lshl_b32 s45, s25, 5
    s_add_u32 s45, s45, s26
    s_lshl_b32 s34, s45, 12
    s_lshl_b32 s35, s45, 13
    s_add_u32 s35, s35, 8388608
    s_add_u32 s44, s35, 4096
    s_lshl_b32 s45, s45, 7
    s_add_u32 s45, s45, 33554432
    s_lshl_b32 s56, s28, 13
    s_lshl_b32 s74, s28, 12
    s_lshl_b32 s57, s20, 12
    s_add_u32 s25, s56, 98304
    v_add_u32 v78, s25, v4
    s_add_u32 s25, s74, 8192
    v_add_u32 v79, s25, v4
    s_sub_u32 s27, s26, 4
    s_lshl_b32 s27, 1, s27
    s_lshl_b32 s25, s21, 2
    s_lshl_b32 s62, 15, s25
    s_lshr_b32 s25, s62, 4
    s_or_b32 s62, s62, s25
    s_cmp_eq_u32 s23, 0
    s_cselect_b32 s62, s27, s62
    v_mov_b32 v17, 0xdddddddd
    v_and_b32 v25, 7, v2
    v_lshrrev_b32 v26, v25, 1
    v_mul_u32_u24 v26, 0x3f80, v26
    v_lshl_or_b32 v28, v26, 16, v26
    v_mov_b32 v29, v28
    v_xor_b32 v25, 4, v25
    v_lshrrev_b32 v26, v25, 1
    v_mul_u32_u24 v26, 0x3f80, v26
    v_lshl_or_b32 v30, v26, 16, v26
    v_mov_b32 v31, v30
    v_bfe_u32 v24, v2, 2, 1
    v_bfe_u32 v25, v2, 3, 2
    v_and_b32 v26, 35, v2
    v_lshl_add_u32 v26, v25, 2, v26
    v_lshl_add_u32 v26, v24, 4, v26
    v_lshlrev_b32 v16, 4, v26
    s_lshl_b32 s25, s24, 18
    s_add_u32 s55, s25, 8388608
    s_add_u32 s54, s25, 16777216
    s_lshl_b32 s25, s24, 12
    s_add_u32 s59, s25, 33554432
    s_add_u32 s58, s25, 33685504
    s_lshr_b32 s25, s21, 2
    s_lshl_b32 s25, s25, 4
    s_lshl_b32 s60, 0xffff, s25
    s_not_b32 s61, s60
    s_and_b32 s25, s24, 1
    s_lshl_b32 s73, s25, 16
    s_lshl_b32 s75, s25, 15
    s_lshl_b32 s25, s25, 4
    s_add_u32 s67, s25, s22
    s_lshl_b32 s71, 0xffff, s25
    s_not_b32 s72, s71
    s_mov_b32 s76, 125829120
    s_mov_b32 s77, 0x7f800000
    s_mov_b32 s78, 2071986176
    s_mov_b32 s68, 3267887104
    s_sub_u32 s25, 11, s20
    s_cmp_gt_u32 s29, s23
    s_cselect_b32 s64, s25, s20
    s_lshl_b32 s63, s21, 3
    s_add_u32 s63, s63, s64
    s_lshl_b32 s25, s24, 6
    s_add_u32 s80, s25, s63
    s_lshl_b32 s80, s80, 11
    s_lshl_b32 s26, s28, 1
    s_add_u32 s26, s26, s29
    s_lshl_b32 s27, s21, 3
    s_add_u32 s25, s25, s27
    s_add_u32 s25, s25, s26
    s_lshl_b32 s79, s25, 11
    s_add_u32 s79, s79, 4194304
    s_cmp_eq_u32 s23, 0
    s_cselect_b32 s26, s64, s26
    s_lshl_b32 s26, s26, 11
    s_add_u32 s26, s26, 8192
    v_add_u32 v12, s26, v3
    v_xor_b32 v13, 0x800, v12
    s_lshl_b32 s25, s29, 14
    s_add_u32 s25, s25, 98304
    s_lshl_b32 s26, s64, 12
    s_add_u32 s26, s26, 65536
    s_cmp_eq_u32 s23, 0
    s_cselect_b32 s25, s26, s25
    v_add_u32 v8, s25, v16
    v_add_u32 v10, s25, v3
    v_bfe_u32 v24, v2, 4, 1
    v_lshrrev_b32 v25, 5, v2
    v_and_b32 v18, 15, v2
    v_lshlrev_b32 v18, 4, v18
    v_lshl_add_u32 v18, v24, 10, v18
    v_lshl_add_u32 v18, v25, 8, v18
    v_and_b32 v24, 31, v2
    v_lshlrev_b32 v25, 4, v25
    v_sub_u32 v24, v24, v25
    v_cvt_f32_i32 v24, v24
    v_mul_f32 v24, 1904214016, v24
    v_add_f32 v32, 1895825408, v24
    v_add_f32 v33, 4043309056, v24
    v_add_f32 v34, 4055891968, v24
    v_add_f32 v35, 4062183424, v24
    v_add_f32 v36, 4066377728, v24
    v_add_f32 v37, 4069523456, v24
    v_add_f32 v38, 4071620608, v24
    v_add_f32 v39, 4073717760, v24
    v_mfma_f32_16x16x32_bf16 v[80:83], v[192:195], v[176:179], v[80:83]
    ds_read_b128 v[216:219], v64 offset:8192
    s_add_u32 m0, s50, 0
    s_mov_b32 s53, 790528
    v_mfma_f32_16x16x32_bf16 v[96:99], v[192:195], v[180:183], v[96:99]
    ds_read_b64_tr_b16 v[232:233], v66 offset:24576
    v_mfma_f32_16x16x32_bf16 v[100:103], v[196:199], v[180:183], v[100:103]
    ds_read_b64_tr_b16 v[234:235], v66 offset:25088
    buffer_load_dwordx4 v76, s[12:15], s53 offen lds
    v_mfma_f32_16x16x32_bf16 v[84:87], v[196:199], v[176:179], v[84:87]
    ds_read_b64_tr_b16 v[236:237], v67 offset:24576
    v_mfma_f32_16x16x32_bf16 v[88:91], v[200:203], v[176:179], v[88:91]
    ds_read_b64_tr_b16 v[238:239], v67 offset:25088
    s_add_u32 m0, s51, 0
    v_mfma_f32_16x16x32_bf16 v[104:107], v[200:203], v[180:183], v[104:107]
    ds_read_b64_tr_b16 v[240:241], v66 offset:32768
    v_mfma_f32_16x16x32_bf16 v[108:111], v[204:207], v[180:183], v[108:111]
    ds_read_b64_tr_b16 v[242:243], v66 offset:33280
    buffer_load_dwordx4 v77, s[12:15], s53 offen lds
    v_mfma_f32_16x16x32_bf16 v[92:95], v[204:207], v[176:179], v[92:95]
    ds_read_b64_tr_b16 v[244:245], v67 offset:32768
    v_mfma_f32_16x16x32_bf16 v[144:147], v[176:179], v[208:211], v[144:147]
    ds_read_b64_tr_b16 v[246:247], v67 offset:33280
    s_add_u32 m0, s46, 0
    s_movk_i32 s52, 384
    v_mfma_f32_16x16x32_bf16 v[148:151], v[180:183], v[208:211], v[148:151]
    ds_read_b64_tr_b16 v[248:249], v66 offset:40960
    v_mfma_f32_16x16x32_bf16 v[156:159], v[180:183], v[212:215], v[156:159]
    ds_read_b64_tr_b16 v[250:251], v66 offset:41472
    buffer_load_dwordx4 v68, s[8:11], s52 offen lds
    v_mfma_f32_16x16x32_bf16 v[152:155], v[176:179], v[212:215], v[152:155]
    ds_read_b64_tr_b16 v[252:253], v67 offset:40960
    v_mfma_f32_16x16x32_bf16 v[160:163], v[184:187], v[208:211], v[160:163]
    ds_read_b64_tr_b16 v[254:255], v67 offset:41472
    buffer_load_dwordx4 v69, s[8:11], s52 offen offset:1024 lds
    v_mfma_f32_16x16x32_bf16 v[164:167], v[188:191], v[208:211], v[164:167]
    ds_read_b128 v[220:223], v64 offset:10240
    v_mfma_f32_16x16x32_bf16 v[172:175], v[188:191], v[212:215], v[172:175]
    ds_read_b128 v[224:227], v64 offset:12288
    s_add_u32 m0, s50, 8192
    s_mov_b32 s53, 1179648
    v_mfma_f32_16x16x32_bf16 v[168:171], v[184:187], v[212:215], v[168:171]
    ds_read_b128 v[228:231], v64 offset:14336
    v_mfma_f32_16x16x32_bf16 v[120:123], v[200:203], v[184:187], v[120:123]
    buffer_load_dwordx4 v76, s[12:15], s53 offen lds
    v_mfma_f32_16x16x32_bf16 v[136:139], v[200:203], v[188:191], v[136:139]
    v_mfma_f32_16x16x32_bf16 v[140:143], v[204:207], v[188:191], v[140:143]
    s_add_u32 m0, s50, 16384
    s_mov_b32 s53, 1181696
    v_mfma_f32_16x16x32_bf16 v[124:127], v[204:207], v[184:187], v[124:127]
    v_mfma_f32_16x16x32_bf16 v[112:115], v[192:195], v[184:187], v[112:115]
    buffer_load_dwordx4 v76, s[12:15], s53 offen lds
    v_mfma_f32_16x16x32_bf16 v[128:131], v[192:195], v[188:191], v[128:131]
    v_mfma_f32_16x16x32_bf16 v[132:135], v[196:199], v[188:191], v[132:135]
    s_add_u32 m0, s47, 0
    v_mfma_f32_16x16x32_bf16 v[116:119], v[196:199], v[184:187], v[116:119]
    s_waitcnt lgkmcnt(0)
    v_mfma_f32_16x16x32_bf16 v[80:83], v[232:235], v[216:219], v[80:83]
    ds_read_b128 v[176:179], v65 offset:8192
    buffer_load_dwordx4 v70, s[8:11], s52 offen lds
    v_mfma_f32_16x16x32_bf16 v[96:99], v[232:235], v[220:223], v[96:99]
    ds_read_b64_tr_b16 v[192:193], v66 offset:28672
    v_mfma_f32_16x16x32_bf16 v[100:103], v[236:239], v[220:223], v[100:103]
    ds_read_b64_tr_b16 v[194:195], v66 offset:29184
    buffer_load_dwordx4 v71, s[8:11], s52 offen offset:1024 lds
    v_mfma_f32_16x16x32_bf16 v[84:87], v[236:239], v[216:219], v[84:87]
    ds_read_b64_tr_b16 v[196:197], v67 offset:28672
    v_mfma_f32_16x16x32_bf16 v[88:91], v[240:243], v[216:219], v[88:91]
    ds_read_b64_tr_b16 v[198:199], v67 offset:29184
    s_add_u32 m0, s51, 8192
    s_mov_b32 s53, 1179648
    v_mfma_f32_16x16x32_bf16 v[104:107], v[240:243], v[220:223], v[104:107]
    ds_read_b64_tr_b16 v[200:201], v66 offset:36864
    v_mfma_f32_16x16x32_bf16 v[108:111], v[244:247], v[220:223], v[108:111]
    ds_read_b64_tr_b16 v[202:203], v66 offset:37376
    buffer_load_dwordx4 v77, s[12:15], s53 offen lds
    v_mfma_f32_16x16x32_bf16 v[92:95], v[244:247], v[216:219], v[92:95]
    ds_read_b64_tr_b16 v[204:205], v67 offset:36864
    v_mfma_f32_16x16x32_bf16 v[144:147], v[216:219], v[248:251], v[144:147]
    ds_read_b64_tr_b16 v[206:207], v67 offset:37376
    s_add_u32 m0, s51, 16384
    s_mov_b32 s53, 1181696
    v_mfma_f32_16x16x32_bf16 v[148:151], v[220:223], v[248:251], v[148:151]
    ds_read_b64_tr_b16 v[208:209], v66 offset:45056
    v_mfma_f32_16x16x32_bf16 v[156:159], v[220:223], v[252:255], v[156:159]
    ds_read_b64_tr_b16 v[210:211], v66 offset:45568
    buffer_load_dwordx4 v77, s[12:15], s53 offen lds
    v_mfma_f32_16x16x32_bf16 v[152:155], v[216:219], v[252:255], v[152:155]
    ds_read_b64_tr_b16 v[212:213], v67 offset:45056
    v_mfma_f32_16x16x32_bf16 v[160:163], v[224:227], v[248:251], v[160:163]
    ds_read_b64_tr_b16 v[214:215], v67 offset:45568
    s_add_u32 m0, s48, 0
    v_mfma_f32_16x16x32_bf16 v[164:167], v[228:231], v[248:251], v[164:167]
    ds_read_b128 v[180:183], v65 offset:10240
    v_mfma_f32_16x16x32_bf16 v[172:175], v[228:231], v[252:255], v[172:175]
    ds_read_b128 v[184:187], v65 offset:12288
    buffer_load_dwordx4 v72, s[8:11], s52 offen lds
    v_mfma_f32_16x16x32_bf16 v[168:171], v[224:227], v[252:255], v[168:171]
    ds_read_b128 v[188:191], v65 offset:14336
    v_mfma_f32_16x16x32_bf16 v[120:123], v[240:243], v[224:227], v[120:123]
    buffer_load_dwordx4 v73, s[8:11], s52 offen offset:1024 lds
    v_mfma_f32_16x16x32_bf16 v[136:139], v[240:243], v[228:231], v[136:139]
    v_mfma_f32_16x16x32_bf16 v[140:143], v[244:247], v[228:231], v[140:143]
    s_add_u32 m0, s49, 0
    v_mfma_f32_16x16x32_bf16 v[124:127], v[244:247], v[224:227], v[124:127]
    v_mfma_f32_16x16x32_bf16 v[112:115], v[232:235], v[224:227], v[112:115]
    buffer_load_dwordx4 v74, s[8:11], s52 offen lds
    v_mfma_f32_16x16x32_bf16 v[128:131], v[232:235], v[228:231], v[128:131]
    v_mfma_f32_16x16x32_bf16 v[132:135], v[236:239], v[228:231], v[132:135]
    buffer_load_dwordx4 v75, s[8:11], s52 offen offset:1024 lds
    v_mfma_f32_16x16x32_bf16 v[116:119], v[236:239], v[224:227], v[116:119]
    s_waitcnt vmcnt(12) lgkmcnt(0)
    s_barrier
    v_add_f32 v40, 4075814912, v24
    v_add_f32 v41, 4077387776, v24
    v_add_f32 v42, 4078436352, v24
    v_add_f32 v43, 4079484928, v24
    v_add_f32 v44, 4080533504, v24
    v_add_f32 v45, 4081582080, v24
    v_add_f32 v46, 4082630656, v24
    v_add_f32 v47, 4083679232, v24
    v_min_f32 v48, 0, v32
    v_min_f32 v49, 0, v33
    v_min_f32 v50, 0, v34
    v_min_f32 v51, 0, v35
    v_min_f32 v52, 0, v36
    v_min_f32 v53, 0, v37
    v_min_f32 v54, 0, v38
    v_min_f32 v55, 0, v39
    v_min_f32 v56, 0, v40
    v_min_f32 v57, 0, v41
    v_min_f32 v58, 0, v42
    v_min_f32 v59, 0, v43
    v_min_f32 v60, 0, v44
    v_min_f32 v61, 0, v45
    v_min_f32 v62, 0, v46
    v_min_f32 v63, 0, v47
    s_lshl_b32 s25, s23, 6
    s_lshl_b32 s26, s22, 2
    s_add_u32 s25, s25, s26
    s_add_u32 s25, s25, s28
    s_lshl_b32 s69, s25, 16
    s_add_u32 s69, s69, 25165824
    s_lshl_b32 s70, s25, 12
    s_add_u32 s70, s70, 33816576
    v_lshrrev_b32 v24, 4, v2
    v_and_b32 v25, 15, v2
    v_lshlrev_b32 v26, 1, v24
    v_xor_b32 v25, v25, v26
    s_lshr_b32 s25, s28, 1
    s_lshl_b32 s25, s25, 6
    s_and_b32 s26, s28, 1
    s_lshl_b32 s26, s26, 4
    s_add_u32 s25, s25, s26
    v_add_u32 v24, s25, v24
    v_lshlrev_b32 v24, 11, v24
    v_lshl_add_u32 v19, v25, 4, v24
    s_lshl_b32 s25, s21, 8
    v_add_u32 v19, s25, v19
    v_xor_b32 v20, 128, v19
    v_add_u32 v20, 7168, v20
    s_and_b32 s26, s22, 7
    s_lshl_b32 s26, s26, 3
    s_add_u32 s26, s26, s20
    s_lshl_b32 s26, s26, 15
    s_add_u32 s25, s25, s26
    v_lshrrev_b32 v24, 2, v2
    v_and_b32 v25, 3, v2
    v_lshlrev_b32 v25, 6, v25
    v_lshl_add_u32 v24, v24, 11, v25
    v_add_u32 v21, s25, v24
    s_lshl_b32 s25, s29, 11
    s_add_u32 s81, s74, s25
    s_add_u32 s83, s69, s25
    s_lshl_b32 s82, s29, 14
    s_and_b32 s25, s28, 1
    s_lshl_b32 s25, s25, 13
    v_add_u32 v11, s25, v3
    v_bfe_u32 v22, v2, 2, 3
    v_lshrrev_b32 v23, 5, v2
    v_lshl_add_u32 v23, v23, 4, v22
    v_lshlrev_b32 v23, 8, v23
    v_and_b32 v24, 3, v2
    v_lshl_add_u32 v23, v24, 3, v23
    s_lshr_b32 s25, s28, 1
    s_lshl_b32 s25, s25, 2
    v_xor_b32 v22, s25, v22
    v_lshl_add_u32 v9, v22, 5, v23
    s_lshl_b32 s25, s63, 5
    s_add_u32 s25, s25, s67
    s_lshl_b32 s85, s25, 11
    s_add_u32 s85, s85, 25165824
    s_lshl_b32 s86, s25, 7
    s_add_u32 s86, s86, 33816576
    s_lshl_b32 s25, s21, 2
    s_add_u32 s25, s25, s28
    s_lshl_b32 s25, s25, 1
    s_add_u32 s25, s25, s29
    s_lshl_b32 s25, s25, 5
    s_add_u32 s25, s25, s67
    s_lshl_b32 s65, s25, 11
    s_add_u32 s65, s65, 29360128
    s_lshl_b32 s66, s25, 7
    s_add_u32 s66, s66, 34078720
    v_mov_b64 v[6:7], 0
    s_or_b32 s25, s24, 1
    s_lshl_b32 s25, s25, 3
    s_add_u32 s25, s25, s21
    s_lshl_b32 s25, s25, 2
    s_add_u32 s25, s25, s28
    s_lshl_b32 s96, s25, 9
    s_add_u32 s96, s96, 34603008
    s_lshl_b32 s25, s21, 2
    s_sub_u32 s25, s25, 4
    s_lshl_b32 s60, 3, s25
    s_lshr_b32 s26, s28, 1
    s_add_u32 s25, s25, s26
    s_lshl_b32 s25, 4, s25
    s_cmp_eq_u32 s23, 0
    s_cselect_b32 s62, s25, s62
    s_add_u32 s33, s45, 786432
    s_and_b32 s25, s21, 4
    s_lshl_b32 s25, s25, 2
    v_mfma_f32_16x16x32_bf16 v[80:83], v[192:195], v[176:179], v[80:83]
    ds_read_b128 v[216:219], v64 offset:16384
    s_add_u32 m0, s50, 24576
    s_mov_b32 s53, 1183744
    v_mfma_f32_16x16x32_bf16 v[96:99], v[192:195], v[180:183], v[96:99]
    ds_read_b64_tr_b16 v[232:233], v66 offset:49152
    v_mfma_f32_16x16x32_bf16 v[100:103], v[196:199], v[180:183], v[100:103]
    ds_read_b64_tr_b16 v[234:235], v66 offset:49664
    buffer_load_dwordx4 v76, s[12:15], s53 offen lds
    v_mfma_f32_16x16x32_bf16 v[84:87], v[196:199], v[176:179], v[84:87]
    ds_read_b64_tr_b16 v[236:237], v67 offset:49152
    v_mfma_f32_16x16x32_bf16 v[88:91], v[200:203], v[176:179], v[88:91]
    ds_read_b64_tr_b16 v[238:239], v67 offset:49664
    s_add_u32 m0, s51, 24576
    v_mfma_f32_16x16x32_bf16 v[104:107], v[200:203], v[180:183], v[104:107]
    ds_read_b64_tr_b16 v[240:241], v66 offset:57344
    v_mfma_f32_16x16x32_bf16 v[108:111], v[204:207], v[180:183], v[108:111]
    ds_read_b64_tr_b16 v[242:243], v66 offset:57856
    buffer_load_dwordx4 v77, s[12:15], s53 offen lds
    v_mfma_f32_16x16x32_bf16 v[92:95], v[204:207], v[176:179], v[92:95]
    ds_read_b64_tr_b16 v[244:245], v67 offset:57344
    v_mfma_f32_16x16x32_bf16 v[144:147], v[176:179], v[208:211], v[144:147]
    ds_read_b64_tr_b16 v[246:247], v67 offset:57856
    s_add_u32 m0, s46, 8192
    s_movk_i32 s52, 512
    v_mfma_f32_16x16x32_bf16 v[148:151], v[180:183], v[208:211], v[148:151]
    ds_read_b64_tr_b16 v[248:249], v66 offset:0
    v_mfma_f32_16x16x32_bf16 v[156:159], v[180:183], v[212:215], v[156:159]
    ds_read_b64_tr_b16 v[250:251], v66 offset:512
    buffer_load_dwordx4 v68, s[8:11], s52 offen lds
    v_mfma_f32_16x16x32_bf16 v[152:155], v[176:179], v[212:215], v[152:155]
    ds_read_b64_tr_b16 v[252:253], v67 offset:0
    v_mfma_f32_16x16x32_bf16 v[160:163], v[184:187], v[208:211], v[160:163]
    ds_read_b64_tr_b16 v[254:255], v67 offset:512
    buffer_load_dwordx4 v69, s[8:11], s52 offen offset:1024 lds
    v_mfma_f32_16x16x32_bf16 v[164:167], v[188:191], v[208:211], v[164:167]
    ds_read_b128 v[220:223], v64 offset:18432
    v_mfma_f32_16x16x32_bf16 v[172:175], v[188:191], v[212:215], v[172:175]
    ds_read_b128 v[224:227], v64 offset:20480
    s_add_u32 m0, s50, 32768
    s_mov_b32 s53, 1572864
    v_mfma_f32_16x16x32_bf16 v[168:171], v[184:187], v[212:215], v[168:171]
    ds_read_b128 v[228:231], v64 offset:22528
    v_mfma_f32_16x16x32_bf16 v[120:123], v[200:203], v[184:187], v[120:123]
    buffer_load_dwordx4 v76, s[12:15], s53 offen lds
    v_mfma_f32_16x16x32_bf16 v[136:139], v[200:203], v[188:191], v[136:139]
    v_mfma_f32_16x16x32_bf16 v[140:143], v[204:207], v[188:191], v[140:143]
    s_add_u32 m0, s50, 40960
    s_mov_b32 s53, 1574912
    v_mfma_f32_16x16x32_bf16 v[124:127], v[204:207], v[184:187], v[124:127]
    v_mfma_f32_16x16x32_bf16 v[112:115], v[192:195], v[184:187], v[112:115]
    buffer_load_dwordx4 v76, s[12:15], s53 offen lds
    v_mfma_f32_16x16x32_bf16 v[128:131], v[192:195], v[188:191], v[128:131]
    v_mfma_f32_16x16x32_bf16 v[132:135], v[196:199], v[188:191], v[132:135]
    s_add_u32 m0, s47, 8192
    v_mfma_f32_16x16x32_bf16 v[116:119], v[196:199], v[184:187], v[116:119]
    s_waitcnt lgkmcnt(0)
    v_mfma_f32_16x16x32_bf16 v[80:83], v[232:235], v[216:219], v[80:83]
    ds_read_b128 v[176:179], v65 offset:16384
    buffer_load_dwordx4 v70, s[8:11], s52 offen lds
    v_mfma_f32_16x16x32_bf16 v[96:99], v[232:235], v[220:223], v[96:99]
    ds_read_b64_tr_b16 v[192:193], v66 offset:53248
    v_mfma_f32_16x16x32_bf16 v[100:103], v[236:239], v[220:223], v[100:103]
    ds_read_b64_tr_b16 v[194:195], v66 offset:53760
    buffer_load_dwordx4 v71, s[8:11], s52 offen offset:1024 lds
    v_mfma_f32_16x16x32_bf16 v[84:87], v[236:239], v[216:219], v[84:87]
    ds_read_b64_tr_b16 v[196:197], v67 offset:53248
    v_mfma_f32_16x16x32_bf16 v[88:91], v[240:243], v[216:219], v[88:91]
    ds_read_b64_tr_b16 v[198:199], v67 offset:53760
    s_add_u32 m0, s51, 32768
    s_mov_b32 s53, 1572864
    v_mfma_f32_16x16x32_bf16 v[104:107], v[240:243], v[220:223], v[104:107]
    ds_read_b64_tr_b16 v[200:201], v66 offset:61440
    v_mfma_f32_16x16x32_bf16 v[108:111], v[244:247], v[220:223], v[108:111]
    ds_read_b64_tr_b16 v[202:203], v66 offset:61952
    buffer_load_dwordx4 v77, s[12:15], s53 offen lds
    v_mfma_f32_16x16x32_bf16 v[92:95], v[244:247], v[216:219], v[92:95]
    ds_read_b64_tr_b16 v[204:205], v67 offset:61440
    v_mfma_f32_16x16x32_bf16 v[144:147], v[216:219], v[248:251], v[144:147]
    ds_read_b64_tr_b16 v[206:207], v67 offset:61952
    s_add_u32 m0, s51, 40960
    s_mov_b32 s53, 1574912
    v_mfma_f32_16x16x32_bf16 v[148:151], v[220:223], v[248:251], v[148:151]
    ds_read_b64_tr_b16 v[208:209], v66 offset:4096
    v_mfma_f32_16x16x32_bf16 v[156:159], v[220:223], v[252:255], v[156:159]
    ds_read_b64_tr_b16 v[210:211], v66 offset:4608
    buffer_load_dwordx4 v77, s[12:15], s53 offen lds
    v_mfma_f32_16x16x32_bf16 v[152:155], v[216:219], v[252:255], v[152:155]
    ds_read_b64_tr_b16 v[212:213], v67 offset:4096
    v_mfma_f32_16x16x32_bf16 v[160:163], v[224:227], v[248:251], v[160:163]
    ds_read_b64_tr_b16 v[214:215], v67 offset:4608
    s_add_u32 m0, s48, 8192
    v_mfma_f32_16x16x32_bf16 v[164:167], v[228:231], v[248:251], v[164:167]
    ds_read_b128 v[180:183], v65 offset:18432
    v_mfma_f32_16x16x32_bf16 v[172:175], v[228:231], v[252:255], v[172:175]
    ds_read_b128 v[184:187], v65 offset:20480
    buffer_load_dwordx4 v72, s[8:11], s52 offen lds
    v_mfma_f32_16x16x32_bf16 v[168:171], v[224:227], v[252:255], v[168:171]
    ds_read_b128 v[188:191], v65 offset:22528
    v_mfma_f32_16x16x32_bf16 v[120:123], v[240:243], v[224:227], v[120:123]
    buffer_load_dwordx4 v73, s[8:11], s52 offen offset:1024 lds
    v_mfma_f32_16x16x32_bf16 v[136:139], v[240:243], v[228:231], v[136:139]
    v_mfma_f32_16x16x32_bf16 v[140:143], v[244:247], v[228:231], v[140:143]
    s_add_u32 m0, s49, 8192
    v_mfma_f32_16x16x32_bf16 v[124:127], v[244:247], v[224:227], v[124:127]
    v_mfma_f32_16x16x32_bf16 v[112:115], v[232:235], v[224:227], v[112:115]
    buffer_load_dwordx4 v74, s[8:11], s52 offen lds
    v_mfma_f32_16x16x32_bf16 v[128:131], v[232:235], v[228:231], v[128:131]
    v_mfma_f32_16x16x32_bf16 v[132:135], v[236:239], v[228:231], v[132:135]
    buffer_load_dwordx4 v75, s[8:11], s52 offen offset:1024 lds
    v_mfma_f32_16x16x32_bf16 v[116:119], v[236:239], v[224:227], v[116:119]
    s_waitcnt vmcnt(12) lgkmcnt(0)
    s_barrier
    s_lshl_b32 s94, 15, s25
    s_lshl_b32 s25, s21, 2
    s_add_u32 s25, s25, s28
    s_lshl_b32 s95, 1, s25
    s_and_b32 s25, s21, 3
    s_mul_i32 s26, s25, s23
    s_cmp_ge_u32 s26, 1
    s_cselect_b32 s27, 0, 4
    s_lshl_b32 s88, s94, s27
    s_cmp_ge_u32 s26, 2
    s_cselect_b32 s27, 4, 8
    s_lshl_b32 s89, s94, s27
    s_cmp_ge_u32 s26, 3
    s_cselect_b32 s27, 8, 12
    s_lshl_b32 s3, s94, s27
    s_lshl_b32 s26, s29, 2
    s_add_u32 s25, s25, s26
    s_lshl_b32 s25, s25, 1
    s_lshr_b32 s87, 63872, s25
    s_and_b32 s87, s87, 3
    s_lshl_b32 s84, s22, 1
    s_and_b32 s25, s28, 1
    s_add_u32 s84, s84, s25
    s_lshl_b32 s84, s84, 18
    s_lshl_b32 s25, s23, 11
    s_add_u32 s84, s84, s25
    s_lshl_b32 s25, s21, 8
    s_add_u32 s84, s84, s25
    s_lshr_b32 s25, s28, 1
    s_lshl_b32 s25, s25, 7
    s_add_u32 s84, s84, s25
    v_mov_b32 v26, 0
    v_mfma_f32_16x16x32_bf16 v[80:83], v[192:195], v[176:179], v[80:83]
    ds_read_b128 v[216:219], v64 offset:0
    s_add_u32 m0, s50, 49152
    s_mov_b32 s53, 1576960
    v_mfma_f32_16x16x32_bf16 v[96:99], v[192:195], v[180:183], v[96:99]
    ds_read_b64_tr_b16 v[232:233], v66 offset:8192
    v_mfma_f32_16x16x32_bf16 v[100:103], v[196:199], v[180:183], v[100:103]
    ds_read_b64_tr_b16 v[234:235], v66 offset:8704
    buffer_load_dwordx4 v76, s[12:15], s53 offen lds
    v_mfma_f32_16x16x32_bf16 v[84:87], v[196:199], v[176:179], v[84:87]
    ds_read_b64_tr_b16 v[236:237], v67 offset:8192
    v_mfma_f32_16x16x32_bf16 v[88:91], v[200:203], v[176:179], v[88:91]
    ds_read_b64_tr_b16 v[238:239], v67 offset:8704
    s_add_u32 m0, s51, 49152
    v_mfma_f32_16x16x32_bf16 v[104:107], v[200:203], v[180:183], v[104:107]
    ds_read_b64_tr_b16 v[240:241], v66 offset:16384
    v_mfma_f32_16x16x32_bf16 v[108:111], v[204:207], v[180:183], v[108:111]
    ds_read_b64_tr_b16 v[242:243], v66 offset:16896
    buffer_load_dwordx4 v77, s[12:15], s53 offen lds
    v_mfma_f32_16x16x32_bf16 v[92:95], v[204:207], v[176:179], v[92:95]
    ds_read_b64_tr_b16 v[244:245], v67 offset:16384
    v_mfma_f32_16x16x32_bf16 v[144:147], v[176:179], v[208:211], v[144:147]
    ds_read_b64_tr_b16 v[246:247], v67 offset:16896
    s_add_u32 m0, s46, 16384
    s_movk_i32 s52, 640
    v_mfma_f32_16x16x32_bf16 v[148:151], v[180:183], v[208:211], v[148:151]
    ds_read_b64_tr_b16 v[248:249], v66 offset:24576
    v_mfma_f32_16x16x32_bf16 v[156:159], v[180:183], v[212:215], v[156:159]
    ds_read_b64_tr_b16 v[250:251], v66 offset:25088
    buffer_load_dwordx4 v68, s[8:11], s52 offen lds
    v_mfma_f32_16x16x32_bf16 v[152:155], v[176:179], v[212:215], v[152:155]
    ds_read_b64_tr_b16 v[252:253], v67 offset:24576
    v_mfma_f32_16x16x32_bf16 v[160:163], v[184:187], v[208:211], v[160:163]
    ds_read_b64_tr_b16 v[254:255], v67 offset:25088
    buffer_load_dwordx4 v69, s[8:11], s52 offen offset:1024 lds
    v_mfma_f32_16x16x32_bf16 v[164:167], v[188:191], v[208:211], v[164:167]
    ds_read_b128 v[220:223], v64 offset:2048
    v_mfma_f32_16x16x32_bf16 v[172:175], v[188:191], v[212:215], v[172:175]
    ds_read_b128 v[224:227], v64 offset:4096
    s_add_u32 m0, s50, 57344
    s_mov_b32 s53, 1966080
    v_mfma_f32_16x16x32_bf16 v[168:171], v[184:187], v[212:215], v[168:171]
    ds_read_b128 v[228:231], v64 offset:6144
    v_mfma_f32_16x16x32_bf16 v[120:123], v[200:203], v[184:187], v[120:123]
    buffer_load_dwordx4 v76, s[12:15], s53 offen lds
    v_mfma_f32_16x16x32_bf16 v[136:139], v[200:203], v[188:191], v[136:139]
    v_mfma_f32_16x16x32_bf16 v[140:143], v[204:207], v[188:191], v[140:143]
    s_add_u32 m0, s50, 0
    s_mov_b32 s53, 1968128
    v_mfma_f32_16x16x32_bf16 v[124:127], v[204:207], v[184:187], v[124:127]
    v_mfma_f32_16x16x32_bf16 v[112:115], v[192:195], v[184:187], v[112:115]
    buffer_load_dwordx4 v76, s[12:15], s53 offen lds
    v_mfma_f32_16x16x32_bf16 v[128:131], v[192:195], v[188:191], v[128:131]
    v_mfma_f32_16x16x32_bf16 v[132:135], v[196:199], v[188:191], v[132:135]
    s_add_u32 m0, s47, 16384
    v_mfma_f32_16x16x32_bf16 v[116:119], v[196:199], v[184:187], v[116:119]
    s_waitcnt lgkmcnt(0)
    v_mfma_f32_16x16x32_bf16 v[80:83], v[232:235], v[216:219], v[80:83]
    ds_read_b128 v[176:179], v65 offset:0
    buffer_load_dwordx4 v70, s[8:11], s52 offen lds
    v_mfma_f32_16x16x32_bf16 v[96:99], v[232:235], v[220:223], v[96:99]
    ds_read_b64_tr_b16 v[192:193], v66 offset:12288
    v_mfma_f32_16x16x32_bf16 v[100:103], v[236:239], v[220:223], v[100:103]
    ds_read_b64_tr_b16 v[194:195], v66 offset:12800
    buffer_load_dwordx4 v71, s[8:11], s52 offen offset:1024 lds
    v_mfma_f32_16x16x32_bf16 v[84:87], v[236:239], v[216:219], v[84:87]
    ds_read_b64_tr_b16 v[196:197], v67 offset:12288
    v_mfma_f32_16x16x32_bf16 v[88:91], v[240:243], v[216:219], v[88:91]
    ds_read_b64_tr_b16 v[198:199], v67 offset:12800
    s_add_u32 m0, s51, 57344
    s_mov_b32 s53, 1966080
    v_mfma_f32_16x16x32_bf16 v[104:107], v[240:243], v[220:223], v[104:107]
    ds_read_b64_tr_b16 v[200:201], v66 offset:20480
    v_mfma_f32_16x16x32_bf16 v[108:111], v[244:247], v[220:223], v[108:111]
    ds_read_b64_tr_b16 v[202:203], v66 offset:20992
    buffer_load_dwordx4 v77, s[12:15], s53 offen lds
    v_mfma_f32_16x16x32_bf16 v[92:95], v[244:247], v[216:219], v[92:95]
    ds_read_b64_tr_b16 v[204:205], v67 offset:20480
    v_mfma_f32_16x16x32_bf16 v[144:147], v[216:219], v[248:251], v[144:147]
    ds_read_b64_tr_b16 v[206:207], v67 offset:20992
    s_add_u32 m0, s51, 0
    s_mov_b32 s53, 1968128
    v_mfma_f32_16x16x32_bf16 v[148:151], v[220:223], v[248:251], v[148:151]
    ds_read_b64_tr_b16 v[208:209], v66 offset:28672
    v_mfma_f32_16x16x32_bf16 v[156:159], v[220:223], v[252:255], v[156:159]
    ds_read_b64_tr_b16 v[210:211], v66 offset:29184
    buffer_load_dwordx4 v77, s[12:15], s53 offen lds
    v_mfma_f32_16x16x32_bf16 v[152:155], v[216:219], v[252:255], v[152:155]
    ds_read_b64_tr_b16 v[212:213], v67 offset:28672
    v_mfma_f32_16x16x32_bf16 v[160:163], v[224:227], v[248:251], v[160:163]
    ds_read_b64_tr_b16 v[214:215], v67 offset:29184
    s_add_u32 m0, s48, 16384
    v_mfma_f32_16x16x32_bf16 v[164:167], v[228:231], v[248:251], v[164:167]
    ds_read_b128 v[180:183], v65 offset:2048
    v_mfma_f32_16x16x32_bf16 v[172:175], v[228:231], v[252:255], v[172:175]
    ds_read_b128 v[184:187], v65 offset:4096
    buffer_load_dwordx4 v72, s[8:11], s52 offen lds
    v_mfma_f32_16x16x32_bf16 v[168:171], v[224:227], v[252:255], v[168:171]
    ds_read_b128 v[188:191], v65 offset:6144
    v_mfma_f32_16x16x32_bf16 v[120:123], v[240:243], v[224:227], v[120:123]
    buffer_load_dwordx4 v73, s[8:11], s52 offen offset:1024 lds
    v_mfma_f32_16x16x32_bf16 v[136:139], v[240:243], v[228:231], v[136:139]
    v_mfma_f32_16x16x32_bf16 v[140:143], v[244:247], v[228:231], v[140:143]
    s_add_u32 m0, s49, 16384
    v_mfma_f32_16x16x32_bf16 v[124:127], v[244:247], v[224:227], v[124:127]
    v_mfma_f32_16x16x32_bf16 v[112:115], v[232:235], v[224:227], v[112:115]
    buffer_load_dwordx4 v74, s[8:11], s52 offen lds
    v_mfma_f32_16x16x32_bf16 v[128:131], v[232:235], v[228:231], v[128:131]
    v_mfma_f32_16x16x32_bf16 v[132:135], v[236:239], v[228:231], v[132:135]
    buffer_load_dwordx4 v75, s[8:11], s52 offen offset:1024 lds
    v_mfma_f32_16x16x32_bf16 v[116:119], v[236:239], v[224:227], v[116:119]
    s_waitcnt vmcnt(12) lgkmcnt(0)
    s_barrier
    v_mfma_f32_16x16x32_bf16 v[80:83], v[192:195], v[176:179], v[80:83]
    ds_read_b128 v[216:219], v64 offset:8192
    s_add_u32 m0, s50, 8192
    s_mov_b32 s53, 1970176
    v_mfma_f32_16x16x32_bf16 v[96:99], v[192:195], v[180:183], v[96:99]
    ds_read_b64_tr_b16 v[232:233], v66 offset:32768
    v_mfma_f32_16x16x32_bf16 v[100:103], v[196:199], v[180:183], v[100:103]
    ds_read_b64_tr_b16 v[234:235], v66 offset:33280
    buffer_load_dwordx4 v76, s[12:15], s53 offen lds
    v_mfma_f32_16x16x32_bf16 v[84:87], v[196:199], v[176:179], v[84:87]
    ds_read_b64_tr_b16 v[236:237], v67 offset:32768
    v_mfma_f32_16x16x32_bf16 v[88:91], v[200:203], v[176:179], v[88:91]
    ds_read_b64_tr_b16 v[238:239], v67 offset:33280
    s_add_u32 m0, s51, 8192
    v_mfma_f32_16x16x32_bf16 v[104:107], v[200:203], v[180:183], v[104:107]
    ds_read_b64_tr_b16 v[240:241], v66 offset:40960
    v_mfma_f32_16x16x32_bf16 v[108:111], v[204:207], v[180:183], v[108:111]
    ds_read_b64_tr_b16 v[242:243], v66 offset:41472
    buffer_load_dwordx4 v77, s[12:15], s53 offen lds
    v_mfma_f32_16x16x32_bf16 v[92:95], v[204:207], v[176:179], v[92:95]
    ds_read_b64_tr_b16 v[244:245], v67 offset:40960
    v_mfma_f32_16x16x32_bf16 v[144:147], v[176:179], v[208:211], v[144:147]
    ds_read_b64_tr_b16 v[246:247], v67 offset:41472
    s_add_u32 m0, s46, 0
    s_movk_i32 s52, 768
    v_mfma_f32_16x16x32_bf16 v[148:151], v[180:183], v[208:211], v[148:151]
    ds_read_b64_tr_b16 v[248:249], v66 offset:49152
    v_mfma_f32_16x16x32_bf16 v[156:159], v[180:183], v[212:215], v[156:159]
    ds_read_b64_tr_b16 v[250:251], v66 offset:49664
    buffer_load_dwordx4 v68, s[8:11], s52 offen lds
    v_mfma_f32_16x16x32_bf16 v[152:155], v[176:179], v[212:215], v[152:155]
    ds_read_b64_tr_b16 v[252:253], v67 offset:49152
    v_mfma_f32_16x16x32_bf16 v[160:163], v[184:187], v[208:211], v[160:163]
    ds_read_b64_tr_b16 v[254:255], v67 offset:49664
    buffer_load_dwordx4 v69, s[8:11], s52 offen offset:1024 lds
    v_mfma_f32_16x16x32_bf16 v[164:167], v[188:191], v[208:211], v[164:167]
    ds_read_b128 v[220:223], v64 offset:10240
    v_mfma_f32_16x16x32_bf16 v[172:175], v[188:191], v[212:215], v[172:175]
    ds_read_b128 v[224:227], v64 offset:12288
    s_add_u32 m0, s50, 16384
    s_mov_b32 s53, 2359296
    v_mfma_f32_16x16x32_bf16 v[168:171], v[184:187], v[212:215], v[168:171]
    ds_read_b128 v[228:231], v64 offset:14336
    v_mfma_f32_16x16x32_bf16 v[120:123], v[200:203], v[184:187], v[120:123]
    buffer_load_dwordx4 v76, s[12:15], s53 offen lds
    v_mfma_f32_16x16x32_bf16 v[136:139], v[200:203], v[188:191], v[136:139]
    v_mfma_f32_16x16x32_bf16 v[140:143], v[204:207], v[188:191], v[140:143]
    s_add_u32 m0, s50, 24576
    s_mov_b32 s53, 2361344
    v_mfma_f32_16x16x32_bf16 v[124:127], v[204:207], v[184:187], v[124:127]
    v_mfma_f32_16x16x32_bf16 v[112:115], v[192:195], v[184:187], v[112:115]
    buffer_load_dwordx4 v76, s[12:15], s53 offen lds
    v_mfma_f32_16x16x32_bf16 v[128:131], v[192:195], v[188:191], v[128:131]
    v_mfma_f32_16x16x32_bf16 v[132:135], v[196:199], v[188:191], v[132:135]
    s_add_u32 m0, s47, 0
    v_mfma_f32_16x16x32_bf16 v[116:119], v[196:199], v[184:187], v[116:119]
    s_waitcnt lgkmcnt(0)
    v_mfma_f32_16x16x32_bf16 v[80:83], v[232:235], v[216:219], v[80:83]
    ds_read_b128 v[176:179], v65 offset:8192
    buffer_load_dwordx4 v70, s[8:11], s52 offen lds
    v_mfma_f32_16x16x32_bf16 v[96:99], v[232:235], v[220:223], v[96:99]
    ds_read_b64_tr_b16 v[192:193], v66 offset:36864
    v_mfma_f32_16x16x32_bf16 v[100:103], v[236:239], v[220:223], v[100:103]
    ds_read_b64_tr_b16 v[194:195], v66 offset:37376
    buffer_load_dwordx4 v71, s[8:11], s52 offen offset:1024 lds
    v_mfma_f32_16x16x32_bf16 v[84:87], v[236:239], v[216:219], v[84:87]
    ds_read_b64_tr_b16 v[196:197], v67 offset:36864
    v_mfma_f32_16x16x32_bf16 v[88:91], v[240:243], v[216:219], v[88:91]
    ds_read_b64_tr_b16 v[198:199], v67 offset:37376
    s_add_u32 m0, s51, 16384
    s_mov_b32 s53, 2359296
    v_mfma_f32_16x16x32_bf16 v[104:107], v[240:243], v[220:223], v[104:107]
    ds_read_b64_tr_b16 v[200:201], v66 offset:45056
    v_mfma_f32_16x16x32_bf16 v[108:111], v[244:247], v[220:223], v[108:111]
    ds_read_b64_tr_b16 v[202:203], v66 offset:45568
    buffer_load_dwordx4 v77, s[12:15], s53 offen lds
    v_mfma_f32_16x16x32_bf16 v[92:95], v[244:247], v[216:219], v[92:95]
    ds_read_b64_tr_b16 v[204:205], v67 offset:45056
    v_mfma_f32_16x16x32_bf16 v[144:147], v[216:219], v[248:251], v[144:147]
    ds_read_b64_tr_b16 v[206:207], v67 offset:45568
    s_add_u32 m0, s51, 24576
    s_mov_b32 s53, 2361344
    v_mfma_f32_16x16x32_bf16 v[148:151], v[220:223], v[248:251], v[148:151]
    ds_read_b64_tr_b16 v[208:209], v66 offset:53248
    v_mfma_f32_16x16x32_bf16 v[156:159], v[220:223], v[252:255], v[156:159]
    ds_read_b64_tr_b16 v[210:211], v66 offset:53760
    buffer_load_dwordx4 v77, s[12:15], s53 offen lds
    v_mfma_f32_16x16x32_bf16 v[152:155], v[216:219], v[252:255], v[152:155]
    ds_read_b64_tr_b16 v[212:213], v67 offset:53248
    v_mfma_f32_16x16x32_bf16 v[160:163], v[224:227], v[248:251], v[160:163]
    ds_read_b64_tr_b16 v[214:215], v67 offset:53760
    s_add_u32 m0, s48, 0
    v_mfma_f32_16x16x32_bf16 v[164:167], v[228:231], v[248:251], v[164:167]
    ds_read_b128 v[180:183], v65 offset:10240
    v_mfma_f32_16x16x32_bf16 v[172:175], v[228:231], v[252:255], v[172:175]
    ds_read_b128 v[184:187], v65 offset:12288
    buffer_load_dwordx4 v72, s[8:11], s52 offen lds
    v_mfma_f32_16x16x32_bf16 v[168:171], v[224:227], v[252:255], v[168:171]
    ds_read_b128 v[188:191], v65 offset:14336
    v_mfma_f32_16x16x32_bf16 v[120:123], v[240:243], v[224:227], v[120:123]
    buffer_load_dwordx4 v73, s[8:11], s52 offen offset:1024 lds
    v_mfma_f32_16x16x32_bf16 v[136:139], v[240:243], v[228:231], v[136:139]
    v_mfma_f32_16x16x32_bf16 v[140:143], v[244:247], v[228:231], v[140:143]
    s_add_u32 m0, s49, 0
    v_mfma_f32_16x16x32_bf16 v[124:127], v[244:247], v[224:227], v[124:127]
    v_mfma_f32_16x16x32_bf16 v[112:115], v[232:235], v[224:227], v[112:115]
    buffer_load_dwordx4 v74, s[8:11], s52 offen lds
    v_mfma_f32_16x16x32_bf16 v[128:131], v[232:235], v[228:231], v[128:131]
    v_mfma_f32_16x16x32_bf16 v[132:135], v[236:239], v[228:231], v[132:135]
    buffer_load_dwordx4 v75, s[8:11], s52 offen offset:1024 lds
    v_mfma_f32_16x16x32_bf16 v[116:119], v[236:239], v[224:227], v[116:119]
    s_waitcnt vmcnt(12) lgkmcnt(0)
    s_barrier
    v_mfma_f32_16x16x32_bf16 v[80:83], v[192:195], v[176:179], v[80:83]
    ds_read_b128 v[216:219], v64 offset:16384
    s_add_u32 m0, s50, 32768
    s_mov_b32 s53, 2363392
    v_mfma_f32_16x16x32_bf16 v[96:99], v[192:195], v[180:183], v[96:99]
    ds_read_b64_tr_b16 v[232:233], v66 offset:57344
    v_mfma_f32_16x16x32_bf16 v[100:103], v[196:199], v[180:183], v[100:103]
    ds_read_b64_tr_b16 v[234:235], v66 offset:57856
    buffer_load_dwordx4 v76, s[12:15], s53 offen lds
    v_mfma_f32_16x16x32_bf16 v[84:87], v[196:199], v[176:179], v[84:87]
    ds_read_b64_tr_b16 v[236:237], v67 offset:57344
    v_mfma_f32_16x16x32_bf16 v[88:91], v[200:203], v[176:179], v[88:91]
    ds_read_b64_tr_b16 v[238:239], v67 offset:57856
    s_add_u32 m0, s51, 32768
    v_mfma_f32_16x16x32_bf16 v[104:107], v[200:203], v[180:183], v[104:107]
    ds_read_b64_tr_b16 v[240:241], v66 offset:0
    v_mfma_f32_16x16x32_bf16 v[108:111], v[204:207], v[180:183], v[108:111]
    ds_read_b64_tr_b16 v[242:243], v66 offset:512
    buffer_load_dwordx4 v77, s[12:15], s53 offen lds
    v_mfma_f32_16x16x32_bf16 v[92:95], v[204:207], v[176:179], v[92:95]
    ds_read_b64_tr_b16 v[244:245], v67 offset:0
    v_mfma_f32_16x16x32_bf16 v[144:147], v[176:179], v[208:211], v[144:147]
    ds_read_b64_tr_b16 v[246:247], v67 offset:512
    s_add_u32 m0, s46, 8192
    s_movk_i32 s52, 896
    v_mfma_f32_16x16x32_bf16 v[148:151], v[180:183], v[208:211], v[148:151]
    ds_read_b64_tr_b16 v[248:249], v66 offset:8192
    v_mfma_f32_16x16x32_bf16 v[156:159], v[180:183], v[212:215], v[156:159]
    ds_read_b64_tr_b16 v[250:251], v66 offset:8704
    buffer_load_dwordx4 v68, s[8:11], s52 offen lds
    v_mfma_f32_16x16x32_bf16 v[152:155], v[176:179], v[212:215], v[152:155]
    ds_read_b64_tr_b16 v[252:253], v67 offset:8192
    v_mfma_f32_16x16x32_bf16 v[160:163], v[184:187], v[208:211], v[160:163]
    ds_read_b64_tr_b16 v[254:255], v67 offset:8704
    buffer_load_dwordx4 v69, s[8:11], s52 offen offset:1024 lds
    v_mfma_f32_16x16x32_bf16 v[164:167], v[188:191], v[208:211], v[164:167]
    ds_read_b128 v[220:223], v64 offset:18432
    v_mfma_f32_16x16x32_bf16 v[172:175], v[188:191], v[212:215], v[172:175]
    ds_read_b128 v[224:227], v64 offset:20480
    s_add_u32 m0, s50, 40960
    s_mov_b32 s53, 2752512
    v_mfma_f32_16x16x32_bf16 v[168:171], v[184:187], v[212:215], v[168:171]
    ds_read_b128 v[228:231], v64 offset:22528
    v_mfma_f32_16x16x32_bf16 v[120:123], v[200:203], v[184:187], v[120:123]
    buffer_load_dwordx4 v76, s[12:15], s53 offen lds
    v_mfma_f32_16x16x32_bf16 v[136:139], v[200:203], v[188:191], v[136:139]
    v_mfma_f32_16x16x32_bf16 v[140:143], v[204:207], v[188:191], v[140:143]
    s_add_u32 m0, s50, 49152
    s_mov_b32 s53, 2754560
    v_mfma_f32_16x16x32_bf16 v[124:127], v[204:207], v[184:187], v[124:127]
    v_mfma_f32_16x16x32_bf16 v[112:115], v[192:195], v[184:187], v[112:115]
    buffer_load_dwordx4 v76, s[12:15], s53 offen lds
    v_mfma_f32_16x16x32_bf16 v[128:131], v[192:195], v[188:191], v[128:131]
    v_mfma_f32_16x16x32_bf16 v[132:135], v[196:199], v[188:191], v[132:135]
    s_add_u32 m0, s47, 8192
    v_mfma_f32_16x16x32_bf16 v[116:119], v[196:199], v[184:187], v[116:119]
    s_waitcnt lgkmcnt(0)
    v_mfma_f32_16x16x32_bf16 v[80:83], v[232:235], v[216:219], v[80:83]
    ds_read_b128 v[176:179], v65 offset:16384
    buffer_load_dwordx4 v70, s[8:11], s52 offen lds
    v_mfma_f32_16x16x32_bf16 v[96:99], v[232:235], v[220:223], v[96:99]
    ds_read_b64_tr_b16 v[192:193], v66 offset:61440
    v_mfma_f32_16x16x32_bf16 v[100:103], v[236:239], v[220:223], v[100:103]
    ds_read_b64_tr_b16 v[194:195], v66 offset:61952
    buffer_load_dwordx4 v71, s[8:11], s52 offen offset:1024 lds
    v_mfma_f32_16x16x32_bf16 v[84:87], v[236:239], v[216:219], v[84:87]
    ds_read_b64_tr_b16 v[196:197], v67 offset:61440
    v_mfma_f32_16x16x32_bf16 v[88:91], v[240:243], v[216:219], v[88:91]
    ds_read_b64_tr_b16 v[198:199], v67 offset:61952
    s_add_u32 m0, s51, 40960
    s_mov_b32 s53, 2752512
    v_mfma_f32_16x16x32_bf16 v[104:107], v[240:243], v[220:223], v[104:107]
    ds_read_b64_tr_b16 v[200:201], v66 offset:4096
    v_mfma_f32_16x16x32_bf16 v[108:111], v[244:247], v[220:223], v[108:111]
    ds_read_b64_tr_b16 v[202:203], v66 offset:4608
    buffer_load_dwordx4 v77, s[12:15], s53 offen lds
    v_mfma_f32_16x16x32_bf16 v[92:95], v[244:247], v[216:219], v[92:95]
    ds_read_b64_tr_b16 v[204:205], v67 offset:4096
    v_mfma_f32_16x16x32_bf16 v[144:147], v[216:219], v[248:251], v[144:147]
    ds_read_b64_tr_b16 v[206:207], v67 offset:4608
    s_add_u32 m0, s51, 49152
    s_mov_b32 s53, 2754560
    v_mfma_f32_16x16x32_bf16 v[148:151], v[220:223], v[248:251], v[148:151]
    ds_read_b64_tr_b16 v[208:209], v66 offset:12288
    v_mfma_f32_16x16x32_bf16 v[156:159], v[220:223], v[252:255], v[156:159]
    ds_read_b64_tr_b16 v[210:211], v66 offset:12800
    buffer_load_dwordx4 v77, s[12:15], s53 offen lds
    v_mfma_f32_16x16x32_bf16 v[152:155], v[216:219], v[252:255], v[152:155]
    ds_read_b64_tr_b16 v[212:213], v67 offset:12288
    v_mfma_f32_16x16x32_bf16 v[160:163], v[224:227], v[248:251], v[160:163]
    ds_read_b64_tr_b16 v[214:215], v67 offset:12800
    s_add_u32 m0, s48, 8192
    v_mfma_f32_16x16x32_bf16 v[164:167], v[228:231], v[248:251], v[164:167]
    ds_read_b128 v[180:183], v65 offset:18432
    v_mfma_f32_16x16x32_bf16 v[172:175], v[228:231], v[252:255], v[172:175]
    ds_read_b128 v[184:187], v65 offset:20480
    buffer_load_dwordx4 v72, s[8:11], s52 offen lds
    v_mfma_f32_16x16x32_bf16 v[168:171], v[224:227], v[252:255], v[168:171]
    ds_read_b128 v[188:191], v65 offset:22528
    v_mfma_f32_16x16x32_bf16 v[120:123], v[240:243], v[224:227], v[120:123]
    buffer_load_dwordx4 v73, s[8:11], s52 offen offset:1024 lds
    v_mfma_f32_16x16x32_bf16 v[136:139], v[240:243], v[228:231], v[136:139]
    v_mfma_f32_16x16x32_bf16 v[140:143], v[244:247], v[228:231], v[140:143]
    s_add_u32 m0, s49, 8192
    v_mfma_f32_16x16x32_bf16 v[124:127], v[244:247], v[224:227], v[124:127]
    v_mfma_f32_16x16x32_bf16 v[112:115], v[232:235], v[224:227], v[112:115]
    buffer_load_dwordx4 v74, s[8:11], s52 offen lds
    v_mfma_f32_16x16x32_bf16 v[128:131], v[232:235], v[228:231], v[128:131]
    v_mfma_f32_16x16x32_bf16 v[132:135], v[236:239], v[228:231], v[132:135]
    buffer_load_dwordx4 v75, s[8:11], s52 offen offset:1024 lds
    v_mfma_f32_16x16x32_bf16 v[116:119], v[236:239], v[224:227], v[116:119]
    s_waitcnt vmcnt(12) lgkmcnt(0)
    s_barrier
    v_mfma_f32_16x16x32_bf16 v[80:83], v[192:195], v[176:179], v[80:83]
    ds_read_b128 v[216:219], v64 offset:0
    s_add_u32 m0, s50, 57344
    s_mov_b32 s53, 2756608
    v_mfma_f32_16x16x32_bf16 v[96:99], v[192:195], v[180:183], v[96:99]
    ds_read_b64_tr_b16 v[232:233], v66 offset:16384
    v_mfma_f32_16x16x32_bf16 v[100:103], v[196:199], v[180:183], v[100:103]
    ds_read_b64_tr_b16 v[234:235], v66 offset:16896
    buffer_load_dwordx4 v76, s[12:15], s53 offen lds
    v_mfma_f32_16x16x32_bf16 v[84:87], v[196:199], v[176:179], v[84:87]
    ds_read_b64_tr_b16 v[236:237], v67 offset:16384
    v_mfma_f32_16x16x32_bf16 v[88:91], v[200:203], v[176:179], v[88:91]
    ds_read_b64_tr_b16 v[238:239], v67 offset:16896
    s_add_u32 m0, s51, 57344
    v_mfma_f32_16x16x32_bf16 v[104:107], v[200:203], v[180:183], v[104:107]
    ds_read_b64_tr_b16 v[240:241], v66 offset:24576
    v_mfma_f32_16x16x32_bf16 v[108:111], v[204:207], v[180:183], v[108:111]
    ds_read_b64_tr_b16 v[242:243], v66 offset:25088
    buffer_load_dwordx4 v77, s[12:15], s53 offen lds
    v_mfma_f32_16x16x32_bf16 v[92:95], v[204:207], v[176:179], v[92:95]
    ds_read_b64_tr_b16 v[244:245], v67 offset:24576
    v_mfma_f32_16x16x32_bf16 v[144:147], v[176:179], v[208:211], v[144:147]
    ds_read_b64_tr_b16 v[246:247], v67 offset:25088
    s_add_u32 m0, s46, 16384
    s_movk_i32 s52, 1024
    v_mfma_f32_16x16x32_bf16 v[148:151], v[180:183], v[208:211], v[148:151]
    ds_read_b64_tr_b16 v[248:249], v66 offset:32768
    v_mfma_f32_16x16x32_bf16 v[156:159], v[180:183], v[212:215], v[156:159]
    ds_read_b64_tr_b16 v[250:251], v66 offset:33280
    buffer_load_dwordx4 v68, s[8:11], s52 offen lds
    v_mfma_f32_16x16x32_bf16 v[152:155], v[176:179], v[212:215], v[152:155]
    ds_read_b64_tr_b16 v[252:253], v67 offset:32768
    v_mfma_f32_16x16x32_bf16 v[160:163], v[184:187], v[208:211], v[160:163]
    ds_read_b64_tr_b16 v[254:255], v67 offset:33280
    buffer_load_dwordx4 v69, s[8:11], s52 offen offset:1024 lds
    v_mfma_f32_16x16x32_bf16 v[164:167], v[188:191], v[208:211], v[164:167]
    ds_read_b128 v[220:223], v64 offset:2048
    v_mfma_f32_16x16x32_bf16 v[172:175], v[188:191], v[212:215], v[172:175]
    ds_read_b128 v[224:227], v64 offset:4096
    s_add_u32 m0, s50, 0
    s_mov_b32 s53, 3145728
    v_mfma_f32_16x16x32_bf16 v[168:171], v[184:187], v[212:215], v[168:171]
    ds_read_b128 v[228:231], v64 offset:6144
    v_mfma_f32_16x16x32_bf16 v[120:123], v[200:203], v[184:187], v[120:123]
    buffer_load_dwordx4 v76, s[12:15], s53 offen lds
    v_mfma_f32_16x16x32_bf16 v[136:139], v[200:203], v[188:191], v[136:139]
    v_mfma_f32_16x16x32_bf16 v[140:143], v[204:207], v[188:191], v[140:143]
    s_add_u32 m0, s50, 8192
    s_mov_b32 s53, 3147776
    v_mfma_f32_16x16x32_bf16 v[124:127], v[204:207], v[184:187], v[124:127]
    v_mfma_f32_16x16x32_bf16 v[112:115], v[192:195], v[184:187], v[112:115]
    buffer_load_dwordx4 v76, s[12:15], s53 offen lds
    v_mfma_f32_16x16x32_bf16 v[128:131], v[192:195], v[188:191], v[128:131]
    v_mfma_f32_16x16x32_bf16 v[132:135], v[196:199], v[188:191], v[132:135]
    s_add_u32 m0, s47, 16384
    v_mfma_f32_16x16x32_bf16 v[116:119], v[196:199], v[184:187], v[116:119]
    s_waitcnt lgkmcnt(0)
    v_mfma_f32_16x16x32_bf16 v[80:83], v[232:235], v[216:219], v[80:83]
    ds_read_b128 v[176:179], v65 offset:0
    buffer_load_dwordx4 v70, s[8:11], s52 offen lds
    v_mfma_f32_16x16x32_bf16 v[96:99], v[232:235], v[220:223], v[96:99]
    ds_read_b64_tr_b16 v[192:193], v66 offset:20480
    v_mfma_f32_16x16x32_bf16 v[100:103], v[236:239], v[220:223], v[100:103]
    ds_read_b64_tr_b16 v[194:195], v66 offset:20992
    buffer_load_dwordx4 v71, s[8:11], s52 offen offset:1024 lds
    v_mfma_f32_16x16x32_bf16 v[84:87], v[236:239], v[216:219], v[84:87]
    ds_read_b64_tr_b16 v[196:197], v67 offset:20480
    v_mfma_f32_16x16x32_bf16 v[88:91], v[240:243], v[216:219], v[88:91]
    ds_read_b64_tr_b16 v[198:199], v67 offset:20992
    s_add_u32 m0, s51, 0
    s_mov_b32 s53, 3145728
    v_mfma_f32_16x16x32_bf16 v[104:107], v[240:243], v[220:223], v[104:107]
    ds_read_b64_tr_b16 v[200:201], v66 offset:28672
    v_mfma_f32_16x16x32_bf16 v[108:111], v[244:247], v[220:223], v[108:111]
    ds_read_b64_tr_b16 v[202:203], v66 offset:29184
    buffer_load_dwordx4 v77, s[12:15], s53 offen lds
    v_mfma_f32_16x16x32_bf16 v[92:95], v[244:247], v[216:219], v[92:95]
    ds_read_b64_tr_b16 v[204:205], v67 offset:28672
    v_mfma_f32_16x16x32_bf16 v[144:147], v[216:219], v[248:251], v[144:147]
    ds_read_b64_tr_b16 v[206:207], v67 offset:29184
    s_add_u32 m0, s51, 8192
    s_mov_b32 s53, 3147776
    v_mfma_f32_16x16x32_bf16 v[148:151], v[220:223], v[248:251], v[148:151]
    ds_read_b64_tr_b16 v[208:209], v66 offset:36864
    v_mfma_f32_16x16x32_bf16 v[156:159], v[220:223], v[252:255], v[156:159]
    ds_read_b64_tr_b16 v[210:211], v66 offset:37376
    buffer_load_dwordx4 v77, s[12:15], s53 offen lds
    v_mfma_f32_16x16x32_bf16 v[152:155], v[216:219], v[252:255], v[152:155]
    ds_read_b64_tr_b16 v[212:213], v67 offset:36864
    v_mfma_f32_16x16x32_bf16 v[160:163], v[224:227], v[248:251], v[160:163]
    ds_read_b64_tr_b16 v[214:215], v67 offset:37376
    s_add_u32 m0, s48, 16384
    v_mfma_f32_16x16x32_bf16 v[164:167], v[228:231], v[248:251], v[164:167]
    ds_read_b128 v[180:183], v65 offset:2048
    v_mfma_f32_16x16x32_bf16 v[172:175], v[228:231], v[252:255], v[172:175]
    ds_read_b128 v[184:187], v65 offset:4096
    buffer_load_dwordx4 v72, s[8:11], s52 offen lds
    v_mfma_f32_16x16x32_bf16 v[168:171], v[224:227], v[252:255], v[168:171]
    ds_read_b128 v[188:191], v65 offset:6144
    v_mfma_f32_16x16x32_bf16 v[120:123], v[240:243], v[224:227], v[120:123]
    buffer_load_dwordx4 v73, s[8:11], s52 offen offset:1024 lds
    v_mfma_f32_16x16x32_bf16 v[136:139], v[240:243], v[228:231], v[136:139]
    v_mfma_f32_16x16x32_bf16 v[140:143], v[244:247], v[228:231], v[140:143]
    s_add_u32 m0, s49, 16384
    v_mfma_f32_16x16x32_bf16 v[124:127], v[244:247], v[224:227], v[124:127]
    v_mfma_f32_16x16x32_bf16 v[112:115], v[232:235], v[224:227], v[112:115]
    buffer_load_dwordx4 v74, s[8:11], s52 offen lds
    v_mfma_f32_16x16x32_bf16 v[128:131], v[232:235], v[228:231], v[128:131]
    v_mfma_f32_16x16x32_bf16 v[132:135], v[236:239], v[228:231], v[132:135]
    buffer_load_dwordx4 v75, s[8:11], s52 offen offset:1024 lds
    v_mfma_f32_16x16x32_bf16 v[116:119], v[236:239], v[224:227], v[116:119]
    s_waitcnt vmcnt(12) lgkmcnt(0)
    s_barrier
    v_mfma_f32_16x16x32_bf16 v[80:83], v[192:195], v[176:179], v[80:83]
    ds_read_b128 v[216:219], v64 offset:8192
    s_add_u32 m0, s50, 16384
    s_mov_b32 s53, 3149824
    v_mfma_f32_16x16x32_bf16 v[96:99], v[192:195], v[180:183], v[96:99]
    ds_read_b64_tr_b16 v[232:233], v66 offset:40960
    v_mfma_f32_16x16x32_bf16 v[100:103], v[196:199], v[180:183], v[100:103]
    ds_read_b64_tr_b16 v[234:235], v66 offset:41472
    buffer_load_dwordx4 v76, s[12:15], s53 offen lds
    v_mfma_f32_16x16x32_bf16 v[84:87], v[196:199], v[176:179], v[84:87]
    ds_read_b64_tr_b16 v[236:237], v67 offset:40960
    v_mfma_f32_16x16x32_bf16 v[88:91], v[200:203], v[176:179], v[88:91]
    ds_read_b64_tr_b16 v[238:239], v67 offset:41472
    s_add_u32 m0, s51, 16384
    v_mfma_f32_16x16x32_bf16 v[104:107], v[200:203], v[180:183], v[104:107]
    ds_read_b64_tr_b16 v[240:241], v66 offset:49152
    v_mfma_f32_16x16x32_bf16 v[108:111], v[204:207], v[180:183], v[108:111]
    ds_read_b64_tr_b16 v[242:243], v66 offset:49664
    buffer_load_dwordx4 v77, s[12:15], s53 offen lds
    v_mfma_f32_16x16x32_bf16 v[92:95], v[204:207], v[176:179], v[92:95]
    ds_read_b64_tr_b16 v[244:245], v67 offset:49152
    v_mfma_f32_16x16x32_bf16 v[144:147], v[176:179], v[208:211], v[144:147]
    ds_read_b64_tr_b16 v[246:247], v67 offset:49664
    s_add_u32 m0, s46, 0
    s_movk_i32 s52, 1152
    v_mfma_f32_16x16x32_bf16 v[148:151], v[180:183], v[208:211], v[148:151]
    ds_read_b64_tr_b16 v[248:249], v66 offset:57344
    v_mfma_f32_16x16x32_bf16 v[156:159], v[180:183], v[212:215], v[156:159]
    ds_read_b64_tr_b16 v[250:251], v66 offset:57856
    buffer_load_dwordx4 v68, s[8:11], s52 offen lds
    v_mfma_f32_16x16x32_bf16 v[152:155], v[176:179], v[212:215], v[152:155]
    ds_read_b64_tr_b16 v[252:253], v67 offset:57344
    v_mfma_f32_16x16x32_bf16 v[160:163], v[184:187], v[208:211], v[160:163]
    ds_read_b64_tr_b16 v[254:255], v67 offset:57856
    buffer_load_dwordx4 v69, s[8:11], s52 offen offset:1024 lds
    v_mfma_f32_16x16x32_bf16 v[164:167], v[188:191], v[208:211], v[164:167]
    ds_read_b128 v[220:223], v64 offset:10240
    v_mfma_f32_16x16x32_bf16 v[172:175], v[188:191], v[212:215], v[172:175]
    ds_read_b128 v[224:227], v64 offset:12288
    s_add_u32 m0, s50, 24576
    s_mov_b32 s53, 3538944
    v_mfma_f32_16x16x32_bf16 v[168:171], v[184:187], v[212:215], v[168:171]
    ds_read_b128 v[228:231], v64 offset:14336
    v_mfma_f32_16x16x32_bf16 v[120:123], v[200:203], v[184:187], v[120:123]
    buffer_load_dwordx4 v76, s[12:15], s53 offen lds
    v_mfma_f32_16x16x32_bf16 v[136:139], v[200:203], v[188:191], v[136:139]
    v_mfma_f32_16x16x32_bf16 v[140:143], v[204:207], v[188:191], v[140:143]
    s_add_u32 m0, s50, 32768
    s_mov_b32 s53, 3540992
    v_mfma_f32_16x16x32_bf16 v[124:127], v[204:207], v[184:187], v[124:127]
    v_mfma_f32_16x16x32_bf16 v[112:115], v[192:195], v[184:187], v[112:115]
    buffer_load_dwordx4 v76, s[12:15], s53 offen lds
    v_mfma_f32_16x16x32_bf16 v[128:131], v[192:195], v[188:191], v[128:131]
    v_mfma_f32_16x16x32_bf16 v[132:135], v[196:199], v[188:191], v[132:135]
    s_add_u32 m0, s47, 0
    v_mfma_f32_16x16x32_bf16 v[116:119], v[196:199], v[184:187], v[116:119]
    s_waitcnt lgkmcnt(0)
    v_mfma_f32_16x16x32_bf16 v[80:83], v[232:235], v[216:219], v[80:83]
    ds_read_b128 v[176:179], v65 offset:8192
    buffer_load_dwordx4 v70, s[8:11], s52 offen lds
    v_mfma_f32_16x16x32_bf16 v[96:99], v[232:235], v[220:223], v[96:99]
    ds_read_b64_tr_b16 v[192:193], v66 offset:45056
    v_mfma_f32_16x16x32_bf16 v[100:103], v[236:239], v[220:223], v[100:103]
    ds_read_b64_tr_b16 v[194:195], v66 offset:45568
    buffer_load_dwordx4 v71, s[8:11], s52 offen offset:1024 lds
    v_mfma_f32_16x16x32_bf16 v[84:87], v[236:239], v[216:219], v[84:87]
    ds_read_b64_tr_b16 v[196:197], v67 offset:45056
    v_mfma_f32_16x16x32_bf16 v[88:91], v[240:243], v[216:219], v[88:91]
    ds_read_b64_tr_b16 v[198:199], v67 offset:45568
    s_add_u32 m0, s51, 24576
    s_mov_b32 s53, 3538944
    v_mfma_f32_16x16x32_bf16 v[104:107], v[240:243], v[220:223], v[104:107]
    ds_read_b64_tr_b16 v[200:201], v66 offset:53248
    v_mfma_f32_16x16x32_bf16 v[108:111], v[244:247], v[220:223], v[108:111]
    ds_read_b64_tr_b16 v[202:203], v66 offset:53760
    buffer_load_dwordx4 v77, s[12:15], s53 offen lds
    v_mfma_f32_16x16x32_bf16 v[92:95], v[244:247], v[216:219], v[92:95]
    ds_read_b64_tr_b16 v[204:205], v67 offset:53248
    v_mfma_f32_16x16x32_bf16 v[144:147], v[216:219], v[248:251], v[144:147]
    ds_read_b64_tr_b16 v[206:207], v67 offset:53760
    s_add_u32 m0, s51, 32768
    s_mov_b32 s53, 3540992
    v_mfma_f32_16x16x32_bf16 v[148:151], v[220:223], v[248:251], v[148:151]
    ds_read_b64_tr_b16 v[208:209], v66 offset:61440
    v_mfma_f32_16x16x32_bf16 v[156:159], v[220:223], v[252:255], v[156:159]
    ds_read_b64_tr_b16 v[210:211], v66 offset:61952
    buffer_load_dwordx4 v77, s[12:15], s53 offen lds
    v_mfma_f32_16x16x32_bf16 v[152:155], v[216:219], v[252:255], v[152:155]
    ds_read_b64_tr_b16 v[212:213], v67 offset:61440
    v_mfma_f32_16x16x32_bf16 v[160:163], v[224:227], v[248:251], v[160:163]
    ds_read_b64_tr_b16 v[214:215], v67 offset:61952
    s_add_u32 m0, s48, 0
    v_mfma_f32_16x16x32_bf16 v[164:167], v[228:231], v[248:251], v[164:167]
    ds_read_b128 v[180:183], v65 offset:10240
    v_mfma_f32_16x16x32_bf16 v[172:175], v[228:231], v[252:255], v[172:175]
    ds_read_b128 v[184:187], v65 offset:12288
    buffer_load_dwordx4 v72, s[8:11], s52 offen lds
    v_mfma_f32_16x16x32_bf16 v[168:171], v[224:227], v[252:255], v[168:171]
    ds_read_b128 v[188:191], v65 offset:14336
    v_mfma_f32_16x16x32_bf16 v[120:123], v[240:243], v[224:227], v[120:123]
    buffer_load_dwordx4 v73, s[8:11], s52 offen offset:1024 lds
    v_mfma_f32_16x16x32_bf16 v[136:139], v[240:243], v[228:231], v[136:139]
    v_mfma_f32_16x16x32_bf16 v[140:143], v[244:247], v[228:231], v[140:143]
    s_add_u32 m0, s49, 0
    v_mfma_f32_16x16x32_bf16 v[124:127], v[244:247], v[224:227], v[124:127]
    v_mfma_f32_16x16x32_bf16 v[112:115], v[232:235], v[224:227], v[112:115]
    buffer_load_dwordx4 v74, s[8:11], s52 offen lds
    v_mfma_f32_16x16x32_bf16 v[128:131], v[232:235], v[228:231], v[128:131]
    v_mfma_f32_16x16x32_bf16 v[132:135], v[236:239], v[228:231], v[132:135]
    buffer_load_dwordx4 v75, s[8:11], s52 offen offset:1024 lds
    v_mfma_f32_16x16x32_bf16 v[116:119], v[236:239], v[224:227], v[116:119]
    s_waitcnt vmcnt(12) lgkmcnt(0)
    s_barrier
    v_mfma_f32_16x16x32_bf16 v[80:83], v[192:195], v[176:179], v[80:83]
    ds_read_b128 v[216:219], v64 offset:16384
    s_add_u32 m0, s50, 40960
    s_mov_b32 s53, 3543040
    v_mfma_f32_16x16x32_bf16 v[96:99], v[192:195], v[180:183], v[96:99]
    ds_read_b64_tr_b16 v[232:233], v66 offset:0
    v_mfma_f32_16x16x32_bf16 v[100:103], v[196:199], v[180:183], v[100:103]
    ds_read_b64_tr_b16 v[234:235], v66 offset:512
    buffer_load_dwordx4 v76, s[12:15], s53 offen lds
    v_mfma_f32_16x16x32_bf16 v[84:87], v[196:199], v[176:179], v[84:87]
    ds_read_b64_tr_b16 v[236:237], v67 offset:0
    v_mfma_f32_16x16x32_bf16 v[88:91], v[200:203], v[176:179], v[88:91]
    ds_read_b64_tr_b16 v[238:239], v67 offset:512
    s_add_u32 m0, s51, 40960
    v_mfma_f32_16x16x32_bf16 v[104:107], v[200:203], v[180:183], v[104:107]
    ds_read_b64_tr_b16 v[240:241], v66 offset:8192
    v_mfma_f32_16x16x32_bf16 v[108:111], v[204:207], v[180:183], v[108:111]
    ds_read_b64_tr_b16 v[242:243], v66 offset:8704
    buffer_load_dwordx4 v77, s[12:15], s53 offen lds
    v_mfma_f32_16x16x32_bf16 v[92:95], v[204:207], v[176:179], v[92:95]
    ds_read_b64_tr_b16 v[244:245], v67 offset:8192
    v_mfma_f32_16x16x32_bf16 v[144:147], v[176:179], v[208:211], v[144:147]
    ds_read_b64_tr_b16 v[246:247], v67 offset:8704
    s_add_u32 m0, s46, 8192
    s_movk_i32 s52, 1280
    v_mfma_f32_16x16x32_bf16 v[148:151], v[180:183], v[208:211], v[148:151]
    ds_read_b64_tr_b16 v[248:249], v66 offset:16384
    v_mfma_f32_16x16x32_bf16 v[156:159], v[180:183], v[212:215], v[156:159]
    ds_read_b64_tr_b16 v[250:251], v66 offset:16896
    buffer_load_dwordx4 v68, s[8:11], s52 offen lds
    v_mfma_f32_16x16x32_bf16 v[152:155], v[176:179], v[212:215], v[152:155]
    ds_read_b64_tr_b16 v[252:253], v67 offset:16384
    v_mfma_f32_16x16x32_bf16 v[160:163], v[184:187], v[208:211], v[160:163]
    ds_read_b64_tr_b16 v[254:255], v67 offset:16896
    buffer_load_dwordx4 v69, s[8:11], s52 offen offset:1024 lds
    v_mfma_f32_16x16x32_bf16 v[164:167], v[188:191], v[208:211], v[164:167]
    ds_read_b128 v[220:223], v64 offset:18432
    v_mfma_f32_16x16x32_bf16 v[172:175], v[188:191], v[212:215], v[172:175]
    ds_read_b128 v[224:227], v64 offset:20480
    s_add_u32 m0, s50, 49152
    s_mov_b32 s53, 3932160
    v_mfma_f32_16x16x32_bf16 v[168:171], v[184:187], v[212:215], v[168:171]
    ds_read_b128 v[228:231], v64 offset:22528
    v_mfma_f32_16x16x32_bf16 v[120:123], v[200:203], v[184:187], v[120:123]
    buffer_load_dwordx4 v76, s[12:15], s53 offen lds
    v_mfma_f32_16x16x32_bf16 v[136:139], v[200:203], v[188:191], v[136:139]
    v_mfma_f32_16x16x32_bf16 v[140:143], v[204:207], v[188:191], v[140:143]
    s_add_u32 m0, s50, 57344
    s_mov_b32 s53, 3934208
    v_mfma_f32_16x16x32_bf16 v[124:127], v[204:207], v[184:187], v[124:127]
    v_mfma_f32_16x16x32_bf16 v[112:115], v[192:195], v[184:187], v[112:115]
    buffer_load_dwordx4 v76, s[12:15], s53 offen lds
    v_mfma_f32_16x16x32_bf16 v[128:131], v[192:195], v[188:191], v[128:131]
    v_mfma_f32_16x16x32_bf16 v[132:135], v[196:199], v[188:191], v[132:135]
    s_add_u32 m0, s47, 8192
    v_mfma_f32_16x16x32_bf16 v[116:119], v[196:199], v[184:187], v[116:119]
    s_waitcnt lgkmcnt(0)
    v_mfma_f32_16x16x32_bf16 v[80:83], v[232:235], v[216:219], v[80:83]
    ds_read_b128 v[176:179], v65 offset:16384
    buffer_load_dwordx4 v70, s[8:11], s52 offen lds
    v_mfma_f32_16x16x32_bf16 v[96:99], v[232:235], v[220:223], v[96:99]
    ds_read_b64_tr_b16 v[192:193], v66 offset:4096
    v_mfma_f32_16x16x32_bf16 v[100:103], v[236:239], v[220:223], v[100:103]
    ds_read_b64_tr_b16 v[194:195], v66 offset:4608
    buffer_load_dwordx4 v71, s[8:11], s52 offen offset:1024 lds
    v_mfma_f32_16x16x32_bf16 v[84:87], v[236:239], v[216:219], v[84:87]
    ds_read_b64_tr_b16 v[196:197], v67 offset:4096
    v_mfma_f32_16x16x32_bf16 v[88:91], v[240:243], v[216:219], v[88:91]
    ds_read_b64_tr_b16 v[198:199], v67 offset:4608
    s_add_u32 m0, s51, 49152
    s_mov_b32 s53, 3932160
    v_mfma_f32_16x16x32_bf16 v[104:107], v[240:243], v[220:223], v[104:107]
    ds_read_b64_tr_b16 v[200:201], v66 offset:12288
    v_mfma_f32_16x16x32_bf16 v[108:111], v[244:247], v[220:223], v[108:111]
    ds_read_b64_tr_b16 v[202:203], v66 offset:12800
    buffer_load_dwordx4 v77, s[12:15], s53 offen lds
    v_mfma_f32_16x16x32_bf16 v[92:95], v[244:247], v[216:219], v[92:95]
    ds_read_b64_tr_b16 v[204:205], v67 offset:12288
    v_mfma_f32_16x16x32_bf16 v[144:147], v[216:219], v[248:251], v[144:147]
    ds_read_b64_tr_b16 v[206:207], v67 offset:12800
    s_add_u32 m0, s51, 57344
    s_mov_b32 s53, 3934208
    v_mfma_f32_16x16x32_bf16 v[148:151], v[220:223], v[248:251], v[148:151]
    ds_read_b64_tr_b16 v[208:209], v66 offset:20480
    v_mfma_f32_16x16x32_bf16 v[156:159], v[220:223], v[252:255], v[156:159]
    ds_read_b64_tr_b16 v[210:211], v66 offset:20992
    buffer_load_dwordx4 v77, s[12:15], s53 offen lds
    v_mfma_f32_16x16x32_bf16 v[152:155], v[216:219], v[252:255], v[152:155]
    ds_read_b64_tr_b16 v[212:213], v67 offset:20480
    v_mfma_f32_16x16x32_bf16 v[160:163], v[224:227], v[248:251], v[160:163]
    ds_read_b64_tr_b16 v[214:215], v67 offset:20992
    s_add_u32 m0, s48, 8192
    v_mfma_f32_16x16x32_bf16 v[164:167], v[228:231], v[248:251], v[164:167]
    ds_read_b128 v[180:183], v65 offset:18432
    v_mfma_f32_16x16x32_bf16 v[172:175], v[228:231], v[252:255], v[172:175]
    ds_read_b128 v[184:187], v65 offset:20480
    buffer_load_dwordx4 v72, s[8:11], s52 offen lds
    v_mfma_f32_16x16x32_bf16 v[168:171], v[224:227], v[252:255], v[168:171]
    ds_read_b128 v[188:191], v65 offset:22528
    v_mfma_f32_16x16x32_bf16 v[120:123], v[240:243], v[224:227], v[120:123]
    buffer_load_dwordx4 v73, s[8:11], s52 offen offset:1024 lds
    v_mfma_f32_16x16x32_bf16 v[136:139], v[240:243], v[228:231], v[136:139]
    v_mfma_f32_16x16x32_bf16 v[140:143], v[244:247], v[228:231], v[140:143]
    s_add_u32 m0, s49, 8192
    v_mfma_f32_16x16x32_bf16 v[124:127], v[244:247], v[224:227], v[124:127]
    v_mfma_f32_16x16x32_bf16 v[112:115], v[232:235], v[224:227], v[112:115]
    buffer_load_dwordx4 v74, s[8:11], s52 offen lds
    v_mfma_f32_16x16x32_bf16 v[128:131], v[232:235], v[228:231], v[128:131]
    v_mfma_f32_16x16x32_bf16 v[132:135], v[236:239], v[228:231], v[132:135]
    buffer_load_dwordx4 v75, s[8:11], s52 offen offset:1024 lds
    v_mfma_f32_16x16x32_bf16 v[116:119], v[236:239], v[224:227], v[116:119]
    s_waitcnt vmcnt(12) lgkmcnt(0)
    s_barrier
    v_mfma_f32_16x16x32_bf16 v[80:83], v[192:195], v[176:179], v[80:83]
    ds_read_b128 v[216:219], v64 offset:0
    s_add_u32 m0, s50, 0
    s_mov_b32 s53, 3936256
    v_mfma_f32_16x16x32_bf16 v[96:99], v[192:195], v[180:183], v[96:99]
    ds_read_b64_tr_b16 v[232:233], v66 offset:24576
    v_mfma_f32_16x16x32_bf16 v[100:103], v[196:199], v[180:183], v[100:103]
    ds_read_b64_tr_b16 v[234:235], v66 offset:25088
    buffer_load_dwordx4 v76, s[12:15], s53 offen lds
    v_mfma_f32_16x16x32_bf16 v[84:87], v[196:199], v[176:179], v[84:87]
    ds_read_b64_tr_b16 v[236:237], v67 offset:24576
    v_mfma_f32_16x16x32_bf16 v[88:91], v[200:203], v[176:179], v[88:91]
    ds_read_b64_tr_b16 v[238:239], v67 offset:25088
    s_add_u32 m0, s51, 0
    v_mfma_f32_16x16x32_bf16 v[104:107], v[200:203], v[180:183], v[104:107]
    ds_read_b64_tr_b16 v[240:241], v66 offset:32768
    v_mfma_f32_16x16x32_bf16 v[108:111], v[204:207], v[180:183], v[108:111]
    ds_read_b64_tr_b16 v[242:243], v66 offset:33280
    buffer_load_dwordx4 v77, s[12:15], s53 offen lds
    v_mfma_f32_16x16x32_bf16 v[92:95], v[204:207], v[176:179], v[92:95]
    ds_read_b64_tr_b16 v[244:245], v67 offset:32768
    v_mfma_f32_16x16x32_bf16 v[144:147], v[176:179], v[208:211], v[144:147]
    ds_read_b64_tr_b16 v[246:247], v67 offset:33280
    s_add_u32 m0, s46, 16384
    s_movk_i32 s52, 1408
    v_mfma_f32_16x16x32_bf16 v[148:151], v[180:183], v[208:211], v[148:151]
    ds_read_b64_tr_b16 v[248:249], v66 offset:40960
    v_mfma_f32_16x16x32_bf16 v[156:159], v[180:183], v[212:215], v[156:159]
    ds_read_b64_tr_b16 v[250:251], v66 offset:41472
    buffer_load_dwordx4 v68, s[8:11], s52 offen lds
    v_mfma_f32_16x16x32_bf16 v[152:155], v[176:179], v[212:215], v[152:155]
    ds_read_b64_tr_b16 v[252:253], v67 offset:40960
    v_mfma_f32_16x16x32_bf16 v[160:163], v[184:187], v[208:211], v[160:163]
    ds_read_b64_tr_b16 v[254:255], v67 offset:41472
    buffer_load_dwordx4 v69, s[8:11], s52 offen offset:1024 lds
    v_mfma_f32_16x16x32_bf16 v[164:167], v[188:191], v[208:211], v[164:167]
    ds_read_b128 v[220:223], v64 offset:2048
    v_mfma_f32_16x16x32_bf16 v[172:175], v[188:191], v[212:215], v[172:175]
    ds_read_b128 v[224:227], v64 offset:4096
    s_add_u32 m0, s50, 8192
    s_mov_b32 s53, 4325376
    v_mfma_f32_16x16x32_bf16 v[168:171], v[184:187], v[212:215], v[168:171]
    ds_read_b128 v[228:231], v64 offset:6144
    v_mfma_f32_16x16x32_bf16 v[120:123], v[200:203], v[184:187], v[120:123]
    buffer_load_dwordx4 v76, s[12:15], s53 offen lds
    v_mfma_f32_16x16x32_bf16 v[136:139], v[200:203], v[188:191], v[136:139]
    v_mfma_f32_16x16x32_bf16 v[140:143], v[204:207], v[188:191], v[140:143]
    s_add_u32 m0, s50, 16384
    s_mov_b32 s53, 4327424
    v_mfma_f32_16x16x32_bf16 v[124:127], v[204:207], v[184:187], v[124:127]
    v_mfma_f32_16x16x32_bf16 v[112:115], v[192:195], v[184:187], v[112:115]
    buffer_load_dwordx4 v76, s[12:15], s53 offen lds
    v_mfma_f32_16x16x32_bf16 v[128:131], v[192:195], v[188:191], v[128:131]
    v_mfma_f32_16x16x32_bf16 v[132:135], v[196:199], v[188:191], v[132:135]
    s_add_u32 m0, s47, 16384
    v_mfma_f32_16x16x32_bf16 v[116:119], v[196:199], v[184:187], v[116:119]
    s_waitcnt lgkmcnt(0)
    v_mfma_f32_16x16x32_bf16 v[80:83], v[232:235], v[216:219], v[80:83]
    ds_read_b128 v[176:179], v65 offset:0
    buffer_load_dwordx4 v70, s[8:11], s52 offen lds
    v_mfma_f32_16x16x32_bf16 v[96:99], v[232:235], v[220:223], v[96:99]
    ds_read_b64_tr_b16 v[192:193], v66 offset:28672
    v_mfma_f32_16x16x32_bf16 v[100:103], v[236:239], v[220:223], v[100:103]
    ds_read_b64_tr_b16 v[194:195], v66 offset:29184
    buffer_load_dwordx4 v71, s[8:11], s52 offen offset:1024 lds
    v_mfma_f32_16x16x32_bf16 v[84:87], v[236:239], v[216:219], v[84:87]
    ds_read_b64_tr_b16 v[196:197], v67 offset:28672
    v_mfma_f32_16x16x32_bf16 v[88:91], v[240:243], v[216:219], v[88:91]
    ds_read_b64_tr_b16 v[198:199], v67 offset:29184
    s_add_u32 m0, s51, 8192
    s_mov_b32 s53, 4325376
    v_mfma_f32_16x16x32_bf16 v[104:107], v[240:243], v[220:223], v[104:107]
    ds_read_b64_tr_b16 v[200:201], v66 offset:36864
    v_mfma_f32_16x16x32_bf16 v[108:111], v[244:247], v[220:223], v[108:111]
    ds_read_b64_tr_b16 v[202:203], v66 offset:37376
    buffer_load_dwordx4 v77, s[12:15], s53 offen lds
    v_mfma_f32_16x16x32_bf16 v[92:95], v[244:247], v[216:219], v[92:95]
    ds_read_b64_tr_b16 v[204:205], v67 offset:36864
    v_mfma_f32_16x16x32_bf16 v[144:147], v[216:219], v[248:251], v[144:147]
    ds_read_b64_tr_b16 v[206:207], v67 offset:37376
    s_add_u32 m0, s51, 16384
    s_mov_b32 s53, 4327424
    v_mfma_f32_16x16x32_bf16 v[148:151], v[220:223], v[248:251], v[148:151]
    ds_read_b64_tr_b16 v[208:209], v66 offset:45056
    v_mfma_f32_16x16x32_bf16 v[156:159], v[220:223], v[252:255], v[156:159]
    ds_read_b64_tr_b16 v[210:211], v66 offset:45568
    buffer_load_dwordx4 v77, s[12:15], s53 offen lds
    v_mfma_f32_16x16x32_bf16 v[152:155], v[216:219], v[252:255], v[152:155]
    ds_read_b64_tr_b16 v[212:213], v67 offset:45056
    v_mfma_f32_16x16x32_bf16 v[160:163], v[224:227], v[248:251], v[160:163]
    ds_read_b64_tr_b16 v[214:215], v67 offset:45568
    s_add_u32 m0, s48, 16384
    v_mfma_f32_16x16x32_bf16 v[164:167], v[228:231], v[248:251], v[164:167]
    ds_read_b128 v[180:183], v65 offset:2048
    v_mfma_f32_16x16x32_bf16 v[172:175], v[228:231], v[252:255], v[172:175]
    ds_read_b128 v[184:187], v65 offset:4096
    buffer_load_dwordx4 v72, s[8:11], s52 offen lds
    v_mfma_f32_16x16x32_bf16 v[168:171], v[224:227], v[252:255], v[168:171]
    ds_read_b128 v[188:191], v65 offset:6144
    v_mfma_f32_16x16x32_bf16 v[120:123], v[240:243], v[224:227], v[120:123]
    buffer_load_dwordx4 v73, s[8:11], s52 offen offset:1024 lds
    v_mfma_f32_16x16x32_bf16 v[136:139], v[240:243], v[228:231], v[136:139]
    v_mfma_f32_16x16x32_bf16 v[140:143], v[244:247], v[228:231], v[140:143]
    s_add_u32 m0, s49, 16384
    v_mfma_f32_16x16x32_bf16 v[124:127], v[244:247], v[224:227], v[124:127]
    v_mfma_f32_16x16x32_bf16 v[112:115], v[232:235], v[224:227], v[112:115]
    buffer_load_dwordx4 v74, s[8:11], s52 offen lds
    v_mfma_f32_16x16x32_bf16 v[128:131], v[232:235], v[228:231], v[128:131]
    v_mfma_f32_16x16x32_bf16 v[132:135], v[236:239], v[228:231], v[132:135]
    buffer_load_dwordx4 v75, s[8:11], s52 offen offset:1024 lds
    v_mfma_f32_16x16x32_bf16 v[116:119], v[236:239], v[224:227], v[116:119]
    s_waitcnt vmcnt(12) lgkmcnt(0)
    s_barrier
    v_mfma_f32_16x16x32_bf16 v[80:83], v[192:195], v[176:179], v[80:83]
    ds_read_b128 v[216:219], v64 offset:8192
    s_add_u32 m0, s50, 24576
    s_mov_b32 s53, 4329472
    v_mfma_f32_16x16x32_bf16 v[96:99], v[192:195], v[180:183], v[96:99]
    ds_read_b64_tr_b16 v[232:233], v66 offset:49152
    v_mfma_f32_16x16x32_bf16 v[100:103], v[196:199], v[180:183], v[100:103]
    ds_read_b64_tr_b16 v[234:235], v66 offset:49664
    buffer_load_dwordx4 v76, s[12:15], s53 offen lds
    v_mfma_f32_16x16x32_bf16 v[84:87], v[196:199], v[176:179], v[84:87]
    ds_read_b64_tr_b16 v[236:237], v67 offset:49152
    v_mfma_f32_16x16x32_bf16 v[88:91], v[200:203], v[176:179], v[88:91]
    ds_read_b64_tr_b16 v[238:239], v67 offset:49664
    s_add_u32 m0, s51, 24576
    v_mfma_f32_16x16x32_bf16 v[104:107], v[200:203], v[180:183], v[104:107]
    ds_read_b64_tr_b16 v[240:241], v66 offset:57344
    v_mfma_f32_16x16x32_bf16 v[108:111], v[204:207], v[180:183], v[108:111]
    ds_read_b64_tr_b16 v[242:243], v66 offset:57856
    buffer_load_dwordx4 v77, s[12:15], s53 offen lds
    v_mfma_f32_16x16x32_bf16 v[92:95], v[204:207], v[176:179], v[92:95]
    ds_read_b64_tr_b16 v[244:245], v67 offset:57344
    v_mfma_f32_16x16x32_bf16 v[144:147], v[176:179], v[208:211], v[144:147]
    ds_read_b64_tr_b16 v[246:247], v67 offset:57856
    s_add_u32 m0, s46, 0
    s_movk_i32 s52, 1536
    v_mfma_f32_16x16x32_bf16 v[148:151], v[180:183], v[208:211], v[148:151]
    ds_read_b64_tr_b16 v[248:249], v66 offset:0
    v_mfma_f32_16x16x32_bf16 v[156:159], v[180:183], v[212:215], v[156:159]
    ds_read_b64_tr_b16 v[250:251], v66 offset:512
    buffer_load_dwordx4 v68, s[8:11], s52 offen lds
    v_mfma_f32_16x16x32_bf16 v[152:155], v[176:179], v[212:215], v[152:155]
    ds_read_b64_tr_b16 v[252:253], v67 offset:0
    v_mfma_f32_16x16x32_bf16 v[160:163], v[184:187], v[208:211], v[160:163]
    ds_read_b64_tr_b16 v[254:255], v67 offset:512
    buffer_load_dwordx4 v69, s[8:11], s52 offen offset:1024 lds
    v_mfma_f32_16x16x32_bf16 v[164:167], v[188:191], v[208:211], v[164:167]
    ds_read_b128 v[220:223], v64 offset:10240
    v_mfma_f32_16x16x32_bf16 v[172:175], v[188:191], v[212:215], v[172:175]
    ds_read_b128 v[224:227], v64 offset:12288
    s_add_u32 m0, s50, 32768
    s_mov_b32 s53, 4718592
    v_mfma_f32_16x16x32_bf16 v[168:171], v[184:187], v[212:215], v[168:171]
    ds_read_b128 v[228:231], v64 offset:14336
    v_mfma_f32_16x16x32_bf16 v[120:123], v[200:203], v[184:187], v[120:123]
    buffer_load_dwordx4 v76, s[12:15], s53 offen lds
    v_mfma_f32_16x16x32_bf16 v[136:139], v[200:203], v[188:191], v[136:139]
    v_mfma_f32_16x16x32_bf16 v[140:143], v[204:207], v[188:191], v[140:143]
    s_add_u32 m0, s50, 40960
    s_mov_b32 s53, 4720640
    v_mfma_f32_16x16x32_bf16 v[124:127], v[204:207], v[184:187], v[124:127]
    v_mfma_f32_16x16x32_bf16 v[112:115], v[192:195], v[184:187], v[112:115]
    buffer_load_dwordx4 v76, s[12:15], s53 offen lds
    v_mfma_f32_16x16x32_bf16 v[128:131], v[192:195], v[188:191], v[128:131]
    v_mfma_f32_16x16x32_bf16 v[132:135], v[196:199], v[188:191], v[132:135]
    s_add_u32 m0, s47, 0
    v_mfma_f32_16x16x32_bf16 v[116:119], v[196:199], v[184:187], v[116:119]
    s_waitcnt lgkmcnt(0)
    v_mfma_f32_16x16x32_bf16 v[80:83], v[232:235], v[216:219], v[80:83]
    ds_read_b128 v[176:179], v65 offset:8192
    buffer_load_dwordx4 v70, s[8:11], s52 offen lds
    v_mfma_f32_16x16x32_bf16 v[96:99], v[232:235], v[220:223], v[96:99]
    ds_read_b64_tr_b16 v[192:193], v66 offset:53248
    v_mfma_f32_16x16x32_bf16 v[100:103], v[236:239], v[220:223], v[100:103]
    ds_read_b64_tr_b16 v[194:195], v66 offset:53760
    buffer_load_dwordx4 v71, s[8:11], s52 offen offset:1024 lds
    v_mfma_f32_16x16x32_bf16 v[84:87], v[236:239], v[216:219], v[84:87]
    ds_read_b64_tr_b16 v[196:197], v67 offset:53248
    v_mfma_f32_16x16x32_bf16 v[88:91], v[240:243], v[216:219], v[88:91]
    ds_read_b64_tr_b16 v[198:199], v67 offset:53760
    s_add_u32 m0, s51, 32768
    s_mov_b32 s53, 4718592
    v_mfma_f32_16x16x32_bf16 v[104:107], v[240:243], v[220:223], v[104:107]
    ds_read_b64_tr_b16 v[200:201], v66 offset:61440
    v_mfma_f32_16x16x32_bf16 v[108:111], v[244:247], v[220:223], v[108:111]
    ds_read_b64_tr_b16 v[202:203], v66 offset:61952
    buffer_load_dwordx4 v77, s[12:15], s53 offen lds
    v_mfma_f32_16x16x32_bf16 v[92:95], v[244:247], v[216:219], v[92:95]
    ds_read_b64_tr_b16 v[204:205], v67 offset:61440
    v_mfma_f32_16x16x32_bf16 v[144:147], v[216:219], v[248:251], v[144:147]
    ds_read_b64_tr_b16 v[206:207], v67 offset:61952
    s_add_u32 m0, s51, 40960
    s_mov_b32 s53, 4720640
    v_mfma_f32_16x16x32_bf16 v[148:151], v[220:223], v[248:251], v[148:151]
    ds_read_b64_tr_b16 v[208:209], v66 offset:4096
    v_mfma_f32_16x16x32_bf16 v[156:159], v[220:223], v[252:255], v[156:159]
    ds_read_b64_tr_b16 v[210:211], v66 offset:4608
    buffer_load_dwordx4 v77, s[12:15], s53 offen lds
    v_mfma_f32_16x16x32_bf16 v[152:155], v[216:219], v[252:255], v[152:155]
    ds_read_b64_tr_b16 v[212:213], v67 offset:4096
    v_mfma_f32_16x16x32_bf16 v[160:163], v[224:227], v[248:251], v[160:163]
    ds_read_b64_tr_b16 v[214:215], v67 offset:4608
    s_add_u32 m0, s48, 0
    v_mfma_f32_16x16x32_bf16 v[164:167], v[228:231], v[248:251], v[164:167]
    ds_read_b128 v[180:183], v65 offset:10240
    v_mfma_f32_16x16x32_bf16 v[172:175], v[228:231], v[252:255], v[172:175]
    ds_read_b128 v[184:187], v65 offset:12288
    buffer_load_dwordx4 v72, s[8:11], s52 offen lds
    v_mfma_f32_16x16x32_bf16 v[168:171], v[224:227], v[252:255], v[168:171]
    ds_read_b128 v[188:191], v65 offset:14336
    v_mfma_f32_16x16x32_bf16 v[120:123], v[240:243], v[224:227], v[120:123]
    buffer_load_dwordx4 v73, s[8:11], s52 offen offset:1024 lds
    v_mfma_f32_16x16x32_bf16 v[136:139], v[240:243], v[228:231], v[136:139]
    v_mfma_f32_16x16x32_bf16 v[140:143], v[244:247], v[228:231], v[140:143]
    s_add_u32 m0, s49, 0
    v_mfma_f32_16x16x32_bf16 v[124:127], v[244:247], v[224:227], v[124:127]
    v_mfma_f32_16x16x32_bf16 v[112:115], v[232:235], v[224:227], v[112:115]
    buffer_load_dwordx4 v74, s[8:11], s52 offen lds
    v_mfma_f32_16x16x32_bf16 v[128:131], v[232:235], v[228:231], v[128:131]
    global_load_dwordx2 v[6:7], v26, s[6:7] sc1
    v_mfma_f32_16x16x32_bf16 v[132:135], v[236:239], v[228:231], v[132:135]
    buffer_load_dwordx4 v75, s[8:11], s52 offen offset:1024 lds
    v_mfma_f32_16x16x32_bf16 v[116:119], v[236:239], v[224:227], v[116:119]
    s_waitcnt vmcnt(12) lgkmcnt(0)
    s_barrier
    v_mfma_f32_16x16x32_bf16 v[80:83], v[192:195], v[176:179], v[80:83]
    ds_read_b128 v[216:219], v64 offset:16384
    s_add_u32 m0, s50, 49152
    s_mov_b32 s53, 4722688
    v_mfma_f32_16x16x32_bf16 v[96:99], v[192:195], v[180:183], v[96:99]
    ds_read_b64_tr_b16 v[232:233], v66 offset:8192
    v_mfma_f32_16x16x32_bf16 v[100:103], v[196:199], v[180:183], v[100:103]
    ds_read_b64_tr_b16 v[234:235], v66 offset:8704
    buffer_load_dwordx4 v76, s[12:15], s53 offen lds
    v_mfma_f32_16x16x32_bf16 v[84:87], v[196:199], v[176:179], v[84:87]
    ds_read_b64_tr_b16 v[236:237], v67 offset:8192
    v_mfma_f32_16x16x32_bf16 v[88:91], v[200:203], v[176:179], v[88:91]
    ds_read_b64_tr_b16 v[238:239], v67 offset:8704
    s_add_u32 m0, s51, 49152
    v_mfma_f32_16x16x32_bf16 v[104:107], v[200:203], v[180:183], v[104:107]
    ds_read_b64_tr_b16 v[240:241], v66 offset:16384
    v_mfma_f32_16x16x32_bf16 v[108:111], v[204:207], v[180:183], v[108:111]
    ds_read_b64_tr_b16 v[242:243], v66 offset:16896
    buffer_load_dwordx4 v77, s[12:15], s53 offen lds
    v_mfma_f32_16x16x32_bf16 v[92:95], v[204:207], v[176:179], v[92:95]
    ds_read_b64_tr_b16 v[244:245], v67 offset:16384
    v_mfma_f32_16x16x32_bf16 v[144:147], v[176:179], v[208:211], v[144:147]
    ds_read_b64_tr_b16 v[246:247], v67 offset:16896
    s_add_u32 m0, s46, 8192
    s_movk_i32 s52, 1664
    v_mfma_f32_16x16x32_bf16 v[148:151], v[180:183], v[208:211], v[148:151]
    ds_read_b64_tr_b16 v[248:249], v66 offset:24576
    v_mfma_f32_16x16x32_bf16 v[156:159], v[180:183], v[212:215], v[156:159]
    ds_read_b64_tr_b16 v[250:251], v66 offset:25088
    buffer_load_dwordx4 v68, s[8:11], s52 offen lds
    v_mfma_f32_16x16x32_bf16 v[152:155], v[176:179], v[212:215], v[152:155]
    ds_read_b64_tr_b16 v[252:253], v67 offset:24576
    v_mfma_f32_16x16x32_bf16 v[160:163], v[184:187], v[208:211], v[160:163]
    ds_read_b64_tr_b16 v[254:255], v67 offset:25088
    buffer_load_dwordx4 v69, s[8:11], s52 offen offset:1024 lds
    v_mfma_f32_16x16x32_bf16 v[164:167], v[188:191], v[208:211], v[164:167]
    ds_read_b128 v[220:223], v64 offset:18432
    v_mfma_f32_16x16x32_bf16 v[172:175], v[188:191], v[212:215], v[172:175]
    ds_read_b128 v[224:227], v64 offset:20480
    s_add_u32 m0, s50, 57344
    s_mov_b32 s53, 5111808
    v_mfma_f32_16x16x32_bf16 v[168:171], v[184:187], v[212:215], v[168:171]
    ds_read_b128 v[228:231], v64 offset:22528
    v_mfma_f32_16x16x32_bf16 v[120:123], v[200:203], v[184:187], v[120:123]
    buffer_load_dwordx4 v76, s[12:15], s53 offen lds
    v_mfma_f32_16x16x32_bf16 v[136:139], v[200:203], v[188:191], v[136:139]
    v_mfma_f32_16x16x32_bf16 v[140:143], v[204:207], v[188:191], v[140:143]
    s_add_u32 m0, s50, 0
    s_mov_b32 s53, 5113856
    v_mfma_f32_16x16x32_bf16 v[124:127], v[204:207], v[184:187], v[124:127]
    v_mfma_f32_16x16x32_bf16 v[112:115], v[192:195], v[184:187], v[112:115]
    buffer_load_dwordx4 v76, s[12:15], s53 offen lds
    v_mfma_f32_16x16x32_bf16 v[128:131], v[192:195], v[188:191], v[128:131]
    v_mfma_f32_16x16x32_bf16 v[132:135], v[196:199], v[188:191], v[132:135]
    s_add_u32 m0, s47, 8192
    v_mfma_f32_16x16x32_bf16 v[116:119], v[196:199], v[184:187], v[116:119]
    s_waitcnt lgkmcnt(0)
    v_mfma_f32_16x16x32_bf16 v[80:83], v[232:235], v[216:219], v[80:83]
    ds_read_b128 v[176:179], v65 offset:16384
    buffer_load_dwordx4 v70, s[8:11], s52 offen lds
    v_mfma_f32_16x16x32_bf16 v[96:99], v[232:235], v[220:223], v[96:99]
    ds_read_b64_tr_b16 v[192:193], v66 offset:12288
    v_mfma_f32_16x16x32_bf16 v[100:103], v[236:239], v[220:223], v[100:103]
    ds_read_b64_tr_b16 v[194:195], v66 offset:12800
    buffer_load_dwordx4 v71, s[8:11], s52 offen offset:1024 lds
    v_mfma_f32_16x16x32_bf16 v[84:87], v[236:239], v[216:219], v[84:87]
    ds_read_b64_tr_b16 v[196:197], v67 offset:12288
    v_mfma_f32_16x16x32_bf16 v[88:91], v[240:243], v[216:219], v[88:91]
    ds_read_b64_tr_b16 v[198:199], v67 offset:12800
    s_add_u32 m0, s51, 57344
    s_mov_b32 s53, 5111808
    v_mfma_f32_16x16x32_bf16 v[104:107], v[240:243], v[220:223], v[104:107]
    ds_read_b64_tr_b16 v[200:201], v66 offset:20480
    v_mfma_f32_16x16x32_bf16 v[108:111], v[244:247], v[220:223], v[108:111]
    ds_read_b64_tr_b16 v[202:203], v66 offset:20992
    buffer_load_dwordx4 v77, s[12:15], s53 offen lds
    v_mfma_f32_16x16x32_bf16 v[92:95], v[244:247], v[216:219], v[92:95]
    ds_read_b64_tr_b16 v[204:205], v67 offset:20480
    v_mfma_f32_16x16x32_bf16 v[144:147], v[216:219], v[248:251], v[144:147]
    ds_read_b64_tr_b16 v[206:207], v67 offset:20992
    s_add_u32 m0, s51, 0
    s_mov_b32 s53, 5113856
    v_mfma_f32_16x16x32_bf16 v[148:151], v[220:223], v[248:251], v[148:151]
    ds_read_b64_tr_b16 v[208:209], v66 offset:28672
    v_mfma_f32_16x16x32_bf16 v[156:159], v[220:223], v[252:255], v[156:159]
    ds_read_b64_tr_b16 v[210:211], v66 offset:29184
    buffer_load_dwordx4 v77, s[12:15], s53 offen lds
    v_mfma_f32_16x16x32_bf16 v[152:155], v[216:219], v[252:255], v[152:155]
    ds_read_b64_tr_b16 v[212:213], v67 offset:28672
    v_mfma_f32_16x16x32_bf16 v[160:163], v[224:227], v[248:251], v[160:163]
    ds_read_b64_tr_b16 v[214:215], v67 offset:29184
    s_add_u32 m0, s48, 8192
    v_mfma_f32_16x16x32_bf16 v[164:167], v[228:231], v[248:251], v[164:167]
    ds_read_b128 v[180:183], v65 offset:18432
    v_mfma_f32_16x16x32_bf16 v[172:175], v[228:231], v[252:255], v[172:175]
    ds_read_b128 v[184:187], v65 offset:20480
    buffer_load_dwordx4 v72, s[8:11], s52 offen lds
    v_mfma_f32_16x16x32_bf16 v[168:171], v[224:227], v[252:255], v[168:171]
    ds_read_b128 v[188:191], v65 offset:22528
    v_mfma_f32_16x16x32_bf16 v[120:123], v[240:243], v[224:227], v[120:123]
    buffer_load_dwordx4 v73, s[8:11], s52 offen offset:1024 lds
    v_mfma_f32_16x16x32_bf16 v[136:139], v[240:243], v[228:231], v[136:139]
    v_mfma_f32_16x16x32_bf16 v[140:143], v[244:247], v[228:231], v[140:143]
    s_add_u32 m0, s49, 8192
    v_mfma_f32_16x16x32_bf16 v[124:127], v[244:247], v[224:227], v[124:127]
    v_mfma_f32_16x16x32_bf16 v[112:115], v[232:235], v[224:227], v[112:115]
    buffer_load_dwordx4 v74, s[8:11], s52 offen lds
    v_mfma_f32_16x16x32_bf16 v[128:131], v[232:235], v[228:231], v[128:131]
    v_mfma_f32_16x16x32_bf16 v[132:135], v[236:239], v[228:231], v[132:135]
    buffer_load_dwordx4 v75, s[8:11], s52 offen offset:1024 lds
    v_mfma_f32_16x16x32_bf16 v[116:119], v[236:239], v[224:227], v[116:119]
    s_waitcnt vmcnt(12) lgkmcnt(0)
    s_barrier
    v_mfma_f32_16x16x32_bf16 v[80:83], v[192:195], v[176:179], v[80:83]
    ds_read_b128 v[216:219], v64 offset:0
    s_add_u32 m0, s50, 8192
    s_mov_b32 s53, 5115904
    v_mfma_f32_16x16x32_bf16 v[96:99], v[192:195], v[180:183], v[96:99]
    ds_read_b64_tr_b16 v[232:233], v66 offset:32768
    v_mfma_f32_16x16x32_bf16 v[100:103], v[196:199], v[180:183], v[100:103]
    ds_read_b64_tr_b16 v[234:235], v66 offset:33280
    buffer_load_dwordx4 v76, s[12:15], s53 offen lds
    v_mfma_f32_16x16x32_bf16 v[84:87], v[196:199], v[176:179], v[84:87]
    ds_read_b64_tr_b16 v[236:237], v67 offset:32768
    v_mfma_f32_16x16x32_bf16 v[88:91], v[200:203], v[176:179], v[88:91]
    ds_read_b64_tr_b16 v[238:239], v67 offset:33280
    s_add_u32 m0, s51, 8192
    v_mfma_f32_16x16x32_bf16 v[104:107], v[200:203], v[180:183], v[104:107]
    ds_read_b64_tr_b16 v[240:241], v66 offset:40960
    v_mfma_f32_16x16x32_bf16 v[108:111], v[204:207], v[180:183], v[108:111]
    ds_read_b64_tr_b16 v[242:243], v66 offset:41472
    buffer_load_dwordx4 v77, s[12:15], s53 offen lds
    v_mfma_f32_16x16x32_bf16 v[92:95], v[204:207], v[176:179], v[92:95]
    ds_read_b64_tr_b16 v[244:245], v67 offset:40960
    v_mfma_f32_16x16x32_bf16 v[144:147], v[176:179], v[208:211], v[144:147]
    ds_read_b64_tr_b16 v[246:247], v67 offset:41472
    s_add_u32 m0, s46, 16384
    s_movk_i32 s52, 1792
    v_mfma_f32_16x16x32_bf16 v[148:151], v[180:183], v[208:211], v[148:151]
    ds_read_b64_tr_b16 v[248:249], v66 offset:49152
    v_mfma_f32_16x16x32_bf16 v[156:159], v[180:183], v[212:215], v[156:159]
    ds_read_b64_tr_b16 v[250:251], v66 offset:49664
    buffer_load_dwordx4 v68, s[8:11], s52 offen lds
    v_mfma_f32_16x16x32_bf16 v[152:155], v[176:179], v[212:215], v[152:155]
    ds_read_b64_tr_b16 v[252:253], v67 offset:49152
    v_mfma_f32_16x16x32_bf16 v[160:163], v[184:187], v[208:211], v[160:163]
    ds_read_b64_tr_b16 v[254:255], v67 offset:49664
    buffer_load_dwordx4 v69, s[8:11], s52 offen offset:1024 lds
    v_mfma_f32_16x16x32_bf16 v[164:167], v[188:191], v[208:211], v[164:167]
    ds_read_b128 v[220:223], v64 offset:2048
    v_mfma_f32_16x16x32_bf16 v[172:175], v[188:191], v[212:215], v[172:175]
    ds_read_b128 v[224:227], v64 offset:4096
    s_add_u32 m0, s50, 16384
    s_mov_b32 s53, 5505024
    v_mfma_f32_16x16x32_bf16 v[168:171], v[184:187], v[212:215], v[168:171]
    ds_read_b128 v[228:231], v64 offset:6144
    v_mfma_f32_16x16x32_bf16 v[120:123], v[200:203], v[184:187], v[120:123]
    buffer_load_dwordx4 v76, s[12:15], s53 offen lds
    v_mfma_f32_16x16x32_bf16 v[136:139], v[200:203], v[188:191], v[136:139]
    v_mfma_f32_16x16x32_bf16 v[140:143], v[204:207], v[188:191], v[140:143]
    s_add_u32 m0, s50, 24576
    s_mov_b32 s53, 5507072
    v_mfma_f32_16x16x32_bf16 v[124:127], v[204:207], v[184:187], v[124:127]
    v_mfma_f32_16x16x32_bf16 v[112:115], v[192:195], v[184:187], v[112:115]
    buffer_load_dwordx4 v76, s[12:15], s53 offen lds
    v_mfma_f32_16x16x32_bf16 v[128:131], v[192:195], v[188:191], v[128:131]
    v_mfma_f32_16x16x32_bf16 v[132:135], v[196:199], v[188:191], v[132:135]
    s_add_u32 m0, s47, 16384
    v_mfma_f32_16x16x32_bf16 v[116:119], v[196:199], v[184:187], v[116:119]
    s_waitcnt lgkmcnt(0)
    v_mfma_f32_16x16x32_bf16 v[80:83], v[232:235], v[216:219], v[80:83]
    ds_read_b128 v[176:179], v65 offset:0
    buffer_load_dwordx4 v70, s[8:11], s52 offen lds
    v_mfma_f32_16x16x32_bf16 v[96:99], v[232:235], v[220:223], v[96:99]
    ds_read_b64_tr_b16 v[192:193], v66 offset:36864
    v_mfma_f32_16x16x32_bf16 v[100:103], v[236:239], v[220:223], v[100:103]
    ds_read_b64_tr_b16 v[194:195], v66 offset:37376
    buffer_load_dwordx4 v71, s[8:11], s52 offen offset:1024 lds
    v_mfma_f32_16x16x32_bf16 v[84:87], v[236:239], v[216:219], v[84:87]
    ds_read_b64_tr_b16 v[196:197], v67 offset:36864
    v_mfma_f32_16x16x32_bf16 v[88:91], v[240:243], v[216:219], v[88:91]
    ds_read_b64_tr_b16 v[198:199], v67 offset:37376
    s_add_u32 m0, s51, 16384
    s_mov_b32 s53, 5505024
    v_mfma_f32_16x16x32_bf16 v[104:107], v[240:243], v[220:223], v[104:107]
    ds_read_b64_tr_b16 v[200:201], v66 offset:45056
    v_mfma_f32_16x16x32_bf16 v[108:111], v[244:247], v[220:223], v[108:111]
    ds_read_b64_tr_b16 v[202:203], v66 offset:45568
    buffer_load_dwordx4 v77, s[12:15], s53 offen lds
    v_mfma_f32_16x16x32_bf16 v[92:95], v[244:247], v[216:219], v[92:95]
    ds_read_b64_tr_b16 v[204:205], v67 offset:45056
    v_mfma_f32_16x16x32_bf16 v[144:147], v[216:219], v[248:251], v[144:147]
    ds_read_b64_tr_b16 v[206:207], v67 offset:45568
    s_add_u32 m0, s51, 24576
    s_mov_b32 s53, 5507072
    v_mfma_f32_16x16x32_bf16 v[148:151], v[220:223], v[248:251], v[148:151]
    ds_read_b64_tr_b16 v[208:209], v66 offset:53248
    v_mfma_f32_16x16x32_bf16 v[156:159], v[220:223], v[252:255], v[156:159]
    ds_read_b64_tr_b16 v[210:211], v66 offset:53760
    buffer_load_dwordx4 v77, s[12:15], s53 offen lds
    v_mfma_f32_16x16x32_bf16 v[152:155], v[216:219], v[252:255], v[152:155]
    ds_read_b64_tr_b16 v[212:213], v67 offset:53248
    v_mfma_f32_16x16x32_bf16 v[160:163], v[224:227], v[248:251], v[160:163]
    ds_read_b64_tr_b16 v[214:215], v67 offset:53760
    s_add_u32 m0, s48, 16384
    v_mfma_f32_16x16x32_bf16 v[164:167], v[228:231], v[248:251], v[164:167]
    ds_read_b128 v[180:183], v65 offset:2048
    v_mfma_f32_16x16x32_bf16 v[172:175], v[228:231], v[252:255], v[172:175]
    ds_read_b128 v[184:187], v65 offset:4096
    buffer_load_dwordx4 v72, s[8:11], s52 offen lds
    v_mfma_f32_16x16x32_bf16 v[168:171], v[224:227], v[252:255], v[168:171]
    ds_read_b128 v[188:191], v65 offset:6144
    v_mfma_f32_16x16x32_bf16 v[120:123], v[240:243], v[224:227], v[120:123]
    buffer_load_dwordx4 v73, s[8:11], s52 offen offset:1024 lds
    v_mfma_f32_16x16x32_bf16 v[136:139], v[240:243], v[228:231], v[136:139]
    v_mfma_f32_16x16x32_bf16 v[140:143], v[244:247], v[228:231], v[140:143]
    s_add_u32 m0, s49, 16384
    v_mfma_f32_16x16x32_bf16 v[124:127], v[244:247], v[224:227], v[124:127]
    v_mfma_f32_16x16x32_bf16 v[112:115], v[232:235], v[224:227], v[112:115]
    buffer_load_dwordx4 v74, s[8:11], s52 offen lds
    v_mfma_f32_16x16x32_bf16 v[128:131], v[232:235], v[228:231], v[128:131]
    v_mfma_f32_16x16x32_bf16 v[132:135], v[236:239], v[228:231], v[132:135]
    buffer_load_dwordx4 v75, s[8:11], s52 offen offset:1024 lds
    v_mfma_f32_16x16x32_bf16 v[116:119], v[236:239], v[224:227], v[116:119]
    s_waitcnt vmcnt(12) lgkmcnt(0)
    v_cmp_eq_u32 vcc, 1, v7
    s_cmp_eq_u64 vcc, -1
    s_cbranch_scc0 DC1
DD2:
    v_not_b32 v7, v6
    s_barrier
    v_mfma_f32_16x16x32_bf16 v[80:83], v[192:195], v[176:179], v[80:83]
    ds_read_b128 v[216:219], v64 offset:8192
    s_add_u32 m0, s50, 32768
    s_mov_b32 s53, 5509120
    v_mfma_f32_16x16x32_bf16 v[96:99], v[192:195], v[180:183], v[96:99]
    ds_read_b64_tr_b16 v[232:233], v66 offset:57344
    v_mfma_f32_16x16x32_bf16 v[100:103], v[196:199], v[180:183], v[100:103]
    ds_read_b64_tr_b16 v[234:235], v66 offset:57856
    buffer_load_dwordx4 v76, s[12:15], s53 offen lds
    v_mfma_f32_16x16x32_bf16 v[84:87], v[196:199], v[176:179], v[84:87]
    ds_read_b64_tr_b16 v[236:237], v67 offset:57344
    v_mfma_f32_16x16x32_bf16 v[88:91], v[200:203], v[176:179], v[88:91]
    ds_read_b64_tr_b16 v[238:239], v67 offset:57856
    s_add_u32 m0, s51, 32768
    v_mfma_f32_16x16x32_bf16 v[104:107], v[200:203], v[180:183], v[104:107]
    ds_read_b64_tr_b16 v[240:241], v66 offset:0
    v_mfma_f32_16x16x32_bf16 v[108:111], v[204:207], v[180:183], v[108:111]
    ds_read_b64_tr_b16 v[242:243], v66 offset:512
    buffer_load_dwordx4 v77, s[12:15], s53 offen lds
    v_mfma_f32_16x16x32_bf16 v[92:95], v[204:207], v[176:179], v[92:95]
    ds_read_b64_tr_b16 v[244:245], v67 offset:0
    v_mfma_f32_16x16x32_bf16 v[144:147], v[176:179], v[208:211], v[144:147]
    ds_read_b64_tr_b16 v[246:247], v67 offset:512
    s_add_u32 m0, s46, 0
    s_movk_i32 s52, 1920
    v_mfma_f32_16x16x32_bf16 v[148:151], v[180:183], v[208:211], v[148:151]
    ds_read_b64_tr_b16 v[248:249], v66 offset:8192
    v_mfma_f32_16x16x32_bf16 v[156:159], v[180:183], v[212:215], v[156:159]
    ds_read_b64_tr_b16 v[250:251], v66 offset:8704
    buffer_load_dwordx4 v68, s[8:11], s52 offen lds
    v_mfma_f32_16x16x32_bf16 v[152:155], v[176:179], v[212:215], v[152:155]
    ds_read_b64_tr_b16 v[252:253], v67 offset:8192
    v_mfma_f32_16x16x32_bf16 v[160:163], v[184:187], v[208:211], v[160:163]
    ds_read_b64_tr_b16 v[254:255], v67 offset:8704
    buffer_load_dwordx4 v69, s[8:11], s52 offen offset:1024 lds
    v_mfma_f32_16x16x32_bf16 v[164:167], v[188:191], v[208:211], v[164:167]
    ds_read_b128 v[220:223], v64 offset:10240
    v_mfma_f32_16x16x32_bf16 v[172:175], v[188:191], v[212:215], v[172:175]
    ds_read_b128 v[224:227], v64 offset:12288
    s_add_u32 m0, s50, 40960
    s_mov_b32 s53, 5898240
    v_mfma_f32_16x16x32_bf16 v[168:171], v[184:187], v[212:215], v[168:171]
    ds_read_b128 v[228:231], v64 offset:14336
    v_mfma_f32_16x16x32_bf16 v[120:123], v[200:203], v[184:187], v[120:123]
    buffer_load_dwordx4 v76, s[12:15], s53 offen lds
    v_mfma_f32_16x16x32_bf16 v[136:139], v[200:203], v[188:191], v[136:139]
    v_mfma_f32_16x16x32_bf16 v[140:143], v[204:207], v[188:191], v[140:143]
    s_add_u32 m0, s50, 49152
    s_mov_b32 s53, 5900288
    v_mfma_f32_16x16x32_bf16 v[124:127], v[204:207], v[184:187], v[124:127]
    v_mfma_f32_16x16x32_bf16 v[112:115], v[192:195], v[184:187], v[112:115]
    buffer_load_dwordx4 v76, s[12:15], s53 offen lds
    v_mfma_f32_16x16x32_bf16 v[128:131], v[192:195], v[188:191], v[128:131]
    v_mfma_f32_16x16x32_bf16 v[132:135], v[196:199], v[188:191], v[132:135]
    s_add_u32 m0, s47, 0
    v_mfma_f32_16x16x32_bf16 v[116:119], v[196:199], v[184:187], v[116:119]
    s_waitcnt lgkmcnt(0)
    v_mfma_f32_16x16x32_bf16 v[80:83], v[232:235], v[216:219], v[80:83]
    ds_read_b128 v[176:179], v65 offset:8192
    buffer_load_dwordx4 v70, s[8:11], s52 offen lds
    v_mfma_f32_16x16x32_bf16 v[96:99], v[232:235], v[220:223], v[96:99]
    ds_read_b64_tr_b16 v[192:193], v66 offset:61440
    v_mfma_f32_16x16x32_bf16 v[100:103], v[236:239], v[220:223], v[100:103]
    ds_read_b64_tr_b16 v[194:195], v66 offset:61952
    buffer_load_dwordx4 v71, s[8:11], s52 offen offset:1024 lds
    v_mfma_f32_16x16x32_bf16 v[84:87], v[236:239], v[216:219], v[84:87]
    ds_read_b64_tr_b16 v[196:197], v67 offset:61440
    v_mfma_f32_16x16x32_bf16 v[88:91], v[240:243], v[216:219], v[88:91]
    ds_read_b64_tr_b16 v[198:199], v67 offset:61952
    s_add_u32 m0, s51, 40960
    s_mov_b32 s53, 5898240
    v_mfma_f32_16x16x32_bf16 v[104:107], v[240:243], v[220:223], v[104:107]
    ds_read_b64_tr_b16 v[200:201], v66 offset:4096
    v_mfma_f32_16x16x32_bf16 v[108:111], v[244:247], v[220:223], v[108:111]
    ds_read_b64_tr_b16 v[202:203], v66 offset:4608
    buffer_load_dwordx4 v77, s[12:15], s53 offen lds
    v_mfma_f32_16x16x32_bf16 v[92:95], v[244:247], v[216:219], v[92:95]
    ds_read_b64_tr_b16 v[204:205], v67 offset:4096
    v_mfma_f32_16x16x32_bf16 v[144:147], v[216:219], v[248:251], v[144:147]
    ds_read_b64_tr_b16 v[206:207], v67 offset:4608
    s_add_u32 m0, s51, 49152
    s_mov_b32 s53, 5900288
    v_mfma_f32_16x16x32_bf16 v[148:151], v[220:223], v[248:251], v[148:151]
    ds_read_b64_tr_b16 v[208:209], v66 offset:12288
    v_mfma_f32_16x16x32_bf16 v[156:159], v[220:223], v[252:255], v[156:159]
    ds_read_b64_tr_b16 v[210:211], v66 offset:12800
    buffer_load_dwordx4 v77, s[12:15], s53 offen lds
    v_mfma_f32_16x16x32_bf16 v[152:155], v[216:219], v[252:255], v[152:155]
    ds_read_b64_tr_b16 v[212:213], v67 offset:12288
    v_mfma_f32_16x16x32_bf16 v[160:163], v[224:227], v[248:251], v[160:163]
    ds_read_b64_tr_b16 v[214:215], v67 offset:12800
    s_add_u32 m0, s48, 0
    v_mfma_f32_16x16x32_bf16 v[164:167], v[228:231], v[248:251], v[164:167]
    ds_read_b128 v[180:183], v65 offset:10240
    v_mfma_f32_16x16x32_bf16 v[172:175], v[228:231], v[252:255], v[172:175]
    ds_read_b128 v[184:187], v65 offset:12288
    buffer_load_dwordx4 v72, s[8:11], s52 offen lds
    v_mfma_f32_16x16x32_bf16 v[168:171], v[224:227], v[252:255], v[168:171]
    ds_read_b128 v[188:191], v65 offset:14336
    v_mfma_f32_16x16x32_bf16 v[120:123], v[240:243], v[224:227], v[120:123]
    buffer_load_dwordx4 v73, s[8:11], s52 offen offset:1024 lds
    v_mfma_f32_16x16x32_bf16 v[136:139], v[240:243], v[228:231], v[136:139]
    v_mfma_f32_16x16x32_bf16 v[140:143], v[244:247], v[228:231], v[140:143]
    s_add_u32 m0, s49, 0
    v_mfma_f32_16x16x32_bf16 v[124:127], v[244:247], v[224:227], v[124:127]
    v_mfma_f32_16x16x32_bf16 v[112:115], v[232:235], v[224:227], v[112:115]
    buffer_load_dwordx4 v74, s[8:11], s52 offen lds
    v_mfma_f32_16x16x32_bf16 v[128:131], v[232:235], v[228:231], v[128:131]
    v_mfma_f32_16x16x32_bf16 v[132:135], v[236:239], v[228:231], v[132:135]
    buffer_load_dwordx4 v75, s[8:11], s52 offen offset:1024 lds
    v_mfma_f32_16x16x32_bf16 v[116:119], v[236:239], v[224:227], v[116:119]
    s_waitcnt vmcnt(12) lgkmcnt(0)
    s_barrier
    v_mfma_f32_16x16x32_bf16 v[80:83], v[192:195], v[176:179], v[80:83]
    ds_read_b128 v[216:219], v64 offset:16384
    s_add_u32 m0, s50, 57344
    s_mov_b32 s53, 5902336
    v_mfma_f32_16x16x32_bf16 v[96:99], v[192:195], v[180:183], v[96:99]
    ds_read_b64_tr_b16 v[232:233], v66 offset:16384
    v_mfma_f32_16x16x32_bf16 v[100:103], v[196:199], v[180:183], v[100:103]
    ds_read_b64_tr_b16 v[234:235], v66 offset:16896
    buffer_load_dwordx4 v76, s[12:15], s53 offen lds
    v_mfma_f32_16x16x32_bf16 v[84:87], v[196:199], v[176:179], v[84:87]
    ds_read_b64_tr_b16 v[236:237], v67 offset:16384
    v_mfma_f32_16x16x32_bf16 v[88:91], v[200:203], v[176:179], v[88:91]
    ds_read_b64_tr_b16 v[238:239], v67 offset:16896
    s_add_u32 m0, s51, 57344
    v_mfma_f32_16x16x32_bf16 v[104:107], v[200:203], v[180:183], v[104:107]
    ds_read_b64_tr_b16 v[240:241], v66 offset:24576
    v_mfma_f32_16x16x32_bf16 v[108:111], v[204:207], v[180:183], v[108:111]
    ds_read_b64_tr_b16 v[242:243], v66 offset:25088
    buffer_load_dwordx4 v77, s[12:15], s53 offen lds
    v_mfma_f32_16x16x32_bf16 v[92:95], v[204:207], v[176:179], v[92:95]
    ds_read_b64_tr_b16 v[244:245], v67 offset:24576
    v_mfma_f32_16x16x32_bf16 v[144:147], v[176:179], v[208:211], v[144:147]
    ds_read_b64_tr_b16 v[246:247], v67 offset:25088
    v_mfma_f32_16x16x32_bf16 v[148:151], v[180:183], v[208:211], v[148:151]
    ds_read_b64_tr_b16 v[248:249], v66 offset:32768
    v_mfma_f32_16x16x32_bf16 v[156:159], v[180:183], v[212:215], v[156:159]
    ds_read_b64_tr_b16 v[250:251], v66 offset:33280
    v_mfma_f32_16x16x32_bf16 v[152:155], v[176:179], v[212:215], v[152:155]
    ds_read_b64_tr_b16 v[252:253], v67 offset:32768
    v_mfma_f32_16x16x32_bf16 v[160:163], v[184:187], v[208:211], v[160:163]
    ds_read_b64_tr_b16 v[254:255], v67 offset:33280
    v_mfma_f32_16x16x32_bf16 v[164:167], v[188:191], v[208:211], v[164:167]
    ds_read_b128 v[220:223], v64 offset:18432
    v_mfma_f32_16x16x32_bf16 v[172:175], v[188:191], v[212:215], v[172:175]
    ds_read_b128 v[224:227], v64 offset:20480
    v_mfma_f32_16x16x32_bf16 v[168:171], v[184:187], v[212:215], v[168:171]
    ds_read_b128 v[228:231], v64 offset:22528
    v_mfma_f32_16x16x32_bf16 v[120:123], v[200:203], v[184:187], v[120:123]
    v_mfma_f32_16x16x32_bf16 v[136:139], v[200:203], v[188:191], v[136:139]
    v_mfma_f32_16x16x32_bf16 v[140:143], v[204:207], v[188:191], v[140:143]
    v_mfma_f32_16x16x32_bf16 v[124:127], v[204:207], v[184:187], v[124:127]
    v_mfma_f32_16x16x32_bf16 v[112:115], v[192:195], v[184:187], v[112:115]
    v_mfma_f32_16x16x32_bf16 v[128:131], v[192:195], v[188:191], v[128:131]
    v_mfma_f32_16x16x32_bf16 v[132:135], v[196:199], v[188:191], v[132:135]
    v_mfma_f32_16x16x32_bf16 v[116:119], v[196:199], v[184:187], v[116:119]
    s_waitcnt lgkmcnt(0)
    v_mfma_f32_16x16x32_bf16 v[80:83], v[232:235], v[216:219], v[80:83]
    ds_read_b128 v[176:179], v65 offset:16384
    v_mfma_f32_16x16x32_bf16 v[96:99], v[232:235], v[220:223], v[96:99]
    ds_read_b64_tr_b16 v[192:193], v66 offset:20480
    v_mfma_f32_16x16x32_bf16 v[100:103], v[236:239], v[220:223], v[100:103]
    ds_read_b64_tr_b16 v[194:195], v66 offset:20992
    v_mfma_f32_16x16x32_bf16 v[84:87], v[236:239], v[216:219], v[84:87]
    ds_read_b64_tr_b16 v[196:197], v67 offset:20480
    v_mfma_f32_16x16x32_bf16 v[88:91], v[240:243], v[216:219], v[88:91]
    ds_read_b64_tr_b16 v[198:199], v67 offset:20992
    v_mfma_f32_16x16x32_bf16 v[104:107], v[240:243], v[220:223], v[104:107]
    ds_read_b64_tr_b16 v[200:201], v66 offset:28672
    v_mfma_f32_16x16x32_bf16 v[108:111], v[244:247], v[220:223], v[108:111]
    ds_read_b64_tr_b16 v[202:203], v66 offset:29184
    v_mfma_f32_16x16x32_bf16 v[92:95], v[244:247], v[216:219], v[92:95]
    ds_read_b64_tr_b16 v[204:205], v67 offset:28672
    v_mfma_f32_16x16x32_bf16 v[144:147], v[216:219], v[248:251], v[144:147]
    ds_read_b64_tr_b16 v[206:207], v67 offset:29184
    v_mfma_f32_16x16x32_bf16 v[148:151], v[220:223], v[248:251], v[148:151]
    ds_read_b64_tr_b16 v[208:209], v66 offset:36864
    v_mfma_f32_16x16x32_bf16 v[156:159], v[220:223], v[252:255], v[156:159]
    ds_read_b64_tr_b16 v[210:211], v66 offset:37376
    v_mfma_f32_16x16x32_bf16 v[152:155], v[216:219], v[252:255], v[152:155]
    ds_read_b64_tr_b16 v[212:213], v67 offset:36864
    v_mfma_f32_16x16x32_bf16 v[160:163], v[224:227], v[248:251], v[160:163]
    ds_read_b64_tr_b16 v[214:215], v67 offset:37376
    v_mfma_f32_16x16x32_bf16 v[164:167], v[228:231], v[248:251], v[164:167]
    ds_read_b128 v[180:183], v65 offset:18432
    v_mfma_f32_16x16x32_bf16 v[172:175], v[228:231], v[252:255], v[172:175]
    ds_read_b128 v[184:187], v65 offset:20480
    v_mfma_f32_16x16x32_bf16 v[168:171], v[224:227], v[252:255], v[168:171]
    ds_read_b128 v[188:191], v65 offset:22528
    v_mfma_f32_16x16x32_bf16 v[120:123], v[240:243], v[224:227], v[120:123]
    v_mfma_f32_16x16x32_bf16 v[136:139], v[240:243], v[228:231], v[136:139]
    v_mfma_f32_16x16x32_bf16 v[140:143], v[244:247], v[228:231], v[140:143]
    v_mfma_f32_16x16x32_bf16 v[124:127], v[244:247], v[224:227], v[124:127]
    v_mfma_f32_16x16x32_bf16 v[112:115], v[232:235], v[224:227], v[112:115]
    v_mfma_f32_16x16x32_bf16 v[128:131], v[232:235], v[228:231], v[128:131]
    v_mfma_f32_16x16x32_bf16 v[132:135], v[236:239], v[228:231], v[132:135]
    v_mfma_f32_16x16x32_bf16 v[116:119], v[236:239], v[224:227], v[116:119]
    s_waitcnt vmcnt(0) lgkmcnt(0)
    s_cmp_eq_u32 s23, 1
    s_cbranch_scc1 VX3
    s_branch VP6
VR5:
    s_branch VE4
VX3:
    s_branch VP8
VR7:
VE4:
    s_barrier
    v_mfma_f32_16x16x32_bf16 v[80:83], v[192:195], v[176:179], v[80:83]
    ds_read_b128 v[216:219], v64 offset:0
    v_mfma_f32_16x16x32_bf16 v[96:99], v[192:195], v[180:183], v[96:99]
    ds_read_b64_tr_b16 v[232:233], v66 offset:40960
    v_mfma_f32_16x16x32_bf16 v[100:103], v[196:199], v[180:183], v[100:103]
    ds_read_b64_tr_b16 v[234:235], v66 offset:41472
    v_mfma_f32_16x16x32_bf16 v[84:87], v[196:199], v[176:179], v[84:87]
    ds_read_b64_tr_b16 v[236:237], v67 offset:40960
    v_mfma_f32_16x16x32_bf16 v[88:91], v[200:203], v[176:179], v[88:91]
    ds_read_b64_tr_b16 v[238:239], v67 offset:41472
    v_mfma_f32_16x16x32_bf16 v[104:107], v[200:203], v[180:183], v[104:107]
    ds_read_b64_tr_b16 v[240:241], v66 offset:49152
    v_mfma_f32_16x16x32_bf16 v[108:111], v[204:207], v[180:183], v[108:111]
    ds_read_b64_tr_b16 v[242:243], v66 offset:49664
    v_mfma_f32_16x16x32_bf16 v[92:95], v[204:207], v[176:179], v[92:95]
    ds_read_b64_tr_b16 v[244:245], v67 offset:49152
    v_mfma_f32_16x16x32_bf16 v[144:147], v[176:179], v[208:211], v[144:147]
    ds_read_b64_tr_b16 v[246:247], v67 offset:49664
    v_mfma_f32_16x16x32_bf16 v[148:151], v[180:183], v[208:211], v[148:151]
    ds_read_b64_tr_b16 v[248:249], v66 offset:57344
    v_mfma_f32_16x16x32_bf16 v[156:159], v[180:183], v[212:215], v[156:159]
    ds_read_b64_tr_b16 v[250:251], v66 offset:57856
    v_mfma_f32_16x16x32_bf16 v[152:155], v[176:179], v[212:215], v[152:155]
    ds_read_b64_tr_b16 v[252:253], v67 offset:57344
    v_mfma_f32_16x16x32_bf16 v[160:163], v[184:187], v[208:211], v[160:163]
    ds_read_b64_tr_b16 v[254:255], v67 offset:57856
    v_mfma_f32_16x16x32_bf16 v[164:167], v[188:191], v[208:211], v[164:167]
    ds_read_b128 v[220:223], v64 offset:2048
    v_mfma_f32_16x16x32_bf16 v[172:175], v[188:191], v[212:215], v[172:175]
    ds_read_b128 v[224:227], v64 offset:4096
    v_mfma_f32_16x16x32_bf16 v[168:171], v[184:187], v[212:215], v[168:171]
    ds_read_b128 v[228:231], v64 offset:6144
    v_mfma_f32_16x16x32_bf16 v[120:123], v[200:203], v[184:187], v[120:123]
    v_mfma_f32_16x16x32_bf16 v[136:139], v[200:203], v[188:191], v[136:139]
    v_mfma_f32_16x16x32_bf16 v[140:143], v[204:207], v[188:191], v[140:143]
    v_mfma_f32_16x16x32_bf16 v[124:127], v[204:207], v[184:187], v[124:127]
    v_mfma_f32_16x16x32_bf16 v[112:115], v[192:195], v[184:187], v[112:115]
    v_mfma_f32_16x16x32_bf16 v[128:131], v[192:195], v[188:191], v[128:131]
    v_mfma_f32_16x16x32_bf16 v[132:135], v[196:199], v[188:191], v[132:135]
    v_mfma_f32_16x16x32_bf16 v[116:119], v[196:199], v[184:187], v[116:119]
    s_waitcnt lgkmcnt(0)
    v_mfma_f32_16x16x32_bf16 v[80:83], v[232:235], v[216:219], v[80:83]
    ds_read_b128 v[176:179], v65 offset:0
    v_mfma_f32_16x16x32_bf16 v[96:99], v[232:235], v[220:223], v[96:99]
    ds_read_b64_tr_b16 v[192:193], v66 offset:45056
    v_mfma_f32_16x16x32_bf16 v[100:103], v[236:239], v[220:223], v[100:103]
    ds_read_b64_tr_b16 v[194:195], v66 offset:45568
    v_mfma_f32_16x16x32_bf16 v[84:87], v[236:239], v[216:219], v[84:87]
    ds_read_b64_tr_b16 v[196:197], v67 offset:45056
    v_mfma_f32_16x16x32_bf16 v[88:91], v[240:243], v[216:219], v[88:91]
    ds_read_b64_tr_b16 v[198:199], v67 offset:45568
    v_mfma_f32_16x16x32_bf16 v[104:107], v[240:243], v[220:223], v[104:107]
    ds_read_b64_tr_b16 v[200:201], v66 offset:53248
    v_mfma_f32_16x16x32_bf16 v[108:111], v[244:247], v[220:223], v[108:111]
    ds_read_b64_tr_b16 v[202:203], v66 offset:53760
    v_mfma_f32_16x16x32_bf16 v[92:95], v[244:247], v[216:219], v[92:95]
    ds_read_b64_tr_b16 v[204:205], v67 offset:53248
    v_mfma_f32_16x16x32_bf16 v[144:147], v[216:219], v[248:251], v[144:147]
    ds_read_b64_tr_b16 v[206:207], v67 offset:53760
    v_mfma_f32_16x16x32_bf16 v[148:151], v[220:223], v[248:251], v[148:151]
    ds_read_b64_tr_b16 v[208:209], v66 offset:61440
    v_mfma_f32_16x16x32_bf16 v[156:159], v[220:223], v[252:255], v[156:159]
    ds_read_b64_tr_b16 v[210:211], v66 offset:61952
    v_mfma_f32_16x16x32_bf16 v[152:155], v[216:219], v[252:255], v[152:155]
    ds_read_b64_tr_b16 v[212:213], v67 offset:61440
    v_mfma_f32_16x16x32_bf16 v[160:163], v[224:227], v[248:251], v[160:163]
    ds_read_b64_tr_b16 v[214:215], v67 offset:61952
    v_mfma_f32_16x16x32_bf16 v[164:167], v[228:231], v[248:251], v[164:167]
    ds_read_b128 v[180:183], v65 offset:2048
    v_mfma_f32_16x16x32_bf16 v[172:175], v[228:231], v[252:255], v[172:175]
    ds_read_b128 v[184:187], v65 offset:4096
    v_mfma_f32_16x16x32_bf16 v[168:171], v[224:227], v[252:255], v[168:171]
    ds_read_b128 v[188:191], v65 offset:6144
    v_mfma_f32_16x16x32_bf16 v[120:123], v[240:243], v[224:227], v[120:123]
    v_mfma_f32_16x16x32_bf16 v[136:139], v[240:243], v[228:231], v[136:139]
    v_mfma_f32_16x16x32_bf16 v[140:143], v[244:247], v[228:231], v[140:143]
    v_mfma_f32_16x16x32_bf16 v[124:127], v[244:247], v[224:227], v[124:127]
    v_mfma_f32_16x16x32_bf16 v[112:115], v[232:235], v[224:227], v[112:115]
    v_mfma_f32_16x16x32_bf16 v[128:131], v[232:235], v[228:231], v[128:131]
    v_mfma_f32_16x16x32_bf16 v[132:135], v[236:239], v[228:231], v[132:135]
    v_mfma_f32_16x16x32_bf16 v[116:119], v[236:239], v[224:227], v[116:119]
    s_waitcnt lgkmcnt(0)
    v_mfma_f32_16x16x32_bf16 v[80:83], v[192:195], v[176:179], v[80:83]
    v_mfma_f32_16x16x32_bf16 v[96:99], v[192:195], v[180:183], v[96:99]
    v_mfma_f32_16x16x32_bf16 v[100:103], v[196:199], v[180:183], v[100:103]
    v_mfma_f32_16x16x32_bf16 v[84:87], v[196:199], v[176:179], v[84:87]
    v_mfma_f32_16x16x32_bf16 v[88:91], v[200:203], v[176:179], v[88:91]
    v_mfma_f32_16x16x32_bf16 v[104:107], v[200:203], v[180:183], v[104:107]
    v_mfma_f32_16x16x32_bf16 v[108:111], v[204:207], v[180:183], v[108:111]
    v_mfma_f32_16x16x32_bf16 v[92:95], v[204:207], v[176:179], v[92:95]
    v_mfma_f32_16x16x32_bf16 v[144:147], v[176:179], v[208:211], v[144:147]
    v_mfma_f32_16x16x32_bf16 v[148:151], v[180:183], v[208:211], v[148:151]
    v_mfma_f32_16x16x32_bf16 v[156:159], v[180:183], v[212:215], v[156:159]
    v_mul_f32 v96, s32, v96
    v_mul_f32 v97, s32, v97
    v_mfma_f32_16x16x32_bf16 v[152:155], v[176:179], v[212:215], v[152:155]
    v_mul_f32 v98, s32, v98
    v_mul_f32 v99, s32, v99
    v_mfma_f32_16x16x32_bf16 v[160:163], v[184:187], v[208:211], v[160:163]
    v_mul_f32 v100, s32, v100
    v_mul_f32 v101, s32, v101
    v_mfma_f32_16x16x32_bf16 v[164:167], v[188:191], v[208:211], v[164:167]
    v_mul_f32 v102, s32, v102
    v_mul_f32 v103, s32, v103
    v_mfma_f32_16x16x32_bf16 v[172:175], v[188:191], v[212:215], v[172:175]
    v_cvt_pk_bf16_f32 v216, v96, v97
    v_cvt_pk_bf16_f32 v217, v98, v99
    v_mfma_f32_16x16x32_bf16 v[168:171], v[184:187], v[212:215], v[168:171]
    v_cvt_pk_bf16_f32 v218, v100, v101
    v_cvt_pk_bf16_f32 v219, v102, v103
    v_mfma_f32_16x16x32_bf16 v[120:123], v[200:203], v[184:187], v[120:123]
    v_mul_f32 v80, s32, v80
    v_mul_f32 v81, s32, v81
    v_mfma_f32_16x16x32_bf16 v[136:139], v[200:203], v[188:191], v[136:139]
    v_mul_f32 v82, s32, v82
    v_mul_f32 v83, s32, v83
    v_mfma_f32_16x16x32_bf16 v[140:143], v[204:207], v[188:191], v[140:143]
    v_mul_f32 v84, s32, v84
    v_mul_f32 v85, s32, v85
    v_mfma_f32_16x16x32_bf16 v[124:127], v[204:207], v[184:187], v[124:127]
    v_mul_f32 v86, s32, v86
    v_mul_f32 v87, s32, v87
    v_mfma_f32_16x16x32_bf16 v[112:115], v[192:195], v[184:187], v[112:115]
    v_cvt_pk_bf16_f32 v220, v80, v81
    v_cvt_pk_bf16_f32 v221, v82, v83
    v_mfma_f32_16x16x32_bf16 v[128:131], v[192:195], v[188:191], v[128:131]
    v_cvt_pk_bf16_f32 v222, v84, v85
    v_cvt_pk_bf16_f32 v223, v86, v87
    v_mfma_f32_16x16x32_bf16 v[132:135], v[196:199], v[188:191], v[132:135]
    v_cvt_pk_bf16_f32 v224, v104, v105
    v_cvt_pk_bf16_f32 v225, v106, v107
    v_mfma_f32_16x16x32_bf16 v[116:119], v[196:199], v[184:187], v[116:119]
    v_cvt_pk_bf16_f32 v226, v108, v109
    v_cvt_pk_bf16_f32 v227, v110, v111
    v_cvt_pk_bf16_f32 v228, v88, v89
    v_cvt_pk_bf16_f32 v229, v90, v91
    v_cvt_pk_bf16_f32 v230, v92, v93
    v_cvt_pk_bf16_f32 v231, v94, v95
    v_cvt_pk_bf16_f32 v232, v144, v145
    v_cvt_pk_bf16_f32 v233, v146, v147
    v_cvt_pk_bf16_f32 v234, v148, v149
    v_cvt_pk_bf16_f32 v235, v150, v151
    v_cvt_pk_bf16_f32 v236, v152, v153
    v_cvt_pk_bf16_f32 v237, v154, v155
    v_cvt_pk_bf16_f32 v238, v156, v157
    v_cvt_pk_bf16_f32 v239, v158, v159
    v_cvt_pk_bf16_f32 v240, v160, v161
    v_cvt_pk_bf16_f32 v241, v162, v163
    v_cvt_pk_bf16_f32 v242, v164, v165
    v_cvt_pk_bf16_f32 v243, v166, v167
    v_cvt_pk_bf16_f32 v244, v168, v169
    v_cvt_pk_bf16_f32 v245, v170, v171
    v_cvt_pk_bf16_f32 v246, v172, v173
    v_cvt_pk_bf16_f32 v247, v174, v175
    v_cvt_pk_bf16_f32 v248, v136, v137
    v_cvt_pk_bf16_f32 v249, v138, v139
    v_cvt_pk_bf16_f32 v250, v140, v141
    v_cvt_pk_bf16_f32 v251, v142, v143
    v_cvt_pk_bf16_f32 v252, v120, v121
    v_cvt_pk_bf16_f32 v253, v122, v123
    v_cvt_pk_bf16_f32 v254, v124, v125
    v_cvt_pk_bf16_f32 v255, v126, v127
    v_mul_f32 v128, s32, v128
    v_mul_f32 v129, s32, v129
    v_mul_f32 v130, s32, v130
    v_mul_f32 v131, s32, v131
    v_mul_f32 v132, s32, v132
    v_mul_f32 v133, s32, v133
    v_mul_f32 v134, s32, v134
    v_mul_f32 v135, s32, v135
    v_cvt_pk_bf16_f32 v208, v128, v129
    v_cvt_pk_bf16_f32 v209, v130, v131
    v_cvt_pk_bf16_f32 v210, v132, v133
    v_cvt_pk_bf16_f32 v211, v134, v135
    v_mul_f32 v112, s32, v112
    v_mul_f32 v113, s32, v113
    v_mul_f32 v114, s32, v114
    v_mul_f32 v115, s32, v115
    v_mul_f32 v116, s32, v116
    v_mul_f32 v117, s32, v117
    v_mul_f32 v118, s32, v118
    v_mul_f32 v119, s32, v119
    v_cvt_pk_bf16_f32 v212, v112, v113
    v_cvt_pk_bf16_f32 v213, v114, v115
    v_cvt_pk_bf16_f32 v214, v116, v117
    v_cvt_pk_bf16_f32 v215, v118, v119
    s_cmp_eq_u32 s23, 0
    s_cbranch_scc1 YOLD
    s_branch XOLD
.p2align 12
G1Y:
    s_lshl_b32 s25, s21, 4
    s_add_u32 s25, s25, s22
    s_and_b32 s26, s25, 1
    s_lshr_b32 s25, s25, 1
    s_lshl_b32 s27, s28, 6
    s_add_u32 s25, s25, s27
    s_mul_i32 s25, s25, 6144
    s_lshl_b32 s26, s26, 10
    s_add_u32 s25, s25, s26
    s_add_u32 s25, s25, 384
    v_min_u32 v24, 5, v2
    v_lshrrev_b32 v25, 1, v24
    v_and_b32 v24, 1, v24
    v_lshlrev_b32 v24, 6, v24
    v_lshl_add_u32 v24, v25, 11, v24
    v_add_u32 v72, s25, v24
    s_waitcnt lgkmcnt(0)
    s_mul_i32 s25, s28, 24576
    v_and_b32 v24, 15, v2
    v_lshrrev_b32 v25, 4, v2
    v_bfe_u32 v26, v2, 1, 3
    v_xor_b32 v26, v26, v25
    v_lshlrev_b32 v26, 4, v26
    v_lshl_add_u32 v26, v24, 7, v26
    v_add_u32 v64, s25, v26
    v_xor_b32 v65, 64, v64
    v_lshlrev_b32 v4, 4, v24
    v_lshl_add_u32 v4, v25, 9, v4
    v_bfe_u32 v24, v2, 2, 2
    v_lshl_add_u32 v26, v25, 3, v24
    v_lshlrev_b32 v26, 7, v26
    v_and_b32 v23, 3, v2
    v_lshl_add_u32 v26, v23, 3, v26
    v_lshrrev_b32 v24, 1, v24
    v_lshl_add_u32 v26, v24, 5, v26
    s_xor_b32 s25, s29, s23
    s_xor_b32 s25, s25, 1
    v_and_b32 v25, 1, v25
    v_xor_b32 v25, s25, v25
    v_lshl_add_u32 v26, v25, 6, v26
    v_add_u32 v66, 98304, v26
    v_xor_b32 v67, 32, v66
    s_getpc_b64 s[4:5]
G1PC:
    s_lshr_b32 s25, s2, 3
    s_lshl_b32 s25, s25, 2
    s_add_u32 s25, s25, s28
    s_mul_i32 s25, s25, 320
    s_sub_u32 s4, s4, G1PC-G1O
    s_subb_u32 s5, s5, 0
    s_load_dword s30, s[4:5], s25 offset:0
    s_load_dword s30, s[4:5], s25 offset:64
    s_load_dword s30, s[4:5], s25 offset:128
    s_load_dword s30, s[4:5], s25 offset:192
    s_load_dword s30, s[4:5], s25 offset:256
    s_lshl_b32 s31, s28, 20
    s_add_u32 s31, s31, 2097152
    s_load_dword s30, s[12:13], s31
    s_lshl_b32 s25, s2, 3
    s_add_u32 s25, s25, s20
    s_cmp_eq_u32 s25, 7
    s_cbranch_scc0 G1Y1
    s_mov_b64 exec, 1
    v_mov_b32 v70, 35127296
    v_mov_b32 v71, 0
    global_load_dword v68, v70, s[16:17] sc1
    v_mov_b32 v69, 1
    s_waitcnt vmcnt(0)
    v_add_u32 v68, 1, v68
    global_store_dword v70, v68, s[16:17] sc1
    global_store_dwordx2 v71, v[68:69], s[6:7] sc1
    s_mov_b64 exec, -1
G1Y1:
    s_getpc_b64 s[4:5]
G1PD:
    s_add_u32 s4, s4, XOLD-G1PD
    s_addc_u32 s5, s5, 0
    s_lshr_b32 s25, s2, 3
    s_lshl_b32 s25, s25, 11
    v_and_b32 v73, 31, v2
    v_lshl_add_u32 v73, v73, 6, s25
    v_min_u32 v73, CODE_END-XOLD-64, v73
    s_barrier
    ds_read_b128 v[216:219], v64 offset:0
    ds_read_b64_tr_b16 v[232:233], v66 offset:0
    ds_read_b64_tr_b16 v[234:235], v66 offset:512
    ds_read_b64_tr_b16 v[236:237], v67 offset:0
    ds_read_b64_tr_b16 v[238:239], v67 offset:512
    ds_read_b64_tr_b16 v[240:241], v66 offset:8192
    ds_read_b64_tr_b16 v[242:243], v66 offset:8704
    ds_read_b64_tr_b16 v[244:245], v67 offset:8192
    ds_read_b64_tr_b16 v[246:247], v67 offset:8704
    ds_read_b64_tr_b16 v[248:249], v66 offset:16384
    ds_read_b64_tr_b16 v[250:251], v66 offset:16896
    ds_read_b64_tr_b16 v[252:253], v67 offset:16384
    ds_read_b64_tr_b16 v[254:255], v67 offset:16896
    ds_read_b128 v[220:223], v64 offset:2048
    ds_read_b128 v[224:227], v64 offset:4096
    ds_read_b128 v[228:231], v64 offset:6144
    s_waitcnt lgkmcnt(0)
    v_mfma_f32_16x16x32_bf16 v[80:83], v[232:235], v[216:219], 0
    ds_read_b128 v[176:179], v65 offset:0
    v_mfma_f32_16x16x32_bf16 v[96:99], v[232:235], v[220:223], 0
    ds_read_b64_tr_b16 v[192:193], v66 offset:4096
    v_mfma_f32_16x16x32_bf16 v[100:103], v[236:239], v[220:223], 0
    ds_read_b64_tr_b16 v[194:195], v66 offset:4608
    v_mfma_f32_16x16x32_bf16 v[84:87], v[236:239], v[216:219], 0
    ds_read_b64_tr_b16 v[196:197], v67 offset:4096
    v_mfma_f32_16x16x32_bf16 v[88:91], v[240:243], v[216:219], 0
    ds_read_b64_tr_b16 v[198:199], v67 offset:4608
    v_mfma_f32_16x16x32_bf16 v[104:107], v[240:243], v[220:223], 0
    ds_read_b64_tr_b16 v[200:201], v66 offset:12288
    v_mfma_f32_16x16x32_bf16 v[108:111], v[244:247], v[220:223], 0
    ds_read_b64_tr_b16 v[202:203], v66 offset:12800
    v_mfma_f32_16x16x32_bf16 v[92:95], v[244:247], v[216:219], 0
    ds_read_b64_tr_b16 v[204:205], v67 offset:12288
    v_mfma_f32_16x16x32_bf16 v[144:147], v[216:219], v[248:251], 0
    ds_read_b64_tr_b16 v[206:207], v67 offset:12800
    v_mfma_f32_16x16x32_bf16 v[148:151], v[220:223], v[248:251], 0
    ds_read_b64_tr_b16 v[208:209], v66 offset:20480
    v_mfma_f32_16x16x32_bf16 v[156:159], v[220:223], v[252:255], 0
    ds_read_b64_tr_b16 v[210:211], v66 offset:20992
    v_mfma_f32_16x16x32_bf16 v[152:155], v[216:219], v[252:255], 0
    ds_read_b64_tr_b16 v[212:213], v67 offset:20480
    v_mfma_f32_16x16x32_bf16 v[160:163], v[224:227], v[248:251], 0
    ds_read_b64_tr_b16 v[214:215], v67 offset:20992
    v_mfma_f32_16x16x32_bf16 v[164:167], v[228:231], v[248:251], 0
    ds_read_b128 v[180:183], v65 offset:2048
    v_mfma_f32_16x16x32_bf16 v[172:175], v[228:231], v[252:255], 0
    ds_read_b128 v[184:187], v65 offset:4096
    v_mfma_f32_16x16x32_bf16 v[168:171], v[224:227], v[252:255], 0
    ds_read_b128 v[188:191], v65 offset:6144
    v_mfma_f32_16x16x32_bf16 v[120:123], v[240:243], v[224:227], 0
    v_mfma_f32_16x16x32_bf16 v[136:139], v[240:243], v[228:231], 0
    v_mfma_f32_16x16x32_bf16 v[140:143], v[244:247], v[228:231], 0
    s_mov_b32 s31, 1572864
    buffer_load_dword v27, v72, s[12:15], s31 offen
    v_mfma_f32_16x16x32_bf16 v[124:127], v[244:247], v[224:227], 0
    v_mfma_f32_16x16x32_bf16 v[112:115], v[232:235], v[224:227], 0
    v_mfma_f32_16x16x32_bf16 v[128:131], v[232:235], v[228:231], 0
    v_mfma_f32_16x16x32_bf16 v[132:135], v[236:239], v[228:231], 0
    v_mfma_f32_16x16x32_bf16 v[116:119], v[236:239], v[224:227], 0
    s_waitcnt lgkmcnt(0)
    s_barrier
GYB1:
    v_lshlrev_b32 v3, 4, v2
    v_and_b32 v5, 31, v2
    v_lshlrev_b32 v5, 7, v5
    v_lshrrev_b32 v22, 5, v2
    v_mul_u32_u24 v22, 786432, v22
    v_add_u32 v5, v5, v22
    s_lshl_b32 s24, s22, 1
    s_add_u32 s24, s24, 1
    s_sub_u32 s24, s24, s23
    s_mov_b32 s18, 35127424
    s_mov_b32 s19, 0x20000
    s_mov_b32 s38, 0x200000
    s_mov_b32 s39, 0x20000
    s_mov_b32 s42, 0x800000
    s_mov_b32 s43, 0x20000
    s_mov_b32 s32, 1048744942
    s_xor_b32 s25, s24, s29
    s_lshl_b32 s26, s23, 5
    s_add_u32 s25, s25, s26
    s_lshl_b32 s26, s21, 2
    s_add_u32 s26, s26, s28
    s_lshl_b32 s45, s25, 5
    s_add_u32 s45, s45, s26
    s_lshl_b32 s34, s45, 12
    s_lshl_b32 s35, s45, 13
    s_add_u32 s35, s35, 8388608
    s_add_u32 s44, s35, 4096
    s_lshl_b32 s45, s45, 7
    s_add_u32 s45, s45, 33554432
    s_lshl_b32 s56, s28, 13
    s_lshl_b32 s74, s28, 12
    s_lshl_b32 s57, s20, 12
    s_add_u32 s25, s56, 98304
    v_add_u32 v78, s25, v4
    s_add_u32 s25, s74, 8192
    v_add_u32 v79, s25, v4
    s_sub_u32 s27, s26, 4
    s_lshl_b32 s27, 1, s27
    s_lshl_b32 s25, s21, 2
    s_lshl_b32 s62, 15, s25
    s_lshr_b32 s25, s62, 4
    s_or_b32 s62, s62, s25
    s_cmp_eq_u32 s23, 0
    s_cselect_b32 s62, s27, s62
    v_mov_b32 v17, 0xdddddddd
    v_and_b32 v25, 7, v2
    v_lshrrev_b32 v26, v25, 1
    v_mul_u32_u24 v26, 0x3f80, v26
    v_lshl_or_b32 v28, v26, 16, v26
    v_mov_b32 v29, v28
    v_xor_b32 v25, 4, v25
    v_lshrrev_b32 v26, v25, 1
    v_mul_u32_u24 v26, 0x3f80, v26
    v_lshl_or_b32 v30, v26, 16, v26
    v_mov_b32 v31, v30
    v_bfe_u32 v24, v2, 2, 1
    v_bfe_u32 v25, v2, 3, 2
    v_and_b32 v26, 35, v2
    v_lshl_add_u32 v26, v25, 2, v26
    v_lshl_add_u32 v26, v24, 4, v26
    v_lshlrev_b32 v16, 4, v26
    s_lshl_b32 s25, s24, 18
    s_add_u32 s55, s25, 8388608
    s_add_u32 s54, s25, 16777216
    s_lshl_b32 s25, s24, 12
    s_add_u32 s59, s25, 33554432
    s_add_u32 s58, s25, 33685504
    s_lshr_b32 s25, s21, 2
    s_lshl_b32 s25, s25, 4
    s_lshl_b32 s60, 0xffff, s25
    s_not_b32 s61, s60
    s_and_b32 s25, s24, 1
    s_lshl_b32 s73, s25, 16
    s_lshl_b32 s75, s25, 15
    s_lshl_b32 s25, s25, 4
    s_add_u32 s67, s25, s22
    s_lshl_b32 s71, 0xffff, s25
    s_not_b32 s72, s71
    s_mov_b32 s76, 125829120
    s_mov_b32 s77, 0x7f800000
    s_mov_b32 s78, 2071986176
    s_mov_b32 s68, 3267887104
    s_sub_u32 s25, 11, s20
    s_cmp_gt_u32 s29, s23
    s_cselect_b32 s64, s25, s20
    s_lshl_b32 s63, s21, 3
    s_add_u32 s63, s63, s64
    s_lshl_b32 s25, s24, 6
    s_add_u32 s80, s25, s63
    s_lshl_b32 s80, s80, 11
    s_lshl_b32 s26, s28, 1
    s_add_u32 s26, s26, s29
    s_lshl_b32 s27, s21, 3
    s_add_u32 s25, s25, s27
    s_add_u32 s25, s25, s26
    s_lshl_b32 s79, s25, 11
    s_add_u32 s79, s79, 4194304
    s_cmp_eq_u32 s23, 0
    s_cselect_b32 s26, s64, s26
    s_lshl_b32 s26, s26, 11
    s_add_u32 s26, s26, 8192
    v_add_u32 v12, s26, v3
    v_xor_b32 v13, 0x800, v12
    s_lshl_b32 s25, s29, 14
    s_add_u32 s25, s25, 98304
    s_lshl_b32 s26, s64, 12
    s_add_u32 s26, s26, 65536
    s_cmp_eq_u32 s23, 0
    s_cselect_b32 s25, s26, s25
    v_add_u32 v8, s25, v16
    v_add_u32 v10, s25, v3
    v_bfe_u32 v24, v2, 4, 1
    v_lshrrev_b32 v25, 5, v2
    v_and_b32 v18, 15, v2
    v_lshlrev_b32 v18, 4, v18
    v_lshl_add_u32 v18, v24, 10, v18
    v_lshl_add_u32 v18, v25, 8, v18
    v_and_b32 v24, 31, v2
    v_lshlrev_b32 v25, 4, v25
    v_sub_u32 v24, v24, v25
    v_cvt_f32_i32 v24, v24
    v_mul_f32 v24, 1904214016, v24
    v_add_f32 v32, 1895825408, v24
    v_add_f32 v33, 4043309056, v24
    v_add_f32 v34, 4055891968, v24
    v_add_f32 v35, 4062183424, v24
    v_add_f32 v36, 4066377728, v24
    v_add_f32 v37, 4069523456, v24
    v_add_f32 v38, 4071620608, v24
    v_add_f32 v39, 4073717760, v24
    v_mfma_f32_16x16x32_bf16 v[80:83], v[192:195], v[176:179], v[80:83]
    ds_read_b128 v[216:219], v64 offset:8192
    v_mfma_f32_16x16x32_bf16 v[96:99], v[192:195], v[180:183], v[96:99]
    ds_read_b64_tr_b16 v[232:233], v66 offset:24576
    v_mfma_f32_16x16x32_bf16 v[100:103], v[196:199], v[180:183], v[100:103]
    ds_read_b64_tr_b16 v[234:235], v66 offset:25088
    v_mfma_f32_16x16x32_bf16 v[84:87], v[196:199], v[176:179], v[84:87]
    ds_read_b64_tr_b16 v[236:237], v67 offset:24576
    v_mfma_f32_16x16x32_bf16 v[88:91], v[200:203], v[176:179], v[88:91]
    ds_read_b64_tr_b16 v[238:239], v67 offset:25088
    v_mfma_f32_16x16x32_bf16 v[104:107], v[200:203], v[180:183], v[104:107]
    ds_read_b64_tr_b16 v[240:241], v66 offset:32768
    v_mfma_f32_16x16x32_bf16 v[108:111], v[204:207], v[180:183], v[108:111]
    ds_read_b64_tr_b16 v[242:243], v66 offset:33280
    v_mfma_f32_16x16x32_bf16 v[92:95], v[204:207], v[176:179], v[92:95]
    ds_read_b64_tr_b16 v[244:245], v67 offset:32768
    v_mfma_f32_16x16x32_bf16 v[144:147], v[176:179], v[208:211], v[144:147]
    ds_read_b64_tr_b16 v[246:247], v67 offset:33280
    v_mfma_f32_16x16x32_bf16 v[148:151], v[180:183], v[208:211], v[148:151]
    ds_read_b64_tr_b16 v[248:249], v66 offset:40960
    v_mfma_f32_16x16x32_bf16 v[156:159], v[180:183], v[212:215], v[156:159]
    ds_read_b64_tr_b16 v[250:251], v66 offset:41472
    v_mfma_f32_16x16x32_bf16 v[152:155], v[176:179], v[212:215], v[152:155]
    ds_read_b64_tr_b16 v[252:253], v67 offset:40960
    v_mfma_f32_16x16x32_bf16 v[160:163], v[184:187], v[208:211], v[160:163]
    ds_read_b64_tr_b16 v[254:255], v67 offset:41472
    v_mfma_f32_16x16x32_bf16 v[164:167], v[188:191], v[208:211], v[164:167]
    ds_read_b128 v[220:223], v64 offset:10240
    v_mfma_f32_16x16x32_bf16 v[172:175], v[188:191], v[212:215], v[172:175]
    ds_read_b128 v[224:227], v64 offset:12288
    v_mfma_f32_16x16x32_bf16 v[168:171], v[184:187], v[212:215], v[168:171]
    ds_read_b128 v[228:231], v64 offset:14336
    v_mfma_f32_16x16x32_bf16 v[120:123], v[200:203], v[184:187], v[120:123]
    v_mfma_f32_16x16x32_bf16 v[136:139], v[200:203], v[188:191], v[136:139]
    v_mfma_f32_16x16x32_bf16 v[140:143], v[204:207], v[188:191], v[140:143]
    v_mfma_f32_16x16x32_bf16 v[124:127], v[204:207], v[184:187], v[124:127]
    v_mfma_f32_16x16x32_bf16 v[112:115], v[192:195], v[184:187], v[112:115]
    v_mfma_f32_16x16x32_bf16 v[128:131], v[192:195], v[188:191], v[128:131]
    v_mfma_f32_16x16x32_bf16 v[132:135], v[196:199], v[188:191], v[132:135]
    v_mfma_f32_16x16x32_bf16 v[116:119], v[196:199], v[184:187], v[116:119]
    s_waitcnt lgkmcnt(0)
    v_mfma_f32_16x16x32_bf16 v[80:83], v[232:235], v[216:219], v[80:83]
    ds_read_b128 v[176:179], v65 offset:8192
    v_mfma_f32_16x16x32_bf16 v[96:99], v[232:235], v[220:223], v[96:99]
    ds_read_b64_tr_b16 v[192:193], v66 offset:28672
    v_mfma_f32_16x16x32_bf16 v[100:103], v[236:239], v[220:223], v[100:103]
    ds_read_b64_tr_b16 v[194:195], v66 offset:29184
    v_mfma_f32_16x16x32_bf16 v[84:87], v[236:239], v[216:219], v[84:87]
    ds_read_b64_tr_b16 v[196:197], v67 offset:28672
    v_mfma_f32_16x16x32_bf16 v[88:91], v[240:243], v[216:219], v[88:91]
    ds_read_b64_tr_b16 v[198:199], v67 offset:29184
    v_mfma_f32_16x16x32_bf16 v[104:107], v[240:243], v[220:223], v[104:107]
    ds_read_b64_tr_b16 v[200:201], v66 offset:36864
    v_mfma_f32_16x16x32_bf16 v[108:111], v[244:247], v[220:223], v[108:111]
    ds_read_b64_tr_b16 v[202:203], v66 offset:37376
    v_mfma_f32_16x16x32_bf16 v[92:95], v[244:247], v[216:219], v[92:95]
    ds_read_b64_tr_b16 v[204:205], v67 offset:36864
    v_mfma_f32_16x16x32_bf16 v[144:147], v[216:219], v[248:251], v[144:147]
    ds_read_b64_tr_b16 v[206:207], v67 offset:37376
    v_mfma_f32_16x16x32_bf16 v[148:151], v[220:223], v[248:251], v[148:151]
    ds_read_b64_tr_b16 v[208:209], v66 offset:45056
    v_mfma_f32_16x16x32_bf16 v[156:159], v[220:223], v[252:255], v[156:159]
    ds_read_b64_tr_b16 v[210:211], v66 offset:45568
    v_mfma_f32_16x16x32_bf16 v[152:155], v[216:219], v[252:255], v[152:155]
    ds_read_b64_tr_b16 v[212:213], v67 offset:45056
    v_mfma_f32_16x16x32_bf16 v[160:163], v[224:227], v[248:251], v[160:163]
    ds_read_b64_tr_b16 v[214:215], v67 offset:45568
    v_mfma_f32_16x16x32_bf16 v[164:167], v[228:231], v[248:251], v[164:167]
    ds_read_b128 v[180:183], v65 offset:10240
    v_mfma_f32_16x16x32_bf16 v[172:175], v[228:231], v[252:255], v[172:175]
    ds_read_b128 v[184:187], v65 offset:12288
    v_mfma_f32_16x16x32_bf16 v[168:171], v[224:227], v[252:255], v[168:171]
    ds_read_b128 v[188:191], v65 offset:14336
    v_mfma_f32_16x16x32_bf16 v[120:123], v[240:243], v[224:227], v[120:123]
    v_mfma_f32_16x16x32_bf16 v[136:139], v[240:243], v[228:231], v[136:139]
    v_mfma_f32_16x16x32_bf16 v[140:143], v[244:247], v[228:231], v[140:143]
    v_mfma_f32_16x16x32_bf16 v[124:127], v[244:247], v[224:227], v[124:127]
    v_mfma_f32_16x16x32_bf16 v[112:115], v[232:235], v[224:227], v[112:115]
    v_mfma_f32_16x16x32_bf16 v[128:131], v[232:235], v[228:231], v[128:131]
    v_mfma_f32_16x16x32_bf16 v[132:135], v[236:239], v[228:231], v[132:135]
    v_mfma_f32_16x16x32_bf16 v[116:119], v[236:239], v[224:227], v[116:119]
    s_waitcnt lgkmcnt(0)
    s_barrier
GYB2:
    v_add_f32 v40, 4075814912, v24
    v_add_f32 v41, 4077387776, v24
    v_add_f32 v42, 4078436352, v24
    v_add_f32 v43, 4079484928, v24
    v_add_f32 v44, 4080533504, v24
    v_add_f32 v45, 4081582080, v24
    v_add_f32 v46, 4082630656, v24
    v_add_f32 v47, 4083679232, v24
    v_min_f32 v48, 0, v32
    v_min_f32 v49, 0, v33
    v_min_f32 v50, 0, v34
    v_min_f32 v51, 0, v35
    v_min_f32 v52, 0, v36
    v_min_f32 v53, 0, v37
    v_min_f32 v54, 0, v38
    v_min_f32 v55, 0, v39
    v_min_f32 v56, 0, v40
    v_min_f32 v57, 0, v41
    v_min_f32 v58, 0, v42
    v_min_f32 v59, 0, v43
    v_min_f32 v60, 0, v44
    v_min_f32 v61, 0, v45
    v_min_f32 v62, 0, v46
    v_min_f32 v63, 0, v47
    s_lshl_b32 s25, s23, 6
    s_lshl_b32 s26, s22, 2
    s_add_u32 s25, s25, s26
    s_add_u32 s25, s25, s28
    s_lshl_b32 s69, s25, 16
    s_add_u32 s69, s69, 25165824
    s_lshl_b32 s70, s25, 12
    s_add_u32 s70, s70, 33816576
    v_lshrrev_b32 v24, 4, v2
    v_and_b32 v25, 15, v2
    v_lshlrev_b32 v26, 1, v24
    v_xor_b32 v25, v25, v26
    s_lshr_b32 s25, s28, 1
    s_lshl_b32 s25, s25, 6
    s_and_b32 s26, s28, 1
    s_lshl_b32 s26, s26, 4
    s_add_u32 s25, s25, s26
    v_add_u32 v24, s25, v24
    v_lshlrev_b32 v24, 11, v24
    v_lshl_add_u32 v19, v25, 4, v24
    s_lshl_b32 s25, s21, 8
    v_add_u32 v19, s25, v19
    v_xor_b32 v20, 128, v19
    v_add_u32 v20, 7168, v20
    s_and_b32 s26, s22, 7
    s_lshl_b32 s26, s26, 3
    s_add_u32 s26, s26, s20
    s_lshl_b32 s26, s26, 15
    s_add_u32 s25, s25, s26
    v_lshrrev_b32 v24, 2, v2
    v_and_b32 v25, 3, v2
    v_lshlrev_b32 v25, 6, v25
    v_lshl_add_u32 v24, v24, 11, v25
    v_add_u32 v21, s25, v24
    s_lshl_b32 s25, s29, 11
    s_add_u32 s81, s74, s25
    s_add_u32 s83, s69, s25
    s_lshl_b32 s82, s29, 14
    s_and_b32 s25, s28, 1
    s_lshl_b32 s25, s25, 13
    v_add_u32 v11, s25, v3
    v_bfe_u32 v22, v2, 2, 3
    v_lshrrev_b32 v23, 5, v2
    v_lshl_add_u32 v23, v23, 4, v22
    v_lshlrev_b32 v23, 8, v23
    v_and_b32 v24, 3, v2
    v_lshl_add_u32 v23, v24, 3, v23
    s_lshr_b32 s25, s28, 1
    s_lshl_b32 s25, s25, 2
    v_xor_b32 v22, s25, v22
    v_lshl_add_u32 v9, v22, 5, v23
    s_lshl_b32 s25, s63, 5
    s_add_u32 s25, s25, s67
    s_lshl_b32 s85, s25, 11
    s_add_u32 s85, s85, 25165824
    s_lshl_b32 s86, s25, 7
    s_add_u32 s86, s86, 33816576
    s_lshl_b32 s25, s21, 2
    s_add_u32 s25, s25, s28
    s_lshl_b32 s25, s25, 1
    s_add_u32 s25, s25, s29
    s_lshl_b32 s25, s25, 5
    s_add_u32 s25, s25, s67
    s_lshl_b32 s65, s25, 11
    s_add_u32 s65, s65, 29360128
    s_lshl_b32 s66, s25, 7
    s_add_u32 s66, s66, 34078720
    v_mov_b64 v[6:7], 0
    s_or_b32 s25, s24, 1
    s_lshl_b32 s25, s25, 3
    s_add_u32 s25, s25, s21
    s_lshl_b32 s25, s25, 2
    s_add_u32 s25, s25, s28
    s_lshl_b32 s96, s25, 9
    s_add_u32 s96, s96, 34603008
    s_lshl_b32 s25, s21, 2
    s_sub_u32 s25, s25, 4
    s_lshl_b32 s60, 3, s25
    s_lshr_b32 s26, s28, 1
    s_add_u32 s25, s25, s26
    s_lshl_b32 s25, 4, s25
    s_cmp_eq_u32 s23, 0
    s_cselect_b32 s62, s25, s62
    s_add_u32 s33, s45, 786432
    s_and_b32 s25, s21, 4
    s_lshl_b32 s25, s25, 2
    v_mfma_f32_16x16x32_bf16 v[80:83], v[192:195], v[176:179], v[80:83]
    ds_read_b128 v[216:219], v64 offset:16384
    v_mfma_f32_16x16x32_bf16 v[96:99], v[192:195], v[180:183], v[96:99]
    ds_read_b64_tr_b16 v[232:233], v66 offset:49152
    v_mfma_f32_16x16x32_bf16 v[100:103], v[196:199], v[180:183], v[100:103]
    ds_read_b64_tr_b16 v[234:235], v66 offset:49664
    v_mfma_f32_16x16x32_bf16 v[84:87], v[196:199], v[176:179], v[84:87]
    ds_read_b64_tr_b16 v[236:237], v67 offset:49152
    v_mfma_f32_16x16x32_bf16 v[88:91], v[200:203], v[176:179], v[88:91]
    ds_read_b64_tr_b16 v[238:239], v67 offset:49664
    v_mfma_f32_16x16x32_bf16 v[104:107], v[200:203], v[180:183], v[104:107]
    ds_read_b64_tr_b16 v[240:241], v66 offset:57344
    v_mfma_f32_16x16x32_bf16 v[108:111], v[204:207], v[180:183], v[108:111]
    ds_read_b64_tr_b16 v[242:243], v66 offset:57856
    v_mfma_f32_16x16x32_bf16 v[92:95], v[204:207], v[176:179], v[92:95]
    ds_read_b64_tr_b16 v[244:245], v67 offset:57344
    v_mfma_f32_16x16x32_bf16 v[144:147], v[176:179], v[208:211], v[144:147]
    ds_read_b64_tr_b16 v[246:247], v67 offset:57856
    v_mfma_f32_16x16x32_bf16 v[148:151], v[180:183], v[208:211], v[148:151]
    ds_read_b64_tr_b16 v[248:249], v66 offset:0
    v_mfma_f32_16x16x32_bf16 v[156:159], v[180:183], v[212:215], v[156:159]
    ds_read_b64_tr_b16 v[250:251], v66 offset:512
    v_mfma_f32_16x16x32_bf16 v[152:155], v[176:179], v[212:215], v[152:155]
    ds_read_b64_tr_b16 v[252:253], v67 offset:0
    v_mfma_f32_16x16x32_bf16 v[160:163], v[184:187], v[208:211], v[160:163]
    ds_read_b64_tr_b16 v[254:255], v67 offset:512
    v_mfma_f32_16x16x32_bf16 v[164:167], v[188:191], v[208:211], v[164:167]
    ds_read_b128 v[220:223], v64 offset:18432
    v_mfma_f32_16x16x32_bf16 v[172:175], v[188:191], v[212:215], v[172:175]
    ds_read_b128 v[224:227], v64 offset:20480
    v_mfma_f32_16x16x32_bf16 v[168:171], v[184:187], v[212:215], v[168:171]
    ds_read_b128 v[228:231], v64 offset:22528
    v_mfma_f32_16x16x32_bf16 v[120:123], v[200:203], v[184:187], v[120:123]
    v_mfma_f32_16x16x32_bf16 v[136:139], v[200:203], v[188:191], v[136:139]
    v_mfma_f32_16x16x32_bf16 v[140:143], v[204:207], v[188:191], v[140:143]
    v_mfma_f32_16x16x32_bf16 v[124:127], v[204:207], v[184:187], v[124:127]
    v_mfma_f32_16x16x32_bf16 v[112:115], v[192:195], v[184:187], v[112:115]
    v_mfma_f32_16x16x32_bf16 v[128:131], v[192:195], v[188:191], v[128:131]
    v_mfma_f32_16x16x32_bf16 v[132:135], v[196:199], v[188:191], v[132:135]
    v_mfma_f32_16x16x32_bf16 v[116:119], v[196:199], v[184:187], v[116:119]
    s_waitcnt lgkmcnt(0)
    v_mfma_f32_16x16x32_bf16 v[80:83], v[232:235], v[216:219], v[80:83]
    ds_read_b128 v[176:179], v65 offset:16384
    v_mfma_f32_16x16x32_bf16 v[96:99], v[232:235], v[220:223], v[96:99]
    ds_read_b64_tr_b16 v[192:193], v66 offset:53248
    v_mfma_f32_16x16x32_bf16 v[100:103], v[236:239], v[220:223], v[100:103]
    ds_read_b64_tr_b16 v[194:195], v66 offset:53760
    v_mfma_f32_16x16x32_bf16 v[84:87], v[236:239], v[216:219], v[84:87]
    ds_read_b64_tr_b16 v[196:197], v67 offset:53248
    v_mfma_f32_16x16x32_bf16 v[88:91], v[240:243], v[216:219], v[88:91]
    ds_read_b64_tr_b16 v[198:199], v67 offset:53760
    v_mfma_f32_16x16x32_bf16 v[104:107], v[240:243], v[220:223], v[104:107]
    ds_read_b64_tr_b16 v[200:201], v66 offset:61440
    v_mfma_f32_16x16x32_bf16 v[108:111], v[244:247], v[220:223], v[108:111]
    ds_read_b64_tr_b16 v[202:203], v66 offset:61952
    v_mfma_f32_16x16x32_bf16 v[92:95], v[244:247], v[216:219], v[92:95]
    ds_read_b64_tr_b16 v[204:205], v67 offset:61440
    v_mfma_f32_16x16x32_bf16 v[144:147], v[216:219], v[248:251], v[144:147]
    ds_read_b64_tr_b16 v[206:207], v67 offset:61952
    v_mfma_f32_16x16x32_bf16 v[148:151], v[220:223], v[248:251], v[148:151]
    ds_read_b64_tr_b16 v[208:209], v66 offset:4096
    v_mfma_f32_16x16x32_bf16 v[156:159], v[220:223], v[252:255], v[156:159]
    ds_read_b64_tr_b16 v[210:211], v66 offset:4608
    v_mfma_f32_16x16x32_bf16 v[152:155], v[216:219], v[252:255], v[152:155]
    ds_read_b64_tr_b16 v[212:213], v67 offset:4096
    v_mfma_f32_16x16x32_bf16 v[160:163], v[224:227], v[248:251], v[160:163]
    ds_read_b64_tr_b16 v[214:215], v67 offset:4608
    v_mfma_f32_16x16x32_bf16 v[164:167], v[228:231], v[248:251], v[164:167]
    ds_read_b128 v[180:183], v65 offset:18432
    v_mfma_f32_16x16x32_bf16 v[172:175], v[228:231], v[252:255], v[172:175]
    ds_read_b128 v[184:187], v65 offset:20480
    v_mfma_f32_16x16x32_bf16 v[168:171], v[224:227], v[252:255], v[168:171]
    ds_read_b128 v[188:191], v65 offset:22528
    v_mfma_f32_16x16x32_bf16 v[120:123], v[240:243], v[224:227], v[120:123]
    v_mfma_f32_16x16x32_bf16 v[136:139], v[240:243], v[228:231], v[136:139]
    v_mfma_f32_16x16x32_bf16 v[140:143], v[244:247], v[228:231], v[140:143]
    v_mfma_f32_16x16x32_bf16 v[124:127], v[244:247], v[224:227], v[124:127]
    v_mfma_f32_16x16x32_bf16 v[112:115], v[232:235], v[224:227], v[112:115]
    v_mfma_f32_16x16x32_bf16 v[128:131], v[232:235], v[228:231], v[128:131]
    v_mfma_f32_16x16x32_bf16 v[132:135], v[236:239], v[228:231], v[132:135]
    v_mfma_f32_16x16x32_bf16 v[116:119], v[236:239], v[224:227], v[116:119]
    s_waitcnt lgkmcnt(0)
    s_barrier
    s_branch GYB3
.p2align 12
GYB3:
    s_lshl_b32 s94, 15, s25
    s_lshl_b32 s25, s21, 2
    s_add_u32 s25, s25, s28
    s_lshl_b32 s95, 1, s25
    s_and_b32 s25, s21, 3
    s_mul_i32 s26, s25, s23
    s_cmp_ge_u32 s26, 1
    s_cselect_b32 s27, 0, 4
    s_lshl_b32 s88, s94, s27
    s_cmp_ge_u32 s26, 2
    s_cselect_b32 s27, 4, 8
    s_lshl_b32 s89, s94, s27
    s_cmp_ge_u32 s26, 3
    s_cselect_b32 s27, 8, 12
    s_lshl_b32 s3, s94, s27
    s_lshl_b32 s26, s29, 2
    s_add_u32 s25, s25, s26
    s_lshl_b32 s25, s25, 1
    s_lshr_b32 s87, 63872, s25
    s_and_b32 s87, s87, 3
    s_lshl_b32 s84, s22, 1
    s_and_b32 s25, s28, 1
    s_add_u32 s84, s84, s25
    s_lshl_b32 s84, s84, 18
    s_lshl_b32 s25, s23, 11
    s_add_u32 s84, s84, s25
    s_lshl_b32 s25, s21, 8
    s_add_u32 s84, s84, s25
    s_lshr_b32 s25, s28, 1
    s_lshl_b32 s25, s25, 7
    s_add_u32 s84, s84, s25
    v_mov_b32 v26, 0
    v_bfe_u32 v24, v2, 3, 1
    v_and_b32 v25, 0x70, v3
    v_lshl_add_u32 v74, v24, 12, v25
    v_lshl_add_u32 v25, v24, 14, v25
    v_xor_b32 v24, s66, v74
    v_xor_b32 v74, s45, v74
    v_xor_b32 v25, s86, v25
    v_mov_b32 v23, v74
    s_mov_b64 exec, 0xffff0000
    v_mov_b32 v74, v25
    s_mov_b32 exec_lo, 0
    s_mov_b32 exec_hi, -1
    v_mov_b32 v74, v24
    s_mov_b32 exec_hi, 0xffff0000
    v_add_u32 v74, 786432, v23
    s_mov_b64 exec, -1
    buffer_store_dwordx4 v[6:9], v74, s[16:19], 0 offen sc1
    v_mfma_f32_16x16x32_bf16 v[80:83], v[192:195], v[176:179], v[80:83]
    ds_read_b128 v[216:219], v64 offset:0
    v_mfma_f32_16x16x32_bf16 v[96:99], v[192:195], v[180:183], v[96:99]
    ds_read_b64_tr_b16 v[232:233], v66 offset:8192
    v_mfma_f32_16x16x32_bf16 v[100:103], v[196:199], v[180:183], v[100:103]
    ds_read_b64_tr_b16 v[234:235], v66 offset:8704
    v_mfma_f32_16x16x32_bf16 v[84:87], v[196:199], v[176:179], v[84:87]
    ds_read_b64_tr_b16 v[236:237], v67 offset:8192
    v_mfma_f32_16x16x32_bf16 v[88:91], v[200:203], v[176:179], v[88:91]
    ds_read_b64_tr_b16 v[238:239], v67 offset:8704
    v_mfma_f32_16x16x32_bf16 v[104:107], v[200:203], v[180:183], v[104:107]
    ds_read_b64_tr_b16 v[240:241], v66 offset:16384
    v_mfma_f32_16x16x32_bf16 v[108:111], v[204:207], v[180:183], v[108:111]
    ds_read_b64_tr_b16 v[242:243], v66 offset:16896
    v_mfma_f32_16x16x32_bf16 v[92:95], v[204:207], v[176:179], v[92:95]
    ds_read_b64_tr_b16 v[244:245], v67 offset:16384
    v_mfma_f32_16x16x32_bf16 v[144:147], v[176:179], v[208:211], v[144:147]
    ds_read_b64_tr_b16 v[246:247], v67 offset:16896
    v_mfma_f32_16x16x32_bf16 v[148:151], v[180:183], v[208:211], v[148:151]
    ds_read_b64_tr_b16 v[248:249], v66 offset:24576
    v_mfma_f32_16x16x32_bf16 v[156:159], v[180:183], v[212:215], v[156:159]
    ds_read_b64_tr_b16 v[250:251], v66 offset:25088
    v_mfma_f32_16x16x32_bf16 v[152:155], v[176:179], v[212:215], v[152:155]
    ds_read_b64_tr_b16 v[252:253], v67 offset:24576
    v_mfma_f32_16x16x32_bf16 v[160:163], v[184:187], v[208:211], v[160:163]
    ds_read_b64_tr_b16 v[254:255], v67 offset:25088
    v_mfma_f32_16x16x32_bf16 v[164:167], v[188:191], v[208:211], v[164:167]
    ds_read_b128 v[220:223], v64 offset:2048
    v_mfma_f32_16x16x32_bf16 v[172:175], v[188:191], v[212:215], v[172:175]
    ds_read_b128 v[224:227], v64 offset:4096
    v_mfma_f32_16x16x32_bf16 v[168:171], v[184:187], v[212:215], v[168:171]
    ds_read_b128 v[228:231], v64 offset:6144
    v_mfma_f32_16x16x32_bf16 v[120:123], v[200:203], v[184:187], v[120:123]
    v_mfma_f32_16x16x32_bf16 v[136:139], v[200:203], v[188:191], v[136:139]
    v_mfma_f32_16x16x32_bf16 v[140:143], v[204:207], v[188:191], v[140:143]
    v_mfma_f32_16x16x32_bf16 v[124:127], v[204:207], v[184:187], v[124:127]
    v_mfma_f32_16x16x32_bf16 v[112:115], v[192:195], v[184:187], v[112:115]
    v_mfma_f32_16x16x32_bf16 v[128:131], v[192:195], v[188:191], v[128:131]
    v_mfma_f32_16x16x32_bf16 v[132:135], v[196:199], v[188:191], v[132:135]
    v_mfma_f32_16x16x32_bf16 v[116:119], v[196:199], v[184:187], v[116:119]
    s_waitcnt lgkmcnt(0)
    v_mfma_f32_16x16x32_bf16 v[80:83], v[232:235], v[216:219], v[80:83]
    ds_read_b128 v[176:179], v65 offset:0
    v_mfma_f32_16x16x32_bf16 v[96:99], v[232:235], v[220:223], v[96:99]
    ds_read_b64_tr_b16 v[192:193], v66 offset:12288
    v_mfma_f32_16x16x32_bf16 v[100:103], v[236:239], v[220:223], v[100:103]
    ds_read_b64_tr_b16 v[194:195], v66 offset:12800
    v_mfma_f32_16x16x32_bf16 v[84:87], v[236:239], v[216:219], v[84:87]
    ds_read_b64_tr_b16 v[196:197], v67 offset:12288
    v_mfma_f32_16x16x32_bf16 v[88:91], v[240:243], v[216:219], v[88:91]
    ds_read_b64_tr_b16 v[198:199], v67 offset:12800
    v_mfma_f32_16x16x32_bf16 v[104:107], v[240:243], v[220:223], v[104:107]
    ds_read_b64_tr_b16 v[200:201], v66 offset:20480
    v_mfma_f32_16x16x32_bf16 v[108:111], v[244:247], v[220:223], v[108:111]
    ds_read_b64_tr_b16 v[202:203], v66 offset:20992
    v_mfma_f32_16x16x32_bf16 v[92:95], v[244:247], v[216:219], v[92:95]
    ds_read_b64_tr_b16 v[204:205], v67 offset:20480
    v_mfma_f32_16x16x32_bf16 v[144:147], v[216:219], v[248:251], v[144:147]
    ds_read_b64_tr_b16 v[206:207], v67 offset:20992
    v_mfma_f32_16x16x32_bf16 v[148:151], v[220:223], v[248:251], v[148:151]
    ds_read_b64_tr_b16 v[208:209], v66 offset:28672
    v_mfma_f32_16x16x32_bf16 v[156:159], v[220:223], v[252:255], v[156:159]
    ds_read_b64_tr_b16 v[210:211], v66 offset:29184
    v_mfma_f32_16x16x32_bf16 v[152:155], v[216:219], v[252:255], v[152:155]
    ds_read_b64_tr_b16 v[212:213], v67 offset:28672
    v_mfma_f32_16x16x32_bf16 v[160:163], v[224:227], v[248:251], v[160:163]
    ds_read_b64_tr_b16 v[214:215], v67 offset:29184
    v_mfma_f32_16x16x32_bf16 v[164:167], v[228:231], v[248:251], v[164:167]
    ds_read_b128 v[180:183], v65 offset:2048
    v_mfma_f32_16x16x32_bf16 v[172:175], v[228:231], v[252:255], v[172:175]
    ds_read_b128 v[184:187], v65 offset:4096
    v_mfma_f32_16x16x32_bf16 v[168:171], v[224:227], v[252:255], v[168:171]
    ds_read_b128 v[188:191], v65 offset:6144
    v_mfma_f32_16x16x32_bf16 v[120:123], v[240:243], v[224:227], v[120:123]
    v_mfma_f32_16x16x32_bf16 v[136:139], v[240:243], v[228:231], v[136:139]
    v_mfma_f32_16x16x32_bf16 v[140:143], v[244:247], v[228:231], v[140:143]
    v_mfma_f32_16x16x32_bf16 v[124:127], v[244:247], v[224:227], v[124:127]
    v_mfma_f32_16x16x32_bf16 v[112:115], v[232:235], v[224:227], v[112:115]
    v_mfma_f32_16x16x32_bf16 v[128:131], v[232:235], v[228:231], v[128:131]
    v_mfma_f32_16x16x32_bf16 v[132:135], v[236:239], v[228:231], v[132:135]
    v_mfma_f32_16x16x32_bf16 v[116:119], v[236:239], v[224:227], v[116:119]
    s_waitcnt lgkmcnt(0)
    s_barrier
GYB4:
    v_mfma_f32_16x16x32_bf16 v[80:83], v[192:195], v[176:179], v[80:83]
    ds_read_b128 v[216:219], v64 offset:8192
    v_mfma_f32_16x16x32_bf16 v[96:99], v[192:195], v[180:183], v[96:99]
    ds_read_b64_tr_b16 v[232:233], v66 offset:32768
    v_mfma_f32_16x16x32_bf16 v[100:103], v[196:199], v[180:183], v[100:103]
    ds_read_b64_tr_b16 v[234:235], v66 offset:33280
    v_mfma_f32_16x16x32_bf16 v[84:87], v[196:199], v[176:179], v[84:87]
    ds_read_b64_tr_b16 v[236:237], v67 offset:32768
    v_mfma_f32_16x16x32_bf16 v[88:91], v[200:203], v[176:179], v[88:91]
    ds_read_b64_tr_b16 v[238:239], v67 offset:33280
    v_mfma_f32_16x16x32_bf16 v[104:107], v[200:203], v[180:183], v[104:107]
    ds_read_b64_tr_b16 v[240:241], v66 offset:40960
    v_mfma_f32_16x16x32_bf16 v[108:111], v[204:207], v[180:183], v[108:111]
    ds_read_b64_tr_b16 v[242:243], v66 offset:41472
    v_mfma_f32_16x16x32_bf16 v[92:95], v[204:207], v[176:179], v[92:95]
    ds_read_b64_tr_b16 v[244:245], v67 offset:40960
    v_mfma_f32_16x16x32_bf16 v[144:147], v[176:179], v[208:211], v[144:147]
    ds_read_b64_tr_b16 v[246:247], v67 offset:41472
    v_mfma_f32_16x16x32_bf16 v[148:151], v[180:183], v[208:211], v[148:151]
    ds_read_b64_tr_b16 v[248:249], v66 offset:49152
    v_mfma_f32_16x16x32_bf16 v[156:159], v[180:183], v[212:215], v[156:159]
    ds_read_b64_tr_b16 v[250:251], v66 offset:49664
    v_mfma_f32_16x16x32_bf16 v[152:155], v[176:179], v[212:215], v[152:155]
    ds_read_b64_tr_b16 v[252:253], v67 offset:49152
    v_mfma_f32_16x16x32_bf16 v[160:163], v[184:187], v[208:211], v[160:163]
    ds_read_b64_tr_b16 v[254:255], v67 offset:49664
    v_mfma_f32_16x16x32_bf16 v[164:167], v[188:191], v[208:211], v[164:167]
    ds_read_b128 v[220:223], v64 offset:10240
    v_mfma_f32_16x16x32_bf16 v[172:175], v[188:191], v[212:215], v[172:175]
    ds_read_b128 v[224:227], v64 offset:12288
    v_mfma_f32_16x16x32_bf16 v[168:171], v[184:187], v[212:215], v[168:171]
    ds_read_b128 v[228:231], v64 offset:14336
    v_mfma_f32_16x16x32_bf16 v[120:123], v[200:203], v[184:187], v[120:123]
    v_mfma_f32_16x16x32_bf16 v[136:139], v[200:203], v[188:191], v[136:139]
    v_mfma_f32_16x16x32_bf16 v[140:143], v[204:207], v[188:191], v[140:143]
    v_mfma_f32_16x16x32_bf16 v[124:127], v[204:207], v[184:187], v[124:127]
    v_mfma_f32_16x16x32_bf16 v[112:115], v[192:195], v[184:187], v[112:115]
    v_mfma_f32_16x16x32_bf16 v[128:131], v[192:195], v[188:191], v[128:131]
    v_mfma_f32_16x16x32_bf16 v[132:135], v[196:199], v[188:191], v[132:135]
    v_mfma_f32_16x16x32_bf16 v[116:119], v[196:199], v[184:187], v[116:119]
    s_waitcnt lgkmcnt(0)
    v_mfma_f32_16x16x32_bf16 v[80:83], v[232:235], v[216:219], v[80:83]
    ds_read_b128 v[176:179], v65 offset:8192
    v_mfma_f32_16x16x32_bf16 v[96:99], v[232:235], v[220:223], v[96:99]
    ds_read_b64_tr_b16 v[192:193], v66 offset:36864
    v_mfma_f32_16x16x32_bf16 v[100:103], v[236:239], v[220:223], v[100:103]
    ds_read_b64_tr_b16 v[194:195], v66 offset:37376
    v_mfma_f32_16x16x32_bf16 v[84:87], v[236:239], v[216:219], v[84:87]
    ds_read_b64_tr_b16 v[196:197], v67 offset:36864
    v_mfma_f32_16x16x32_bf16 v[88:91], v[240:243], v[216:219], v[88:91]
    ds_read_b64_tr_b16 v[198:199], v67 offset:37376
    v_mfma_f32_16x16x32_bf16 v[104:107], v[240:243], v[220:223], v[104:107]
    ds_read_b64_tr_b16 v[200:201], v66 offset:45056
    v_mfma_f32_16x16x32_bf16 v[108:111], v[244:247], v[220:223], v[108:111]
    ds_read_b64_tr_b16 v[202:203], v66 offset:45568
    v_mfma_f32_16x16x32_bf16 v[92:95], v[244:247], v[216:219], v[92:95]
    ds_read_b64_tr_b16 v[204:205], v67 offset:45056
    v_mfma_f32_16x16x32_bf16 v[144:147], v[216:219], v[248:251], v[144:147]
    ds_read_b64_tr_b16 v[206:207], v67 offset:45568
    v_mfma_f32_16x16x32_bf16 v[148:151], v[220:223], v[248:251], v[148:151]
    ds_read_b64_tr_b16 v[208:209], v66 offset:53248
    v_mfma_f32_16x16x32_bf16 v[156:159], v[220:223], v[252:255], v[156:159]
    ds_read_b64_tr_b16 v[210:211], v66 offset:53760
    v_mfma_f32_16x16x32_bf16 v[152:155], v[216:219], v[252:255], v[152:155]
    ds_read_b64_tr_b16 v[212:213], v67 offset:53248
    v_mfma_f32_16x16x32_bf16 v[160:163], v[224:227], v[248:251], v[160:163]
    ds_read_b64_tr_b16 v[214:215], v67 offset:53760
    v_mfma_f32_16x16x32_bf16 v[164:167], v[228:231], v[248:251], v[164:167]
    ds_read_b128 v[180:183], v65 offset:10240
    v_mfma_f32_16x16x32_bf16 v[172:175], v[228:231], v[252:255], v[172:175]
    ds_read_b128 v[184:187], v65 offset:12288
    v_mfma_f32_16x16x32_bf16 v[168:171], v[224:227], v[252:255], v[168:171]
    ds_read_b128 v[188:191], v65 offset:14336
    v_mfma_f32_16x16x32_bf16 v[120:123], v[240:243], v[224:227], v[120:123]
    v_mfma_f32_16x16x32_bf16 v[136:139], v[240:243], v[228:231], v[136:139]
    v_mfma_f32_16x16x32_bf16 v[140:143], v[244:247], v[228:231], v[140:143]
    s_mov_b32 s31, 3145728
    buffer_load_dword v27, v72, s[12:15], s31 offen
    v_mfma_f32_16x16x32_bf16 v[124:127], v[244:247], v[224:227], v[124:127]
    v_mfma_f32_16x16x32_bf16 v[112:115], v[232:235], v[224:227], v[112:115]
    v_mfma_f32_16x16x32_bf16 v[128:131], v[232:235], v[228:231], v[128:131]
    v_mfma_f32_16x16x32_bf16 v[132:135], v[236:239], v[228:231], v[132:135]
    v_mfma_f32_16x16x32_bf16 v[116:119], v[236:239], v[224:227], v[116:119]
    s_waitcnt lgkmcnt(0)
    s_barrier
GYB5:
    v_mfma_f32_16x16x32_bf16 v[80:83], v[192:195], v[176:179], v[80:83]
    ds_read_b128 v[216:219], v64 offset:16384
    v_mfma_f32_16x16x32_bf16 v[96:99], v[192:195], v[180:183], v[96:99]
    ds_read_b64_tr_b16 v[232:233], v66 offset:57344
    v_mfma_f32_16x16x32_bf16 v[100:103], v[196:199], v[180:183], v[100:103]
    ds_read_b64_tr_b16 v[234:235], v66 offset:57856
    v_mfma_f32_16x16x32_bf16 v[84:87], v[196:199], v[176:179], v[84:87]
    ds_read_b64_tr_b16 v[236:237], v67 offset:57344
    v_mfma_f32_16x16x32_bf16 v[88:91], v[200:203], v[176:179], v[88:91]
    ds_read_b64_tr_b16 v[238:239], v67 offset:57856
    v_mfma_f32_16x16x32_bf16 v[104:107], v[200:203], v[180:183], v[104:107]
    ds_read_b64_tr_b16 v[240:241], v66 offset:0
    v_mfma_f32_16x16x32_bf16 v[108:111], v[204:207], v[180:183], v[108:111]
    ds_read_b64_tr_b16 v[242:243], v66 offset:512
    v_mfma_f32_16x16x32_bf16 v[92:95], v[204:207], v[176:179], v[92:95]
    ds_read_b64_tr_b16 v[244:245], v67 offset:0
    v_mfma_f32_16x16x32_bf16 v[144:147], v[176:179], v[208:211], v[144:147]
    ds_read_b64_tr_b16 v[246:247], v67 offset:512
    v_mfma_f32_16x16x32_bf16 v[148:151], v[180:183], v[208:211], v[148:151]
    ds_read_b64_tr_b16 v[248:249], v66 offset:8192
    v_mfma_f32_16x16x32_bf16 v[156:159], v[180:183], v[212:215], v[156:159]
    ds_read_b64_tr_b16 v[250:251], v66 offset:8704
    v_mfma_f32_16x16x32_bf16 v[152:155], v[176:179], v[212:215], v[152:155]
    ds_read_b64_tr_b16 v[252:253], v67 offset:8192
    v_mfma_f32_16x16x32_bf16 v[160:163], v[184:187], v[208:211], v[160:163]
    ds_read_b64_tr_b16 v[254:255], v67 offset:8704
    v_mfma_f32_16x16x32_bf16 v[164:167], v[188:191], v[208:211], v[164:167]
    ds_read_b128 v[220:223], v64 offset:18432
    v_mfma_f32_16x16x32_bf16 v[172:175], v[188:191], v[212:215], v[172:175]
    ds_read_b128 v[224:227], v64 offset:20480
    v_mfma_f32_16x16x32_bf16 v[168:171], v[184:187], v[212:215], v[168:171]
    ds_read_b128 v[228:231], v64 offset:22528
    v_mfma_f32_16x16x32_bf16 v[120:123], v[200:203], v[184:187], v[120:123]
    v_mfma_f32_16x16x32_bf16 v[136:139], v[200:203], v[188:191], v[136:139]
    v_mfma_f32_16x16x32_bf16 v[140:143], v[204:207], v[188:191], v[140:143]
    v_mfma_f32_16x16x32_bf16 v[124:127], v[204:207], v[184:187], v[124:127]
    v_mfma_f32_16x16x32_bf16 v[112:115], v[192:195], v[184:187], v[112:115]
    v_mfma_f32_16x16x32_bf16 v[128:131], v[192:195], v[188:191], v[128:131]
    v_mfma_f32_16x16x32_bf16 v[132:135], v[196:199], v[188:191], v[132:135]
    v_mfma_f32_16x16x32_bf16 v[116:119], v[196:199], v[184:187], v[116:119]
    s_waitcnt lgkmcnt(0)
    v_mfma_f32_16x16x32_bf16 v[80:83], v[232:235], v[216:219], v[80:83]
    ds_read_b128 v[176:179], v65 offset:16384
    v_mfma_f32_16x16x32_bf16 v[96:99], v[232:235], v[220:223], v[96:99]
    ds_read_b64_tr_b16 v[192:193], v66 offset:61440
    v_mfma_f32_16x16x32_bf16 v[100:103], v[236:239], v[220:223], v[100:103]
    ds_read_b64_tr_b16 v[194:195], v66 offset:61952
    v_mfma_f32_16x16x32_bf16 v[84:87], v[236:239], v[216:219], v[84:87]
    ds_read_b64_tr_b16 v[196:197], v67 offset:61440
    v_mfma_f32_16x16x32_bf16 v[88:91], v[240:243], v[216:219], v[88:91]
    ds_read_b64_tr_b16 v[198:199], v67 offset:61952
    v_mfma_f32_16x16x32_bf16 v[104:107], v[240:243], v[220:223], v[104:107]
    ds_read_b64_tr_b16 v[200:201], v66 offset:4096
    v_mfma_f32_16x16x32_bf16 v[108:111], v[244:247], v[220:223], v[108:111]
    ds_read_b64_tr_b16 v[202:203], v66 offset:4608
    v_mfma_f32_16x16x32_bf16 v[92:95], v[244:247], v[216:219], v[92:95]
    ds_read_b64_tr_b16 v[204:205], v67 offset:4096
    v_mfma_f32_16x16x32_bf16 v[144:147], v[216:219], v[248:251], v[144:147]
    ds_read_b64_tr_b16 v[206:207], v67 offset:4608
    v_mfma_f32_16x16x32_bf16 v[148:151], v[220:223], v[248:251], v[148:151]
    ds_read_b64_tr_b16 v[208:209], v66 offset:12288
    v_mfma_f32_16x16x32_bf16 v[156:159], v[220:223], v[252:255], v[156:159]
    ds_read_b64_tr_b16 v[210:211], v66 offset:12800
    v_mfma_f32_16x16x32_bf16 v[152:155], v[216:219], v[252:255], v[152:155]
    ds_read_b64_tr_b16 v[212:213], v67 offset:12288
    v_mfma_f32_16x16x32_bf16 v[160:163], v[224:227], v[248:251], v[160:163]
    ds_read_b64_tr_b16 v[214:215], v67 offset:12800
    v_mfma_f32_16x16x32_bf16 v[164:167], v[228:231], v[248:251], v[164:167]
    ds_read_b128 v[180:183], v65 offset:18432
    v_mfma_f32_16x16x32_bf16 v[172:175], v[228:231], v[252:255], v[172:175]
    ds_read_b128 v[184:187], v65 offset:20480
    v_mfma_f32_16x16x32_bf16 v[168:171], v[224:227], v[252:255], v[168:171]
    ds_read_b128 v[188:191], v65 offset:22528
    v_mfma_f32_16x16x32_bf16 v[120:123], v[240:243], v[224:227], v[120:123]
    v_mfma_f32_16x16x32_bf16 v[136:139], v[240:243], v[228:231], v[136:139]
    v_mfma_f32_16x16x32_bf16 v[140:143], v[244:247], v[228:231], v[140:143]
    v_mfma_f32_16x16x32_bf16 v[124:127], v[244:247], v[224:227], v[124:127]
    v_mfma_f32_16x16x32_bf16 v[112:115], v[232:235], v[224:227], v[112:115]
    v_mfma_f32_16x16x32_bf16 v[128:131], v[232:235], v[228:231], v[128:131]
    v_mfma_f32_16x16x32_bf16 v[132:135], v[236:239], v[228:231], v[132:135]
    v_mfma_f32_16x16x32_bf16 v[116:119], v[236:239], v[224:227], v[116:119]
    s_waitcnt lgkmcnt(0)
    s_barrier
GYB6:
    v_mfma_f32_16x16x32_bf16 v[80:83], v[192:195], v[176:179], v[80:83]
    ds_read_b128 v[216:219], v64 offset:0
    v_mfma_f32_16x16x32_bf16 v[96:99], v[192:195], v[180:183], v[96:99]
    ds_read_b64_tr_b16 v[232:233], v66 offset:16384
    v_mfma_f32_16x16x32_bf16 v[100:103], v[196:199], v[180:183], v[100:103]
    ds_read_b64_tr_b16 v[234:235], v66 offset:16896
    v_mfma_f32_16x16x32_bf16 v[84:87], v[196:199], v[176:179], v[84:87]
    ds_read_b64_tr_b16 v[236:237], v67 offset:16384
    v_mfma_f32_16x16x32_bf16 v[88:91], v[200:203], v[176:179], v[88:91]
    ds_read_b64_tr_b16 v[238:239], v67 offset:16896
    v_mfma_f32_16x16x32_bf16 v[104:107], v[200:203], v[180:183], v[104:107]
    ds_read_b64_tr_b16 v[240:241], v66 offset:24576
    v_mfma_f32_16x16x32_bf16 v[108:111], v[204:207], v[180:183], v[108:111]
    ds_read_b64_tr_b16 v[242:243], v66 offset:25088
    v_mfma_f32_16x16x32_bf16 v[92:95], v[204:207], v[176:179], v[92:95]
    ds_read_b64_tr_b16 v[244:245], v67 offset:24576
    v_mfma_f32_16x16x32_bf16 v[144:147], v[176:179], v[208:211], v[144:147]
    ds_read_b64_tr_b16 v[246:247], v67 offset:25088
    v_mfma_f32_16x16x32_bf16 v[148:151], v[180:183], v[208:211], v[148:151]
    ds_read_b64_tr_b16 v[248:249], v66 offset:32768
    v_mfma_f32_16x16x32_bf16 v[156:159], v[180:183], v[212:215], v[156:159]
    ds_read_b64_tr_b16 v[250:251], v66 offset:33280
    v_mfma_f32_16x16x32_bf16 v[152:155], v[176:179], v[212:215], v[152:155]
    ds_read_b64_tr_b16 v[252:253], v67 offset:32768
    v_mfma_f32_16x16x32_bf16 v[160:163], v[184:187], v[208:211], v[160:163]
    ds_read_b64_tr_b16 v[254:255], v67 offset:33280
    v_mfma_f32_16x16x32_bf16 v[164:167], v[188:191], v[208:211], v[164:167]
    ds_read_b128 v[220:223], v64 offset:2048
    v_mfma_f32_16x16x32_bf16 v[172:175], v[188:191], v[212:215], v[172:175]
    ds_read_b128 v[224:227], v64 offset:4096
    v_mfma_f32_16x16x32_bf16 v[168:171], v[184:187], v[212:215], v[168:171]
    ds_read_b128 v[228:231], v64 offset:6144
    v_mfma_f32_16x16x32_bf16 v[120:123], v[200:203], v[184:187], v[120:123]
    v_mfma_f32_16x16x32_bf16 v[136:139], v[200:203], v[188:191], v[136:139]
    v_mfma_f32_16x16x32_bf16 v[140:143], v[204:207], v[188:191], v[140:143]
    v_mfma_f32_16x16x32_bf16 v[124:127], v[204:207], v[184:187], v[124:127]
    v_mfma_f32_16x16x32_bf16 v[112:115], v[192:195], v[184:187], v[112:115]
    v_mfma_f32_16x16x32_bf16 v[128:131], v[192:195], v[188:191], v[128:131]
    v_mfma_f32_16x16x32_bf16 v[132:135], v[196:199], v[188:191], v[132:135]
    v_mfma_f32_16x16x32_bf16 v[116:119], v[196:199], v[184:187], v[116:119]
    s_waitcnt lgkmcnt(0)
    v_mfma_f32_16x16x32_bf16 v[80:83], v[232:235], v[216:219], v[80:83]
    ds_read_b128 v[176:179], v65 offset:0
    v_mfma_f32_16x16x32_bf16 v[96:99], v[232:235], v[220:223], v[96:99]
    ds_read_b64_tr_b16 v[192:193], v66 offset:20480
    v_mfma_f32_16x16x32_bf16 v[100:103], v[236:239], v[220:223], v[100:103]
    ds_read_b64_tr_b16 v[194:195], v66 offset:20992
    v_mfma_f32_16x16x32_bf16 v[84:87], v[236:239], v[216:219], v[84:87]
    ds_read_b64_tr_b16 v[196:197], v67 offset:20480
    v_mfma_f32_16x16x32_bf16 v[88:91], v[240:243], v[216:219], v[88:91]
    ds_read_b64_tr_b16 v[198:199], v67 offset:20992
    v_mfma_f32_16x16x32_bf16 v[104:107], v[240:243], v[220:223], v[104:107]
    ds_read_b64_tr_b16 v[200:201], v66 offset:28672
    v_mfma_f32_16x16x32_bf16 v[108:111], v[244:247], v[220:223], v[108:111]
    ds_read_b64_tr_b16 v[202:203], v66 offset:29184
    v_mfma_f32_16x16x32_bf16 v[92:95], v[244:247], v[216:219], v[92:95]
    ds_read_b64_tr_b16 v[204:205], v67 offset:28672
    v_mfma_f32_16x16x32_bf16 v[144:147], v[216:219], v[248:251], v[144:147]
    ds_read_b64_tr_b16 v[206:207], v67 offset:29184
    v_mfma_f32_16x16x32_bf16 v[148:151], v[220:223], v[248:251], v[148:151]
    ds_read_b64_tr_b16 v[208:209], v66 offset:36864
    v_mfma_f32_16x16x32_bf16 v[156:159], v[220:223], v[252:255], v[156:159]
    ds_read_b64_tr_b16 v[210:211], v66 offset:37376
    v_mfma_f32_16x16x32_bf16 v[152:155], v[216:219], v[252:255], v[152:155]
    ds_read_b64_tr_b16 v[212:213], v67 offset:36864
    v_mfma_f32_16x16x32_bf16 v[160:163], v[224:227], v[248:251], v[160:163]
    ds_read_b64_tr_b16 v[214:215], v67 offset:37376
    v_mfma_f32_16x16x32_bf16 v[164:167], v[228:231], v[248:251], v[164:167]
    ds_read_b128 v[180:183], v65 offset:2048
    v_mfma_f32_16x16x32_bf16 v[172:175], v[228:231], v[252:255], v[172:175]
    ds_read_b128 v[184:187], v65 offset:4096
    v_mfma_f32_16x16x32_bf16 v[168:171], v[224:227], v[252:255], v[168:171]
    ds_read_b128 v[188:191], v65 offset:6144
    v_mfma_f32_16x16x32_bf16 v[120:123], v[240:243], v[224:227], v[120:123]
    v_mfma_f32_16x16x32_bf16 v[136:139], v[240:243], v[228:231], v[136:139]
    v_mfma_f32_16x16x32_bf16 v[140:143], v[244:247], v[228:231], v[140:143]
    v_mfma_f32_16x16x32_bf16 v[124:127], v[244:247], v[224:227], v[124:127]
    v_mfma_f32_16x16x32_bf16 v[112:115], v[232:235], v[224:227], v[112:115]
    v_mfma_f32_16x16x32_bf16 v[128:131], v[232:235], v[228:231], v[128:131]
    v_mfma_f32_16x16x32_bf16 v[132:135], v[236:239], v[228:231], v[132:135]
    v_mfma_f32_16x16x32_bf16 v[116:119], v[236:239], v[224:227], v[116:119]
    s_waitcnt lgkmcnt(0)
    s_barrier
GYB7:
    v_mfma_f32_16x16x32_bf16 v[80:83], v[192:195], v[176:179], v[80:83]
    ds_read_b128 v[216:219], v64 offset:8192
    v_mfma_f32_16x16x32_bf16 v[96:99], v[192:195], v[180:183], v[96:99]
    ds_read_b64_tr_b16 v[232:233], v66 offset:40960
    v_mfma_f32_16x16x32_bf16 v[100:103], v[196:199], v[180:183], v[100:103]
    ds_read_b64_tr_b16 v[234:235], v66 offset:41472
    v_mfma_f32_16x16x32_bf16 v[84:87], v[196:199], v[176:179], v[84:87]
    ds_read_b64_tr_b16 v[236:237], v67 offset:40960
    v_mfma_f32_16x16x32_bf16 v[88:91], v[200:203], v[176:179], v[88:91]
    ds_read_b64_tr_b16 v[238:239], v67 offset:41472
    v_mfma_f32_16x16x32_bf16 v[104:107], v[200:203], v[180:183], v[104:107]
    ds_read_b64_tr_b16 v[240:241], v66 offset:49152
    v_mfma_f32_16x16x32_bf16 v[108:111], v[204:207], v[180:183], v[108:111]
    ds_read_b64_tr_b16 v[242:243], v66 offset:49664
    v_mfma_f32_16x16x32_bf16 v[92:95], v[204:207], v[176:179], v[92:95]
    ds_read_b64_tr_b16 v[244:245], v67 offset:49152
    v_mfma_f32_16x16x32_bf16 v[144:147], v[176:179], v[208:211], v[144:147]
    ds_read_b64_tr_b16 v[246:247], v67 offset:49664
    v_mfma_f32_16x16x32_bf16 v[148:151], v[180:183], v[208:211], v[148:151]
    ds_read_b64_tr_b16 v[248:249], v66 offset:57344
    v_mfma_f32_16x16x32_bf16 v[156:159], v[180:183], v[212:215], v[156:159]
    ds_read_b64_tr_b16 v[250:251], v66 offset:57856
    v_mfma_f32_16x16x32_bf16 v[152:155], v[176:179], v[212:215], v[152:155]
    ds_read_b64_tr_b16 v[252:253], v67 offset:57344
    v_mfma_f32_16x16x32_bf16 v[160:163], v[184:187], v[208:211], v[160:163]
    ds_read_b64_tr_b16 v[254:255], v67 offset:57856
    v_mfma_f32_16x16x32_bf16 v[164:167], v[188:191], v[208:211], v[164:167]
    ds_read_b128 v[220:223], v64 offset:10240
    v_mfma_f32_16x16x32_bf16 v[172:175], v[188:191], v[212:215], v[172:175]
    ds_read_b128 v[224:227], v64 offset:12288
    v_mfma_f32_16x16x32_bf16 v[168:171], v[184:187], v[212:215], v[168:171]
    ds_read_b128 v[228:231], v64 offset:14336
    v_mfma_f32_16x16x32_bf16 v[120:123], v[200:203], v[184:187], v[120:123]
    v_mfma_f32_16x16x32_bf16 v[136:139], v[200:203], v[188:191], v[136:139]
    v_mfma_f32_16x16x32_bf16 v[140:143], v[204:207], v[188:191], v[140:143]
    v_mfma_f32_16x16x32_bf16 v[124:127], v[204:207], v[184:187], v[124:127]
    v_mfma_f32_16x16x32_bf16 v[112:115], v[192:195], v[184:187], v[112:115]
    v_mfma_f32_16x16x32_bf16 v[128:131], v[192:195], v[188:191], v[128:131]
    v_mfma_f32_16x16x32_bf16 v[132:135], v[196:199], v[188:191], v[132:135]
    v_mfma_f32_16x16x32_bf16 v[116:119], v[196:199], v[184:187], v[116:119]
    s_waitcnt lgkmcnt(0)
    v_mfma_f32_16x16x32_bf16 v[80:83], v[232:235], v[216:219], v[80:83]
    ds_read_b128 v[176:179], v65 offset:8192
    v_mfma_f32_16x16x32_bf16 v[96:99], v[232:235], v[220:223], v[96:99]
    ds_read_b64_tr_b16 v[192:193], v66 offset:45056
    v_mfma_f32_16x16x32_bf16 v[100:103], v[236:239], v[220:223], v[100:103]
    ds_read_b64_tr_b16 v[194:195], v66 offset:45568
    v_mfma_f32_16x16x32_bf16 v[84:87], v[236:239], v[216:219], v[84:87]
    ds_read_b64_tr_b16 v[196:197], v67 offset:45056
    v_mfma_f32_16x16x32_bf16 v[88:91], v[240:243], v[216:219], v[88:91]
    ds_read_b64_tr_b16 v[198:199], v67 offset:45568
    v_mfma_f32_16x16x32_bf16 v[104:107], v[240:243], v[220:223], v[104:107]
    ds_read_b64_tr_b16 v[200:201], v66 offset:53248
    v_mfma_f32_16x16x32_bf16 v[108:111], v[244:247], v[220:223], v[108:111]
    ds_read_b64_tr_b16 v[202:203], v66 offset:53760
    v_mfma_f32_16x16x32_bf16 v[92:95], v[244:247], v[216:219], v[92:95]
    ds_read_b64_tr_b16 v[204:205], v67 offset:53248
    v_mfma_f32_16x16x32_bf16 v[144:147], v[216:219], v[248:251], v[144:147]
    ds_read_b64_tr_b16 v[206:207], v67 offset:53760
    v_mfma_f32_16x16x32_bf16 v[148:151], v[220:223], v[248:251], v[148:151]
    ds_read_b64_tr_b16 v[208:209], v66 offset:61440
    v_mfma_f32_16x16x32_bf16 v[156:159], v[220:223], v[252:255], v[156:159]
    ds_read_b64_tr_b16 v[210:211], v66 offset:61952
    v_mfma_f32_16x16x32_bf16 v[152:155], v[216:219], v[252:255], v[152:155]
    ds_read_b64_tr_b16 v[212:213], v67 offset:61440
    v_mfma_f32_16x16x32_bf16 v[160:163], v[224:227], v[248:251], v[160:163]
    ds_read_b64_tr_b16 v[214:215], v67 offset:61952
    v_mfma_f32_16x16x32_bf16 v[164:167], v[228:231], v[248:251], v[164:167]
    ds_read_b128 v[180:183], v65 offset:10240
    v_mfma_f32_16x16x32_bf16 v[172:175], v[228:231], v[252:255], v[172:175]
    ds_read_b128 v[184:187], v65 offset:12288
    v_mfma_f32_16x16x32_bf16 v[168:171], v[224:227], v[252:255], v[168:171]
    ds_read_b128 v[188:191], v65 offset:14336
    v_mfma_f32_16x16x32_bf16 v[120:123], v[240:243], v[224:227], v[120:123]
    v_mfma_f32_16x16x32_bf16 v[136:139], v[240:243], v[228:231], v[136:139]
    v_mfma_f32_16x16x32_bf16 v[140:143], v[244:247], v[228:231], v[140:143]
    v_mfma_f32_16x16x32_bf16 v[124:127], v[244:247], v[224:227], v[124:127]
    v_mfma_f32_16x16x32_bf16 v[112:115], v[232:235], v[224:227], v[112:115]
    v_mfma_f32_16x16x32_bf16 v[128:131], v[232:235], v[228:231], v[128:131]
    v_mfma_f32_16x16x32_bf16 v[132:135], v[236:239], v[228:231], v[132:135]
    v_mfma_f32_16x16x32_bf16 v[116:119], v[236:239], v[224:227], v[116:119]
    s_waitcnt lgkmcnt(0)
    s_barrier
    s_branch GYB8
.p2align 12
GYB8:
    v_mfma_f32_16x16x32_bf16 v[80:83], v[192:195], v[176:179], v[80:83]
    ds_read_b128 v[216:219], v64 offset:16384
    v_mfma_f32_16x16x32_bf16 v[96:99], v[192:195], v[180:183], v[96:99]
    ds_read_b64_tr_b16 v[232:233], v66 offset:0
    v_mfma_f32_16x16x32_bf16 v[100:103], v[196:199], v[180:183], v[100:103]
    ds_read_b64_tr_b16 v[234:235], v66 offset:512
    v_mfma_f32_16x16x32_bf16 v[84:87], v[196:199], v[176:179], v[84:87]
    ds_read_b64_tr_b16 v[236:237], v67 offset:0
    v_mfma_f32_16x16x32_bf16 v[88:91], v[200:203], v[176:179], v[88:91]
    ds_read_b64_tr_b16 v[238:239], v67 offset:512
    v_mfma_f32_16x16x32_bf16 v[104:107], v[200:203], v[180:183], v[104:107]
    ds_read_b64_tr_b16 v[240:241], v66 offset:8192
    v_mfma_f32_16x16x32_bf16 v[108:111], v[204:207], v[180:183], v[108:111]
    ds_read_b64_tr_b16 v[242:243], v66 offset:8704
    v_mfma_f32_16x16x32_bf16 v[92:95], v[204:207], v[176:179], v[92:95]
    ds_read_b64_tr_b16 v[244:245], v67 offset:8192
    v_mfma_f32_16x16x32_bf16 v[144:147], v[176:179], v[208:211], v[144:147]
    ds_read_b64_tr_b16 v[246:247], v67 offset:8704
    v_mfma_f32_16x16x32_bf16 v[148:151], v[180:183], v[208:211], v[148:151]
    ds_read_b64_tr_b16 v[248:249], v66 offset:16384
    v_mfma_f32_16x16x32_bf16 v[156:159], v[180:183], v[212:215], v[156:159]
    ds_read_b64_tr_b16 v[250:251], v66 offset:16896
    v_mfma_f32_16x16x32_bf16 v[152:155], v[176:179], v[212:215], v[152:155]
    ds_read_b64_tr_b16 v[252:253], v67 offset:16384
    v_mfma_f32_16x16x32_bf16 v[160:163], v[184:187], v[208:211], v[160:163]
    ds_read_b64_tr_b16 v[254:255], v67 offset:16896
    v_mfma_f32_16x16x32_bf16 v[164:167], v[188:191], v[208:211], v[164:167]
    ds_read_b128 v[220:223], v64 offset:18432
    v_mfma_f32_16x16x32_bf16 v[172:175], v[188:191], v[212:215], v[172:175]
    ds_read_b128 v[224:227], v64 offset:20480
    v_mfma_f32_16x16x32_bf16 v[168:171], v[184:187], v[212:215], v[168:171]
    ds_read_b128 v[228:231], v64 offset:22528
    v_mfma_f32_16x16x32_bf16 v[120:123], v[200:203], v[184:187], v[120:123]
    v_mfma_f32_16x16x32_bf16 v[136:139], v[200:203], v[188:191], v[136:139]
    v_mfma_f32_16x16x32_bf16 v[140:143], v[204:207], v[188:191], v[140:143]
    v_mfma_f32_16x16x32_bf16 v[124:127], v[204:207], v[184:187], v[124:127]
    v_mfma_f32_16x16x32_bf16 v[112:115], v[192:195], v[184:187], v[112:115]
    v_mfma_f32_16x16x32_bf16 v[128:131], v[192:195], v[188:191], v[128:131]
    v_mfma_f32_16x16x32_bf16 v[132:135], v[196:199], v[188:191], v[132:135]
    v_mfma_f32_16x16x32_bf16 v[116:119], v[196:199], v[184:187], v[116:119]
    s_waitcnt lgkmcnt(0)
    v_mfma_f32_16x16x32_bf16 v[80:83], v[232:235], v[216:219], v[80:83]
    ds_read_b128 v[176:179], v65 offset:16384
    v_mfma_f32_16x16x32_bf16 v[96:99], v[232:235], v[220:223], v[96:99]
    ds_read_b64_tr_b16 v[192:193], v66 offset:4096
    v_mfma_f32_16x16x32_bf16 v[100:103], v[236:239], v[220:223], v[100:103]
    ds_read_b64_tr_b16 v[194:195], v66 offset:4608
    v_mfma_f32_16x16x32_bf16 v[84:87], v[236:239], v[216:219], v[84:87]
    ds_read_b64_tr_b16 v[196:197], v67 offset:4096
    v_mfma_f32_16x16x32_bf16 v[88:91], v[240:243], v[216:219], v[88:91]
    ds_read_b64_tr_b16 v[198:199], v67 offset:4608
    v_mfma_f32_16x16x32_bf16 v[104:107], v[240:243], v[220:223], v[104:107]
    ds_read_b64_tr_b16 v[200:201], v66 offset:12288
    v_mfma_f32_16x16x32_bf16 v[108:111], v[244:247], v[220:223], v[108:111]
    ds_read_b64_tr_b16 v[202:203], v66 offset:12800
    v_mfma_f32_16x16x32_bf16 v[92:95], v[244:247], v[216:219], v[92:95]
    ds_read_b64_tr_b16 v[204:205], v67 offset:12288
    v_mfma_f32_16x16x32_bf16 v[144:147], v[216:219], v[248:251], v[144:147]
    ds_read_b64_tr_b16 v[206:207], v67 offset:12800
    v_mfma_f32_16x16x32_bf16 v[148:151], v[220:223], v[248:251], v[148:151]
    ds_read_b64_tr_b16 v[208:209], v66 offset:20480
    v_mfma_f32_16x16x32_bf16 v[156:159], v[220:223], v[252:255], v[156:159]
    ds_read_b64_tr_b16 v[210:211], v66 offset:20992
    v_mfma_f32_16x16x32_bf16 v[152:155], v[216:219], v[252:255], v[152:155]
    ds_read_b64_tr_b16 v[212:213], v67 offset:20480
    v_mfma_f32_16x16x32_bf16 v[160:163], v[224:227], v[248:251], v[160:163]
    ds_read_b64_tr_b16 v[214:215], v67 offset:20992
    v_mfma_f32_16x16x32_bf16 v[164:167], v[228:231], v[248:251], v[164:167]
    ds_read_b128 v[180:183], v65 offset:18432
    v_mfma_f32_16x16x32_bf16 v[172:175], v[228:231], v[252:255], v[172:175]
    ds_read_b128 v[184:187], v65 offset:20480
    v_mfma_f32_16x16x32_bf16 v[168:171], v[224:227], v[252:255], v[168:171]
    ds_read_b128 v[188:191], v65 offset:22528
    v_mfma_f32_16x16x32_bf16 v[120:123], v[240:243], v[224:227], v[120:123]
    v_mfma_f32_16x16x32_bf16 v[136:139], v[240:243], v[228:231], v[136:139]
    v_mfma_f32_16x16x32_bf16 v[140:143], v[244:247], v[228:231], v[140:143]
    s_mov_b32 s31, 4718592
    buffer_load_dword v27, v72, s[12:15], s31 offen
    v_mfma_f32_16x16x32_bf16 v[124:127], v[244:247], v[224:227], v[124:127]
    v_mfma_f32_16x16x32_bf16 v[112:115], v[232:235], v[224:227], v[112:115]
    v_mfma_f32_16x16x32_bf16 v[128:131], v[232:235], v[228:231], v[128:131]
    v_mfma_f32_16x16x32_bf16 v[132:135], v[236:239], v[228:231], v[132:135]
    v_mfma_f32_16x16x32_bf16 v[116:119], v[236:239], v[224:227], v[116:119]
    s_waitcnt lgkmcnt(0)
    s_barrier
GYB9:
    v_mfma_f32_16x16x32_bf16 v[80:83], v[192:195], v[176:179], v[80:83]
    ds_read_b128 v[216:219], v64 offset:0
    v_mfma_f32_16x16x32_bf16 v[96:99], v[192:195], v[180:183], v[96:99]
    ds_read_b64_tr_b16 v[232:233], v66 offset:24576
    v_mfma_f32_16x16x32_bf16 v[100:103], v[196:199], v[180:183], v[100:103]
    ds_read_b64_tr_b16 v[234:235], v66 offset:25088
    v_mfma_f32_16x16x32_bf16 v[84:87], v[196:199], v[176:179], v[84:87]
    ds_read_b64_tr_b16 v[236:237], v67 offset:24576
    v_mfma_f32_16x16x32_bf16 v[88:91], v[200:203], v[176:179], v[88:91]
    ds_read_b64_tr_b16 v[238:239], v67 offset:25088
    v_mfma_f32_16x16x32_bf16 v[104:107], v[200:203], v[180:183], v[104:107]
    ds_read_b64_tr_b16 v[240:241], v66 offset:32768
    v_mfma_f32_16x16x32_bf16 v[108:111], v[204:207], v[180:183], v[108:111]
    ds_read_b64_tr_b16 v[242:243], v66 offset:33280
    v_mfma_f32_16x16x32_bf16 v[92:95], v[204:207], v[176:179], v[92:95]
    ds_read_b64_tr_b16 v[244:245], v67 offset:32768
    v_mfma_f32_16x16x32_bf16 v[144:147], v[176:179], v[208:211], v[144:147]
    ds_read_b64_tr_b16 v[246:247], v67 offset:33280
    v_mfma_f32_16x16x32_bf16 v[148:151], v[180:183], v[208:211], v[148:151]
    ds_read_b64_tr_b16 v[248:249], v66 offset:40960
    v_mfma_f32_16x16x32_bf16 v[156:159], v[180:183], v[212:215], v[156:159]
    ds_read_b64_tr_b16 v[250:251], v66 offset:41472
    v_mfma_f32_16x16x32_bf16 v[152:155], v[176:179], v[212:215], v[152:155]
    ds_read_b64_tr_b16 v[252:253], v67 offset:40960
    v_mfma_f32_16x16x32_bf16 v[160:163], v[184:187], v[208:211], v[160:163]
    ds_read_b64_tr_b16 v[254:255], v67 offset:41472
    v_mfma_f32_16x16x32_bf16 v[164:167], v[188:191], v[208:211], v[164:167]
    ds_read_b128 v[220:223], v64 offset:2048
    v_mfma_f32_16x16x32_bf16 v[172:175], v[188:191], v[212:215], v[172:175]
    ds_read_b128 v[224:227], v64 offset:4096
    v_mfma_f32_16x16x32_bf16 v[168:171], v[184:187], v[212:215], v[168:171]
    ds_read_b128 v[228:231], v64 offset:6144
    v_mfma_f32_16x16x32_bf16 v[120:123], v[200:203], v[184:187], v[120:123]
    v_mfma_f32_16x16x32_bf16 v[136:139], v[200:203], v[188:191], v[136:139]
    v_mfma_f32_16x16x32_bf16 v[140:143], v[204:207], v[188:191], v[140:143]
    v_mfma_f32_16x16x32_bf16 v[124:127], v[204:207], v[184:187], v[124:127]
    v_mfma_f32_16x16x32_bf16 v[112:115], v[192:195], v[184:187], v[112:115]
    v_mfma_f32_16x16x32_bf16 v[128:131], v[192:195], v[188:191], v[128:131]
    v_mfma_f32_16x16x32_bf16 v[132:135], v[196:199], v[188:191], v[132:135]
    v_mfma_f32_16x16x32_bf16 v[116:119], v[196:199], v[184:187], v[116:119]
    s_waitcnt lgkmcnt(0)
    v_mfma_f32_16x16x32_bf16 v[80:83], v[232:235], v[216:219], v[80:83]
    ds_read_b128 v[176:179], v65 offset:0
    v_mfma_f32_16x16x32_bf16 v[96:99], v[232:235], v[220:223], v[96:99]
    ds_read_b64_tr_b16 v[192:193], v66 offset:28672
    v_mfma_f32_16x16x32_bf16 v[100:103], v[236:239], v[220:223], v[100:103]
    ds_read_b64_tr_b16 v[194:195], v66 offset:29184
    v_mfma_f32_16x16x32_bf16 v[84:87], v[236:239], v[216:219], v[84:87]
    ds_read_b64_tr_b16 v[196:197], v67 offset:28672
    v_mfma_f32_16x16x32_bf16 v[88:91], v[240:243], v[216:219], v[88:91]
    ds_read_b64_tr_b16 v[198:199], v67 offset:29184
    v_mfma_f32_16x16x32_bf16 v[104:107], v[240:243], v[220:223], v[104:107]
    ds_read_b64_tr_b16 v[200:201], v66 offset:36864
    v_mfma_f32_16x16x32_bf16 v[108:111], v[244:247], v[220:223], v[108:111]
    ds_read_b64_tr_b16 v[202:203], v66 offset:37376
    v_mfma_f32_16x16x32_bf16 v[92:95], v[244:247], v[216:219], v[92:95]
    ds_read_b64_tr_b16 v[204:205], v67 offset:36864
    v_mfma_f32_16x16x32_bf16 v[144:147], v[216:219], v[248:251], v[144:147]
    ds_read_b64_tr_b16 v[206:207], v67 offset:37376
    v_mfma_f32_16x16x32_bf16 v[148:151], v[220:223], v[248:251], v[148:151]
    ds_read_b64_tr_b16 v[208:209], v66 offset:45056
    v_mfma_f32_16x16x32_bf16 v[156:159], v[220:223], v[252:255], v[156:159]
    ds_read_b64_tr_b16 v[210:211], v66 offset:45568
    v_mfma_f32_16x16x32_bf16 v[152:155], v[216:219], v[252:255], v[152:155]
    ds_read_b64_tr_b16 v[212:213], v67 offset:45056
    v_mfma_f32_16x16x32_bf16 v[160:163], v[224:227], v[248:251], v[160:163]
    ds_read_b64_tr_b16 v[214:215], v67 offset:45568
    v_mfma_f32_16x16x32_bf16 v[164:167], v[228:231], v[248:251], v[164:167]
    ds_read_b128 v[180:183], v65 offset:2048
    v_mfma_f32_16x16x32_bf16 v[172:175], v[228:231], v[252:255], v[172:175]
    ds_read_b128 v[184:187], v65 offset:4096
    v_mfma_f32_16x16x32_bf16 v[168:171], v[224:227], v[252:255], v[168:171]
    ds_read_b128 v[188:191], v65 offset:6144
    v_mfma_f32_16x16x32_bf16 v[120:123], v[240:243], v[224:227], v[120:123]
    v_mfma_f32_16x16x32_bf16 v[136:139], v[240:243], v[228:231], v[136:139]
    v_mfma_f32_16x16x32_bf16 v[140:143], v[244:247], v[228:231], v[140:143]
    v_mfma_f32_16x16x32_bf16 v[124:127], v[244:247], v[224:227], v[124:127]
    v_mfma_f32_16x16x32_bf16 v[112:115], v[232:235], v[224:227], v[112:115]
    v_mfma_f32_16x16x32_bf16 v[128:131], v[232:235], v[228:231], v[128:131]
    v_mfma_f32_16x16x32_bf16 v[132:135], v[236:239], v[228:231], v[132:135]
    v_mfma_f32_16x16x32_bf16 v[116:119], v[236:239], v[224:227], v[116:119]
    s_waitcnt lgkmcnt(0)
    s_barrier
GYB10:
    v_mfma_f32_16x16x32_bf16 v[80:83], v[192:195], v[176:179], v[80:83]
    ds_read_b128 v[216:219], v64 offset:8192
    v_mfma_f32_16x16x32_bf16 v[96:99], v[192:195], v[180:183], v[96:99]
    ds_read_b64_tr_b16 v[232:233], v66 offset:49152
    v_mfma_f32_16x16x32_bf16 v[100:103], v[196:199], v[180:183], v[100:103]
    ds_read_b64_tr_b16 v[234:235], v66 offset:49664
    v_mfma_f32_16x16x32_bf16 v[84:87], v[196:199], v[176:179], v[84:87]
    ds_read_b64_tr_b16 v[236:237], v67 offset:49152
    v_mfma_f32_16x16x32_bf16 v[88:91], v[200:203], v[176:179], v[88:91]
    ds_read_b64_tr_b16 v[238:239], v67 offset:49664
    v_mfma_f32_16x16x32_bf16 v[104:107], v[200:203], v[180:183], v[104:107]
    ds_read_b64_tr_b16 v[240:241], v66 offset:57344
    v_mfma_f32_16x16x32_bf16 v[108:111], v[204:207], v[180:183], v[108:111]
    ds_read_b64_tr_b16 v[242:243], v66 offset:57856
    v_mfma_f32_16x16x32_bf16 v[92:95], v[204:207], v[176:179], v[92:95]
    ds_read_b64_tr_b16 v[244:245], v67 offset:57344
    v_mfma_f32_16x16x32_bf16 v[144:147], v[176:179], v[208:211], v[144:147]
    ds_read_b64_tr_b16 v[246:247], v67 offset:57856
    v_mfma_f32_16x16x32_bf16 v[148:151], v[180:183], v[208:211], v[148:151]
    ds_read_b64_tr_b16 v[248:249], v66 offset:0
    v_mfma_f32_16x16x32_bf16 v[156:159], v[180:183], v[212:215], v[156:159]
    ds_read_b64_tr_b16 v[250:251], v66 offset:512
    v_mfma_f32_16x16x32_bf16 v[152:155], v[176:179], v[212:215], v[152:155]
    ds_read_b64_tr_b16 v[252:253], v67 offset:0
    v_mfma_f32_16x16x32_bf16 v[160:163], v[184:187], v[208:211], v[160:163]
    ds_read_b64_tr_b16 v[254:255], v67 offset:512
    v_mfma_f32_16x16x32_bf16 v[164:167], v[188:191], v[208:211], v[164:167]
    ds_read_b128 v[220:223], v64 offset:10240
    v_mfma_f32_16x16x32_bf16 v[172:175], v[188:191], v[212:215], v[172:175]
    ds_read_b128 v[224:227], v64 offset:12288
    v_mfma_f32_16x16x32_bf16 v[168:171], v[184:187], v[212:215], v[168:171]
    ds_read_b128 v[228:231], v64 offset:14336
    v_mfma_f32_16x16x32_bf16 v[120:123], v[200:203], v[184:187], v[120:123]
    v_mfma_f32_16x16x32_bf16 v[136:139], v[200:203], v[188:191], v[136:139]
    v_mfma_f32_16x16x32_bf16 v[140:143], v[204:207], v[188:191], v[140:143]
    v_mfma_f32_16x16x32_bf16 v[124:127], v[204:207], v[184:187], v[124:127]
    v_mfma_f32_16x16x32_bf16 v[112:115], v[192:195], v[184:187], v[112:115]
    v_mfma_f32_16x16x32_bf16 v[128:131], v[192:195], v[188:191], v[128:131]
    v_mfma_f32_16x16x32_bf16 v[132:135], v[196:199], v[188:191], v[132:135]
    v_mfma_f32_16x16x32_bf16 v[116:119], v[196:199], v[184:187], v[116:119]
    s_waitcnt lgkmcnt(0)
    v_mfma_f32_16x16x32_bf16 v[80:83], v[232:235], v[216:219], v[80:83]
    ds_read_b128 v[176:179], v65 offset:8192
    v_mfma_f32_16x16x32_bf16 v[96:99], v[232:235], v[220:223], v[96:99]
    ds_read_b64_tr_b16 v[192:193], v66 offset:53248
    v_mfma_f32_16x16x32_bf16 v[100:103], v[236:239], v[220:223], v[100:103]
    ds_read_b64_tr_b16 v[194:195], v66 offset:53760
    v_mfma_f32_16x16x32_bf16 v[84:87], v[236:239], v[216:219], v[84:87]
    ds_read_b64_tr_b16 v[196:197], v67 offset:53248
    v_mfma_f32_16x16x32_bf16 v[88:91], v[240:243], v[216:219], v[88:91]
    ds_read_b64_tr_b16 v[198:199], v67 offset:53760
    v_mfma_f32_16x16x32_bf16 v[104:107], v[240:243], v[220:223], v[104:107]
    ds_read_b64_tr_b16 v[200:201], v66 offset:61440
    v_mfma_f32_16x16x32_bf16 v[108:111], v[244:247], v[220:223], v[108:111]
    ds_read_b64_tr_b16 v[202:203], v66 offset:61952
    v_mfma_f32_16x16x32_bf16 v[92:95], v[244:247], v[216:219], v[92:95]
    ds_read_b64_tr_b16 v[204:205], v67 offset:61440
    v_mfma_f32_16x16x32_bf16 v[144:147], v[216:219], v[248:251], v[144:147]
    ds_read_b64_tr_b16 v[206:207], v67 offset:61952
    v_mfma_f32_16x16x32_bf16 v[148:151], v[220:223], v[248:251], v[148:151]
    ds_read_b64_tr_b16 v[208:209], v66 offset:4096
    v_mfma_f32_16x16x32_bf16 v[156:159], v[220:223], v[252:255], v[156:159]
    ds_read_b64_tr_b16 v[210:211], v66 offset:4608
    v_mfma_f32_16x16x32_bf16 v[152:155], v[216:219], v[252:255], v[152:155]
    ds_read_b64_tr_b16 v[212:213], v67 offset:4096
    v_mfma_f32_16x16x32_bf16 v[160:163], v[224:227], v[248:251], v[160:163]
    ds_read_b64_tr_b16 v[214:215], v67 offset:4608
    v_mfma_f32_16x16x32_bf16 v[164:167], v[228:231], v[248:251], v[164:167]
    ds_read_b128 v[180:183], v65 offset:10240
    v_mfma_f32_16x16x32_bf16 v[172:175], v[228:231], v[252:255], v[172:175]
    ds_read_b128 v[184:187], v65 offset:12288
    v_mfma_f32_16x16x32_bf16 v[168:171], v[224:227], v[252:255], v[168:171]
    ds_read_b128 v[188:191], v65 offset:14336
    v_mfma_f32_16x16x32_bf16 v[120:123], v[240:243], v[224:227], v[120:123]
    v_mfma_f32_16x16x32_bf16 v[136:139], v[240:243], v[228:231], v[136:139]
    v_mfma_f32_16x16x32_bf16 v[140:143], v[244:247], v[228:231], v[140:143]
    v_mfma_f32_16x16x32_bf16 v[124:127], v[244:247], v[224:227], v[124:127]
    v_mfma_f32_16x16x32_bf16 v[112:115], v[232:235], v[224:227], v[112:115]
    v_mfma_f32_16x16x32_bf16 v[128:131], v[232:235], v[228:231], v[128:131]
    global_load_dwordx2 v[6:7], v26, s[6:7] sc1
    v_mfma_f32_16x16x32_bf16 v[132:135], v[236:239], v[228:231], v[132:135]
    v_mfma_f32_16x16x32_bf16 v[116:119], v[236:239], v[224:227], v[116:119]
    s_waitcnt lgkmcnt(0)
    s_barrier
GYB11:
    v_mfma_f32_16x16x32_bf16 v[80:83], v[192:195], v[176:179], v[80:83]
    ds_read_b128 v[216:219], v64 offset:16384
    v_mfma_f32_16x16x32_bf16 v[96:99], v[192:195], v[180:183], v[96:99]
    ds_read_b64_tr_b16 v[232:233], v66 offset:8192
    v_mfma_f32_16x16x32_bf16 v[100:103], v[196:199], v[180:183], v[100:103]
    ds_read_b64_tr_b16 v[234:235], v66 offset:8704
    v_mfma_f32_16x16x32_bf16 v[84:87], v[196:199], v[176:179], v[84:87]
    ds_read_b64_tr_b16 v[236:237], v67 offset:8192
    v_mfma_f32_16x16x32_bf16 v[88:91], v[200:203], v[176:179], v[88:91]
    ds_read_b64_tr_b16 v[238:239], v67 offset:8704
    v_mfma_f32_16x16x32_bf16 v[104:107], v[200:203], v[180:183], v[104:107]
    ds_read_b64_tr_b16 v[240:241], v66 offset:16384
    v_mfma_f32_16x16x32_bf16 v[108:111], v[204:207], v[180:183], v[108:111]
    ds_read_b64_tr_b16 v[242:243], v66 offset:16896
    v_mfma_f32_16x16x32_bf16 v[92:95], v[204:207], v[176:179], v[92:95]
    ds_read_b64_tr_b16 v[244:245], v67 offset:16384
    v_mfma_f32_16x16x32_bf16 v[144:147], v[176:179], v[208:211], v[144:147]
    ds_read_b64_tr_b16 v[246:247], v67 offset:16896
    v_mfma_f32_16x16x32_bf16 v[148:151], v[180:183], v[208:211], v[148:151]
    ds_read_b64_tr_b16 v[248:249], v66 offset:24576
    v_mfma_f32_16x16x32_bf16 v[156:159], v[180:183], v[212:215], v[156:159]
    ds_read_b64_tr_b16 v[250:251], v66 offset:25088
    v_mfma_f32_16x16x32_bf16 v[152:155], v[176:179], v[212:215], v[152:155]
    ds_read_b64_tr_b16 v[252:253], v67 offset:24576
    v_mfma_f32_16x16x32_bf16 v[160:163], v[184:187], v[208:211], v[160:163]
    ds_read_b64_tr_b16 v[254:255], v67 offset:25088
    v_mfma_f32_16x16x32_bf16 v[164:167], v[188:191], v[208:211], v[164:167]
    ds_read_b128 v[220:223], v64 offset:18432
    v_mfma_f32_16x16x32_bf16 v[172:175], v[188:191], v[212:215], v[172:175]
    ds_read_b128 v[224:227], v64 offset:20480
    v_mfma_f32_16x16x32_bf16 v[168:171], v[184:187], v[212:215], v[168:171]
    ds_read_b128 v[228:231], v64 offset:22528
    v_mfma_f32_16x16x32_bf16 v[120:123], v[200:203], v[184:187], v[120:123]
    v_mfma_f32_16x16x32_bf16 v[136:139], v[200:203], v[188:191], v[136:139]
    v_mfma_f32_16x16x32_bf16 v[140:143], v[204:207], v[188:191], v[140:143]
    v_mfma_f32_16x16x32_bf16 v[124:127], v[204:207], v[184:187], v[124:127]
    v_mfma_f32_16x16x32_bf16 v[112:115], v[192:195], v[184:187], v[112:115]
    v_mfma_f32_16x16x32_bf16 v[128:131], v[192:195], v[188:191], v[128:131]
    v_mfma_f32_16x16x32_bf16 v[132:135], v[196:199], v[188:191], v[132:135]
    v_mfma_f32_16x16x32_bf16 v[116:119], v[196:199], v[184:187], v[116:119]
    s_waitcnt lgkmcnt(0)
    v_mfma_f32_16x16x32_bf16 v[80:83], v[232:235], v[216:219], v[80:83]
    ds_read_b128 v[176:179], v65 offset:16384
    v_mfma_f32_16x16x32_bf16 v[96:99], v[232:235], v[220:223], v[96:99]
    ds_read_b64_tr_b16 v[192:193], v66 offset:12288
    v_mfma_f32_16x16x32_bf16 v[100:103], v[236:239], v[220:223], v[100:103]
    ds_read_b64_tr_b16 v[194:195], v66 offset:12800
    v_mfma_f32_16x16x32_bf16 v[84:87], v[236:239], v[216:219], v[84:87]
    ds_read_b64_tr_b16 v[196:197], v67 offset:12288
    v_mfma_f32_16x16x32_bf16 v[88:91], v[240:243], v[216:219], v[88:91]
    ds_read_b64_tr_b16 v[198:199], v67 offset:12800
    v_mfma_f32_16x16x32_bf16 v[104:107], v[240:243], v[220:223], v[104:107]
    ds_read_b64_tr_b16 v[200:201], v66 offset:20480
    v_mfma_f32_16x16x32_bf16 v[108:111], v[244:247], v[220:223], v[108:111]
    ds_read_b64_tr_b16 v[202:203], v66 offset:20992
    v_mfma_f32_16x16x32_bf16 v[92:95], v[244:247], v[216:219], v[92:95]
    ds_read_b64_tr_b16 v[204:205], v67 offset:20480
    v_mfma_f32_16x16x32_bf16 v[144:147], v[216:219], v[248:251], v[144:147]
    ds_read_b64_tr_b16 v[206:207], v67 offset:20992
    v_mfma_f32_16x16x32_bf16 v[148:151], v[220:223], v[248:251], v[148:151]
    ds_read_b64_tr_b16 v[208:209], v66 offset:28672
    v_mfma_f32_16x16x32_bf16 v[156:159], v[220:223], v[252:255], v[156:159]
    ds_read_b64_tr_b16 v[210:211], v66 offset:29184
    v_mfma_f32_16x16x32_bf16 v[152:155], v[216:219], v[252:255], v[152:155]
    ds_read_b64_tr_b16 v[212:213], v67 offset:28672
    v_mfma_f32_16x16x32_bf16 v[160:163], v[224:227], v[248:251], v[160:163]
    ds_read_b64_tr_b16 v[214:215], v67 offset:29184
    v_mfma_f32_16x16x32_bf16 v[164:167], v[228:231], v[248:251], v[164:167]
    ds_read_b128 v[180:183], v65 offset:18432
    v_mfma_f32_16x16x32_bf16 v[172:175], v[228:231], v[252:255], v[172:175]
    ds_read_b128 v[184:187], v65 offset:20480
    v_mfma_f32_16x16x32_bf16 v[168:171], v[224:227], v[252:255], v[168:171]
    ds_read_b128 v[188:191], v65 offset:22528
    v_mfma_f32_16x16x32_bf16 v[120:123], v[240:243], v[224:227], v[120:123]
    v_mfma_f32_16x16x32_bf16 v[136:139], v[240:243], v[228:231], v[136:139]
    v_mfma_f32_16x16x32_bf16 v[140:143], v[244:247], v[228:231], v[140:143]
    v_mfma_f32_16x16x32_bf16 v[124:127], v[244:247], v[224:227], v[124:127]
    v_mfma_f32_16x16x32_bf16 v[112:115], v[232:235], v[224:227], v[112:115]
    v_mfma_f32_16x16x32_bf16 v[128:131], v[232:235], v[228:231], v[128:131]
    v_mfma_f32_16x16x32_bf16 v[132:135], v[236:239], v[228:231], v[132:135]
    v_mfma_f32_16x16x32_bf16 v[116:119], v[236:239], v[224:227], v[116:119]
    s_waitcnt lgkmcnt(0)
    s_barrier
GYB12:
    v_mfma_f32_16x16x32_bf16 v[80:83], v[192:195], v[176:179], v[80:83]
    ds_read_b128 v[216:219], v64 offset:0
    v_mfma_f32_16x16x32_bf16 v[96:99], v[192:195], v[180:183], v[96:99]
    ds_read_b64_tr_b16 v[232:233], v66 offset:32768
    v_mfma_f32_16x16x32_bf16 v[100:103], v[196:199], v[180:183], v[100:103]
    ds_read_b64_tr_b16 v[234:235], v66 offset:33280
    v_mfma_f32_16x16x32_bf16 v[84:87], v[196:199], v[176:179], v[84:87]
    ds_read_b64_tr_b16 v[236:237], v67 offset:32768
    v_mfma_f32_16x16x32_bf16 v[88:91], v[200:203], v[176:179], v[88:91]
    ds_read_b64_tr_b16 v[238:239], v67 offset:33280
    v_mfma_f32_16x16x32_bf16 v[104:107], v[200:203], v[180:183], v[104:107]
    ds_read_b64_tr_b16 v[240:241], v66 offset:40960
    v_mfma_f32_16x16x32_bf16 v[108:111], v[204:207], v[180:183], v[108:111]
    ds_read_b64_tr_b16 v[242:243], v66 offset:41472
    v_mfma_f32_16x16x32_bf16 v[92:95], v[204:207], v[176:179], v[92:95]
    ds_read_b64_tr_b16 v[244:245], v67 offset:40960
    v_mfma_f32_16x16x32_bf16 v[144:147], v[176:179], v[208:211], v[144:147]
    ds_read_b64_tr_b16 v[246:247], v67 offset:41472
    v_mfma_f32_16x16x32_bf16 v[148:151], v[180:183], v[208:211], v[148:151]
    ds_read_b64_tr_b16 v[248:249], v66 offset:49152
    v_mfma_f32_16x16x32_bf16 v[156:159], v[180:183], v[212:215], v[156:159]
    ds_read_b64_tr_b16 v[250:251], v66 offset:49664
    v_mfma_f32_16x16x32_bf16 v[152:155], v[176:179], v[212:215], v[152:155]
    ds_read_b64_tr_b16 v[252:253], v67 offset:49152
    v_mfma_f32_16x16x32_bf16 v[160:163], v[184:187], v[208:211], v[160:163]
    ds_read_b64_tr_b16 v[254:255], v67 offset:49664
    v_mfma_f32_16x16x32_bf16 v[164:167], v[188:191], v[208:211], v[164:167]
    ds_read_b128 v[220:223], v64 offset:2048
    v_mfma_f32_16x16x32_bf16 v[172:175], v[188:191], v[212:215], v[172:175]
    ds_read_b128 v[224:227], v64 offset:4096
    v_mfma_f32_16x16x32_bf16 v[168:171], v[184:187], v[212:215], v[168:171]
    ds_read_b128 v[228:231], v64 offset:6144
    v_mfma_f32_16x16x32_bf16 v[120:123], v[200:203], v[184:187], v[120:123]
    v_mfma_f32_16x16x32_bf16 v[136:139], v[200:203], v[188:191], v[136:139]
    v_mfma_f32_16x16x32_bf16 v[140:143], v[204:207], v[188:191], v[140:143]
    v_mfma_f32_16x16x32_bf16 v[124:127], v[204:207], v[184:187], v[124:127]
    v_mfma_f32_16x16x32_bf16 v[112:115], v[192:195], v[184:187], v[112:115]
    v_mfma_f32_16x16x32_bf16 v[128:131], v[192:195], v[188:191], v[128:131]
    v_mfma_f32_16x16x32_bf16 v[132:135], v[196:199], v[188:191], v[132:135]
    v_mfma_f32_16x16x32_bf16 v[116:119], v[196:199], v[184:187], v[116:119]
    s_waitcnt lgkmcnt(0)
    v_mfma_f32_16x16x32_bf16 v[80:83], v[232:235], v[216:219], v[80:83]
    ds_read_b128 v[176:179], v65 offset:0
    v_mfma_f32_16x16x32_bf16 v[96:99], v[232:235], v[220:223], v[96:99]
    ds_read_b64_tr_b16 v[192:193], v66 offset:36864
    v_mfma_f32_16x16x32_bf16 v[100:103], v[236:239], v[220:223], v[100:103]
    ds_read_b64_tr_b16 v[194:195], v66 offset:37376
    v_mfma_f32_16x16x32_bf16 v[84:87], v[236:239], v[216:219], v[84:87]
    ds_read_b64_tr_b16 v[196:197], v67 offset:36864
    v_mfma_f32_16x16x32_bf16 v[88:91], v[240:243], v[216:219], v[88:91]
    ds_read_b64_tr_b16 v[198:199], v67 offset:37376
    v_mfma_f32_16x16x32_bf16 v[104:107], v[240:243], v[220:223], v[104:107]
    ds_read_b64_tr_b16 v[200:201], v66 offset:45056
    v_mfma_f32_16x16x32_bf16 v[108:111], v[244:247], v[220:223], v[108:111]
    ds_read_b64_tr_b16 v[202:203], v66 offset:45568
    v_mfma_f32_16x16x32_bf16 v[92:95], v[244:247], v[216:219], v[92:95]
    ds_read_b64_tr_b16 v[204:205], v67 offset:45056
    v_mfma_f32_16x16x32_bf16 v[144:147], v[216:219], v[248:251], v[144:147]
    ds_read_b64_tr_b16 v[206:207], v67 offset:45568
    v_mfma_f32_16x16x32_bf16 v[148:151], v[220:223], v[248:251], v[148:151]
    ds_read_b64_tr_b16 v[208:209], v66 offset:53248
    v_mfma_f32_16x16x32_bf16 v[156:159], v[220:223], v[252:255], v[156:159]
    ds_read_b64_tr_b16 v[210:211], v66 offset:53760
    v_mfma_f32_16x16x32_bf16 v[152:155], v[216:219], v[252:255], v[152:155]
    ds_read_b64_tr_b16 v[212:213], v67 offset:53248
    v_mfma_f32_16x16x32_bf16 v[160:163], v[224:227], v[248:251], v[160:163]
    ds_read_b64_tr_b16 v[214:215], v67 offset:53760
    v_mfma_f32_16x16x32_bf16 v[164:167], v[228:231], v[248:251], v[164:167]
    ds_read_b128 v[180:183], v65 offset:2048
    v_mfma_f32_16x16x32_bf16 v[172:175], v[228:231], v[252:255], v[172:175]
    ds_read_b128 v[184:187], v65 offset:4096
    v_mfma_f32_16x16x32_bf16 v[168:171], v[224:227], v[252:255], v[168:171]
    ds_read_b128 v[188:191], v65 offset:6144
    v_mfma_f32_16x16x32_bf16 v[120:123], v[240:243], v[224:227], v[120:123]
    v_mfma_f32_16x16x32_bf16 v[136:139], v[240:243], v[228:231], v[136:139]
    v_mfma_f32_16x16x32_bf16 v[140:143], v[244:247], v[228:231], v[140:143]
    v_mfma_f32_16x16x32_bf16 v[124:127], v[244:247], v[224:227], v[124:127]
    v_mfma_f32_16x16x32_bf16 v[112:115], v[232:235], v[224:227], v[112:115]
    v_mfma_f32_16x16x32_bf16 v[128:131], v[232:235], v[228:231], v[128:131]
    v_mfma_f32_16x16x32_bf16 v[132:135], v[236:239], v[228:231], v[132:135]
    v_mfma_f32_16x16x32_bf16 v[116:119], v[236:239], v[224:227], v[116:119]
    s_waitcnt vmcnt(0) lgkmcnt(0)
    v_cmp_eq_u32 vcc, 1, v7
    s_cmp_eq_u64 vcc, -1
    s_cbranch_scc0 DC10
DD11:
    v_not_b32 v7, v6
    s_barrier
GYB13:
    v_mfma_f32_16x16x32_bf16 v[80:83], v[192:195], v[176:179], v[80:83]
    ds_read_b128 v[216:219], v64 offset:8192
    v_mfma_f32_16x16x32_bf16 v[96:99], v[192:195], v[180:183], v[96:99]
    ds_read_b64_tr_b16 v[232:233], v66 offset:57344
    v_mfma_f32_16x16x32_bf16 v[100:103], v[196:199], v[180:183], v[100:103]
    ds_read_b64_tr_b16 v[234:235], v66 offset:57856
    v_mfma_f32_16x16x32_bf16 v[84:87], v[196:199], v[176:179], v[84:87]
    ds_read_b64_tr_b16 v[236:237], v67 offset:57344
    v_mfma_f32_16x16x32_bf16 v[88:91], v[200:203], v[176:179], v[88:91]
    ds_read_b64_tr_b16 v[238:239], v67 offset:57856
    v_mfma_f32_16x16x32_bf16 v[104:107], v[200:203], v[180:183], v[104:107]
    ds_read_b64_tr_b16 v[240:241], v66 offset:0
    v_mfma_f32_16x16x32_bf16 v[108:111], v[204:207], v[180:183], v[108:111]
    ds_read_b64_tr_b16 v[242:243], v66 offset:512
    v_mfma_f32_16x16x32_bf16 v[92:95], v[204:207], v[176:179], v[92:95]
    ds_read_b64_tr_b16 v[244:245], v67 offset:0
    v_mfma_f32_16x16x32_bf16 v[144:147], v[176:179], v[208:211], v[144:147]
    ds_read_b64_tr_b16 v[246:247], v67 offset:512
    v_mfma_f32_16x16x32_bf16 v[148:151], v[180:183], v[208:211], v[148:151]
    ds_read_b64_tr_b16 v[248:249], v66 offset:8192
    v_mfma_f32_16x16x32_bf16 v[156:159], v[180:183], v[212:215], v[156:159]
    ds_read_b64_tr_b16 v[250:251], v66 offset:8704
    v_mfma_f32_16x16x32_bf16 v[152:155], v[176:179], v[212:215], v[152:155]
    ds_read_b64_tr_b16 v[252:253], v67 offset:8192
    v_mfma_f32_16x16x32_bf16 v[160:163], v[184:187], v[208:211], v[160:163]
    ds_read_b64_tr_b16 v[254:255], v67 offset:8704
    v_mfma_f32_16x16x32_bf16 v[164:167], v[188:191], v[208:211], v[164:167]
    ds_read_b128 v[220:223], v64 offset:10240
    v_mfma_f32_16x16x32_bf16 v[172:175], v[188:191], v[212:215], v[172:175]
    ds_read_b128 v[224:227], v64 offset:12288
    v_mfma_f32_16x16x32_bf16 v[168:171], v[184:187], v[212:215], v[168:171]
    ds_read_b128 v[228:231], v64 offset:14336
    v_mfma_f32_16x16x32_bf16 v[120:123], v[200:203], v[184:187], v[120:123]
    v_mfma_f32_16x16x32_bf16 v[136:139], v[200:203], v[188:191], v[136:139]
    v_mfma_f32_16x16x32_bf16 v[140:143], v[204:207], v[188:191], v[140:143]
    v_mfma_f32_16x16x32_bf16 v[124:127], v[204:207], v[184:187], v[124:127]
    v_mfma_f32_16x16x32_bf16 v[112:115], v[192:195], v[184:187], v[112:115]
    v_mfma_f32_16x16x32_bf16 v[128:131], v[192:195], v[188:191], v[128:131]
    v_mfma_f32_16x16x32_bf16 v[132:135], v[196:199], v[188:191], v[132:135]
    v_mfma_f32_16x16x32_bf16 v[116:119], v[196:199], v[184:187], v[116:119]
    s_waitcnt lgkmcnt(0)
    v_mfma_f32_16x16x32_bf16 v[80:83], v[232:235], v[216:219], v[80:83]
    ds_read_b128 v[176:179], v65 offset:8192
    v_mfma_f32_16x16x32_bf16 v[96:99], v[232:235], v[220:223], v[96:99]
    ds_read_b64_tr_b16 v[192:193], v66 offset:61440
    v_mfma_f32_16x16x32_bf16 v[100:103], v[236:239], v[220:223], v[100:103]
    ds_read_b64_tr_b16 v[194:195], v66 offset:61952
    v_mfma_f32_16x16x32_bf16 v[84:87], v[236:239], v[216:219], v[84:87]
    ds_read_b64_tr_b16 v[196:197], v67 offset:61440
    v_mfma_f32_16x16x32_bf16 v[88:91], v[240:243], v[216:219], v[88:91]
    ds_read_b64_tr_b16 v[198:199], v67 offset:61952
    v_mfma_f32_16x16x32_bf16 v[104:107], v[240:243], v[220:223], v[104:107]
    ds_read_b64_tr_b16 v[200:201], v66 offset:4096
    v_mfma_f32_16x16x32_bf16 v[108:111], v[244:247], v[220:223], v[108:111]
    ds_read_b64_tr_b16 v[202:203], v66 offset:4608
    v_mfma_f32_16x16x32_bf16 v[92:95], v[244:247], v[216:219], v[92:95]
    ds_read_b64_tr_b16 v[204:205], v67 offset:4096
    v_mfma_f32_16x16x32_bf16 v[144:147], v[216:219], v[248:251], v[144:147]
    ds_read_b64_tr_b16 v[206:207], v67 offset:4608
    v_mfma_f32_16x16x32_bf16 v[148:151], v[220:223], v[248:251], v[148:151]
    ds_read_b64_tr_b16 v[208:209], v66 offset:12288
    v_mfma_f32_16x16x32_bf16 v[156:159], v[220:223], v[252:255], v[156:159]
    ds_read_b64_tr_b16 v[210:211], v66 offset:12800
    v_mfma_f32_16x16x32_bf16 v[152:155], v[216:219], v[252:255], v[152:155]
    ds_read_b64_tr_b16 v[212:213], v67 offset:12288
    v_mfma_f32_16x16x32_bf16 v[160:163], v[224:227], v[248:251], v[160:163]
    ds_read_b64_tr_b16 v[214:215], v67 offset:12800
    v_mfma_f32_16x16x32_bf16 v[164:167], v[228:231], v[248:251], v[164:167]
    ds_read_b128 v[180:183], v65 offset:10240
    v_mfma_f32_16x16x32_bf16 v[172:175], v[228:231], v[252:255], v[172:175]
    ds_read_b128 v[184:187], v65 offset:12288
    v_mfma_f32_16x16x32_bf16 v[168:171], v[224:227], v[252:255], v[168:171]
    ds_read_b128 v[188:191], v65 offset:14336
    v_mfma_f32_16x16x32_bf16 v[120:123], v[240:243], v[224:227], v[120:123]
    v_mfma_f32_16x16x32_bf16 v[136:139], v[240:243], v[228:231], v[136:139]
    v_mfma_f32_16x16x32_bf16 v[140:143], v[244:247], v[228:231], v[140:143]
    s_cmp_lg_u32 s20, 4
    s_cbranch_scc1 CT9
    global_load_dword v27, v73, s[4:5]
CT9:
    v_mfma_f32_16x16x32_bf16 v[124:127], v[244:247], v[224:227], v[124:127]
    v_mfma_f32_16x16x32_bf16 v[112:115], v[232:235], v[224:227], v[112:115]
    v_mfma_f32_16x16x32_bf16 v[128:131], v[232:235], v[228:231], v[128:131]
    v_mfma_f32_16x16x32_bf16 v[132:135], v[236:239], v[228:231], v[132:135]
    v_mfma_f32_16x16x32_bf16 v[116:119], v[236:239], v[224:227], v[116:119]
    s_waitcnt lgkmcnt(0)
    s_barrier
    s_branch GYB14
.p2align 12
GYB14:
    v_mfma_f32_16x16x32_bf16 v[80:83], v[192:195], v[176:179], v[80:83]
    ds_read_b128 v[216:219], v64 offset:16384
    v_mfma_f32_16x16x32_bf16 v[96:99], v[192:195], v[180:183], v[96:99]
    ds_read_b64_tr_b16 v[232:233], v66 offset:16384
    v_mfma_f32_16x16x32_bf16 v[100:103], v[196:199], v[180:183], v[100:103]
    ds_read_b64_tr_b16 v[234:235], v66 offset:16896
    v_mfma_f32_16x16x32_bf16 v[84:87], v[196:199], v[176:179], v[84:87]
    ds_read_b64_tr_b16 v[236:237], v67 offset:16384
    v_mfma_f32_16x16x32_bf16 v[88:91], v[200:203], v[176:179], v[88:91]
    ds_read_b64_tr_b16 v[238:239], v67 offset:16896
    v_mfma_f32_16x16x32_bf16 v[104:107], v[200:203], v[180:183], v[104:107]
    ds_read_b64_tr_b16 v[240:241], v66 offset:24576
    v_mfma_f32_16x16x32_bf16 v[108:111], v[204:207], v[180:183], v[108:111]
    ds_read_b64_tr_b16 v[242:243], v66 offset:25088
    v_mfma_f32_16x16x32_bf16 v[92:95], v[204:207], v[176:179], v[92:95]
    ds_read_b64_tr_b16 v[244:245], v67 offset:24576
    v_mfma_f32_16x16x32_bf16 v[144:147], v[176:179], v[208:211], v[144:147]
    ds_read_b64_tr_b16 v[246:247], v67 offset:25088
    v_mfma_f32_16x16x32_bf16 v[148:151], v[180:183], v[208:211], v[148:151]
    ds_read_b64_tr_b16 v[248:249], v66 offset:32768
    v_mfma_f32_16x16x32_bf16 v[156:159], v[180:183], v[212:215], v[156:159]
    ds_read_b64_tr_b16 v[250:251], v66 offset:33280
    v_mfma_f32_16x16x32_bf16 v[152:155], v[176:179], v[212:215], v[152:155]
    ds_read_b64_tr_b16 v[252:253], v67 offset:32768
    v_mfma_f32_16x16x32_bf16 v[160:163], v[184:187], v[208:211], v[160:163]
    ds_read_b64_tr_b16 v[254:255], v67 offset:33280
    v_mfma_f32_16x16x32_bf16 v[164:167], v[188:191], v[208:211], v[164:167]
    ds_read_b128 v[220:223], v64 offset:18432
    v_mfma_f32_16x16x32_bf16 v[172:175], v[188:191], v[212:215], v[172:175]
    ds_read_b128 v[224:227], v64 offset:20480
    v_mfma_f32_16x16x32_bf16 v[168:171], v[184:187], v[212:215], v[168:171]
    ds_read_b128 v[228:231], v64 offset:22528
    v_mfma_f32_16x16x32_bf16 v[120:123], v[200:203], v[184:187], v[120:123]
    v_mfma_f32_16x16x32_bf16 v[136:139], v[200:203], v[188:191], v[136:139]
    v_mfma_f32_16x16x32_bf16 v[140:143], v[204:207], v[188:191], v[140:143]
    v_mfma_f32_16x16x32_bf16 v[124:127], v[204:207], v[184:187], v[124:127]
    v_mfma_f32_16x16x32_bf16 v[112:115], v[192:195], v[184:187], v[112:115]
    v_mfma_f32_16x16x32_bf16 v[128:131], v[192:195], v[188:191], v[128:131]
    v_mfma_f32_16x16x32_bf16 v[132:135], v[196:199], v[188:191], v[132:135]
    v_mfma_f32_16x16x32_bf16 v[116:119], v[196:199], v[184:187], v[116:119]
    s_waitcnt lgkmcnt(0)
    v_mfma_f32_16x16x32_bf16 v[80:83], v[232:235], v[216:219], v[80:83]
    ds_read_b128 v[176:179], v65 offset:16384
    v_mfma_f32_16x16x32_bf16 v[96:99], v[232:235], v[220:223], v[96:99]
    ds_read_b64_tr_b16 v[192:193], v66 offset:20480
    v_mfma_f32_16x16x32_bf16 v[100:103], v[236:239], v[220:223], v[100:103]
    ds_read_b64_tr_b16 v[194:195], v66 offset:20992
    v_mfma_f32_16x16x32_bf16 v[84:87], v[236:239], v[216:219], v[84:87]
    ds_read_b64_tr_b16 v[196:197], v67 offset:20480
    v_mfma_f32_16x16x32_bf16 v[88:91], v[240:243], v[216:219], v[88:91]
    ds_read_b64_tr_b16 v[198:199], v67 offset:20992
    v_mfma_f32_16x16x32_bf16 v[104:107], v[240:243], v[220:223], v[104:107]
    ds_read_b64_tr_b16 v[200:201], v66 offset:28672
    v_mfma_f32_16x16x32_bf16 v[108:111], v[244:247], v[220:223], v[108:111]
    ds_read_b64_tr_b16 v[202:203], v66 offset:29184
    v_mfma_f32_16x16x32_bf16 v[92:95], v[244:247], v[216:219], v[92:95]
    ds_read_b64_tr_b16 v[204:205], v67 offset:28672
    v_mfma_f32_16x16x32_bf16 v[144:147], v[216:219], v[248:251], v[144:147]
    ds_read_b64_tr_b16 v[206:207], v67 offset:29184
    v_mfma_f32_16x16x32_bf16 v[148:151], v[220:223], v[248:251], v[148:151]
    ds_read_b64_tr_b16 v[208:209], v66 offset:36864
    v_mfma_f32_16x16x32_bf16 v[156:159], v[220:223], v[252:255], v[156:159]
    ds_read_b64_tr_b16 v[210:211], v66 offset:37376
    v_mfma_f32_16x16x32_bf16 v[152:155], v[216:219], v[252:255], v[152:155]
    ds_read_b64_tr_b16 v[212:213], v67 offset:36864
    v_mfma_f32_16x16x32_bf16 v[160:163], v[224:227], v[248:251], v[160:163]
    ds_read_b64_tr_b16 v[214:215], v67 offset:37376
    v_mfma_f32_16x16x32_bf16 v[164:167], v[228:231], v[248:251], v[164:167]
    ds_read_b128 v[180:183], v65 offset:18432
    v_mfma_f32_16x16x32_bf16 v[172:175], v[228:231], v[252:255], v[172:175]
    ds_read_b128 v[184:187], v65 offset:20480
    v_mfma_f32_16x16x32_bf16 v[168:171], v[224:227], v[252:255], v[168:171]
    ds_read_b128 v[188:191], v65 offset:22528
    v_mfma_f32_16x16x32_bf16 v[120:123], v[240:243], v[224:227], v[120:123]
    v_mfma_f32_16x16x32_bf16 v[136:139], v[240:243], v[228:231], v[136:139]
    v_mfma_f32_16x16x32_bf16 v[140:143], v[244:247], v[228:231], v[140:143]
    v_mfma_f32_16x16x32_bf16 v[124:127], v[244:247], v[224:227], v[124:127]
    v_mfma_f32_16x16x32_bf16 v[112:115], v[232:235], v[224:227], v[112:115]
    v_mfma_f32_16x16x32_bf16 v[128:131], v[232:235], v[228:231], v[128:131]
    v_mfma_f32_16x16x32_bf16 v[132:135], v[236:239], v[228:231], v[132:135]
    v_mfma_f32_16x16x32_bf16 v[116:119], v[236:239], v[224:227], v[116:119]
    s_waitcnt lgkmcnt(0)
    s_barrier
GYB15:
    ds_read_b128 v[216:219], v64 offset:0
    ds_read_b64_tr_b16 v[232:233], v66 offset:40960
    ds_read_b64_tr_b16 v[234:235], v66 offset:41472
    ds_read_b64_tr_b16 v[236:237], v67 offset:40960
    ds_read_b64_tr_b16 v[238:239], v67 offset:41472
    ds_read_b64_tr_b16 v[240:241], v66 offset:49152
    ds_read_b64_tr_b16 v[242:243], v66 offset:49664
    ds_read_b64_tr_b16 v[244:245], v67 offset:49152
    ds_read_b64_tr_b16 v[246:247], v67 offset:49664
    ds_read_b64_tr_b16 v[248:249], v66 offset:57344
    ds_read_b64_tr_b16 v[250:251], v66 offset:57856
    ds_read_b64_tr_b16 v[252:253], v67 offset:57344
    ds_read_b64_tr_b16 v[254:255], v67 offset:57856
    ds_read_b128 v[220:223], v64 offset:2048
    ds_read_b128 v[224:227], v64 offset:4096
    ds_read_b128 v[228:231], v64 offset:6144
    v_mfma_f32_16x16x32_bf16 v[80:83], v[192:195], v[176:179], v[80:83]
    v_mfma_f32_16x16x32_bf16 v[96:99], v[192:195], v[180:183], v[96:99]
    v_mfma_f32_16x16x32_bf16 v[100:103], v[196:199], v[180:183], v[100:103]
    v_mfma_f32_16x16x32_bf16 v[84:87], v[196:199], v[176:179], v[84:87]
    v_mfma_f32_16x16x32_bf16 v[88:91], v[200:203], v[176:179], v[88:91]
    v_mfma_f32_16x16x32_bf16 v[104:107], v[200:203], v[180:183], v[104:107]
    v_mfma_f32_16x16x32_bf16 v[108:111], v[204:207], v[180:183], v[108:111]
    v_mfma_f32_16x16x32_bf16 v[92:95], v[204:207], v[176:179], v[92:95]
    v_mfma_f32_16x16x32_bf16 v[144:147], v[176:179], v[208:211], v[144:147]
    v_mfma_f32_16x16x32_bf16 v[148:151], v[180:183], v[208:211], v[148:151]
    v_mfma_f32_16x16x32_bf16 v[156:159], v[180:183], v[212:215], v[156:159]
    v_mfma_f32_16x16x32_bf16 v[152:155], v[176:179], v[212:215], v[152:155]
    v_mfma_f32_16x16x32_bf16 v[160:163], v[184:187], v[208:211], v[160:163]
    v_mfma_f32_16x16x32_bf16 v[164:167], v[188:191], v[208:211], v[164:167]
    v_mfma_f32_16x16x32_bf16 v[172:175], v[188:191], v[212:215], v[172:175]
    v_mfma_f32_16x16x32_bf16 v[168:171], v[184:187], v[212:215], v[168:171]
    v_mfma_f32_16x16x32_bf16 v[120:123], v[200:203], v[184:187], v[120:123]
    v_mfma_f32_16x16x32_bf16 v[136:139], v[200:203], v[188:191], v[136:139]
    v_mfma_f32_16x16x32_bf16 v[140:143], v[204:207], v[188:191], v[140:143]
    v_mfma_f32_16x16x32_bf16 v[124:127], v[204:207], v[184:187], v[124:127]
    v_mfma_f32_16x16x32_bf16 v[112:115], v[192:195], v[184:187], v[112:115]
    v_mfma_f32_16x16x32_bf16 v[128:131], v[192:195], v[188:191], v[128:131]
    v_mfma_f32_16x16x32_bf16 v[132:135], v[196:199], v[188:191], v[132:135]
    v_mfma_f32_16x16x32_bf16 v[116:119], v[196:199], v[184:187], v[116:119]
    s_waitcnt lgkmcnt(0)
    ds_read_b128 v[176:179], v65 offset:0
    ds_read_b64_tr_b16 v[192:193], v66 offset:45056
    ds_read_b64_tr_b16 v[194:195], v66 offset:45568
    ds_read_b64_tr_b16 v[196:197], v67 offset:45056
    ds_read_b64_tr_b16 v[198:199], v67 offset:45568
    ds_read_b64_tr_b16 v[200:201], v66 offset:53248
    ds_read_b64_tr_b16 v[202:203], v66 offset:53760
    ds_read_b64_tr_b16 v[204:205], v67 offset:53248
    ds_read_b64_tr_b16 v[206:207], v67 offset:53760
    ds_read_b64_tr_b16 v[208:209], v66 offset:61440
    ds_read_b64_tr_b16 v[210:211], v66 offset:61952
    ds_read_b64_tr_b16 v[212:213], v67 offset:61440
    ds_read_b64_tr_b16 v[214:215], v67 offset:61952
    ds_read_b128 v[180:183], v65 offset:2048
    ds_read_b128 v[184:187], v65 offset:4096
    ds_read_b128 v[188:191], v65 offset:6144
    s_setprio 0
    v_mfma_f32_16x16x32_bf16 v[80:83], v[232:235], v[216:219], v[80:83]
    v_mfma_f32_16x16x32_bf16 v[96:99], v[232:235], v[220:223], v[96:99]
    v_mfma_f32_16x16x32_bf16 v[100:103], v[236:239], v[220:223], v[100:103]
    v_mfma_f32_16x16x32_bf16 v[84:87], v[236:239], v[216:219], v[84:87]
    v_mfma_f32_16x16x32_bf16 v[88:91], v[240:243], v[216:219], v[88:91]
    v_mfma_f32_16x16x32_bf16 v[104:107], v[240:243], v[220:223], v[104:107]
    v_mfma_f32_16x16x32_bf16 v[108:111], v[244:247], v[220:223], v[108:111]
    v_mfma_f32_16x16x32_bf16 v[92:95], v[244:247], v[216:219], v[92:95]
    v_mfma_f32_16x16x32_bf16 v[144:147], v[216:219], v[248:251], v[144:147]
    v_mfma_f32_16x16x32_bf16 v[148:151], v[220:223], v[248:251], v[148:151]
    v_mfma_f32_16x16x32_bf16 v[156:159], v[220:223], v[252:255], v[156:159]
    v_mfma_f32_16x16x32_bf16 v[152:155], v[216:219], v[252:255], v[152:155]
    v_mfma_f32_16x16x32_bf16 v[160:163], v[224:227], v[248:251], v[160:163]
    v_mfma_f32_16x16x32_bf16 v[164:167], v[228:231], v[248:251], v[164:167]
    v_mfma_f32_16x16x32_bf16 v[172:175], v[228:231], v[252:255], v[172:175]
    v_mfma_f32_16x16x32_bf16 v[168:171], v[224:227], v[252:255], v[168:171]
    v_mfma_f32_16x16x32_bf16 v[120:123], v[240:243], v[224:227], v[120:123]
    v_mfma_f32_16x16x32_bf16 v[136:139], v[240:243], v[228:231], v[136:139]
    v_mfma_f32_16x16x32_bf16 v[140:143], v[244:247], v[228:231], v[140:143]
    v_mfma_f32_16x16x32_bf16 v[124:127], v[244:247], v[224:227], v[124:127]
    v_mfma_f32_16x16x32_bf16 v[112:115], v[232:235], v[224:227], v[112:115]
    v_mfma_f32_16x16x32_bf16 v[128:131], v[232:235], v[228:231], v[128:131]
    v_mfma_f32_16x16x32_bf16 v[132:135], v[236:239], v[228:231], v[132:135]
    v_mfma_f32_16x16x32_bf16 v[116:119], v[236:239], v[224:227], v[116:119]
    s_waitcnt lgkmcnt(0)
    v_mfma_f32_16x16x32_bf16 v[80:83], v[192:195], v[176:179], v[80:83]
    v_mfma_f32_16x16x32_bf16 v[96:99], v[192:195], v[180:183], v[96:99]
    v_mfma_f32_16x16x32_bf16 v[100:103], v[196:199], v[180:183], v[100:103]
    v_mfma_f32_16x16x32_bf16 v[84:87], v[196:199], v[176:179], v[84:87]
    v_mfma_f32_16x16x32_bf16 v[88:91], v[200:203], v[176:179], v[88:91]
    v_mfma_f32_16x16x32_bf16 v[104:107], v[200:203], v[180:183], v[104:107]
    v_mfma_f32_16x16x32_bf16 v[108:111], v[204:207], v[180:183], v[108:111]
    v_mfma_f32_16x16x32_bf16 v[92:95], v[204:207], v[176:179], v[92:95]
    v_mfma_f32_16x16x32_bf16 v[144:147], v[176:179], v[208:211], v[144:147]
    v_mfma_f32_16x16x32_bf16 v[148:151], v[180:183], v[208:211], v[148:151]
    v_mfma_f32_16x16x32_bf16 v[156:159], v[180:183], v[212:215], v[156:159]
    v_mul_f32 v96, s32, v96
    v_mul_f32 v97, s32, v97
    v_mfma_f32_16x16x32_bf16 v[152:155], v[176:179], v[212:215], v[152:155]
    v_mul_f32 v98, s32, v98
    v_mul_f32 v99, s32, v99
    v_mfma_f32_16x16x32_bf16 v[160:163], v[184:187], v[208:211], v[160:163]
    v_mul_f32 v100, s32, v100
    v_mul_f32 v101, s32, v101
    v_mfma_f32_16x16x32_bf16 v[164:167], v[188:191], v[208:211], v[164:167]
    v_mul_f32 v102, s32, v102
    v_mul_f32 v103, s32, v103
    v_mfma_f32_16x16x32_bf16 v[172:175], v[188:191], v[212:215], v[172:175]
    v_cvt_pk_bf16_f32 v216, v96, v97
    v_cvt_pk_bf16_f32 v217, v98, v99
    v_mfma_f32_16x16x32_bf16 v[168:171], v[184:187], v[212:215], v[168:171]
    v_cvt_pk_bf16_f32 v218, v100, v101
    v_cvt_pk_bf16_f32 v219, v102, v103
    v_mfma_f32_16x16x32_bf16 v[120:123], v[200:203], v[184:187], v[120:123]
    v_mul_f32 v80, s32, v80
    v_mul_f32 v81, s32, v81
    v_mfma_f32_16x16x32_bf16 v[136:139], v[200:203], v[188:191], v[136:139]
    v_mul_f32 v82, s32, v82
    v_mul_f32 v83, s32, v83
    v_mfma_f32_16x16x32_bf16 v[140:143], v[204:207], v[188:191], v[140:143]
    v_mul_f32 v84, s32, v84
    v_mul_f32 v85, s32, v85
    v_mfma_f32_16x16x32_bf16 v[124:127], v[204:207], v[184:187], v[124:127]
    v_mul_f32 v86, s32, v86
    v_mul_f32 v87, s32, v87
    v_mfma_f32_16x16x32_bf16 v[112:115], v[192:195], v[184:187], v[112:115]
    v_cvt_pk_bf16_f32 v220, v80, v81
    v_cvt_pk_bf16_f32 v221, v82, v83
    v_mfma_f32_16x16x32_bf16 v[128:131], v[192:195], v[188:191], v[128:131]
    v_cvt_pk_bf16_f32 v222, v84, v85
    v_cvt_pk_bf16_f32 v223, v86, v87
    v_mfma_f32_16x16x32_bf16 v[132:135], v[196:199], v[188:191], v[132:135]
    v_cvt_pk_bf16_f32 v224, v104, v105
    v_cvt_pk_bf16_f32 v225, v106, v107
    v_mfma_f32_16x16x32_bf16 v[116:119], v[196:199], v[184:187], v[116:119]
    v_cvt_pk_bf16_f32 v226, v108, v109
    v_cvt_pk_bf16_f32 v227, v110, v111
    v_cvt_pk_bf16_f32 v228, v88, v89
    v_cvt_pk_bf16_f32 v229, v90, v91
    v_cvt_pk_bf16_f32 v230, v92, v93
    v_cvt_pk_bf16_f32 v231, v94, v95
    v_cvt_pk_bf16_f32 v232, v144, v145
    v_cvt_pk_bf16_f32 v233, v146, v147
    v_cvt_pk_bf16_f32 v234, v148, v149
    v_cvt_pk_bf16_f32 v235, v150, v151
    v_cvt_pk_bf16_f32 v236, v152, v153
    v_cvt_pk_bf16_f32 v237, v154, v155
    v_cvt_pk_bf16_f32 v238, v156, v157
    v_cvt_pk_bf16_f32 v239, v158, v159
    v_cvt_pk_bf16_f32 v240, v160, v161
    v_cvt_pk_bf16_f32 v241, v162, v163
    v_cvt_pk_bf16_f32 v242, v164, v165
    v_cvt_pk_bf16_f32 v243, v166, v167
    v_cvt_pk_bf16_f32 v244, v168, v169
    v_cvt_pk_bf16_f32 v245, v170, v171
    v_cvt_pk_bf16_f32 v246, v172, v173
    v_cvt_pk_bf16_f32 v247, v174, v175
    v_cvt_pk_bf16_f32 v248, v136, v137
    v_cvt_pk_bf16_f32 v249, v138, v139
    v_cvt_pk_bf16_f32 v250, v140, v141
    v_cvt_pk_bf16_f32 v251, v142, v143
    v_cvt_pk_bf16_f32 v252, v120, v121
    v_cvt_pk_bf16_f32 v253, v122, v123
    v_cvt_pk_bf16_f32 v254, v124, v125
    v_cvt_pk_bf16_f32 v255, v126, v127
    v_mul_f32 v128, s32, v128
    v_mul_f32 v129, s32, v129
    v_mul_f32 v130, s32, v130
    v_mul_f32 v131, s32, v131
    v_mul_f32 v132, s32, v132
    v_mul_f32 v133, s32, v133
    v_mul_f32 v134, s32, v134
    v_mul_f32 v135, s32, v135
    v_cvt_pk_bf16_f32 v208, v128, v129
    v_cvt_pk_bf16_f32 v209, v130, v131
    v_cvt_pk_bf16_f32 v210, v132, v133
    v_cvt_pk_bf16_f32 v211, v134, v135
    v_mul_f32 v112, s32, v112
    v_mul_f32 v113, s32, v113
    v_mul_f32 v114, s32, v114
    v_mul_f32 v115, s32, v115
    v_mul_f32 v116, s32, v116
    v_mul_f32 v117, s32, v117
    v_mul_f32 v118, s32, v118
    v_mul_f32 v119, s32, v119
    v_cvt_pk_bf16_f32 v212, v112, v113
    v_cvt_pk_bf16_f32 v213, v114, v115
    v_cvt_pk_bf16_f32 v214, v116, v117
    v_cvt_pk_bf16_f32 v215, v118, v119
    s_cmp_eq_u32 s23, 0
    s_cbranch_scc1 YPATH
    s_branch XPATH
GYB16:
.p2align 12
.fill 160, 4, 0xbf800000
VP8:
    s_branch VR7
XOLD:
    s_cmp_lg_u32 s87, 0
    s_cbranch_scc1 WH12
    buffer_store_dwordx4 v[224:227], v4, s[16:19], s35 offen offset:256 sc1
    buffer_store_dwordx4 v[228:231], v4, s[16:19], s35 offen offset:0 sc1
    buffer_store_dwordx4 v[232:235], v4, s[16:19], s35 offen offset:2048 sc1
    buffer_store_dwordx4 v[236:239], v4, s[16:19], s35 offen offset:2304 sc1
    buffer_store_dwordx4 v[240:243], v4, s[16:19], s44 offen offset:2048 sc1
    buffer_store_dwordx4 v[244:247], v4, s[16:19], s44 offen offset:2304 sc1
    buffer_store_dwordx4 v[248:251], v4, s[16:19], s44 offen offset:256 sc1
    buffer_store_dwordx4 v[252:255], v4, s[16:19], s44 offen offset:0 sc1
WH12:
    ds_write_b128 v79, v[216:219] offset:256
    ds_write_b128 v79, v[220:223] offset:0
    ds_write_b128 v78, v[224:227] offset:256
    ds_write_b128 v78, v[228:231] offset:0
    ds_write_b128 v78, v[232:235] offset:2048
    ds_write_b128 v78, v[236:239] offset:2304
    ds_write_b128 v78, v[240:243] offset:6144
    ds_write_b128 v78, v[244:247] offset:6400
    ds_write_b128 v78, v[248:251] offset:4352
    ds_write_b128 v78, v[252:255] offset:4096
    ds_write_b128 v79, v[208:211] offset:2304
    ds_write_b128 v79, v[212:215] offset:2048
    s_nop 1
    v_mfma_f32_16x16x32_bf16 v[48:51], v[228:231], v[220:223], 0
    v_mfma_f32_16x16x32_bf16 v[52:55], v[224:227], v[220:223], 0
    v_mfma_f32_16x16x32_bf16 v[56:59], v[252:255], v[220:223], 0
    v_mfma_f32_16x16x32_bf16 v[60:63], v[248:251], v[220:223], 0
    v_mfma_f32_16x16x32_bf16 v[64:67], v[228:231], v[216:219], 0
    v_mfma_f32_16x16x32_bf16 v[68:71], v[224:227], v[216:219], 0
    v_mfma_f32_16x16x32_bf16 v[72:75], v[252:255], v[216:219], 0
    v_mfma_f32_16x16x32_bf16 v[76:79], v[248:251], v[216:219], 0
    v_mfma_f32_16x16x32_bf16 v[136:139], v[228:231], v[212:215], 0
    v_mfma_f32_16x16x32_bf16 v[140:143], v[224:227], v[212:215], 0
    v_mfma_f32_16x16x32_bf16 v[144:147], v[252:255], v[212:215], 0
    v_mfma_f32_16x16x32_bf16 v[148:151], v[248:251], v[212:215], 0
    v_mfma_f32_16x16x32_bf16 v[152:155], v[228:231], v[208:211], 0
    v_mfma_f32_16x16x32_bf16 v[156:159], v[224:227], v[208:211], 0
    v_mfma_f32_16x16x32_bf16 v[160:163], v[252:255], v[208:211], 0
    v_mfma_f32_16x16x32_bf16 v[164:167], v[248:251], v[208:211], 0
    v_max3_f32 v22, v48, v49, v50
    v_max3_f32 v22, v22, v51, v52
    v_max3_f32 v22, v22, v53, v54
    v_max3_f32 v22, v22, v55, v56
    v_max3_f32 v22, v22, v57, v58
    v_max3_f32 v22, v22, v59, v60
    v_max3_f32 v22, v22, v61, v62
    v_max_f32 v22, v22, v63
    v_max3_f32 v23, v64, v65, v66
    v_max3_f32 v23, v23, v67, v68
    v_max3_f32 v23, v23, v69, v70
    v_max3_f32 v23, v23, v71, v72
    v_max3_f32 v23, v23, v73, v74
    v_max3_f32 v23, v23, v75, v76
    v_max3_f32 v23, v23, v77, v78
    v_max_f32 v23, v23, v79
    v_max3_f32 v24, v136, v137, v138
    v_max3_f32 v24, v24, v139, v140
    v_max3_f32 v24, v24, v141, v142
    v_max3_f32 v24, v24, v143, v144
    v_max3_f32 v24, v24, v145, v146
    v_max3_f32 v24, v24, v147, v148
    v_max3_f32 v24, v24, v149, v150
    v_max_f32 v24, v24, v151
    v_max3_f32 v25, v152, v153, v154
    v_max3_f32 v25, v25, v155, v156
    v_max3_f32 v25, v25, v157, v158
    v_max3_f32 v25, v25, v159, v160
    v_max3_f32 v25, v25, v161, v162
    v_max3_f32 v25, v25, v163, v164
    v_max3_f32 v25, v25, v165, v166
    v_max_f32 v25, v25, v167
    v_lshlrev_b32 v27, 2, v2
    v_permlane16_swap_b32 v22, v23
    v_permlane16_swap_b32 v24, v25
    s_nop 0
    v_max_f32 v22, v22, v23
    v_max_f32 v24, v24, v25
    v_mov_b32 v23, v22
    v_mov_b32 v25, v24
    s_nop 0
    v_permlane32_swap_b32 v22, v23
    v_permlane32_swap_b32 v24, v25
    s_nop 0
    v_max_f32 v22, v22, v23
    v_max_f32 v24, v24, v25
    v_sub_f32 v22, s68, v22
    v_sub_f32 v24, s68, v24
    s_lshr_b32 s25, s74, 3
    v_add_u32 v27, s25, v27
    ds_write_b32 v27, v22 offset:32768
    ds_write_b32 v27, v24 offset:33024
XPATH:
    s_lshr_b32 s25, s81, 3
    s_add_u32 s25, s25, 32768
    v_lshl_add_u32 v26, v2, 2, s25
    v_xor_b32 v14, 0x100, v26
    v_mov_b64 v[96:97], 0
    v_mov_b64 v[98:99], 0
    v_mov_b64 v[100:101], 0
    v_mov_b64 v[102:103], 0
    v_mov_b64 v[104:105], 0
    v_mov_b64 v[106:107], 0
    v_mov_b64 v[108:109], 0
    v_mov_b64 v[110:111], 0
    v_mov_b64 v[112:113], 0
    v_mov_b64 v[114:115], 0
    v_mov_b64 v[116:117], 0
    v_mov_b64 v[118:119], 0
    v_mov_b64 v[120:121], 0
    v_mov_b64 v[122:123], 0
    v_mov_b64 v[124:125], 0
    v_mov_b64 v[126:127], 0
    v_mov_b64 v[128:129], 0
    v_mov_b64 v[130:131], 0
    v_mov_b64 v[132:133], 0
    v_mov_b64 v[134:135], 0
    s_waitcnt lgkmcnt(0)
    s_barrier
    ds_read_b128 v[80:83], v12 offset:0
    ds_read_b128 v[84:87], v12 offset:1024
    ds_read_b128 v[88:91], v13 offset:0
    ds_read_b128 v[92:95], v13 offset:1024
    ds_read_b128 v[168:171], v8 offset:0
    ds_read_b128 v[172:175], v8 offset:1024
    ds_read_b128 v[184:187], v10 offset:2048
    ds_read_b128 v[188:191], v10 offset:3072
    s_cmp_lt_u32 s20, 4
    s_cbranch_scc1 YB13
    s_setprio 3
    s_waitcnt vmcnt(0)
    buffer_store_dwordx4 v[216:219], v4, s[16:19], s34 offen offset:256 sc1
    buffer_store_dwordx4 v[220:223], v4, s[16:19], s34 offen offset:0 sc1
    buffer_store_dwordx4 v[208:211], v4, s[16:19], s34 offen offset:2304 sc1
    buffer_store_dwordx4 v[212:215], v4, s[16:19], s34 offen offset:2048 sc1
    s_nop 1
    v_mfma_f32_16x16x32_bf16 v[48:51], v[228:231], v[220:223], 0
    v_mfma_f32_16x16x32_bf16 v[52:55], v[224:227], v[220:223], 0
    v_mfma_f32_16x16x32_bf16 v[56:59], v[252:255], v[220:223], 0
    v_mfma_f32_16x16x32_bf16 v[60:63], v[248:251], v[220:223], 0
    v_mfma_f32_16x16x32_bf16 v[64:67], v[228:231], v[216:219], 0
    v_mfma_f32_16x16x32_bf16 v[68:71], v[224:227], v[216:219], 0
    v_mfma_f32_16x16x32_bf16 v[72:75], v[252:255], v[216:219], 0
    v_mfma_f32_16x16x32_bf16 v[76:79], v[248:251], v[216:219], 0
    v_mfma_f32_16x16x32_bf16 v[136:139], v[228:231], v[212:215], 0
    v_mfma_f32_16x16x32_bf16 v[140:143], v[224:227], v[212:215], 0
    v_mfma_f32_16x16x32_bf16 v[144:147], v[252:255], v[212:215], 0
    v_mfma_f32_16x16x32_bf16 v[148:151], v[248:251], v[212:215], 0
    v_mfma_f32_16x16x32_bf16 v[152:155], v[228:231], v[208:211], 0
    v_mfma_f32_16x16x32_bf16 v[156:159], v[224:227], v[208:211], 0
    v_mfma_f32_16x16x32_bf16 v[160:163], v[252:255], v[208:211], 0
    v_mfma_f32_16x16x32_bf16 v[164:167], v[248:251], v[208:211], 0
    v_max3_f32 v22, v48, v49, v50
    v_max3_f32 v22, v22, v51, v52
    v_max3_f32 v22, v22, v53, v54
    v_max3_f32 v22, v22, v55, v56
    v_max3_f32 v22, v22, v57, v58
    v_max3_f32 v22, v22, v59, v60
    v_max3_f32 v22, v22, v61, v62
    v_max_f32 v22, v22, v63
    v_max3_f32 v23, v64, v65, v66
    v_max3_f32 v23, v23, v67, v68
    v_max3_f32 v23, v23, v69, v70
    v_max3_f32 v23, v23, v71, v72
    v_max3_f32 v23, v23, v73, v74
    v_max3_f32 v23, v23, v75, v76
    v_max3_f32 v23, v23, v77, v78
    v_max_f32 v23, v23, v79
    v_max3_f32 v24, v136, v137, v138
    v_max3_f32 v24, v24, v139, v140
    v_max3_f32 v24, v24, v141, v142
    v_max3_f32 v24, v24, v143, v144
    v_max3_f32 v24, v24, v145, v146
    v_max3_f32 v24, v24, v147, v148
    v_max3_f32 v24, v24, v149, v150
    v_max_f32 v24, v24, v151
    v_max3_f32 v25, v152, v153, v154
    v_max3_f32 v25, v25, v155, v156
    v_max3_f32 v25, v25, v157, v158
    v_max3_f32 v25, v25, v159, v160
    v_max3_f32 v25, v25, v161, v162
    v_max3_f32 v25, v25, v163, v164
    v_max3_f32 v25, v25, v165, v166
    v_max_f32 v25, v25, v167
    v_lshlrev_b32 v27, 2, v2
    v_permlane16_swap_b32 v22, v23
    v_permlane16_swap_b32 v24, v25
    s_nop 0
    v_max_f32 v22, v22, v23
    v_max_f32 v24, v24, v25
    v_mov_b32 v23, v22
    v_mov_b32 v25, v24
    s_nop 0
    v_permlane32_swap_b32 v22, v23
    v_permlane32_swap_b32 v24, v25
    s_nop 0
    v_max_f32 v22, v22, v23
    v_max_f32 v24, v24, v25
    v_sub_f32 v22, s68, v22
    v_sub_f32 v24, s68, v24
    buffer_store_dword v22, v27, s[16:19], s96 offen offset:0 sc1
    buffer_store_dword v24, v27, s[16:19], s96 offen offset:256 sc1
    s_cmp_lg_u32 s87, 1
    s_cbranch_scc1 WH14
    buffer_store_dwordx4 v[224:227], v4, s[16:19], s35 offen offset:256 sc1
    buffer_store_dwordx4 v[228:231], v4, s[16:19], s35 offen offset:0 sc1
    buffer_store_dwordx4 v[232:235], v4, s[16:19], s35 offen offset:2048 sc1
    buffer_store_dwordx4 v[236:239], v4, s[16:19], s35 offen offset:2304 sc1
    buffer_store_dwordx4 v[240:243], v4, s[16:19], s44 offen offset:2048 sc1
    buffer_store_dwordx4 v[244:247], v4, s[16:19], s44 offen offset:2304 sc1
    buffer_store_dwordx4 v[248:251], v4, s[16:19], s44 offen offset:256 sc1
    buffer_store_dwordx4 v[252:255], v4, s[16:19], s44 offen offset:0 sc1
WH14:
    s_setprio 0
YB13:
    ds_read_b32 v64, v26
    ds_read_b32 v48, v14
    s_cmp_lg_u32 s87, 0
    s_cbranch_scc1 WH15
    s_waitcnt vmcnt(0)
    s_mov_b64 exec, 0xff
    buffer_store_dwordx4 v[6:9], v3, s[16:19], s45 offen sc1
    s_mov_b64 exec, -1
WH15:
    s_waitcnt lgkmcnt(0)
    v_mov_b32 v65, v64
    v_mov_b64 v[66:67], v[64:65]
    v_mov_b64 v[68:69], v[64:65]
    v_mov_b64 v[70:71], v[64:65]
    v_mov_b64 v[72:73], v[64:65]
    v_mov_b64 v[74:75], v[64:65]
    v_mov_b64 v[76:77], v[64:65]
    v_mov_b64 v[78:79], v[64:65]
    v_mov_b32 v49, v48
    v_mov_b64 v[50:51], v[48:49]
    v_mfma_f32_32x32x16_bf16 v[136:151], v[168:171], v[80:83], v[64:79]
    v_mfma_f32_32x32x16_bf16 v[136:151], v[172:175], v[84:87], v[136:151]
    v_mov_b64 v[52:53], v[48:49]
    v_mov_b64 v[54:55], v[48:49]
    v_mov_b64 v[56:57], v[48:49]
    v_mov_b64 v[58:59], v[48:49]
    v_mov_b64 v[60:61], v[48:49]
    v_mov_b64 v[62:63], v[48:49]
    s_nop 5
XS0:
    v_exp_f32 v136, v136
    v_exp_f32 v137, v137
    s_waitcnt lgkmcnt(0)
    v_exp_f32 v138, v138
    ds_read_b128 v[176:179], v8 offset:4096
    v_exp_f32 v139, v139
    v_exp_f32 v140, v140
    v_exp_f32 v141, v141
    v_mfma_f32_32x32x16_bf16 v[152:167], v[168:171], v[88:91], v[48:63]
    ds_read_b128 v[180:183], v8 offset:5120
    v_exp_f32 v142, v142
    v_exp_f32 v143, v143
    v_exp_f32 v144, v144
    v_mfma_f32_32x32x16_bf16 v[152:167], v[172:175], v[92:95], v[152:167]
    s_setprio 2
    v_exp_f32 v145, v145
    v_exp_f32 v146, v146
    v_exp_f32 v147, v147
    v_smfmac_f32_16x16x64_bf16 v[128:131], v[28:31], v[136:143], v17
    s_nop 0
    v_exp_f32 v148, v148
    v_smfmac_f32_32x32x32_bf16 v[96:111], v[184:187], v[136:143], v17
    s_nop 0
    v_exp_f32 v149, v149
    v_exp_f32 v150, v150
    v_exp_f32 v151, v151
XS1:
    v_exp_f32 v152, v152
    v_exp_f32 v153, v153
    v_smfmac_f32_16x16x64_bf16 v[128:131], v[28:31], v[144:151], v17
    s_waitcnt lgkmcnt(0)
    v_exp_f32 v154, v154
    v_smfmac_f32_32x32x32_bf16 v[96:111], v[188:191], v[144:151], v17
    ds_read_b128 v[192:195], v10 offset:6144
    s_cmp_lt_u32 s20, 4
    s_cbranch_scc1 YB17
    s_waitcnt vmcnt(0)
    s_mov_b64 exec, 0xff
    buffer_store_dwordx4 v[6:9], v3, s[16:19], s33 offen sc1
    s_mov_b64 exec, -1
    s_cmp_lg_u32 s87, 1
    s_cbranch_scc1 WH18
    s_mov_b64 exec, 0xff
    buffer_store_dwordx4 v[6:9], v3, s[16:19], s45 offen sc1
    s_mov_b64 exec, -1
WH18:
YB17:
    v_exp_f32 v155, v155
    v_exp_f32 v156, v156
    v_exp_f32 v157, v157
    v_mfma_f32_32x32x16_bf16 v[136:151], v[176:179], v[80:83], v[64:79]
    ds_read_b128 v[196:199], v10 offset:7168
    v_exp_f32 v158, v158
    v_exp_f32 v159, v159
    v_exp_f32 v160, v160
    v_mfma_f32_32x32x16_bf16 v[136:151], v[180:183], v[84:87], v[136:151]
    s_nop 0
    v_exp_f32 v161, v161
    v_exp_f32 v162, v162
    v_exp_f32 v163, v163
    v_smfmac_f32_16x16x64_bf16 v[132:135], v[28:31], v[152:159], v17
    s_nop 0
    v_exp_f32 v164, v164
    v_smfmac_f32_32x32x32_bf16 v[112:127], v[184:187], v[152:159], v17
    s_nop 0
    v_exp_f32 v165, v165
    v_exp_f32 v166, v166
    v_exp_f32 v167, v167
XS2:
    v_exp_f32 v136, v136
    v_exp_f32 v137, v137
    v_smfmac_f32_16x16x64_bf16 v[132:135], v[28:31], v[160:167], v17
    s_waitcnt lgkmcnt(0)
    v_exp_f32 v138, v138
    v_smfmac_f32_32x32x32_bf16 v[112:127], v[188:191], v[160:167], v17
    ds_read_b128 v[168:171], v8 offset:8192
    v_exp_f32 v139, v139
    v_exp_f32 v140, v140
    v_exp_f32 v141, v141
    v_mfma_f32_32x32x16_bf16 v[152:167], v[176:179], v[88:91], v[48:63]
    ds_read_b128 v[172:175], v8 offset:9216
    v_exp_f32 v142, v142
    v_exp_f32 v143, v143
    v_exp_f32 v144, v144
    v_mfma_f32_32x32x16_bf16 v[152:167], v[180:183], v[92:95], v[152:167]
    s_setprio 1
    v_exp_f32 v145, v145
    v_exp_f32 v146, v146
    v_exp_f32 v147, v147
    v_smfmac_f32_16x16x64_bf16 v[128:131], v[28:31], v[136:143], v17
    s_nop 0
    v_exp_f32 v148, v148
    v_smfmac_f32_32x32x32_bf16 v[96:111], v[192:195], v[136:143], v17
    s_cmp_ge_u32 s20, 4
    s_cbranch_scc1 OB19
    s_mov_b32 exec_lo, s88
    s_mov_b32 exec_hi, 0
    buffer_load_dwordx2 v[14:15], v5, s[16:19], s58 offen sc1
    s_mov_b64 exec, -1
OB19:
    v_exp_f32 v149, v149
    v_exp_f32 v150, v150
    v_exp_f32 v151, v151
XS3:
    v_exp_f32 v152, v152
    v_exp_f32 v153, v153
    v_smfmac_f32_16x16x64_bf16 v[128:131], v[28:31], v[144:151], v17
    s_waitcnt lgkmcnt(0)
    v_exp_f32 v154, v154
    v_smfmac_f32_32x32x32_bf16 v[96:111], v[196:199], v[144:151], v17
    ds_read_b128 v[184:187], v10 offset:10240
    s_cmp_lg_u32 s87, 2
    s_cbranch_scc1 WH20
    buffer_store_dwordx4 v[224:227], v4, s[16:19], s35 offen offset:256 sc1
    buffer_store_dwordx4 v[228:231], v4, s[16:19], s35 offen offset:0 sc1
    buffer_store_dwordx4 v[232:235], v4, s[16:19], s35 offen offset:2048 sc1
    buffer_store_dwordx4 v[236:239], v4, s[16:19], s35 offen offset:2304 sc1
    buffer_store_dwordx4 v[240:243], v4, s[16:19], s44 offen offset:2048 sc1
    buffer_store_dwordx4 v[244:247], v4, s[16:19], s44 offen offset:2304 sc1
    buffer_store_dwordx4 v[248:251], v4, s[16:19], s44 offen offset:256 sc1
    buffer_store_dwordx4 v[252:255], v4, s[16:19], s44 offen offset:0 sc1
WH20:
    v_exp_f32 v155, v155
    v_exp_f32 v156, v156
    v_exp_f32 v157, v157
    v_mfma_f32_32x32x16_bf16 v[136:151], v[168:171], v[80:83], v[64:79]
    ds_read_b128 v[188:191], v10 offset:11264
    v_exp_f32 v158, v158
    v_exp_f32 v159, v159
    v_exp_f32 v160, v160
    v_mfma_f32_32x32x16_bf16 v[136:151], v[172:175], v[84:87], v[136:151]
    s_nop 0
    v_exp_f32 v161, v161
    v_exp_f32 v162, v162
    v_exp_f32 v163, v163
    v_smfmac_f32_16x16x64_bf16 v[132:135], v[28:31], v[152:159], v17
    s_nop 0
    v_exp_f32 v164, v164
    v_smfmac_f32_32x32x32_bf16 v[112:127], v[192:195], v[152:159], v17
    s_cmp_ge_u32 s20, 4
    s_cbranch_scc1 OB21
    s_waitcnt vmcnt(0)
    v_cmp_eq_u64 vcc, v[6:7], v[14:15]
    s_and_b32 s27, vcc_lo, s88
    s_cmp_eq_u32 s27, s88
    s_cbranch_scc0 FC22
FD23:
    s_and_b32 s31, s21, 3
    s_cmp_ge_u32 s31, 1
    s_cselect_b32 s31, 0, 1
    s_and_b32 s27, s21, 4
    s_or_b32 s31, s31, s27
    s_lshl_b32 s31, s31, 15
    s_add_u32 s31, s31, s54
    s_add_u32 s31, s31, s56
    s_add_u32 m0, s56, 131072
    s_nop 0
    buffer_load_dwordx4 v3, s[16:19], s31 offen offset:0 sc1 lds
    buffer_load_dwordx4 v3, s[16:19], s31 offen offset:1024 sc1 lds
    buffer_load_dwordx4 v3, s[16:19], s31 offen offset:2048 sc1 lds
    buffer_load_dwordx4 v3, s[16:19], s31 offen offset:3072 sc1 lds
    s_add_u32 m0, s56, 135168
    s_add_u32 s31, s31, 4096
    buffer_load_dwordx4 v3, s[16:19], s31 offen offset:0 sc1 lds
    buffer_load_dwordx4 v3, s[16:19], s31 offen offset:1024 sc1 lds
    buffer_load_dwordx4 v3, s[16:19], s31 offen offset:2048 sc1 lds
    buffer_load_dwordx4 v3, s[16:19], s31 offen offset:3072 sc1 lds
OB21:
    v_exp_f32 v165, v165
    v_exp_f32 v166, v166
    v_exp_f32 v167, v167
XS4:
    v_exp_f32 v136, v136
    v_exp_f32 v137, v137
    v_smfmac_f32_16x16x64_bf16 v[132:135], v[28:31], v[160:167], v17
    s_waitcnt lgkmcnt(0)
    v_exp_f32 v138, v138
    v_smfmac_f32_32x32x32_bf16 v[112:127], v[196:199], v[160:167], v17
    ds_read_b128 v[176:179], v8 offset:12288
    v_exp_f32 v139, v139
    v_exp_f32 v140, v140
    v_exp_f32 v141, v141
    v_mfma_f32_32x32x16_bf16 v[152:167], v[168:171], v[88:91], v[48:63]
    ds_read_b128 v[180:183], v8 offset:13312
    v_exp_f32 v142, v142
    v_exp_f32 v143, v143
    v_exp_f32 v144, v144
    v_mfma_f32_32x32x16_bf16 v[152:167], v[172:175], v[92:95], v[152:167]
    s_setprio 0
    v_exp_f32 v145, v145
    v_exp_f32 v146, v146
    v_exp_f32 v147, v147
    v_smfmac_f32_16x16x64_bf16 v[128:131], v[28:31], v[136:143], v17
    s_nop 0
    v_exp_f32 v148, v148
    v_smfmac_f32_32x32x32_bf16 v[96:111], v[184:187], v[136:143], v17
    s_nop 0
    v_exp_f32 v149, v149
    v_exp_f32 v150, v150
    v_exp_f32 v151, v151
XS5:
    v_exp_f32 v152, v152
    v_exp_f32 v153, v153
    v_smfmac_f32_16x16x64_bf16 v[128:131], v[28:31], v[144:151], v17
    s_waitcnt lgkmcnt(0)
    v_exp_f32 v154, v154
    v_smfmac_f32_32x32x32_bf16 v[96:111], v[188:191], v[144:151], v17
    ds_read_b128 v[192:195], v10 offset:14336
    v_exp_f32 v155, v155
    v_exp_f32 v156, v156
    v_exp_f32 v157, v157
    v_mfma_f32_32x32x16_bf16 v[136:151], v[176:179], v[80:83], v[64:79]
    ds_read_b128 v[196:199], v10 offset:15360
    v_exp_f32 v158, v158
    v_exp_f32 v159, v159
    v_exp_f32 v160, v160
    v_mfma_f32_32x32x16_bf16 v[136:151], v[180:183], v[84:87], v[136:151]
    s_nop 0
    v_exp_f32 v161, v161
    v_exp_f32 v162, v162
    v_exp_f32 v163, v163
    v_smfmac_f32_16x16x64_bf16 v[132:135], v[28:31], v[152:159], v17
    s_nop 0
    v_exp_f32 v164, v164
    v_smfmac_f32_32x32x32_bf16 v[112:127], v[184:187], v[152:159], v17
    s_mov_b32 exec_lo, s89
    s_mov_b32 exec_hi, 0
    buffer_load_dwordx2 v[14:15], v5, s[16:19], s58 offen sc1
    s_mov_b64 exec, -1
    v_exp_f32 v165, v165
    v_exp_f32 v166, v166
    v_exp_f32 v167, v167
XS6:
    v_exp_f32 v136, v136
    v_exp_f32 v137, v137
    v_smfmac_f32_16x16x64_bf16 v[132:135], v[28:31], v[160:167], v17
    s_waitcnt vmcnt(1) lgkmcnt(0)
    s_barrier
    v_exp_f32 v138, v138
    v_smfmac_f32_32x32x32_bf16 v[112:127], v[188:191], v[160:167], v17
    ds_read_b128 v[168:171], v8 offset:32768
    v_exp_f32 v139, v139
    v_exp_f32 v140, v140
    v_exp_f32 v141, v141
    v_mfma_f32_32x32x16_bf16 v[152:167], v[176:179], v[88:91], v[48:63]
    ds_read_b128 v[172:175], v8 offset:33792
    s_waitcnt vmcnt(0)
    s_cmp_eq_u32 s87, 2
    s_cselect_b64 exec, 0xff, 0
    buffer_store_dwordx4 v[6:9], v3, s[16:19], s45 offen sc1
    s_mov_b64 exec, -1
    v_cmp_eq_u64 vcc, v[6:7], v[14:15]
    s_and_b32 s27, vcc_lo, s89
    s_cmp_eq_u32 s27, s89
    s_cbranch_scc0 FC24
FD25:
    v_exp_f32 v142, v142
    v_exp_f32 v143, v143
    v_exp_f32 v144, v144
    v_mfma_f32_32x32x16_bf16 v[152:167], v[180:183], v[92:95], v[152:167]
    s_and_b32 s31, s21, 3
    s_cmp_ge_u32 s31, 2
    s_cselect_b32 s31, 1, 2
    s_and_b32 s27, s21, 4
    s_or_b32 s31, s31, s27
    s_setprio 3
    v_exp_f32 v145, v145
    v_exp_f32 v146, v146
    v_exp_f32 v147, v147
    v_smfmac_f32_16x16x64_bf16 v[128:131], v[28:31], v[136:143], v17
    s_lshl_b32 s31, s31, 15
    s_add_u32 s31, s31, s54
    s_add_u32 s31, s31, s57
    s_add_u32 m0, s57, 98304
    v_exp_f32 v148, v148
    v_smfmac_f32_32x32x32_bf16 v[96:111], v[192:195], v[136:143], v17
    buffer_load_dwordx4 v3, s[16:19], s31 offen offset:0 sc1 lds
    v_exp_f32 v149, v149
    v_exp_f32 v150, v150
    v_exp_f32 v151, v151
XS7:
    v_exp_f32 v152, v152
    v_exp_f32 v153, v153
    v_smfmac_f32_16x16x64_bf16 v[128:131], v[28:31], v[144:151], v17
    s_waitcnt lgkmcnt(0)
    v_exp_f32 v154, v154
    v_smfmac_f32_32x32x32_bf16 v[96:111], v[196:199], v[144:151], v17
    ds_read_b128 v[184:187], v10 offset:34816
    v_exp_f32 v155, v155
    v_exp_f32 v156, v156
    v_exp_f32 v157, v157
    v_mfma_f32_32x32x16_bf16 v[136:151], v[168:171], v[80:83], v[64:79]
    ds_read_b128 v[188:191], v10 offset:35840
    v_exp_f32 v158, v158
    v_exp_f32 v159, v159
    v_exp_f32 v160, v160
    v_mfma_f32_32x32x16_bf16 v[136:151], v[172:175], v[84:87], v[136:151]
    s_nop 0
    v_exp_f32 v161, v161
    v_exp_f32 v162, v162
    v_exp_f32 v163, v163
    v_smfmac_f32_16x16x64_bf16 v[132:135], v[28:31], v[152:159], v17
    s_nop 0
    v_exp_f32 v164, v164
    v_smfmac_f32_32x32x32_bf16 v[112:127], v[192:195], v[152:159], v17
    buffer_load_dwordx4 v3, s[16:19], s31 offen offset:1024 sc1 lds
    v_exp_f32 v165, v165
    v_exp_f32 v166, v166
    v_exp_f32 v167, v167
XS8:
    v_exp_f32 v136, v136
    v_exp_f32 v137, v137
    v_smfmac_f32_16x16x64_bf16 v[132:135], v[28:31], v[160:167], v17
    s_waitcnt lgkmcnt(0)
    v_exp_f32 v138, v138
    v_smfmac_f32_32x32x32_bf16 v[112:127], v[196:199], v[160:167], v17
    ds_read_b128 v[176:179], v8 offset:36864
    v_exp_f32 v139, v139
    v_exp_f32 v140, v140
    v_exp_f32 v141, v141
    v_mfma_f32_32x32x16_bf16 v[152:167], v[168:171], v[88:91], v[48:63]
    ds_read_b128 v[180:183], v8 offset:37888
    v_exp_f32 v142, v142
    v_exp_f32 v143, v143
    v_exp_f32 v144, v144
    v_mfma_f32_32x32x16_bf16 v[152:167], v[172:175], v[92:95], v[152:167]
    s_setprio 2
    v_exp_f32 v145, v145
    v_exp_f32 v146, v146
    v_exp_f32 v147, v147
    v_smfmac_f32_16x16x64_bf16 v[128:131], v[28:31], v[136:143], v17
    s_nop 0
    v_exp_f32 v148, v148
    v_smfmac_f32_32x32x32_bf16 v[96:111], v[184:187], v[136:143], v17
    buffer_load_dwordx4 v3, s[16:19], s31 offen offset:2048 sc1 lds
    v_exp_f32 v149, v149
    v_exp_f32 v150, v150
    v_exp_f32 v151, v151
XS9:
    v_exp_f32 v152, v152
    v_exp_f32 v153, v153
    v_smfmac_f32_16x16x64_bf16 v[128:131], v[28:31], v[144:151], v17
    s_waitcnt lgkmcnt(0)
    v_exp_f32 v154, v154
    v_smfmac_f32_32x32x32_bf16 v[96:111], v[188:191], v[144:151], v17
    ds_read_b128 v[192:195], v10 offset:38912
    v_exp_f32 v155, v155
    v_exp_f32 v156, v156
    v_exp_f32 v157, v157
    v_mfma_f32_32x32x16_bf16 v[136:151], v[176:179], v[80:83], v[64:79]
    ds_read_b128 v[196:199], v10 offset:39936
    v_exp_f32 v158, v158
    v_exp_f32 v159, v159
    v_exp_f32 v160, v160
    v_mfma_f32_32x32x16_bf16 v[136:151], v[180:183], v[84:87], v[136:151]
    s_nop 0
    v_exp_f32 v161, v161
    v_exp_f32 v162, v162
    v_exp_f32 v163, v163
    v_smfmac_f32_16x16x64_bf16 v[132:135], v[28:31], v[152:159], v17
    s_nop 0
    v_exp_f32 v164, v164
    v_smfmac_f32_32x32x32_bf16 v[112:127], v[184:187], v[152:159], v17
    buffer_load_dwordx4 v3, s[16:19], s31 offen offset:3072 sc1 lds
    v_exp_f32 v165, v165
    v_exp_f32 v166, v166
    v_exp_f32 v167, v167
XS10:
    v_exp_f32 v136, v136
    v_exp_f32 v137, v137
    v_smfmac_f32_16x16x64_bf16 v[132:135], v[28:31], v[160:167], v17
    s_waitcnt lgkmcnt(0)
    v_exp_f32 v138, v138
    v_smfmac_f32_32x32x32_bf16 v[112:127], v[188:191], v[160:167], v17
    ds_read_b128 v[168:171], v8 offset:40960
    s_cmp_lg_u32 s87, 3
    s_cbranch_scc1 WH26
    buffer_store_dwordx4 v[224:227], v4, s[16:19], s35 offen offset:256 sc1
    buffer_store_dwordx4 v[228:231], v4, s[16:19], s35 offen offset:0 sc1
    buffer_store_dwordx4 v[232:235], v4, s[16:19], s35 offen offset:2048 sc1
    buffer_store_dwordx4 v[236:239], v4, s[16:19], s35 offen offset:2304 sc1
    buffer_store_dwordx4 v[240:243], v4, s[16:19], s44 offen offset:2048 sc1
    buffer_store_dwordx4 v[244:247], v4, s[16:19], s44 offen offset:2304 sc1
    buffer_store_dwordx4 v[248:251], v4, s[16:19], s44 offen offset:256 sc1
    buffer_store_dwordx4 v[252:255], v4, s[16:19], s44 offen offset:0 sc1
WH26:
    v_exp_f32 v139, v139
    v_exp_f32 v140, v140
    v_exp_f32 v141, v141
    v_mfma_f32_32x32x16_bf16 v[152:167], v[176:179], v[88:91], v[48:63]
    ds_read_b128 v[172:175], v8 offset:41984
    v_exp_f32 v142, v142
    v_exp_f32 v143, v143
    v_exp_f32 v144, v144
    v_mfma_f32_32x32x16_bf16 v[152:167], v[180:183], v[92:95], v[152:167]
    s_setprio 1
    v_exp_f32 v145, v145
    v_exp_f32 v146, v146
    v_exp_f32 v147, v147
    v_smfmac_f32_16x16x64_bf16 v[128:131], v[28:31], v[136:143], v17
    s_nop 0
    v_exp_f32 v148, v148
    v_smfmac_f32_32x32x32_bf16 v[96:111], v[192:195], v[136:143], v17
    s_nop 0
    v_exp_f32 v149, v149
    v_exp_f32 v150, v150
    v_exp_f32 v151, v151
XS11:
    v_exp_f32 v152, v152
    v_exp_f32 v153, v153
    v_smfmac_f32_16x16x64_bf16 v[128:131], v[28:31], v[144:151], v17
    s_waitcnt lgkmcnt(0)
    v_exp_f32 v154, v154
    v_smfmac_f32_32x32x32_bf16 v[96:111], v[196:199], v[144:151], v17
    ds_read_b128 v[184:187], v10 offset:43008
    v_exp_f32 v155, v155
    v_exp_f32 v156, v156
    v_exp_f32 v157, v157
    v_mfma_f32_32x32x16_bf16 v[136:151], v[168:171], v[80:83], v[64:79]
    ds_read_b128 v[188:191], v10 offset:44032
    v_exp_f32 v158, v158
    v_exp_f32 v159, v159
    v_exp_f32 v160, v160
    v_mfma_f32_32x32x16_bf16 v[136:151], v[172:175], v[84:87], v[136:151]
    s_nop 0
    v_exp_f32 v161, v161
    v_exp_f32 v162, v162
    v_exp_f32 v163, v163
    v_smfmac_f32_16x16x64_bf16 v[132:135], v[28:31], v[152:159], v17
    s_nop 0
    v_exp_f32 v164, v164
    v_smfmac_f32_32x32x32_bf16 v[112:127], v[192:195], v[152:159], v17
    s_mov_b32 exec_lo, s3
    s_mov_b32 exec_hi, 0
    buffer_load_dwordx2 v[14:15], v5, s[16:19], s58 offen sc1
    s_mov_b64 exec, -1
    v_exp_f32 v165, v165
    v_exp_f32 v166, v166
    v_exp_f32 v167, v167
XS12:
    v_exp_f32 v136, v136
    v_exp_f32 v137, v137
    v_smfmac_f32_16x16x64_bf16 v[132:135], v[28:31], v[160:167], v17
    s_waitcnt lgkmcnt(0)
    v_exp_f32 v138, v138
    v_smfmac_f32_32x32x32_bf16 v[112:127], v[196:199], v[160:167], v17
    ds_read_b128 v[176:179], v8 offset:45056
    v_exp_f32 v139, v139
    v_exp_f32 v140, v140
    v_exp_f32 v141, v141
    v_mfma_f32_32x32x16_bf16 v[152:167], v[168:171], v[88:91], v[48:63]
    ds_read_b128 v[180:183], v8 offset:46080
    v_exp_f32 v142, v142
    v_exp_f32 v143, v143
    v_exp_f32 v144, v144
    v_mfma_f32_32x32x16_bf16 v[152:167], v[172:175], v[92:95], v[152:167]
    s_setprio 0
    v_exp_f32 v145, v145
    v_exp_f32 v146, v146
    v_exp_f32 v147, v147
    v_smfmac_f32_16x16x64_bf16 v[128:131], v[28:31], v[136:143], v17
    s_nop 0
    v_exp_f32 v148, v148
    v_smfmac_f32_32x32x32_bf16 v[96:111], v[184:187], v[136:143], v17
    s_nop 0
    v_exp_f32 v149, v149
    v_exp_f32 v150, v150
    v_exp_f32 v151, v151
XS13:
    v_exp_f32 v152, v152
    v_exp_f32 v153, v153
    v_smfmac_f32_16x16x64_bf16 v[128:131], v[28:31], v[144:151], v17
    s_waitcnt lgkmcnt(0)
    v_exp_f32 v154, v154
    v_smfmac_f32_32x32x32_bf16 v[96:111], v[188:191], v[144:151], v17
    ds_read_b128 v[192:195], v10 offset:47104
    v_exp_f32 v155, v155
    v_exp_f32 v156, v156
    v_exp_f32 v157, v157
    v_mfma_f32_32x32x16_bf16 v[136:151], v[176:179], v[80:83], v[64:79]
    ds_read_b128 v[196:199], v10 offset:48128
    v_exp_f32 v158, v158
    v_exp_f32 v159, v159
    v_exp_f32 v160, v160
    v_mfma_f32_32x32x16_bf16 v[136:151], v[180:183], v[84:87], v[136:151]
    s_nop 0
    v_exp_f32 v161, v161
    v_exp_f32 v162, v162
    v_exp_f32 v163, v163
    v_smfmac_f32_16x16x64_bf16 v[132:135], v[28:31], v[152:159], v17
    s_nop 0
    v_exp_f32 v164, v164
    v_smfmac_f32_32x32x32_bf16 v[112:127], v[184:187], v[152:159], v17
    s_nop 0
    v_exp_f32 v165, v165
    v_exp_f32 v166, v166
    v_exp_f32 v167, v167
XS14:
    v_exp_f32 v136, v136
    v_exp_f32 v137, v137
    v_smfmac_f32_16x16x64_bf16 v[132:135], v[28:31], v[160:167], v17
    s_waitcnt vmcnt(1) lgkmcnt(0)
    s_barrier
    v_exp_f32 v138, v138
    v_smfmac_f32_32x32x32_bf16 v[112:127], v[188:191], v[160:167], v17
    ds_read_b128 v[168:171], v8 offset:0
    v_exp_f32 v139, v139
    v_exp_f32 v140, v140
    v_exp_f32 v141, v141
    v_mfma_f32_32x32x16_bf16 v[152:167], v[176:179], v[88:91], v[48:63]
    ds_read_b128 v[172:175], v8 offset:1024
    s_waitcnt vmcnt(0)
    s_cmp_eq_u32 s87, 3
    s_cselect_b64 exec, 0xff, 0
    buffer_store_dwordx4 v[6:9], v3, s[16:19], s45 offen sc1
    s_mov_b64 exec, -1
    v_cmp_eq_u64 vcc, v[6:7], v[14:15]
    s_and_b32 s27, vcc_lo, s3
    s_cmp_eq_u32 s27, s3
    s_cbranch_scc0 FC27
FD28:
    v_exp_f32 v142, v142
    v_exp_f32 v143, v143
    v_exp_f32 v144, v144
    v_mfma_f32_32x32x16_bf16 v[152:167], v[180:183], v[92:95], v[152:167]
    s_and_b32 s31, s21, 3
    s_cmp_ge_u32 s31, 3
    s_cselect_b32 s31, 2, 3
    s_and_b32 s27, s21, 4
    s_or_b32 s31, s31, s27
    s_setprio 3
    v_exp_f32 v145, v145
    v_exp_f32 v146, v146
    v_exp_f32 v147, v147
    v_smfmac_f32_16x16x64_bf16 v[128:131], v[28:31], v[136:143], v17
    s_lshl_b32 s31, s31, 15
    s_add_u32 s31, s31, s54
    s_add_u32 s31, s31, s57
    s_add_u32 m0, s57, 131072
    v_exp_f32 v148, v148
    v_smfmac_f32_32x32x32_bf16 v[96:111], v[192:195], v[136:143], v17
    buffer_load_dwordx4 v3, s[16:19], s31 offen offset:0 sc1 lds
    v_exp_f32 v149, v149
    v_exp_f32 v150, v150
    v_exp_f32 v151, v151
XS15:
    v_exp_f32 v152, v152
    v_exp_f32 v153, v153
    v_smfmac_f32_16x16x64_bf16 v[128:131], v[28:31], v[144:151], v17
    s_waitcnt lgkmcnt(0)
    v_exp_f32 v154, v154
    v_smfmac_f32_32x32x32_bf16 v[96:111], v[196:199], v[144:151], v17
    ds_read_b128 v[184:187], v10 offset:2048
    v_exp_f32 v155, v155
    v_exp_f32 v156, v156
    v_exp_f32 v157, v157
    v_mfma_f32_32x32x16_bf16 v[136:151], v[168:171], v[80:83], v[64:79]
    ds_read_b128 v[188:191], v10 offset:3072
    v_exp_f32 v158, v158
    v_exp_f32 v159, v159
    v_exp_f32 v160, v160
    v_mfma_f32_32x32x16_bf16 v[136:151], v[172:175], v[84:87], v[136:151]
    s_nop 0
    v_exp_f32 v161, v161
    v_exp_f32 v162, v162
    v_exp_f32 v163, v163
    v_smfmac_f32_16x16x64_bf16 v[132:135], v[28:31], v[152:159], v17
    s_nop 0
    v_exp_f32 v164, v164
    v_smfmac_f32_32x32x32_bf16 v[112:127], v[192:195], v[152:159], v17
    buffer_load_dwordx4 v3, s[16:19], s31 offen offset:1024 sc1 lds
    v_exp_f32 v165, v165
    v_exp_f32 v166, v166
    v_exp_f32 v167, v167
XS16:
    v_exp_f32 v136, v136
    v_exp_f32 v137, v137
    v_smfmac_f32_16x16x64_bf16 v[132:135], v[28:31], v[160:167], v17
    s_waitcnt lgkmcnt(0)
    v_exp_f32 v138, v138
    v_smfmac_f32_32x32x32_bf16 v[112:127], v[196:199], v[160:167], v17
    ds_read_b128 v[176:179], v8 offset:4096
    v_exp_f32 v139, v139
    v_exp_f32 v140, v140
    v_exp_f32 v141, v141
    v_mfma_f32_32x32x16_bf16 v[152:167], v[168:171], v[88:91], v[48:63]
    ds_read_b128 v[180:183], v8 offset:5120
    v_exp_f32 v142, v142
    v_exp_f32 v143, v143
    v_exp_f32 v144, v144
    v_mfma_f32_32x32x16_bf16 v[152:167], v[172:175], v[92:95], v[152:167]
    s_setprio 2
    v_exp_f32 v145, v145
    v_exp_f32 v146, v146
    v_exp_f32 v147, v147
    v_smfmac_f32_16x16x64_bf16 v[128:131], v[28:31], v[136:143], v17
    s_nop 0
    v_exp_f32 v148, v148
    v_smfmac_f32_32x32x32_bf16 v[96:111], v[184:187], v[136:143], v17
    buffer_load_dwordx4 v3, s[16:19], s31 offen offset:2048 sc1 lds
    v_exp_f32 v149, v149
    v_exp_f32 v150, v150
    v_exp_f32 v151, v151
XS17:
    v_exp_f32 v152, v152
    v_exp_f32 v153, v153
    v_smfmac_f32_16x16x64_bf16 v[128:131], v[28:31], v[144:151], v17
    s_waitcnt lgkmcnt(0)
    v_exp_f32 v154, v154
    v_smfmac_f32_32x32x32_bf16 v[96:111], v[188:191], v[144:151], v17
    ds_read_b128 v[192:195], v10 offset:6144
    v_exp_f32 v155, v155
    v_exp_f32 v156, v156
    v_exp_f32 v157, v157
    v_mfma_f32_32x32x16_bf16 v[136:151], v[176:179], v[80:83], v[64:79]
    ds_read_b128 v[196:199], v10 offset:7168
    v_exp_f32 v158, v158
    v_exp_f32 v159, v159
    v_exp_f32 v160, v160
    v_mfma_f32_32x32x16_bf16 v[136:151], v[180:183], v[84:87], v[136:151]
    s_nop 0
    v_exp_f32 v161, v161
    v_exp_f32 v162, v162
    v_exp_f32 v163, v163
    v_smfmac_f32_16x16x64_bf16 v[132:135], v[28:31], v[152:159], v17
    s_nop 0
    v_exp_f32 v164, v164
    v_smfmac_f32_32x32x32_bf16 v[112:127], v[184:187], v[152:159], v17
    buffer_load_dwordx4 v3, s[16:19], s31 offen offset:3072 sc1 lds
    v_exp_f32 v165, v165
    v_exp_f32 v166, v166
    v_exp_f32 v167, v167
XS18:
    v_exp_f32 v136, v136
    v_exp_f32 v137, v137
    v_smfmac_f32_16x16x64_bf16 v[132:135], v[28:31], v[160:167], v17
    s_waitcnt lgkmcnt(0)
    v_exp_f32 v138, v138
    v_smfmac_f32_32x32x32_bf16 v[112:127], v[188:191], v[160:167], v17
    ds_read_b128 v[168:171], v8 offset:8192
    v_exp_f32 v139, v139
    v_exp_f32 v140, v140
    v_exp_f32 v141, v141
    v_mfma_f32_32x32x16_bf16 v[152:167], v[176:179], v[88:91], v[48:63]
    ds_read_b128 v[172:175], v8 offset:9216
    v_exp_f32 v142, v142
    v_exp_f32 v143, v143
    v_exp_f32 v144, v144
    v_mfma_f32_32x32x16_bf16 v[152:167], v[180:183], v[92:95], v[152:167]
    s_setprio 1
    v_exp_f32 v145, v145
    v_exp_f32 v146, v146
    v_exp_f32 v147, v147
    v_smfmac_f32_16x16x64_bf16 v[128:131], v[28:31], v[136:143], v17
    s_nop 0
    v_exp_f32 v148, v148
    v_smfmac_f32_32x32x32_bf16 v[96:111], v[192:195], v[136:143], v17
    s_nop 0
    v_exp_f32 v149, v149
    v_exp_f32 v150, v150
    v_exp_f32 v151, v151
XS19:
    v_exp_f32 v152, v152
    v_exp_f32 v153, v153
    v_smfmac_f32_16x16x64_bf16 v[128:131], v[28:31], v[144:151], v17
    s_waitcnt lgkmcnt(0)
    v_exp_f32 v154, v154
    v_smfmac_f32_32x32x32_bf16 v[96:111], v[196:199], v[144:151], v17
    ds_read_b128 v[184:187], v10 offset:10240
    v_exp_f32 v155, v155
    v_exp_f32 v156, v156
    v_exp_f32 v157, v157
    v_mfma_f32_32x32x16_bf16 v[136:151], v[168:171], v[80:83], v[64:79]
    ds_read_b128 v[188:191], v10 offset:11264
    v_exp_f32 v158, v158
    v_exp_f32 v159, v159
    v_exp_f32 v160, v160
    v_mfma_f32_32x32x16_bf16 v[136:151], v[172:175], v[84:87], v[136:151]
    s_nop 0
    v_exp_f32 v161, v161
    v_exp_f32 v162, v162
    v_exp_f32 v163, v163
    v_smfmac_f32_16x16x64_bf16 v[132:135], v[28:31], v[152:159], v17
    s_nop 0
    v_exp_f32 v164, v164
    v_smfmac_f32_32x32x32_bf16 v[112:127], v[192:195], v[152:159], v17
    s_nop 0
    v_exp_f32 v165, v165
    v_exp_f32 v166, v166
    v_exp_f32 v167, v167
XS20:
    v_exp_f32 v136, v136
    v_exp_f32 v137, v137
    v_smfmac_f32_16x16x64_bf16 v[132:135], v[28:31], v[160:167], v17
    s_waitcnt lgkmcnt(0)
    v_exp_f32 v138, v138
    v_smfmac_f32_32x32x32_bf16 v[112:127], v[196:199], v[160:167], v17
    ds_read_b128 v[176:179], v8 offset:12288
    v_exp_f32 v139, v139
    v_exp_f32 v140, v140
    v_exp_f32 v141, v141
    v_mfma_f32_32x32x16_bf16 v[152:167], v[168:171], v[88:91], v[48:63]
    ds_read_b128 v[180:183], v8 offset:13312
    v_exp_f32 v142, v142
    v_exp_f32 v143, v143
    v_exp_f32 v144, v144
    v_mfma_f32_32x32x16_bf16 v[152:167], v[172:175], v[92:95], v[152:167]
    s_setprio 0
    v_exp_f32 v145, v145
    v_exp_f32 v146, v146
    v_exp_f32 v147, v147
    v_smfmac_f32_16x16x64_bf16 v[128:131], v[28:31], v[136:143], v17
    s_nop 0
    v_exp_f32 v148, v148
    v_smfmac_f32_32x32x32_bf16 v[96:111], v[184:187], v[136:143], v17
    s_mov_b32 exec_lo, s61
    s_mov_b32 exec_hi, 0
    buffer_load_dwordx2 v[14:15], v5, s[16:19], s58 offen sc1
    s_mov_b64 exec, -1
    v_exp_f32 v149, v149
    v_exp_f32 v150, v150
    v_exp_f32 v151, v151
XS21:
    v_exp_f32 v152, v152
    v_exp_f32 v153, v153
    v_smfmac_f32_16x16x64_bf16 v[128:131], v[28:31], v[144:151], v17
    s_waitcnt lgkmcnt(0)
    v_exp_f32 v154, v154
    v_smfmac_f32_32x32x32_bf16 v[96:111], v[188:191], v[144:151], v17
    ds_read_b128 v[192:195], v10 offset:14336
    v_exp_f32 v155, v155
    v_exp_f32 v156, v156
    v_exp_f32 v157, v157
    v_mfma_f32_32x32x16_bf16 v[136:151], v[176:179], v[80:83], v[64:79]
    ds_read_b128 v[196:199], v10 offset:15360
    v_exp_f32 v158, v158
    v_exp_f32 v159, v159
    v_exp_f32 v160, v160
    v_mfma_f32_32x32x16_bf16 v[136:151], v[180:183], v[84:87], v[136:151]
    s_nop 0
    v_exp_f32 v161, v161
    v_exp_f32 v162, v162
    v_exp_f32 v163, v163
    v_smfmac_f32_16x16x64_bf16 v[132:135], v[28:31], v[152:159], v17
    s_nop 0
    v_exp_f32 v164, v164
    v_smfmac_f32_32x32x32_bf16 v[112:127], v[184:187], v[152:159], v17
    s_nop 0
    v_exp_f32 v165, v165
    v_exp_f32 v166, v166
    v_exp_f32 v167, v167
XS22:
    v_exp_f32 v136, v136
    v_exp_f32 v137, v137
    v_smfmac_f32_16x16x64_bf16 v[132:135], v[28:31], v[160:167], v17
    s_waitcnt vmcnt(1) lgkmcnt(0)
    s_barrier
    v_exp_f32 v138, v138
    v_smfmac_f32_32x32x32_bf16 v[112:127], v[188:191], v[160:167], v17
    ds_read_b128 v[168:171], v8 offset:32768
    v_exp_f32 v139, v139
    v_exp_f32 v140, v140
    v_exp_f32 v141, v141
    v_mfma_f32_32x32x16_bf16 v[152:167], v[176:179], v[88:91], v[48:63]
    ds_read_b128 v[172:175], v8 offset:33792
    s_waitcnt vmcnt(0)
    v_cmp_eq_u64 vcc, v[6:7], v[14:15]
    s_and_b32 s27, vcc_lo, s61
    s_cmp_eq_u32 s27, s61
    s_cbranch_scc0 FC29
FD30:
    v_exp_f32 v142, v142
    v_exp_f32 v143, v143
    v_exp_f32 v144, v144
    v_mfma_f32_32x32x16_bf16 v[152:167], v[180:183], v[92:95], v[152:167]
    s_and_b32 s31, s21, 4
    s_xor_b32 s31, s31, 4
    s_lshl_b32 s31, s31, 15
    s_setprio 3
    v_exp_f32 v145, v145
    v_exp_f32 v146, v146
    v_exp_f32 v147, v147
    v_smfmac_f32_16x16x64_bf16 v[128:131], v[28:31], v[136:143], v17
    s_add_u32 s31, s31, s54
    s_add_u32 s31, s31, s57
    s_add_u32 m0, s57, 98304
    v_exp_f32 v148, v148
    v_smfmac_f32_32x32x32_bf16 v[96:111], v[192:195], v[136:143], v17
    buffer_load_dwordx4 v3, s[16:19], s31 offen offset:0 sc1 lds
    v_exp_f32 v149, v149
    v_exp_f32 v150, v150
    v_exp_f32 v151, v151
XS23:
    v_exp_f32 v152, v152
    v_exp_f32 v153, v153
    v_smfmac_f32_16x16x64_bf16 v[128:131], v[28:31], v[144:151], v17
    s_waitcnt lgkmcnt(0)
    v_exp_f32 v154, v154
    v_smfmac_f32_32x32x32_bf16 v[96:111], v[196:199], v[144:151], v17
    ds_read_b128 v[184:187], v10 offset:34816
    v_exp_f32 v155, v155
    v_exp_f32 v156, v156
    v_exp_f32 v157, v157
    v_mfma_f32_32x32x16_bf16 v[136:151], v[168:171], v[80:83], v[64:79]
    ds_read_b128 v[188:191], v10 offset:35840
    v_exp_f32 v158, v158
    v_exp_f32 v159, v159
    v_exp_f32 v160, v160
    v_mfma_f32_32x32x16_bf16 v[136:151], v[172:175], v[84:87], v[136:151]
    s_nop 0
    v_exp_f32 v161, v161
    v_exp_f32 v162, v162
    v_exp_f32 v163, v163
    v_smfmac_f32_16x16x64_bf16 v[132:135], v[28:31], v[152:159], v17
    s_nop 0
    v_exp_f32 v164, v164
    v_smfmac_f32_32x32x32_bf16 v[112:127], v[192:195], v[152:159], v17
    buffer_load_dwordx4 v3, s[16:19], s31 offen offset:1024 sc1 lds
    v_exp_f32 v165, v165
    v_exp_f32 v166, v166
    v_exp_f32 v167, v167
XS24:
    v_exp_f32 v136, v136
    v_exp_f32 v137, v137
    v_smfmac_f32_16x16x64_bf16 v[132:135], v[28:31], v[160:167], v17
    s_waitcnt lgkmcnt(0)
    v_exp_f32 v138, v138
    v_smfmac_f32_32x32x32_bf16 v[112:127], v[196:199], v[160:167], v17
    ds_read_b128 v[176:179], v8 offset:36864
    v_exp_f32 v139, v139
    v_exp_f32 v140, v140
    v_exp_f32 v141, v141
    v_mfma_f32_32x32x16_bf16 v[152:167], v[168:171], v[88:91], v[48:63]
    ds_read_b128 v[180:183], v8 offset:37888
    v_exp_f32 v142, v142
    v_exp_f32 v143, v143
    v_exp_f32 v144, v144
    v_mfma_f32_32x32x16_bf16 v[152:167], v[172:175], v[92:95], v[152:167]
    s_setprio 2
    v_exp_f32 v145, v145
    v_exp_f32 v146, v146
    v_exp_f32 v147, v147
    v_smfmac_f32_16x16x64_bf16 v[128:131], v[28:31], v[136:143], v17
    s_nop 0
    v_exp_f32 v148, v148
    v_smfmac_f32_32x32x32_bf16 v[96:111], v[184:187], v[136:143], v17
    buffer_load_dwordx4 v3, s[16:19], s31 offen offset:2048 sc1 lds
    v_exp_f32 v149, v149
    v_exp_f32 v150, v150
    v_exp_f32 v151, v151
XS25:
    v_exp_f32 v152, v152
    v_exp_f32 v153, v153
    v_smfmac_f32_16x16x64_bf16 v[128:131], v[28:31], v[144:151], v17
    s_waitcnt lgkmcnt(0)
    v_exp_f32 v154, v154
    v_smfmac_f32_32x32x32_bf16 v[96:111], v[188:191], v[144:151], v17
    ds_read_b128 v[192:195], v10 offset:38912
    v_exp_f32 v155, v155
    v_exp_f32 v156, v156
    v_exp_f32 v157, v157
    v_mfma_f32_32x32x16_bf16 v[136:151], v[176:179], v[80:83], v[64:79]
    ds_read_b128 v[196:199], v10 offset:39936
    v_exp_f32 v158, v158
    v_exp_f32 v159, v159
    v_exp_f32 v160, v160
    v_mfma_f32_32x32x16_bf16 v[136:151], v[180:183], v[84:87], v[136:151]
    s_nop 0
    v_exp_f32 v161, v161
    v_exp_f32 v162, v162
    v_exp_f32 v163, v163
    v_smfmac_f32_16x16x64_bf16 v[132:135], v[28:31], v[152:159], v17
    s_nop 0
    v_exp_f32 v164, v164
    v_smfmac_f32_32x32x32_bf16 v[112:127], v[184:187], v[152:159], v17
    buffer_load_dwordx4 v3, s[16:19], s31 offen offset:3072 sc1 lds
    v_exp_f32 v165, v165
    v_exp_f32 v166, v166
    v_exp_f32 v167, v167
XS26:
    v_exp_f32 v136, v136
    v_exp_f32 v137, v137
    v_smfmac_f32_16x16x64_bf16 v[132:135], v[28:31], v[160:167], v17
    s_waitcnt lgkmcnt(0)
    v_exp_f32 v138, v138
    v_smfmac_f32_32x32x32_bf16 v[112:127], v[188:191], v[160:167], v17
    ds_read_b128 v[168:171], v8 offset:40960
    v_exp_f32 v139, v139
    v_exp_f32 v140, v140
    v_exp_f32 v141, v141
    v_mfma_f32_32x32x16_bf16 v[152:167], v[176:179], v[88:91], v[48:63]
    ds_read_b128 v[172:175], v8 offset:41984
    v_exp_f32 v142, v142
    v_exp_f32 v143, v143
    v_exp_f32 v144, v144
    v_mfma_f32_32x32x16_bf16 v[152:167], v[180:183], v[92:95], v[152:167]
    s_mov_b32 s51, 0
    s_setprio 1
    v_exp_f32 v145, v145
    v_exp_f32 v146, v146
    v_exp_f32 v147, v147
    v_smfmac_f32_16x16x64_bf16 v[128:131], v[28:31], v[136:143], v17
    s_nop 0
    v_exp_f32 v148, v148
    v_smfmac_f32_32x32x32_bf16 v[96:111], v[192:195], v[136:143], v17
    buffer_load_dword v27, v21, s[36:39], s51 offen
    v_exp_f32 v149, v149
    v_exp_f32 v150, v150
    v_exp_f32 v151, v151
XS27:
    v_exp_f32 v152, v152
    v_exp_f32 v153, v153
    v_smfmac_f32_16x16x64_bf16 v[128:131], v[28:31], v[144:151], v17
    s_waitcnt lgkmcnt(0)
    v_exp_f32 v154, v154
    v_smfmac_f32_32x32x32_bf16 v[96:111], v[196:199], v[144:151], v17
    ds_read_b128 v[184:187], v10 offset:43008
    v_exp_f32 v155, v155
    v_exp_f32 v156, v156
    v_exp_f32 v157, v157
    v_mfma_f32_32x32x16_bf16 v[136:151], v[168:171], v[80:83], v[64:79]
    ds_read_b128 v[188:191], v10 offset:44032
    v_exp_f32 v158, v158
    v_exp_f32 v159, v159
    v_exp_f32 v160, v160
    v_mfma_f32_32x32x16_bf16 v[136:151], v[172:175], v[84:87], v[136:151]
    s_nop 0
    v_exp_f32 v161, v161
    v_exp_f32 v162, v162
    v_exp_f32 v163, v163
    v_smfmac_f32_16x16x64_bf16 v[132:135], v[28:31], v[152:159], v17
    s_nop 0
    v_exp_f32 v164, v164
    v_smfmac_f32_32x32x32_bf16 v[112:127], v[192:195], v[152:159], v17
    s_nop 0
    v_exp_f32 v165, v165
    v_exp_f32 v166, v166
    v_exp_f32 v167, v167
XS28:
    v_exp_f32 v136, v136
    v_exp_f32 v137, v137
    v_smfmac_f32_16x16x64_bf16 v[132:135], v[28:31], v[160:167], v17
    s_waitcnt lgkmcnt(0)
    v_exp_f32 v138, v138
    v_smfmac_f32_32x32x32_bf16 v[112:127], v[196:199], v[160:167], v17
    ds_read_b128 v[176:179], v8 offset:45056
    v_exp_f32 v139, v139
    v_exp_f32 v140, v140
    v_exp_f32 v141, v141
    v_mfma_f32_32x32x16_bf16 v[152:167], v[168:171], v[88:91], v[48:63]
    ds_read_b128 v[180:183], v8 offset:46080
    v_exp_f32 v142, v142
    v_exp_f32 v143, v143
    v_exp_f32 v144, v144
    v_mfma_f32_32x32x16_bf16 v[152:167], v[172:175], v[92:95], v[152:167]
    s_setprio 0
    v_exp_f32 v145, v145
    v_exp_f32 v146, v146
    v_exp_f32 v147, v147
    v_smfmac_f32_16x16x64_bf16 v[128:131], v[28:31], v[136:143], v17
    s_nop 0
    v_exp_f32 v148, v148
    v_smfmac_f32_32x32x32_bf16 v[96:111], v[184:187], v[136:143], v17
    s_nop 0
    v_exp_f32 v149, v149
    v_exp_f32 v150, v150
    v_exp_f32 v151, v151
XS29:
    v_exp_f32 v152, v152
    v_exp_f32 v153, v153
    v_smfmac_f32_16x16x64_bf16 v[128:131], v[28:31], v[144:151], v17
    s_waitcnt lgkmcnt(0)
    v_exp_f32 v154, v154
    v_smfmac_f32_32x32x32_bf16 v[96:111], v[188:191], v[144:151], v17
    ds_read_b128 v[192:195], v10 offset:47104
    v_exp_f32 v155, v155
    v_exp_f32 v156, v156
    v_exp_f32 v157, v157
    v_mfma_f32_32x32x16_bf16 v[136:151], v[176:179], v[80:83], v[64:79]
    ds_read_b128 v[196:199], v10 offset:48128
    v_exp_f32 v158, v158
    v_exp_f32 v159, v159
    v_exp_f32 v160, v160
    v_mfma_f32_32x32x16_bf16 v[136:151], v[180:183], v[84:87], v[136:151]
    s_nop 0
    v_exp_f32 v161, v161
    v_exp_f32 v162, v162
    v_exp_f32 v163, v163
    v_smfmac_f32_16x16x64_bf16 v[132:135], v[28:31], v[152:159], v17
    s_nop 0
    v_exp_f32 v164, v164
    v_smfmac_f32_32x32x32_bf16 v[112:127], v[184:187], v[152:159], v17
    s_nop 0
    v_exp_f32 v165, v165
    v_exp_f32 v166, v166
    v_exp_f32 v167, v167
XS30:
    v_exp_f32 v136, v136
    v_exp_f32 v137, v137
    v_smfmac_f32_16x16x64_bf16 v[132:135], v[28:31], v[160:167], v17
    s_waitcnt vmcnt(1) lgkmcnt(0)
    s_barrier
    v_exp_f32 v138, v138
    v_smfmac_f32_32x32x32_bf16 v[112:127], v[188:191], v[160:167], v17
    ds_read_b128 v[168:171], v8 offset:0
    v_exp_f32 v139, v139
    v_exp_f32 v140, v140
    v_exp_f32 v141, v141
    v_mfma_f32_32x32x16_bf16 v[152:167], v[176:179], v[88:91], v[48:63]
    ds_read_b128 v[172:175], v8 offset:1024
    v_exp_f32 v142, v142
    v_exp_f32 v143, v143
    v_exp_f32 v144, v144
    v_mfma_f32_32x32x16_bf16 v[152:167], v[180:183], v[92:95], v[152:167]
    s_and_b32 s31, s21, 4
    s_xor_b32 s31, s31, 5
    s_lshl_b32 s31, s31, 15
    s_setprio 3
    v_exp_f32 v145, v145
    v_exp_f32 v146, v146
    v_exp_f32 v147, v147
    v_smfmac_f32_16x16x64_bf16 v[128:131], v[28:31], v[136:143], v17
    s_add_u32 s31, s31, s54
    s_add_u32 s31, s31, s57
    s_add_u32 m0, s57, 131072
    v_exp_f32 v148, v148
    v_smfmac_f32_32x32x32_bf16 v[96:111], v[192:195], v[136:143], v17
    buffer_load_dwordx4 v3, s[16:19], s31 offen offset:0 sc1 lds
    v_exp_f32 v149, v149
    v_exp_f32 v150, v150
    v_exp_f32 v151, v151
XS31:
    v_exp_f32 v152, v152
    v_exp_f32 v153, v153
    v_smfmac_f32_16x16x64_bf16 v[128:131], v[28:31], v[144:151], v17
    s_waitcnt lgkmcnt(0)
    v_exp_f32 v154, v154
    v_smfmac_f32_32x32x32_bf16 v[96:111], v[196:199], v[144:151], v17
    ds_read_b128 v[184:187], v10 offset:2048
    v_exp_f32 v155, v155
    v_exp_f32 v156, v156
    v_exp_f32 v157, v157
    v_mfma_f32_32x32x16_bf16 v[136:151], v[168:171], v[80:83], v[64:79]
    ds_read_b128 v[188:191], v10 offset:3072
    v_exp_f32 v158, v158
    v_exp_f32 v159, v159
    v_exp_f32 v160, v160
    v_mfma_f32_32x32x16_bf16 v[136:151], v[172:175], v[84:87], v[136:151]
    s_nop 0
    v_exp_f32 v161, v161
    v_exp_f32 v162, v162
    v_exp_f32 v163, v163
    v_smfmac_f32_16x16x64_bf16 v[132:135], v[28:31], v[152:159], v17
    s_nop 0
    v_exp_f32 v164, v164
    v_smfmac_f32_32x32x32_bf16 v[112:127], v[192:195], v[152:159], v17
    buffer_load_dwordx4 v3, s[16:19], s31 offen offset:1024 sc1 lds
    v_exp_f32 v165, v165
    v_exp_f32 v166, v166
    v_exp_f32 v167, v167
XS32:
    v_exp_f32 v136, v136
    v_exp_f32 v137, v137
    v_smfmac_f32_16x16x64_bf16 v[132:135], v[28:31], v[160:167], v17
    s_waitcnt lgkmcnt(0)
    v_exp_f32 v138, v138
    v_smfmac_f32_32x32x32_bf16 v[112:127], v[196:199], v[160:167], v17
    ds_read_b128 v[176:179], v8 offset:4096
    v_exp_f32 v139, v139
    v_exp_f32 v140, v140
    v_exp_f32 v141, v141
    v_mfma_f32_32x32x16_bf16 v[152:167], v[168:171], v[88:91], v[48:63]
    ds_read_b128 v[180:183], v8 offset:5120
    v_exp_f32 v142, v142
    v_exp_f32 v143, v143
    v_exp_f32 v144, v144
    v_mfma_f32_32x32x16_bf16 v[152:167], v[172:175], v[92:95], v[152:167]
    s_setprio 2
    v_exp_f32 v145, v145
    v_exp_f32 v146, v146
    v_exp_f32 v147, v147
    v_smfmac_f32_16x16x64_bf16 v[128:131], v[28:31], v[136:143], v17
    s_nop 0
    v_exp_f32 v148, v148
    v_smfmac_f32_32x32x32_bf16 v[96:111], v[184:187], v[136:143], v17
    buffer_load_dwordx4 v3, s[16:19], s31 offen offset:2048 sc1 lds
    v_exp_f32 v149, v149
    v_exp_f32 v150, v150
    v_exp_f32 v151, v151
XS33:
    v_exp_f32 v152, v152
    v_exp_f32 v153, v153
    v_smfmac_f32_16x16x64_bf16 v[128:131], v[28:31], v[144:151], v17
    s_waitcnt lgkmcnt(0)
    v_exp_f32 v154, v154
    v_smfmac_f32_32x32x32_bf16 v[96:111], v[188:191], v[144:151], v17
    ds_read_b128 v[192:195], v10 offset:6144
    v_exp_f32 v155, v155
    v_exp_f32 v156, v156
    v_exp_f32 v157, v157
    v_mfma_f32_32x32x16_bf16 v[136:151], v[176:179], v[80:83], v[64:79]
    ds_read_b128 v[196:199], v10 offset:7168
    v_exp_f32 v158, v158
    v_exp_f32 v159, v159
    v_exp_f32 v160, v160
    v_mfma_f32_32x32x16_bf16 v[136:151], v[180:183], v[84:87], v[136:151]
    s_nop 0
    v_exp_f32 v161, v161
    v_exp_f32 v162, v162
    v_exp_f32 v163, v163
    v_smfmac_f32_16x16x64_bf16 v[132:135], v[28:31], v[152:159], v17
    s_nop 0
    v_exp_f32 v164, v164
    v_smfmac_f32_32x32x32_bf16 v[112:127], v[184:187], v[152:159], v17
    buffer_load_dwordx4 v3, s[16:19], s31 offen offset:3072 sc1 lds
    v_exp_f32 v165, v165
    v_exp_f32 v166, v166
    v_exp_f32 v167, v167
XS34:
    v_exp_f32 v136, v136
    v_exp_f32 v137, v137
    v_smfmac_f32_16x16x64_bf16 v[132:135], v[28:31], v[160:167], v17
    s_waitcnt lgkmcnt(0)
    v_exp_f32 v138, v138
    v_smfmac_f32_32x32x32_bf16 v[112:127], v[188:191], v[160:167], v17
    ds_read_b128 v[168:171], v8 offset:8192
    v_exp_f32 v139, v139
    v_exp_f32 v140, v140
    v_exp_f32 v141, v141
    v_mfma_f32_32x32x16_bf16 v[152:167], v[176:179], v[88:91], v[48:63]
    ds_read_b128 v[172:175], v8 offset:9216
    v_exp_f32 v142, v142
    v_exp_f32 v143, v143
    v_exp_f32 v144, v144
    v_mfma_f32_32x32x16_bf16 v[152:167], v[180:183], v[92:95], v[152:167]
    s_setprio 1
    v_exp_f32 v145, v145
    v_exp_f32 v146, v146
    v_exp_f32 v147, v147
    v_smfmac_f32_16x16x64_bf16 v[128:131], v[28:31], v[136:143], v17
    s_nop 0
    v_exp_f32 v148, v148
    v_smfmac_f32_32x32x32_bf16 v[96:111], v[192:195], v[136:143], v17
    s_nop 0
    v_exp_f32 v149, v149
    v_exp_f32 v150, v150
    v_exp_f32 v151, v151
XS35:
    v_exp_f32 v152, v152
    v_exp_f32 v153, v153
    v_smfmac_f32_16x16x64_bf16 v[128:131], v[28:31], v[144:151], v17
    s_waitcnt lgkmcnt(0)
    v_exp_f32 v154, v154
    v_smfmac_f32_32x32x32_bf16 v[96:111], v[196:199], v[144:151], v17
    ds_read_b128 v[184:187], v10 offset:10240
    v_exp_f32 v155, v155
    v_exp_f32 v156, v156
    v_exp_f32 v157, v157
    v_mfma_f32_32x32x16_bf16 v[136:151], v[168:171], v[80:83], v[64:79]
    ds_read_b128 v[188:191], v10 offset:11264
    v_exp_f32 v158, v158
    v_exp_f32 v159, v159
    v_exp_f32 v160, v160
    v_mfma_f32_32x32x16_bf16 v[136:151], v[172:175], v[84:87], v[136:151]
    s_getpc_b64 s[4:5]
PC16:
    s_add_u32 s4, s4, OUTC-PC16
    s_addc_u32 s5, s5, 0
    s_andn2_b32 s51, s2, 7
    s_add_u32 s51, s51, s20
    v_exp_f32 v161, v161
    v_exp_f32 v162, v162
    v_exp_f32 v163, v163
    v_smfmac_f32_16x16x64_bf16 v[132:135], v[28:31], v[152:159], v17
    s_lshl_b32 s51, s51, 6
    s_min_u32 s51, s51, CODE_END-OUTC-64
    v_mov_b32 v22, s51
    v_exp_f32 v164, v164
    v_smfmac_f32_32x32x32_bf16 v[112:127], v[192:195], v[152:159], v17
    global_load_dword v27, v22, s[4:5]
    v_exp_f32 v165, v165
    v_exp_f32 v166, v166
    v_exp_f32 v167, v167
XS36:
    v_exp_f32 v136, v136
    v_exp_f32 v137, v137
    v_smfmac_f32_16x16x64_bf16 v[132:135], v[28:31], v[160:167], v17
    s_waitcnt lgkmcnt(0)
    v_exp_f32 v138, v138
    v_smfmac_f32_32x32x32_bf16 v[112:127], v[196:199], v[160:167], v17
    ds_read_b128 v[176:179], v8 offset:12288
    v_exp_f32 v139, v139
    v_exp_f32 v140, v140
    v_exp_f32 v141, v141
    v_mfma_f32_32x32x16_bf16 v[152:167], v[168:171], v[88:91], v[48:63]
    ds_read_b128 v[180:183], v8 offset:13312
    v_exp_f32 v142, v142
    v_exp_f32 v143, v143
    v_exp_f32 v144, v144
    v_mfma_f32_32x32x16_bf16 v[152:167], v[172:175], v[92:95], v[152:167]
    s_setprio 0
    v_exp_f32 v145, v145
    v_exp_f32 v146, v146
    v_exp_f32 v147, v147
    v_smfmac_f32_16x16x64_bf16 v[128:131], v[28:31], v[136:143], v17
    s_nop 0
    v_exp_f32 v148, v148
    v_smfmac_f32_32x32x32_bf16 v[96:111], v[184:187], v[136:143], v17
    s_nop 0
    v_exp_f32 v149, v149
    v_exp_f32 v150, v150
    v_exp_f32 v151, v151
XS37:
    v_exp_f32 v152, v152
    v_exp_f32 v153, v153
    v_smfmac_f32_16x16x64_bf16 v[128:131], v[28:31], v[144:151], v17
    s_waitcnt lgkmcnt(0)
    v_exp_f32 v154, v154
    v_smfmac_f32_32x32x32_bf16 v[96:111], v[188:191], v[144:151], v17
    ds_read_b128 v[192:195], v10 offset:14336
    v_exp_f32 v155, v155
    v_exp_f32 v156, v156
    v_exp_f32 v157, v157
    v_mfma_f32_32x32x16_bf16 v[136:151], v[176:179], v[80:83], v[64:79]
    ds_read_b128 v[196:199], v10 offset:15360
    v_exp_f32 v158, v158
    v_exp_f32 v159, v159
    v_exp_f32 v160, v160
    v_mfma_f32_32x32x16_bf16 v[136:151], v[180:183], v[84:87], v[136:151]
    s_nop 0
    v_exp_f32 v161, v161
    v_exp_f32 v162, v162
    v_exp_f32 v163, v163
    v_smfmac_f32_16x16x64_bf16 v[132:135], v[28:31], v[152:159], v17
    s_nop 0
    v_exp_f32 v164, v164
    v_smfmac_f32_32x32x32_bf16 v[112:127], v[184:187], v[152:159], v17
    s_nop 0
    v_exp_f32 v165, v165
    v_exp_f32 v166, v166
    v_exp_f32 v167, v167
XS38:
    v_exp_f32 v136, v136
    v_exp_f32 v137, v137
    v_smfmac_f32_16x16x64_bf16 v[132:135], v[28:31], v[160:167], v17
    s_waitcnt vmcnt(1) lgkmcnt(0)
    s_barrier
    v_exp_f32 v138, v138
    v_smfmac_f32_32x32x32_bf16 v[112:127], v[188:191], v[160:167], v17
    ds_read_b128 v[168:171], v8 offset:32768
    v_exp_f32 v139, v139
    v_exp_f32 v140, v140
    v_exp_f32 v141, v141
    v_mfma_f32_32x32x16_bf16 v[152:167], v[176:179], v[88:91], v[48:63]
    ds_read_b128 v[172:175], v8 offset:33792
    v_exp_f32 v142, v142
    v_exp_f32 v143, v143
    v_exp_f32 v144, v144
    v_mfma_f32_32x32x16_bf16 v[152:167], v[180:183], v[92:95], v[152:167]
    s_and_b32 s31, s21, 4
    s_xor_b32 s31, s31, 6
    s_lshl_b32 s31, s31, 15
    s_setprio 3
    v_exp_f32 v145, v145
    v_exp_f32 v146, v146
    v_exp_f32 v147, v147
    v_smfmac_f32_16x16x64_bf16 v[128:131], v[28:31], v[136:143], v17
    s_add_u32 s31, s31, s54
    s_add_u32 s31, s31, s57
    s_add_u32 m0, s57, 98304
    v_exp_f32 v148, v148
    v_smfmac_f32_32x32x32_bf16 v[96:111], v[192:195], v[136:143], v17
    buffer_load_dwordx4 v3, s[16:19], s31 offen offset:0 sc1 lds
    v_exp_f32 v149, v149
    v_exp_f32 v150, v150
    v_exp_f32 v151, v151
XS39:
    v_exp_f32 v152, v152
    v_exp_f32 v153, v153
    v_smfmac_f32_16x16x64_bf16 v[128:131], v[28:31], v[144:151], v17
    s_waitcnt lgkmcnt(0)
    v_exp_f32 v154, v154
    v_smfmac_f32_32x32x32_bf16 v[96:111], v[196:199], v[144:151], v17
    ds_read_b128 v[184:187], v10 offset:34816
    v_exp_f32 v155, v155
    v_exp_f32 v156, v156
    v_exp_f32 v157, v157
    v_mfma_f32_32x32x16_bf16 v[136:151], v[168:171], v[80:83], v[64:79]
    ds_read_b128 v[188:191], v10 offset:35840
    v_exp_f32 v158, v158
    v_exp_f32 v159, v159
    v_exp_f32 v160, v160
    v_mfma_f32_32x32x16_bf16 v[136:151], v[172:175], v[84:87], v[136:151]
    s_nop 0
    v_exp_f32 v161, v161
    v_exp_f32 v162, v162
    v_exp_f32 v163, v163
    v_smfmac_f32_16x16x64_bf16 v[132:135], v[28:31], v[152:159], v17
    s_nop 0
    v_exp_f32 v164, v164
    v_smfmac_f32_32x32x32_bf16 v[112:127], v[192:195], v[152:159], v17
    buffer_load_dwordx4 v3, s[16:19], s31 offen offset:1024 sc1 lds
    v_exp_f32 v165, v165
    v_exp_f32 v166, v166
    v_exp_f32 v167, v167
XS40:
    v_exp_f32 v136, v136
    v_exp_f32 v137, v137
    v_smfmac_f32_16x16x64_bf16 v[132:135], v[28:31], v[160:167], v17
    s_waitcnt lgkmcnt(0)
    v_exp_f32 v138, v138
    v_smfmac_f32_32x32x32_bf16 v[112:127], v[196:199], v[160:167], v17
    ds_read_b128 v[176:179], v8 offset:36864
    v_exp_f32 v139, v139
    v_exp_f32 v140, v140
    v_exp_f32 v141, v141
    v_mfma_f32_32x32x16_bf16 v[152:167], v[168:171], v[88:91], v[48:63]
    ds_read_b128 v[180:183], v8 offset:37888
    v_exp_f32 v142, v142
    v_exp_f32 v143, v143
    v_exp_f32 v144, v144
    v_mfma_f32_32x32x16_bf16 v[152:167], v[172:175], v[92:95], v[152:167]
    s_setprio 2
    v_exp_f32 v145, v145
    v_exp_f32 v146, v146
    v_exp_f32 v147, v147
    v_smfmac_f32_16x16x64_bf16 v[128:131], v[28:31], v[136:143], v17
    s_nop 0
    v_exp_f32 v148, v148
    v_smfmac_f32_32x32x32_bf16 v[96:111], v[184:187], v[136:143], v17
    buffer_load_dwordx4 v3, s[16:19], s31 offen offset:2048 sc1 lds
    v_exp_f32 v149, v149
    v_exp_f32 v150, v150
    v_exp_f32 v151, v151
XS41:
    v_exp_f32 v152, v152
    v_exp_f32 v153, v153
    v_smfmac_f32_16x16x64_bf16 v[128:131], v[28:31], v[144:151], v17
    s_waitcnt lgkmcnt(0)
    v_exp_f32 v154, v154
    v_smfmac_f32_32x32x32_bf16 v[96:111], v[188:191], v[144:151], v17
    ds_read_b128 v[192:195], v10 offset:38912
    v_exp_f32 v155, v155
    v_exp_f32 v156, v156
    v_exp_f32 v157, v157
    v_mfma_f32_32x32x16_bf16 v[136:151], v[176:179], v[80:83], v[64:79]
    ds_read_b128 v[196:199], v10 offset:39936
    v_exp_f32 v158, v158
    v_exp_f32 v159, v159
    v_exp_f32 v160, v160
    v_mfma_f32_32x32x16_bf16 v[136:151], v[180:183], v[84:87], v[136:151]
    s_nop 0
    v_exp_f32 v161, v161
    v_exp_f32 v162, v162
    v_exp_f32 v163, v163
    v_smfmac_f32_16x16x64_bf16 v[132:135], v[28:31], v[152:159], v17
    s_nop 0
    v_exp_f32 v164, v164
    v_smfmac_f32_32x32x32_bf16 v[112:127], v[184:187], v[152:159], v17
    buffer_load_dwordx4 v3, s[16:19], s31 offen offset:3072 sc1 lds
    v_exp_f32 v165, v165
    v_exp_f32 v166, v166
    v_exp_f32 v167, v167
XS42:
    v_exp_f32 v136, v136
    v_exp_f32 v137, v137
    v_smfmac_f32_16x16x64_bf16 v[132:135], v[28:31], v[160:167], v17
    s_waitcnt lgkmcnt(0)
    v_exp_f32 v138, v138
    v_smfmac_f32_32x32x32_bf16 v[112:127], v[188:191], v[160:167], v17
    ds_read_b128 v[168:171], v8 offset:40960
    v_exp_f32 v139, v139
    v_exp_f32 v140, v140
    v_exp_f32 v141, v141
    v_mfma_f32_32x32x16_bf16 v[152:167], v[176:179], v[88:91], v[48:63]
    ds_read_b128 v[172:175], v8 offset:41984
    v_exp_f32 v142, v142
    v_exp_f32 v143, v143
    v_exp_f32 v144, v144
    v_mfma_f32_32x32x16_bf16 v[152:167], v[180:183], v[92:95], v[152:167]
    s_setprio 1
    v_exp_f32 v145, v145
    v_exp_f32 v146, v146
    v_exp_f32 v147, v147
    v_smfmac_f32_16x16x64_bf16 v[128:131], v[28:31], v[136:143], v17
    s_nop 0
    v_exp_f32 v148, v148
    v_smfmac_f32_32x32x32_bf16 v[96:111], v[192:195], v[136:143], v17
    s_nop 0
    v_exp_f32 v149, v149
    v_exp_f32 v150, v150
    v_exp_f32 v151, v151
XS43:
    v_exp_f32 v152, v152
    v_exp_f32 v153, v153
    v_smfmac_f32_16x16x64_bf16 v[128:131], v[28:31], v[144:151], v17
    s_waitcnt lgkmcnt(0)
    v_exp_f32 v154, v154
    v_smfmac_f32_32x32x32_bf16 v[96:111], v[196:199], v[144:151], v17
    ds_read_b128 v[184:187], v10 offset:43008
    v_exp_f32 v155, v155
    v_exp_f32 v156, v156
    v_exp_f32 v157, v157
    v_mfma_f32_32x32x16_bf16 v[136:151], v[168:171], v[80:83], v[64:79]
    ds_read_b128 v[188:191], v10 offset:44032
    v_exp_f32 v158, v158
    v_exp_f32 v159, v159
    v_exp_f32 v160, v160
    v_mfma_f32_32x32x16_bf16 v[136:151], v[172:175], v[84:87], v[136:151]
    s_nop 0
    v_exp_f32 v161, v161
    v_exp_f32 v162, v162
    v_exp_f32 v163, v163
    v_smfmac_f32_16x16x64_bf16 v[132:135], v[28:31], v[152:159], v17
    s_nop 0
    v_exp_f32 v164, v164
    v_smfmac_f32_32x32x32_bf16 v[112:127], v[192:195], v[152:159], v17
    s_nop 0
    v_exp_f32 v165, v165
    v_exp_f32 v166, v166
    v_exp_f32 v167, v167
XS44:
    v_exp_f32 v136, v136
    v_exp_f32 v137, v137
    v_smfmac_f32_16x16x64_bf16 v[132:135], v[28:31], v[160:167], v17
    s_waitcnt lgkmcnt(0)
    v_exp_f32 v138, v138
    v_smfmac_f32_32x32x32_bf16 v[112:127], v[196:199], v[160:167], v17
    ds_read_b128 v[176:179], v8 offset:45056
    v_exp_f32 v139, v139
    v_exp_f32 v140, v140
    v_exp_f32 v141, v141
    v_mfma_f32_32x32x16_bf16 v[152:167], v[168:171], v[88:91], v[48:63]
    ds_read_b128 v[180:183], v8 offset:46080
    v_exp_f32 v142, v142
    v_exp_f32 v143, v143
    v_exp_f32 v144, v144
    v_mfma_f32_32x32x16_bf16 v[152:167], v[172:175], v[92:95], v[152:167]
    s_setprio 0
    v_exp_f32 v145, v145
    v_exp_f32 v146, v146
    v_exp_f32 v147, v147
    v_smfmac_f32_16x16x64_bf16 v[128:131], v[28:31], v[136:143], v17
    s_nop 0
    v_exp_f32 v148, v148
    v_smfmac_f32_32x32x32_bf16 v[96:111], v[184:187], v[136:143], v17
    s_mov_b32 exec_lo, s62
    s_mov_b32 exec_hi, 0
    buffer_load_dwordx2 v[14:15], v5, s[16:19], s59 offen sc1
    s_mov_b64 exec, -1
    v_exp_f32 v149, v149
    v_exp_f32 v150, v150
    v_exp_f32 v151, v151
XS45:
    v_exp_f32 v152, v152
    v_exp_f32 v153, v153
    v_smfmac_f32_16x16x64_bf16 v[128:131], v[28:31], v[144:151], v17
    s_waitcnt lgkmcnt(0)
    v_exp_f32 v154, v154
    v_smfmac_f32_32x32x32_bf16 v[96:111], v[188:191], v[144:151], v17
    ds_read_b128 v[192:195], v10 offset:47104
    v_exp_f32 v155, v155
    v_exp_f32 v156, v156
    v_exp_f32 v157, v157
    v_mfma_f32_32x32x16_bf16 v[136:151], v[176:179], v[80:83], v[64:79]
    ds_read_b128 v[196:199], v10 offset:48128
    v_exp_f32 v158, v158
    v_exp_f32 v159, v159
    v_exp_f32 v160, v160
    v_mfma_f32_32x32x16_bf16 v[136:151], v[180:183], v[84:87], v[136:151]
    s_nop 0
    v_exp_f32 v161, v161
    v_exp_f32 v162, v162
    v_exp_f32 v163, v163
    v_smfmac_f32_16x16x64_bf16 v[132:135], v[28:31], v[152:159], v17
    s_nop 0
    v_exp_f32 v164, v164
    v_smfmac_f32_32x32x32_bf16 v[112:127], v[184:187], v[152:159], v17
    s_nop 0
    v_exp_f32 v165, v165
    v_exp_f32 v166, v166
    v_exp_f32 v167, v167
XS46:
    v_exp_f32 v136, v136
    v_exp_f32 v137, v137
    v_smfmac_f32_16x16x64_bf16 v[132:135], v[28:31], v[160:167], v17
    s_waitcnt vmcnt(1) lgkmcnt(0)
    s_barrier
    v_exp_f32 v138, v138
    v_smfmac_f32_32x32x32_bf16 v[112:127], v[188:191], v[160:167], v17
    ds_read_b128 v[168:171], v8 offset:0
    v_exp_f32 v139, v139
    v_exp_f32 v140, v140
    v_exp_f32 v141, v141
    v_mfma_f32_32x32x16_bf16 v[152:167], v[176:179], v[88:91], v[48:63]
    ds_read_b128 v[172:175], v8 offset:1024
    s_waitcnt vmcnt(0)
    v_cmp_eq_u64 vcc, v[6:7], v[14:15]
    s_and_b32 s27, vcc_lo, s62
    s_cmp_eq_u32 s27, s62
    s_cbranch_scc0 FC31
FD32:
    v_exp_f32 v142, v142
    v_exp_f32 v143, v143
    v_exp_f32 v144, v144
    v_mfma_f32_32x32x16_bf16 v[152:167], v[180:183], v[92:95], v[152:167]
    s_and_b32 s31, s21, 4
    s_xor_b32 s31, s31, 7
    s_lshl_b32 s31, s31, 15
    s_setprio 3
    v_exp_f32 v145, v145
    v_exp_f32 v146, v146
    v_exp_f32 v147, v147
    v_smfmac_f32_16x16x64_bf16 v[128:131], v[28:31], v[136:143], v17
    s_add_u32 s31, s31, s54
    s_add_u32 s31, s31, s57
    s_add_u32 m0, s57, 131072
    v_exp_f32 v148, v148
    v_smfmac_f32_32x32x32_bf16 v[96:111], v[192:195], v[136:143], v17
    buffer_load_dwordx4 v3, s[16:19], s31 offen offset:0 sc1 lds
    v_exp_f32 v149, v149
    v_exp_f32 v150, v150
    v_exp_f32 v151, v151
XS47:
    v_exp_f32 v152, v152
    v_exp_f32 v153, v153
    v_smfmac_f32_16x16x64_bf16 v[128:131], v[28:31], v[144:151], v17
    s_waitcnt lgkmcnt(0)
    v_exp_f32 v154, v154
    v_smfmac_f32_32x32x32_bf16 v[96:111], v[196:199], v[144:151], v17
    ds_read_b128 v[184:187], v10 offset:2048
    v_exp_f32 v155, v155
    v_exp_f32 v156, v156
    v_exp_f32 v157, v157
    v_mfma_f32_32x32x16_bf16 v[136:151], v[168:171], v[80:83], v[64:79]
    ds_read_b128 v[188:191], v10 offset:3072
    v_exp_f32 v158, v158
    v_exp_f32 v159, v159
    v_exp_f32 v160, v160
    v_mfma_f32_32x32x16_bf16 v[136:151], v[172:175], v[84:87], v[136:151]
    s_nop 0
    v_exp_f32 v161, v161
    v_exp_f32 v162, v162
    v_exp_f32 v163, v163
    v_smfmac_f32_16x16x64_bf16 v[132:135], v[28:31], v[152:159], v17
    s_nop 0
    v_exp_f32 v164, v164
    v_smfmac_f32_32x32x32_bf16 v[112:127], v[192:195], v[152:159], v17
    buffer_load_dwordx4 v3, s[16:19], s31 offen offset:1024 sc1 lds
    v_exp_f32 v165, v165
    v_exp_f32 v166, v166
    v_exp_f32 v167, v167
XS48:
    v_exp_f32 v136, v136
    v_exp_f32 v137, v137
    v_smfmac_f32_16x16x64_bf16 v[132:135], v[28:31], v[160:167], v17
    s_waitcnt lgkmcnt(0)
    v_exp_f32 v138, v138
    v_smfmac_f32_32x32x32_bf16 v[112:127], v[196:199], v[160:167], v17
    ds_read_b128 v[176:179], v8 offset:4096
    v_exp_f32 v139, v139
    v_exp_f32 v140, v140
    v_exp_f32 v141, v141
    v_mfma_f32_32x32x16_bf16 v[152:167], v[168:171], v[88:91], v[48:63]
    ds_read_b128 v[180:183], v8 offset:5120
    v_exp_f32 v142, v142
    v_exp_f32 v143, v143
    v_exp_f32 v144, v144
    v_mfma_f32_32x32x16_bf16 v[152:167], v[172:175], v[92:95], v[152:167]
    s_setprio 2
    v_exp_f32 v145, v145
    v_exp_f32 v146, v146
    v_exp_f32 v147, v147
    v_smfmac_f32_16x16x64_bf16 v[128:131], v[28:31], v[136:143], v17
    s_nop 0
    v_exp_f32 v148, v148
    v_smfmac_f32_32x32x32_bf16 v[96:111], v[184:187], v[136:143], v17
    buffer_load_dwordx4 v3, s[16:19], s31 offen offset:2048 sc1 lds
    v_exp_f32 v149, v149
    v_exp_f32 v150, v150
    v_exp_f32 v151, v151
XS49:
    v_exp_f32 v152, v152
    v_exp_f32 v153, v153
    v_smfmac_f32_16x16x64_bf16 v[128:131], v[28:31], v[144:151], v17
    s_waitcnt lgkmcnt(0)
    v_exp_f32 v154, v154
    v_smfmac_f32_32x32x32_bf16 v[96:111], v[188:191], v[144:151], v17
    ds_read_b128 v[192:195], v10 offset:6144
    v_exp_f32 v155, v155
    v_exp_f32 v156, v156
    v_exp_f32 v157, v157
    v_mfma_f32_32x32x16_bf16 v[136:151], v[176:179], v[80:83], v[64:79]
    ds_read_b128 v[196:199], v10 offset:7168
    v_exp_f32 v158, v158
    v_exp_f32 v159, v159
    v_exp_f32 v160, v160
    v_mfma_f32_32x32x16_bf16 v[136:151], v[180:183], v[84:87], v[136:151]
    s_nop 0
    v_exp_f32 v161, v161
    v_exp_f32 v162, v162
    v_exp_f32 v163, v163
    v_smfmac_f32_16x16x64_bf16 v[132:135], v[28:31], v[152:159], v17
    s_nop 0
    v_exp_f32 v164, v164
    v_smfmac_f32_32x32x32_bf16 v[112:127], v[184:187], v[152:159], v17
    buffer_load_dwordx4 v3, s[16:19], s31 offen offset:3072 sc1 lds
    v_exp_f32 v165, v165
    v_exp_f32 v166, v166
    v_exp_f32 v167, v167
XS50:
    v_exp_f32 v136, v136
    v_exp_f32 v137, v137
    v_smfmac_f32_16x16x64_bf16 v[132:135], v[28:31], v[160:167], v17
    s_waitcnt lgkmcnt(0)
    v_exp_f32 v138, v138
    v_smfmac_f32_32x32x32_bf16 v[112:127], v[188:191], v[160:167], v17
    ds_read_b128 v[168:171], v8 offset:8192
    v_exp_f32 v139, v139
    v_exp_f32 v140, v140
    v_exp_f32 v141, v141
    v_mfma_f32_32x32x16_bf16 v[152:167], v[176:179], v[88:91], v[48:63]
    ds_read_b128 v[172:175], v8 offset:9216
    v_exp_f32 v142, v142
    v_exp_f32 v143, v143
    v_exp_f32 v144, v144
    v_mfma_f32_32x32x16_bf16 v[152:167], v[180:183], v[92:95], v[152:167]
    s_max_u32 s31, s21, 1
    s_sub_u32 s31, s31, 1
    s_lshl_b32 s31, s31, 15
    s_setprio 1
    v_exp_f32 v145, v145
    v_exp_f32 v146, v146
    v_exp_f32 v147, v147
    v_smfmac_f32_16x16x64_bf16 v[128:131], v[28:31], v[136:143], v17
    s_add_u32 s31, s31, s55
    s_add_u32 s31, s31, s57
    s_add_u32 m0, s57, 0
    v_exp_f32 v148, v148
    v_smfmac_f32_32x32x32_bf16 v[96:111], v[192:195], v[136:143], v17
    buffer_load_dwordx4 v3, s[16:19], s31 offen offset:0 sc1 lds
    v_exp_f32 v149, v149
    v_exp_f32 v150, v150
    v_exp_f32 v151, v151
XS51:
    v_exp_f32 v152, v152
    v_exp_f32 v153, v153
    v_smfmac_f32_16x16x64_bf16 v[128:131], v[28:31], v[144:151], v17
    s_waitcnt lgkmcnt(0)
    v_exp_f32 v154, v154
    v_smfmac_f32_32x32x32_bf16 v[96:111], v[196:199], v[144:151], v17
    ds_read_b128 v[184:187], v10 offset:10240
    v_exp_f32 v155, v155
    v_exp_f32 v156, v156
    v_exp_f32 v157, v157
    v_mfma_f32_32x32x16_bf16 v[136:151], v[168:171], v[80:83], v[64:79]
    ds_read_b128 v[188:191], v10 offset:11264
    v_exp_f32 v158, v158
    v_exp_f32 v159, v159
    v_exp_f32 v160, v160
    v_mfma_f32_32x32x16_bf16 v[136:151], v[172:175], v[84:87], v[136:151]
    s_nop 0
    v_exp_f32 v161, v161
    v_exp_f32 v162, v162
    v_exp_f32 v163, v163
    v_smfmac_f32_16x16x64_bf16 v[132:135], v[28:31], v[152:159], v17
    s_nop 0
    v_exp_f32 v164, v164
    v_smfmac_f32_32x32x32_bf16 v[112:127], v[192:195], v[152:159], v17
    buffer_load_dwordx4 v3, s[16:19], s31 offen offset:1024 sc1 lds
    v_exp_f32 v165, v165
    v_exp_f32 v166, v166
    v_exp_f32 v167, v167
XS52:
    v_exp_f32 v136, v136
    v_exp_f32 v137, v137
    v_smfmac_f32_16x16x64_bf16 v[132:135], v[28:31], v[160:167], v17
    s_waitcnt lgkmcnt(0)
    v_exp_f32 v138, v138
    v_smfmac_f32_32x32x32_bf16 v[112:127], v[196:199], v[160:167], v17
    ds_read_b128 v[176:179], v8 offset:12288
    v_exp_f32 v139, v139
    v_exp_f32 v140, v140
    v_exp_f32 v141, v141
    v_mfma_f32_32x32x16_bf16 v[152:167], v[168:171], v[88:91], v[48:63]
    ds_read_b128 v[180:183], v8 offset:13312
    v_exp_f32 v142, v142
    v_exp_f32 v143, v143
    v_exp_f32 v144, v144
    v_mfma_f32_32x32x16_bf16 v[152:167], v[172:175], v[92:95], v[152:167]
    s_setprio 0
    v_exp_f32 v145, v145
    v_exp_f32 v146, v146
    v_exp_f32 v147, v147
    v_smfmac_f32_16x16x64_bf16 v[128:131], v[28:31], v[136:143], v17
    s_nop 0
    v_exp_f32 v148, v148
    v_smfmac_f32_32x32x32_bf16 v[96:111], v[184:187], v[136:143], v17
    buffer_load_dwordx4 v3, s[16:19], s31 offen offset:2048 sc1 lds
    v_exp_f32 v149, v149
    v_exp_f32 v150, v150
    v_exp_f32 v151, v151
XS53:
    v_exp_f32 v152, v152
    v_exp_f32 v153, v153
    v_smfmac_f32_16x16x64_bf16 v[128:131], v[28:31], v[144:151], v17
    s_waitcnt lgkmcnt(0)
    v_exp_f32 v154, v154
    v_smfmac_f32_32x32x32_bf16 v[96:111], v[188:191], v[144:151], v17
    ds_read_b128 v[192:195], v10 offset:14336
    v_exp_f32 v155, v155
    v_exp_f32 v156, v156
    v_exp_f32 v157, v157
    v_mfma_f32_32x32x16_bf16 v[136:151], v[176:179], v[80:83], v[64:79]
    ds_read_b128 v[196:199], v10 offset:15360
    v_exp_f32 v158, v158
    v_exp_f32 v159, v159
    v_exp_f32 v160, v160
    v_mfma_f32_32x32x16_bf16 v[136:151], v[180:183], v[84:87], v[136:151]
    s_nop 0
    v_exp_f32 v161, v161
    v_exp_f32 v162, v162
    v_exp_f32 v163, v163
    v_smfmac_f32_16x16x64_bf16 v[132:135], v[28:31], v[152:159], v17
    s_nop 0
    v_exp_f32 v164, v164
    v_smfmac_f32_32x32x32_bf16 v[112:127], v[184:187], v[152:159], v17
    buffer_load_dwordx4 v3, s[16:19], s31 offen offset:3072 sc1 lds
    v_exp_f32 v165, v165
    v_exp_f32 v166, v166
    v_exp_f32 v167, v167
XS54:
    v_exp_f32 v136, v136
    v_exp_f32 v137, v137
    v_smfmac_f32_16x16x64_bf16 v[132:135], v[28:31], v[160:167], v17
    s_waitcnt vmcnt(4) lgkmcnt(0)
    s_barrier
    v_exp_f32 v138, v138
    v_smfmac_f32_32x32x32_bf16 v[112:127], v[188:191], v[160:167], v17
    ds_read_b128 v[168:171], v8 offset:32768
    v_exp_f32 v139, v139
    v_exp_f32 v140, v140
    v_exp_f32 v141, v141
    v_mfma_f32_32x32x16_bf16 v[152:167], v[176:179], v[88:91], v[48:63]
    ds_read_b128 v[172:175], v8 offset:33792
    v_exp_f32 v142, v142
    v_exp_f32 v143, v143
    v_exp_f32 v144, v144
    v_mfma_f32_32x32x16_bf16 v[152:167], v[180:183], v[92:95], v[152:167]
    s_lshl_b32 s31, s21, 15
    s_add_u32 s31, s31, s55
    s_setprio 3
    v_exp_f32 v145, v145
    v_exp_f32 v146, v146
    v_exp_f32 v147, v147
    v_smfmac_f32_16x16x64_bf16 v[128:131], v[28:31], v[136:143], v17
    s_add_u32 s31, s31, s57
    s_add_u32 m0, s57, 32768
    v_exp_f32 v148, v148
    v_smfmac_f32_32x32x32_bf16 v[96:111], v[192:195], v[136:143], v17
    buffer_load_dwordx4 v3, s[16:19], s31 offen offset:0 sc1 lds
    v_exp_f32 v149, v149
    v_exp_f32 v150, v150
    v_exp_f32 v151, v151
XS55:
    v_exp_f32 v152, v152
    v_exp_f32 v153, v153
    v_smfmac_f32_16x16x64_bf16 v[128:131], v[28:31], v[144:151], v17
    s_waitcnt lgkmcnt(0)
    v_exp_f32 v154, v154
    v_smfmac_f32_32x32x32_bf16 v[96:111], v[196:199], v[144:151], v17
    ds_read_b128 v[184:187], v10 offset:34816
    v_exp_f32 v155, v155
    v_exp_f32 v156, v156
    v_exp_f32 v157, v157
    v_mfma_f32_32x32x16_bf16 v[136:151], v[168:171], v[80:83], v[64:79]
    ds_read_b128 v[188:191], v10 offset:35840
    v_exp_f32 v158, v158
    v_exp_f32 v159, v159
    v_exp_f32 v160, v160
    v_mfma_f32_32x32x16_bf16 v[136:151], v[172:175], v[84:87], v[136:151]
    s_nop 0
    v_exp_f32 v161, v161
    v_exp_f32 v162, v162
    v_exp_f32 v163, v163
    v_smfmac_f32_16x16x64_bf16 v[132:135], v[28:31], v[152:159], v17
    s_nop 0
    v_exp_f32 v164, v164
    v_smfmac_f32_32x32x32_bf16 v[112:127], v[192:195], v[152:159], v17
    buffer_load_dwordx4 v3, s[16:19], s31 offen offset:1024 sc1 lds
    v_exp_f32 v165, v165
    v_exp_f32 v166, v166
    v_exp_f32 v167, v167
XS56:
    v_exp_f32 v136, v136
    v_exp_f32 v137, v137
    v_smfmac_f32_16x16x64_bf16 v[132:135], v[28:31], v[160:167], v17
    s_waitcnt lgkmcnt(0)
    v_exp_f32 v138, v138
    v_smfmac_f32_32x32x32_bf16 v[112:127], v[196:199], v[160:167], v17
    ds_read_b128 v[176:179], v8 offset:36864
    v_exp_f32 v139, v139
    v_exp_f32 v140, v140
    v_exp_f32 v141, v141
    v_mfma_f32_32x32x16_bf16 v[152:167], v[168:171], v[88:91], v[48:63]
    ds_read_b128 v[180:183], v8 offset:37888
    v_exp_f32 v142, v142
    v_exp_f32 v143, v143
    v_exp_f32 v144, v144
    v_mfma_f32_32x32x16_bf16 v[152:167], v[172:175], v[92:95], v[152:167]
    s_setprio 3
    v_exp_f32 v145, v145
    v_exp_f32 v146, v146
    v_exp_f32 v147, v147
    v_smfmac_f32_16x16x64_bf16 v[128:131], v[28:31], v[136:143], v17
    s_nop 0
    v_exp_f32 v148, v148
    v_smfmac_f32_32x32x32_bf16 v[96:111], v[184:187], v[136:143], v17
    buffer_load_dwordx4 v3, s[16:19], s31 offen offset:2048 sc1 lds
    v_exp_f32 v149, v149
    v_exp_f32 v150, v150
    v_exp_f32 v151, v151
XS57:
    v_exp_f32 v152, v152
    v_exp_f32 v153, v153
    v_smfmac_f32_16x16x64_bf16 v[128:131], v[28:31], v[144:151], v17
    s_waitcnt lgkmcnt(0)
    v_exp_f32 v154, v154
    v_smfmac_f32_32x32x32_bf16 v[96:111], v[188:191], v[144:151], v17
    ds_read_b128 v[192:195], v10 offset:38912
    v_exp_f32 v155, v155
    v_exp_f32 v156, v156
    v_exp_f32 v157, v157
    v_mfma_f32_32x32x16_bf16 v[136:151], v[176:179], v[80:83], v[64:79]
    ds_read_b128 v[196:199], v10 offset:39936
    v_exp_f32 v158, v158
    v_exp_f32 v159, v159
    v_exp_f32 v160, v160
    v_mfma_f32_32x32x16_bf16 v[136:151], v[180:183], v[84:87], v[136:151]
    s_nop 0
    v_exp_f32 v161, v161
    v_exp_f32 v162, v162
    v_exp_f32 v163, v163
    v_smfmac_f32_16x16x64_bf16 v[132:135], v[28:31], v[152:159], v17
    s_nop 0
    v_exp_f32 v164, v164
    v_smfmac_f32_32x32x32_bf16 v[112:127], v[184:187], v[152:159], v17
    buffer_load_dwordx4 v3, s[16:19], s31 offen offset:3072 sc1 lds
    v_exp_f32 v165, v165
    v_exp_f32 v166, v166
    v_exp_f32 v167, v167
XS58:
    v_exp_f32 v136, v136
    v_exp_f32 v137, v137
    v_smfmac_f32_16x16x64_bf16 v[132:135], v[28:31], v[160:167], v17
    s_waitcnt lgkmcnt(0)
    v_exp_f32 v138, v138
    v_smfmac_f32_32x32x32_bf16 v[112:127], v[188:191], v[160:167], v17
    ds_read_b128 v[168:171], v8 offset:40960
    v_exp_f32 v139, v139
    v_exp_f32 v140, v140
    v_exp_f32 v141, v141
    v_mfma_f32_32x32x16_bf16 v[152:167], v[176:179], v[88:91], v[48:63]
    ds_read_b128 v[172:175], v8 offset:41984
    v_exp_f32 v142, v142
    v_exp_f32 v143, v143
    v_exp_f32 v144, v144
    v_mfma_f32_32x32x16_bf16 v[152:167], v[180:183], v[92:95], v[152:167]
    s_setprio 2
    v_exp_f32 v145, v145
    v_exp_f32 v146, v146
    v_exp_f32 v147, v147
    v_smfmac_f32_16x16x64_bf16 v[128:131], v[28:31], v[136:143], v17
    s_nop 0
    v_exp_f32 v148, v148
    v_smfmac_f32_32x32x32_bf16 v[96:111], v[192:195], v[136:143], v17
    buffer_load_dwordx4 v[200:203], v3, s[16:19], s80 offen offset:0 sc1
    v_exp_f32 v149, v149
    v_exp_f32 v150, v150
    v_exp_f32 v151, v151
XS59:
    v_exp_f32 v152, v152
    v_exp_f32 v153, v153
    v_smfmac_f32_16x16x64_bf16 v[128:131], v[28:31], v[144:151], v17
    s_waitcnt lgkmcnt(0)
    v_exp_f32 v154, v154
    v_smfmac_f32_32x32x32_bf16 v[96:111], v[196:199], v[144:151], v17
    ds_read_b128 v[184:187], v10 offset:43008
    v_exp_f32 v155, v155
    v_exp_f32 v156, v156
    v_exp_f32 v157, v157
    v_mfma_f32_32x32x16_bf16 v[136:151], v[168:171], v[80:83], v[64:79]
    ds_read_b128 v[188:191], v10 offset:44032
    v_exp_f32 v158, v158
    v_exp_f32 v159, v159
    v_exp_f32 v160, v160
    v_mfma_f32_32x32x16_bf16 v[136:151], v[172:175], v[84:87], v[136:151]
    s_nop 0
    v_exp_f32 v161, v161
    v_exp_f32 v162, v162
    v_exp_f32 v163, v163
    v_smfmac_f32_16x16x64_bf16 v[132:135], v[28:31], v[152:159], v17
    s_nop 0
    v_exp_f32 v164, v164
    v_smfmac_f32_32x32x32_bf16 v[112:127], v[192:195], v[152:159], v17
    buffer_load_dwordx4 v[204:207], v3, s[16:19], s80 offen offset:1024 sc1
    v_exp_f32 v165, v165
    v_exp_f32 v166, v166
    v_exp_f32 v167, v167
XS60:
    v_exp_f32 v136, v136
    v_exp_f32 v137, v137
    v_smfmac_f32_16x16x64_bf16 v[132:135], v[28:31], v[160:167], v17
    s_waitcnt lgkmcnt(0)
    v_exp_f32 v138, v138
    v_smfmac_f32_32x32x32_bf16 v[112:127], v[196:199], v[160:167], v17
    ds_read_b128 v[176:179], v8 offset:45056
    v_exp_f32 v139, v139
    v_exp_f32 v140, v140
    v_exp_f32 v141, v141
    v_mfma_f32_32x32x16_bf16 v[152:167], v[168:171], v[88:91], v[48:63]
    ds_read_b128 v[180:183], v8 offset:46080
    v_exp_f32 v142, v142
    v_exp_f32 v143, v143
    v_exp_f32 v144, v144
    v_mfma_f32_32x32x16_bf16 v[152:167], v[172:175], v[92:95], v[152:167]
    s_setprio 1
    v_exp_f32 v145, v145
    v_exp_f32 v146, v146
    v_exp_f32 v147, v147
    v_smfmac_f32_16x16x64_bf16 v[128:131], v[28:31], v[136:143], v17
    s_nop 0
    v_exp_f32 v148, v148
    v_smfmac_f32_32x32x32_bf16 v[96:111], v[184:187], v[136:143], v17
    s_nop 0
    v_exp_f32 v149, v149
    v_exp_f32 v150, v150
    v_exp_f32 v151, v151
XS61:
    v_exp_f32 v152, v152
    v_exp_f32 v153, v153
    v_smfmac_f32_16x16x64_bf16 v[128:131], v[28:31], v[144:151], v17
    s_waitcnt lgkmcnt(0)
    v_exp_f32 v154, v154
    v_smfmac_f32_32x32x32_bf16 v[96:111], v[188:191], v[144:151], v17
    ds_read_b128 v[192:195], v10 offset:47104
    v_exp_f32 v155, v155
    v_exp_f32 v156, v156
    v_exp_f32 v157, v157
    v_mfma_f32_32x32x16_bf16 v[136:151], v[176:179], v[80:83], v[64:79]
    ds_read_b128 v[196:199], v10 offset:48128
    v_exp_f32 v158, v158
    v_exp_f32 v159, v159
    v_exp_f32 v160, v160
    v_mfma_f32_32x32x16_bf16 v[136:151], v[180:183], v[84:87], v[136:151]
    s_nop 0
    v_exp_f32 v161, v161
    v_exp_f32 v162, v162
    v_exp_f32 v163, v163
    v_smfmac_f32_16x16x64_bf16 v[132:135], v[28:31], v[152:159], v17
    s_nop 0
    v_exp_f32 v164, v164
    v_smfmac_f32_32x32x32_bf16 v[112:127], v[184:187], v[152:159], v17
    s_nop 0
    v_exp_f32 v165, v165
    v_exp_f32 v166, v166
    v_exp_f32 v167, v167
XS62:
    v_exp_f32 v136, v136
    v_exp_f32 v137, v137
    v_smfmac_f32_16x16x64_bf16 v[132:135], v[28:31], v[160:167], v17
    s_waitcnt lgkmcnt(0)
    v_exp_f32 v138, v138
    v_smfmac_f32_32x32x32_bf16 v[112:127], v[188:191], v[160:167], v17
    v_exp_f32 v139, v139
    v_exp_f32 v140, v140
    v_exp_f32 v141, v141
    v_mfma_f32_32x32x16_bf16 v[152:167], v[176:179], v[88:91], v[48:63]
    v_exp_f32 v142, v142
    v_exp_f32 v143, v143
    v_exp_f32 v144, v144
    v_mfma_f32_32x32x16_bf16 v[152:167], v[180:183], v[92:95], v[152:167]
    s_setprio 1
    v_exp_f32 v145, v145
    v_exp_f32 v146, v146
    v_exp_f32 v147, v147
    v_smfmac_f32_16x16x64_bf16 v[128:131], v[28:31], v[136:143], v17
    s_nop 0
    v_exp_f32 v148, v148
    v_smfmac_f32_32x32x32_bf16 v[96:111], v[192:195], v[136:143], v17
    s_nop 0
    v_exp_f32 v149, v149
    v_exp_f32 v150, v150
    v_exp_f32 v151, v151
XS63:
    v_exp_f32 v152, v152
    v_exp_f32 v153, v153
    v_smfmac_f32_16x16x64_bf16 v[128:131], v[28:31], v[144:151], v17
    s_waitcnt lgkmcnt(0)
    v_exp_f32 v154, v154
    v_smfmac_f32_32x32x32_bf16 v[96:111], v[196:199], v[144:151], v17
    v_exp_f32 v155, v155
    v_exp_f32 v156, v156
    v_exp_f32 v157, v157
    v_exp_f32 v158, v158
    v_exp_f32 v159, v159
    v_exp_f32 v160, v160
    s_nop 0
    v_exp_f32 v161, v161
    v_exp_f32 v162, v162
    v_exp_f32 v163, v163
    v_smfmac_f32_16x16x64_bf16 v[132:135], v[28:31], v[152:159], v17
    s_nop 0
    v_exp_f32 v164, v164
    v_smfmac_f32_32x32x32_bf16 v[112:127], v[192:195], v[152:159], v17
    s_nop 0
    v_exp_f32 v165, v165
    v_exp_f32 v166, v166
    v_exp_f32 v167, v167
XS64:
    s_add_u32 s25, s57, 98304
    s_setprio 0
    v_smfmac_f32_16x16x64_bf16 v[132:135], v[28:31], v[160:167], v17
    v_smfmac_f32_32x32x32_bf16 v[112:127], v[196:199], v[160:167], v17
    v_add_u32 v24, s25, v3
    v_xor_b32 v25, 0x4000, v24
    s_add_u32 s25, s81, 65536
    s_nop 0
    v_lshl_add_u32 v26, v2, 2, s25
    v_xor_b32 v22, 0x800, v26
    v_add_u32 v8, s57, v16
    v_add_u32 v10, s57, v3
    v_min_f32 v48, 0, v32
    v_min_f32 v49, 0, v33
    v_min_f32 v50, 0, v34
    v_min_f32 v51, 0, v35
    v_min_f32 v52, 0, v36
    v_min_f32 v53, 0, v37
    v_min_f32 v54, 0, v38
    v_min_f32 v55, 0, v39
    v_min_f32 v56, 0, v40
    v_min_f32 v57, 0, v41
    v_min_f32 v58, 0, v42
    v_min_f32 v59, 0, v43
    v_min_f32 v60, 0, v44
    v_min_f32 v61, 0, v45
    v_min_f32 v62, 0, v46
    v_min_f32 v63, 0, v47
    ds_write_b32 v26, v132
    ds_write_b128 v24, v[112:115] offset:0
    ds_write_b128 v24, v[116:119] offset:1024
    ds_write_b128 v24, v[120:123] offset:2048
    ds_write_b128 v24, v[124:127] offset:3072
    s_cmp_ge_u32 s20, 4
    s_cbranch_scc1 OB37
    s_branch VP34
VR33:
    s_branch VP36
VR35:
OB37:
    s_waitcnt vmcnt(0) lgkmcnt(0)
    s_barrier
    ds_read_b32 v132, v22
    ds_read_b128 v[112:115], v25 offset:0
    ds_read_b128 v[116:119], v25 offset:1024
    ds_read_b128 v[120:123], v25 offset:2048
    ds_read_b128 v[124:127], v25 offset:3072
    s_waitcnt lgkmcnt(0)
    s_barrier
    v_add_f32 v128, v128, v132
    v_add_f32 v96, v96, v112
    v_add_f32 v97, v97, v113
    v_add_f32 v98, v98, v114
    v_add_f32 v99, v99, v115
    v_add_f32 v100, v100, v116
    v_add_f32 v101, v101, v117
    v_add_f32 v102, v102, v118
    v_add_f32 v103, v103, v119
    v_add_f32 v104, v104, v120
    v_add_f32 v105, v105, v121
    v_add_f32 v106, v106, v122
    v_add_f32 v107, v107, v123
    v_add_f32 v108, v108, v124
    v_add_f32 v109, v109, v125
    v_add_f32 v110, v110, v126
    v_add_f32 v111, v111, v127
    v_rcp_f32 v22, v128
    v_cmp_gt_f32 s[4:5], s78, v128
    v_maximum3_f32 v23, abs(v96), abs(v97), 0
    v_maximum3_f32 v23, abs(v98), abs(v99), v23
    v_maximum3_f32 v23, abs(v100), abs(v101), v23
    v_maximum3_f32 v23, abs(v102), abs(v103), v23
    v_maximum3_f32 v23, abs(v104), abs(v105), v23
    v_maximum3_f32 v23, abs(v106), abs(v107), v23
    v_maximum3_f32 v23, abs(v108), abs(v109), v23
    v_maximum3_f32 v23, abs(v110), abs(v111), v23
    v_cmp_gt_f32 s[6:7], s77, v23
    v_cmp_lt_f32 vcc, s76, v23
    s_and_b64 s[4:5], s[4:5], s[6:7]
    s_and_b64 s[4:5], s[4:5], vcc
    s_cmp_eq_u64 s[4:5], -1
    s_cbranch_scc0 FB38
RT39:
    v_mul_f32 v96, v22, v96
    v_mul_f32 v97, v22, v97
    v_mul_f32 v98, v22, v98
    v_mul_f32 v99, v22, v99
    v_mul_f32 v100, v22, v100
    v_mul_f32 v101, v22, v101
    v_mul_f32 v102, v22, v102
    v_mul_f32 v103, v22, v103
    v_mul_f32 v104, v22, v104
    v_mul_f32 v105, v22, v105
    v_mul_f32 v106, v22, v106
    v_mul_f32 v107, v22, v107
    v_mul_f32 v108, v22, v108
    v_mul_f32 v109, v22, v109
    v_mul_f32 v110, v22, v110
    v_mul_f32 v111, v22, v111
    v_cvt_pk_bf16_f32 v88, v96, v97
    v_cvt_pk_bf16_f32 v89, v98, v99
    v_cvt_pk_bf16_f32 v90, v100, v101
    v_cvt_pk_bf16_f32 v91, v102, v103
    v_cvt_pk_bf16_f32 v92, v104, v105
    v_cvt_pk_bf16_f32 v93, v106, v107
    v_cvt_pk_bf16_f32 v94, v108, v109
    v_cvt_pk_bf16_f32 v95, v110, v111
    buffer_store_dwordx4 v[88:91], v18, s[16:19], s65 offen offset:0 sc1
    buffer_store_dwordx4 v[92:95], v18, s[16:19], s65 offen offset:512 sc1
    ds_read_b128 v[168:171], v8 offset:32768
    ds_read_b128 v[172:175], v8 offset:33792
    ds_read_b128 v[184:187], v10 offset:34816
    ds_read_b128 v[188:191], v10 offset:35840
    s_setprio 3
    ds_read_b128 v[176:179], v8 offset:28672
    ds_read_b128 v[180:183], v8 offset:29696
    v_mov_b64 v[112:113], 0
    v_mov_b64 v[114:115], 0
    v_mov_b64 v[116:117], 0
    v_mov_b64 v[118:119], 0
    v_mov_b64 v[120:121], 0
    v_mov_b64 v[122:123], 0
    v_mov_b64 v[124:125], 0
    v_mov_b64 v[126:127], 0
    v_mov_b64 v[128:129], 0
    v_mov_b64 v[130:131], 0
    s_waitcnt lgkmcnt(0)
    v_mfma_f32_32x32x16_bf16 v[136:151], v[168:171], v[200:203], v[48:63]
    v_mfma_f32_32x32x16_bf16 v[136:151], v[172:175], v[204:207], v[136:151]
    v_mfma_f32_32x32x16_bf16 v[152:167], v[176:179], v[200:203], 0
    v_mfma_f32_32x32x16_bf16 v[152:167], v[180:183], v[204:207], v[152:167]
    s_nop 9
    v_max3_f32 v26, v136, v137, v138
    v_max3_f32 v26, v26, v139, v140
    v_max3_f32 v26, v26, v141, v142
    v_max3_f32 v26, v26, v143, v144
    v_max3_f32 v26, v26, v145, v146
    v_max3_f32 v26, v26, v147, v148
    v_max3_f32 v26, v26, v149, v150
    v_max_f32 v26, v26, v151
    s_cmp_eq_u32 s63, 0
    s_cbranch_scc1 AM42
    v_max3_f32 v26, v26, v152, v153
    v_max3_f32 v26, v26, v154, v155
    v_max3_f32 v26, v26, v156, v157
    v_max3_f32 v26, v26, v158, v159
    v_max3_f32 v26, v26, v160, v161
    v_max3_f32 v26, v26, v162, v163
    v_max3_f32 v26, v26, v164, v165
    v_max3_f32 v26, v26, v166, v167
AM42:
    v_mov_b32 v24, v26
    s_nop 1
    v_permlane32_swap_b32 v24, v26
    s_nop 1
    v_max_f32 v26, v26, v24
    v_sub_f32 v64, s68, v26
    v_mov_b32 v65, v64
    v_mov_b64 v[66:67], v[64:65]
    v_mov_b64 v[68:69], v[64:65]
    v_mov_b64 v[70:71], v[64:65]
    v_mov_b64 v[72:73], v[64:65]
    v_mov_b64 v[74:75], v[64:65]
    v_mov_b64 v[76:77], v[64:65]
    v_mov_b64 v[78:79], v[64:65]
    v_add_f32 v136, v136, v64
    v_add_f32 v137, v137, v64
    v_add_f32 v138, v138, v64
    v_add_f32 v139, v139, v64
    v_add_f32 v140, v140, v64
    v_add_f32 v141, v141, v64
    v_add_f32 v142, v142, v64
    v_add_f32 v143, v143, v64
    v_add_f32 v144, v144, v64
    v_add_f32 v145, v145, v64
    v_add_f32 v146, v146, v64
    v_add_f32 v147, v147, v64
    v_add_f32 v148, v148, v64
    v_add_f32 v149, v149, v64
    v_add_f32 v150, v150, v64
    v_add_f32 v151, v151, v64
    v_exp_f32 v136, v136
    v_exp_f32 v137, v137
    s_cmp_eq_u32 s63, 0
    s_cbranch_scc1 AP43
AR44:
    v_exp_f32 v138, v138
    s_waitcnt lgkmcnt(0)
    s_add_u32 m0, s81, 81920
    s_xor_b32 s31, s73, 0
    s_add_u32 s31, s31, s82
    buffer_load_dwordx4 v19, s[36:39], s31 offen offset:0 lds
    v_exp_f32 v139, v139
    v_exp_f32 v140, v140
    v_exp_f32 v141, v141
    v_mfma_f32_32x32x16_bf16 v[152:167], v[176:179], v[200:203], v[64:79]
    ds_read_b128 v[192:195], v10 offset:30720
    v_exp_f32 v142, v142
    v_exp_f32 v143, v143
    v_exp_f32 v144, v144
    v_mfma_f32_32x32x16_bf16 v[152:167], v[180:183], v[204:207], v[152:167]
    ds_read_b128 v[196:199], v10 offset:31744
    s_setprio 2
    v_exp_f32 v145, v145
    v_exp_f32 v146, v146
    v_exp_f32 v147, v147
    v_smfmac_f32_16x16x64_bf16 v[128:131], v[28:31], v[136:143], v17
    ds_read_b128 v[168:171], v8 offset:24576
    v_exp_f32 v148, v148
    v_smfmac_f32_32x32x32_bf16 v[112:127], v[184:187], v[136:143], v17
    ds_read_b128 v[172:175], v8 offset:25600
    buffer_load_dwordx4 v20, s[36:39], s31 offen offset:1024 lds
    s_waitcnt vmcnt(2)
    s_mov_b64 exec, 0xff
    buffer_store_dwordx4 v[6:9], v3, s[16:19], s66 offen sc1
    s_mov_b64 exec, -1
    v_exp_f32 v149, v149
    v_exp_f32 v150, v150
    v_exp_f32 v151, v151
    v_exp_f32 v152, v152
    v_exp_f32 v153, v153
    v_smfmac_f32_16x16x64_bf16 v[128:131], v[28:31], v[144:151], v17
    s_cmp_eq_u32 s63, 1
    s_cbranch_scc1 AP45
AR46:
    v_exp_f32 v154, v154
    v_smfmac_f32_32x32x32_bf16 v[112:127], v[188:191], v[144:151], v17
    s_waitcnt lgkmcnt(0)
    s_add_u32 m0, s81, 114688
    s_xor_b32 s31, s73, 262144
    s_add_u32 s31, s31, s82
    buffer_load_dwordx4 v19, s[36:39], s31 offen offset:0 lds
    v_exp_f32 v155, v155
    v_exp_f32 v156, v156
    v_exp_f32 v157, v157
    v_mfma_f32_32x32x16_bf16 v[136:151], v[168:171], v[200:203], v[64:79]
    ds_read_b128 v[184:187], v10 offset:26624
    v_exp_f32 v158, v158
    v_exp_f32 v159, v159
    v_exp_f32 v160, v160
    v_mfma_f32_32x32x16_bf16 v[136:151], v[172:175], v[204:207], v[136:151]
    ds_read_b128 v[188:191], v10 offset:27648
    v_exp_f32 v161, v161
    v_exp_f32 v162, v162
    v_exp_f32 v163, v163
    v_smfmac_f32_16x16x64_bf16 v[128:131], v[28:31], v[152:159], v17
    ds_read_b128 v[176:179], v8 offset:20480
    v_exp_f32 v164, v164
    v_smfmac_f32_32x32x32_bf16 v[112:127], v[192:195], v[152:159], v17
    ds_read_b128 v[180:183], v8 offset:21504
    buffer_load_dwordx4 v20, s[36:39], s31 offen offset:1024 lds
    v_exp_f32 v165, v165
    v_exp_f32 v166, v166
    v_exp_f32 v167, v167
    v_exp_f32 v136, v136
    v_exp_f32 v137, v137
    v_smfmac_f32_16x16x64_bf16 v[128:131], v[28:31], v[160:167], v17
    s_cmp_eq_u32 s63, 2
    s_cbranch_scc1 AP47
AR48:
    v_exp_f32 v138, v138
    v_smfmac_f32_32x32x32_bf16 v[112:127], v[196:199], v[160:167], v17
    s_waitcnt lgkmcnt(0)
    s_add_u32 m0, s81, 147456
    s_xor_b32 s31, s73, 524288
    s_add_u32 s31, s31, s82
    buffer_load_dwordx4 v19, s[36:39], s31 offen offset:0 lds
    v_exp_f32 v139, v139
    v_exp_f32 v140, v140
    v_exp_f32 v141, v141
    v_mfma_f32_32x32x16_bf16 v[152:167], v[176:179], v[200:203], v[64:79]
    ds_read_b128 v[192:195], v10 offset:22528
    v_exp_f32 v142, v142
    v_exp_f32 v143, v143
    v_exp_f32 v144, v144
    v_mfma_f32_32x32x16_bf16 v[152:167], v[180:183], v[204:207], v[152:167]
    ds_read_b128 v[196:199], v10 offset:23552
    s_setprio 1
    v_exp_f32 v145, v145
    v_exp_f32 v146, v146
    v_exp_f32 v147, v147
    v_smfmac_f32_16x16x64_bf16 v[128:131], v[28:31], v[136:143], v17
    ds_read_b128 v[168:171], v8 offset:16384
    v_exp_f32 v148, v148
    v_smfmac_f32_32x32x32_bf16 v[112:127], v[184:187], v[136:143], v17
    ds_read_b128 v[172:175], v8 offset:17408
    buffer_load_dwordx4 v20, s[36:39], s31 offen offset:1024 lds
    v_exp_f32 v149, v149
    v_exp_f32 v150, v150
    v_exp_f32 v151, v151
    v_exp_f32 v152, v152
    v_exp_f32 v153, v153
    v_smfmac_f32_16x16x64_bf16 v[128:131], v[28:31], v[144:151], v17
    s_cmp_eq_u32 s63, 3
    s_cbranch_scc1 AP49
AR50:
    v_exp_f32 v154, v154
    v_smfmac_f32_32x32x32_bf16 v[112:127], v[188:191], v[144:151], v17
    s_waitcnt lgkmcnt(0)
    s_barrier
    v_exp_f32 v155, v155
    v_exp_f32 v156, v156
    v_exp_f32 v157, v157
    v_mfma_f32_32x32x16_bf16 v[136:151], v[168:171], v[200:203], v[64:79]
    ds_read_b128 v[184:187], v10 offset:18432
    v_exp_f32 v158, v158
    v_exp_f32 v159, v159
    v_exp_f32 v160, v160
    v_mfma_f32_32x32x16_bf16 v[136:151], v[172:175], v[204:207], v[136:151]
    ds_read_b128 v[188:191], v10 offset:19456
    v_exp_f32 v161, v161
    v_exp_f32 v162, v162
    v_exp_f32 v163, v163
    v_smfmac_f32_16x16x64_bf16 v[128:131], v[28:31], v[152:159], v17
    ds_read_b128 v[176:179], v8 offset:12288
    v_exp_f32 v164, v164
    v_smfmac_f32_32x32x32_bf16 v[112:127], v[192:195], v[152:159], v17
    ds_read_b128 v[180:183], v8 offset:13312
    s_add_u32 m0, s81, 49152
    s_xor_b32 s31, s73, 1048576
    s_add_u32 s31, s31, s82
    buffer_load_dwordx4 v19, s[36:39], s31 offen offset:0 lds
    v_exp_f32 v165, v165
    v_exp_f32 v166, v166
    v_exp_f32 v167, v167
    v_exp_f32 v136, v136
    v_exp_f32 v137, v137
    v_smfmac_f32_16x16x64_bf16 v[128:131], v[28:31], v[160:167], v17
    s_cmp_eq_u32 s63, 4
    s_cbranch_scc1 AP51
AR52:
    v_exp_f32 v138, v138
    v_smfmac_f32_32x32x32_bf16 v[112:127], v[196:199], v[160:167], v17
    s_waitcnt lgkmcnt(0)
    buffer_load_dwordx4 v20, s[36:39], s31 offen offset:1024 lds
    v_exp_f32 v139, v139
    v_exp_f32 v140, v140
    v_exp_f32 v141, v141
    v_mfma_f32_32x32x16_bf16 v[152:167], v[176:179], v[200:203], v[64:79]
    ds_read_b128 v[192:195], v10 offset:14336
    v_exp_f32 v142, v142
    v_exp_f32 v143, v143
    v_exp_f32 v144, v144
    v_mfma_f32_32x32x16_bf16 v[152:167], v[180:183], v[204:207], v[152:167]
    ds_read_b128 v[196:199], v10 offset:15360
    s_setprio 0
    v_exp_f32 v145, v145
    v_exp_f32 v146, v146
    v_exp_f32 v147, v147
    v_smfmac_f32_16x16x64_bf16 v[128:131], v[28:31], v[136:143], v17
    ds_read_b128 v[168:171], v8 offset:8192
    v_exp_f32 v148, v148
    v_smfmac_f32_32x32x32_bf16 v[112:127], v[184:187], v[136:143], v17
    ds_read_b128 v[172:175], v8 offset:9216
    s_mov_b32 exec_lo, s71
    s_mov_b32 exec_hi, 0
    buffer_load_dwordx2 v[14:15], v5, s[16:19], s70 offen sc1
    s_mov_b64 exec, -1
    v_exp_f32 v149, v149
    v_exp_f32 v150, v150
    v_exp_f32 v151, v151
    v_exp_f32 v152, v152
    v_exp_f32 v153, v153
    v_smfmac_f32_16x16x64_bf16 v[128:131], v[28:31], v[144:151], v17
    s_cmp_eq_u32 s63, 5
    s_cbranch_scc1 AP53
AR54:
    v_exp_f32 v154, v154
    v_smfmac_f32_32x32x32_bf16 v[112:127], v[188:191], v[144:151], v17
    s_waitcnt lgkmcnt(0)
    v_exp_f32 v155, v155
    v_exp_f32 v156, v156
    v_exp_f32 v157, v157
    v_mfma_f32_32x32x16_bf16 v[136:151], v[168:171], v[200:203], v[64:79]
    ds_read_b128 v[184:187], v10 offset:10240
    v_exp_f32 v158, v158
    v_exp_f32 v159, v159
    v_exp_f32 v160, v160
    v_mfma_f32_32x32x16_bf16 v[136:151], v[172:175], v[204:207], v[136:151]
    ds_read_b128 v[188:191], v10 offset:11264
    v_exp_f32 v161, v161
    v_exp_f32 v162, v162
    v_exp_f32 v163, v163
    v_smfmac_f32_16x16x64_bf16 v[128:131], v[28:31], v[152:159], v17
    ds_read_b128 v[176:179], v8 offset:4096
    v_exp_f32 v164, v164
    v_smfmac_f32_32x32x32_bf16 v[112:127], v[192:195], v[152:159], v17
    ds_read_b128 v[180:183], v8 offset:5120
    v_exp_f32 v165, v165
    v_exp_f32 v166, v166
    v_exp_f32 v167, v167
    v_exp_f32 v136, v136
    v_exp_f32 v137, v137
    v_smfmac_f32_16x16x64_bf16 v[128:131], v[28:31], v[160:167], v17
    s_cmp_eq_u32 s63, 6
    s_cbranch_scc1 AP55
AR56:
    v_exp_f32 v138, v138
    v_smfmac_f32_32x32x32_bf16 v[112:127], v[196:199], v[160:167], v17
    s_waitcnt lgkmcnt(0)
    s_waitcnt vmcnt(0)
    v_cmp_eq_u64 vcc, v[6:7], v[14:15]
    s_and_b32 s27, vcc_lo, s71
    s_cmp_eq_u32 s27, s71
    s_cbranch_scc0 FC57
FD58:
    s_add_u32 m0, s81, 65536
    s_xor_b32 s31, s75, 0
    s_add_u32 s31, s31, s83
    buffer_load_dwordx4 v3, s[16:19], s31 offen offset:0 sc1 lds
    v_exp_f32 v139, v139
    v_exp_f32 v140, v140
    v_exp_f32 v141, v141
    v_mfma_f32_32x32x16_bf16 v[152:167], v[176:179], v[200:203], v[64:79]
    ds_read_b128 v[192:195], v10 offset:6144
    v_exp_f32 v142, v142
    v_exp_f32 v143, v143
    v_exp_f32 v144, v144
    v_mfma_f32_32x32x16_bf16 v[152:167], v[180:183], v[204:207], v[152:167]
    ds_read_b128 v[196:199], v10 offset:7168
    s_setprio 0
    v_exp_f32 v145, v145
    v_exp_f32 v146, v146
    v_exp_f32 v147, v147
    v_smfmac_f32_16x16x64_bf16 v[128:131], v[28:31], v[136:143], v17
    ds_read_b128 v[168:171], v8 offset:0
    v_exp_f32 v148, v148
    v_smfmac_f32_32x32x32_bf16 v[112:127], v[184:187], v[136:143], v17
    ds_read_b128 v[172:175], v8 offset:1024
    buffer_load_dwordx4 v3, s[16:19], s31 offen offset:1024 sc1 lds
    v_exp_f32 v149, v149
    v_exp_f32 v150, v150
    v_exp_f32 v151, v151
    v_exp_f32 v152, v152
    v_exp_f32 v153, v153
    v_smfmac_f32_16x16x64_bf16 v[128:131], v[28:31], v[144:151], v17
    s_cmp_eq_u32 s63, 7
    s_cbranch_scc1 AP59
AR60:
    v_exp_f32 v154, v154
    v_smfmac_f32_32x32x32_bf16 v[112:127], v[188:191], v[144:151], v17
    s_waitcnt lgkmcnt(0)
    v_min_f32 v48, v64, -v32
    v_min_f32 v49, v64, -v33
    v_min_f32 v50, v64, -v34
    v_min_f32 v51, v64, -v35
    v_min_f32 v52, v64, -v36
    v_min_f32 v53, v64, -v37
    v_min_f32 v54, v64, -v38
    v_min_f32 v55, v64, -v39
    v_min_f32 v56, v64, -v40
    v_min_f32 v57, v64, -v41
    v_min_f32 v58, v64, -v42
    v_min_f32 v59, v64, -v43
    v_min_f32 v60, v64, -v44
    v_min_f32 v61, v64, -v45
    v_min_f32 v62, v64, -v46
    v_min_f32 v63, v64, -v47
    s_add_u32 m0, s81, 98304
    s_xor_b32 s31, s75, 4096
    s_add_u32 s31, s31, s83
    buffer_load_dwordx4 v3, s[16:19], s31 offen offset:0 sc1 lds
    v_exp_f32 v155, v155
    v_exp_f32 v156, v156
    v_exp_f32 v157, v157
    v_mfma_f32_32x32x16_bf16 v[136:151], v[168:171], v[200:203], v[48:63]
    ds_read_b128 v[184:187], v10 offset:2048
    v_exp_f32 v158, v158
    v_exp_f32 v159, v159
    v_exp_f32 v160, v160
    v_mfma_f32_32x32x16_bf16 v[136:151], v[172:175], v[204:207], v[136:151]
    ds_read_b128 v[188:191], v10 offset:3072
    v_exp_f32 v161, v161
    v_exp_f32 v162, v162
    v_exp_f32 v163, v163
    v_smfmac_f32_16x16x64_bf16 v[128:131], v[28:31], v[152:159], v17
    s_nop 0
    v_exp_f32 v164, v164
    v_smfmac_f32_32x32x32_bf16 v[112:127], v[192:195], v[152:159], v17
    s_nop 0
    buffer_load_dwordx4 v3, s[16:19], s31 offen offset:1024 sc1 lds
    v_exp_f32 v165, v165
    v_exp_f32 v166, v166
    v_exp_f32 v167, v167
    v_exp_f32 v136, v136
    v_exp_f32 v137, v137
    v_smfmac_f32_16x16x64_bf16 v[128:131], v[28:31], v[160:167], v17
    v_exp_f32 v138, v138
    v_smfmac_f32_32x32x32_bf16 v[112:127], v[196:199], v[160:167], v17
    s_waitcnt lgkmcnt(0)
    s_add_u32 m0, s81, 131072
    s_xor_b32 s31, s75, 8192
    s_add_u32 s31, s31, s83
    buffer_load_dwordx4 v3, s[16:19], s31 offen offset:0 sc1 lds
    v_exp_f32 v139, v139
    v_exp_f32 v140, v140
    v_exp_f32 v141, v141
    v_exp_f32 v142, v142
    v_exp_f32 v143, v143
    v_exp_f32 v144, v144
    v_exp_f32 v145, v145
    v_exp_f32 v146, v146
    v_exp_f32 v147, v147
    v_smfmac_f32_16x16x64_bf16 v[128:131], v[28:31], v[136:143], v17
    v_exp_f32 v148, v148
    v_smfmac_f32_32x32x32_bf16 v[112:127], v[184:187], v[136:143], v17
    buffer_load_dwordx4 v3, s[16:19], s31 offen offset:1024 sc1 lds
    v_exp_f32 v149, v149
    v_exp_f32 v150, v150
    v_exp_f32 v151, v151
    s_nop 1
    v_smfmac_f32_16x16x64_bf16 v[128:131], v[28:31], v[144:151], v17
    v_smfmac_f32_32x32x32_bf16 v[112:127], v[188:191], v[144:151], v17
    s_nop 11
    v_rcp_f32 v22, v128
    v_cmp_gt_f32 s[4:5], s78, v128
    v_maximum3_f32 v23, abs(v112), abs(v113), 0
    v_maximum3_f32 v23, abs(v114), abs(v115), v23
    v_maximum3_f32 v23, abs(v116), abs(v117), v23
    v_maximum3_f32 v23, abs(v118), abs(v119), v23
    v_maximum3_f32 v23, abs(v120), abs(v121), v23
    v_maximum3_f32 v23, abs(v122), abs(v123), v23
    v_maximum3_f32 v23, abs(v124), abs(v125), v23
    v_maximum3_f32 v23, abs(v126), abs(v127), v23
    v_cmp_gt_f32 s[6:7], s77, v23
    v_cmp_lt_f32 vcc, s76, v23
    s_and_b64 s[4:5], s[4:5], s[6:7]
    s_and_b64 s[4:5], s[4:5], vcc
    s_cmp_eq_u64 s[4:5], -1
    s_cbranch_scc0 FB61
RT62:
    v_mul_f32 v112, v22, v112
    v_mul_f32 v113, v22, v113
    v_mul_f32 v114, v22, v114
    v_mul_f32 v115, v22, v115
    v_mul_f32 v116, v22, v116
    v_mul_f32 v117, v22, v117
    v_mul_f32 v118, v22, v118
    v_mul_f32 v119, v22, v119
    v_mul_f32 v120, v22, v120
    v_mul_f32 v121, v22, v121
    v_mul_f32 v122, v22, v122
    v_mul_f32 v123, v22, v123
    v_mul_f32 v124, v22, v124
    v_mul_f32 v125, v22, v125
    v_mul_f32 v126, v22, v126
    v_mul_f32 v127, v22, v127
    v_cvt_pk_bf16_f32 v152, v112, v113
    v_cvt_pk_bf16_f32 v153, v114, v115
    v_cvt_pk_bf16_f32 v154, v116, v117
    v_cvt_pk_bf16_f32 v155, v118, v119
    v_cvt_pk_bf16_f32 v156, v120, v121
    v_cvt_pk_bf16_f32 v157, v122, v123
    v_cvt_pk_bf16_f32 v158, v124, v125
    v_cvt_pk_bf16_f32 v159, v126, v127
    buffer_store_dwordx4 v[152:155], v18, s[16:19], s85 offen offset:0 sc1
    buffer_store_dwordx4 v[156:159], v18, s[16:19], s85 offen offset:512 sc1
    s_mov_b32 s66, s86
    s_waitcnt vmcnt(6)
    s_barrier
    s_cmp_ge_u32 s20, 4
    s_cbranch_scc1 OUTC
    s_xor_b32 s51, s66, 16384
    s_branch OUTL0
XEND:
.p2align 12
.fill 32, 4, 0xbf800000
VP6:
    s_branch VR5
YOLD:
    buffer_store_dwordx4 v[224:227], v4, s[16:19], s35 offen offset:256 sc1
    buffer_store_dwordx4 v[228:231], v4, s[16:19], s35 offen offset:0 sc1
    buffer_store_dwordx4 v[232:235], v4, s[16:19], s35 offen offset:2048 sc1
    buffer_store_dwordx4 v[236:239], v4, s[16:19], s35 offen offset:2304 sc1
    buffer_store_dwordx4 v[240:243], v4, s[16:19], s44 offen offset:2048 sc1
    buffer_store_dwordx4 v[244:247], v4, s[16:19], s44 offen offset:2304 sc1
    buffer_store_dwordx4 v[248:251], v4, s[16:19], s44 offen offset:256 sc1
    buffer_store_dwordx4 v[252:255], v4, s[16:19], s44 offen offset:0 sc1
    ds_write_b128 v79, v[216:219] offset:256
    ds_write_b128 v79, v[220:223] offset:0
    ds_write_b128 v78, v[224:227] offset:256
    ds_write_b128 v78, v[228:231] offset:0
    ds_write_b128 v78, v[232:235] offset:2048
    ds_write_b128 v78, v[236:239] offset:2304
    ds_write_b128 v78, v[240:243] offset:6144
    ds_write_b128 v78, v[244:247] offset:6400
    ds_write_b128 v78, v[248:251] offset:4352
    ds_write_b128 v78, v[252:255] offset:4096
    ds_write_b128 v79, v[208:211] offset:2304
    ds_write_b128 v79, v[212:215] offset:2048
    s_branch VP66
VR65:
YPATH:
    v_mov_b64 v[112:113], 0
    v_mov_b64 v[114:115], 0
    v_mov_b64 v[116:117], 0
    v_mov_b64 v[118:119], 0
    v_mov_b64 v[120:121], 0
    v_mov_b64 v[122:123], 0
    v_mov_b64 v[124:125], 0
    v_mov_b64 v[126:127], 0
    v_mov_b64 v[128:129], 0
    v_mov_b64 v[130:131], 0
    s_waitcnt lgkmcnt(0)
    s_barrier
    ds_read_b128 v[200:203], v12 offset:0
    ds_read_b128 v[204:207], v12 offset:1024
    ds_read_b128 v[168:171], v8 offset:32768
    ds_read_b128 v[172:175], v8 offset:33792
    ds_read_b128 v[184:187], v10 offset:34816
    ds_read_b128 v[188:191], v10 offset:35840
    s_cmp_ge_u32 s20, 4
    s_cbranch_scc1 OB69
    s_waitcnt vmcnt(0)
    s_mov_b64 exec, 0xff
    buffer_store_dwordx4 v[6:9], v3, s[16:19], s45 offen sc1
    s_mov_b64 exec, -1
OB69:
    s_waitcnt lgkmcnt(0)
    v_mfma_f32_32x32x16_bf16 v[136:151], v[168:171], v[200:203], v[48:63]
    v_mfma_f32_32x32x16_bf16 v[136:151], v[172:175], v[204:207], v[136:151]
    s_nop 11
    v_max3_f32 v26, v136, v137, v138
    v_max3_f32 v26, v26, v139, v140
    v_max3_f32 v26, v26, v141, v142
    v_max3_f32 v26, v26, v143, v144
    v_max3_f32 v26, v26, v145, v146
    v_max3_f32 v26, v26, v147, v148
    v_max3_f32 v26, v26, v149, v150
    v_max_f32 v26, v26, v151
    s_cmp_ge_u32 s20, 4
    s_cbranch_scc1 OB70
    s_cmp_eq_u32 s21, 0
    s_cbranch_scc1 YN68
    s_mov_b32 exec_lo, s62
    s_mov_b32 exec_hi, 0
    buffer_load_dwordx2 v[14:15], v5, s[16:19], s59 offen sc1
    s_mov_b64 exec, -1
    s_waitcnt vmcnt(0)
    v_cmp_eq_u64 vcc, v[6:7], v[14:15]
    s_and_b32 s27, vcc_lo, s62
    s_cmp_eq_u32 s27, s62
    s_cbranch_scc0 FC71
FD72:
    s_max_u32 s31, s21, 1
    s_sub_u32 s31, s31, 1
    s_lshl_b32 s31, s31, 15
    s_add_u32 s31, s31, s55
    s_add_u32 s51, s31, s74
    s_add_u32 m0, s74, 81920
    s_add_u32 s51, s51, 16384
    buffer_load_dwordx4 v3, s[16:19], s51 offen offset:0 sc1 lds
    buffer_load_dwordx4 v3, s[16:19], s51 offen offset:1024 sc1 lds
    buffer_load_dwordx4 v3, s[16:19], s51 offen offset:2048 sc1 lds
    buffer_load_dwordx4 v3, s[16:19], s51 offen offset:3072 sc1 lds
    s_mov_b32 exec_lo, s60
    s_mov_b32 exec_hi, 0
    buffer_load_dwordx2 v[14:15], v5, s[16:19], s59 offen sc1
    s_mov_b64 exec, -1
YN68:
OB70:
    s_cmp_lg_u32 s64, 0
    s_cbranch_scc1 YK73
    s_waitcnt vmcnt(0)
    s_barrier
    s_cmp_eq_u32 s21, 0
    s_cbranch_scc1 YK73
    v_cmp_eq_u64 vcc, v[6:7], v[14:15]
    s_and_b32 s27, vcc_lo, s60
    s_cmp_eq_u32 s27, s60
    s_cbranch_scc0 FC74
FD75:
    s_mov_b32 m0, 77824
    s_add_u32 s51, s31, 12288
    buffer_load_dwordx4 v3, s[16:19], s51 offen offset:0 sc1 lds
    buffer_load_dwordx4 v3, s[16:19], s51 offen offset:1024 sc1 lds
    buffer_load_dwordx4 v3, s[16:19], s51 offen offset:2048 sc1 lds
    buffer_load_dwordx4 v3, s[16:19], s51 offen offset:3072 sc1 lds
    s_mov_b32 m0, 73728
    s_add_u32 s51, s31, 8192
    buffer_load_dwordx4 v3, s[16:19], s51 offen offset:0 sc1 lds
    buffer_load_dwordx4 v3, s[16:19], s51 offen offset:1024 sc1 lds
    buffer_load_dwordx4 v3, s[16:19], s51 offen offset:2048 sc1 lds
    buffer_load_dwordx4 v3, s[16:19], s51 offen offset:3072 sc1 lds
    s_mov_b32 m0, 69632
    s_add_u32 s51, s31, 4096
    buffer_load_dwordx4 v3, s[16:19], s51 offen offset:0 sc1 lds
    buffer_load_dwordx4 v3, s[16:19], s51 offen offset:1024 sc1 lds
    buffer_load_dwordx4 v3, s[16:19], s51 offen offset:2048 sc1 lds
    buffer_load_dwordx4 v3, s[16:19], s51 offen offset:3072 sc1 lds
    s_mov_b32 m0, 65536
    s_add_u32 s51, s31, 0
    buffer_load_dwordx4 v3, s[16:19], s51 offen offset:0 sc1 lds
    buffer_load_dwordx4 v3, s[16:19], s51 offen offset:1024 sc1 lds
    buffer_load_dwordx4 v3, s[16:19], s51 offen offset:2048 sc1 lds
    buffer_load_dwordx4 v3, s[16:19], s51 offen offset:3072 sc1 lds
YK73:
    ds_read_b128 v[176:179], v8 offset:28672
    ds_read_b128 v[180:183], v8 offset:29696
    s_waitcnt lgkmcnt(0)
    v_mfma_f32_32x32x16_bf16 v[152:167], v[176:179], v[200:203], 0
    v_mfma_f32_32x32x16_bf16 v[152:167], v[180:183], v[204:207], v[152:167]
    s_nop 9
    s_cmp_eq_u32 s63, 0
    s_cbranch_scc1 AM76
    v_max3_f32 v26, v26, v152, v153
    v_max3_f32 v26, v26, v154, v155
    v_max3_f32 v26, v26, v156, v157
    v_max3_f32 v26, v26, v158, v159
    v_max3_f32 v26, v26, v160, v161
    v_max3_f32 v26, v26, v162, v163
    v_max3_f32 v26, v26, v164, v165
    v_max3_f32 v26, v26, v166, v167
AM76:
    v_mov_b32 v24, v26
    s_nop 1
    v_permlane32_swap_b32 v24, v26
    s_nop 1
    v_max_f32 v26, v26, v24
    v_sub_f32 v64, s68, v26
    v_mov_b32 v65, v64
    v_mov_b64 v[66:67], v[64:65]
    v_mov_b64 v[68:69], v[64:65]
    v_mov_b64 v[70:71], v[64:65]
    v_mov_b64 v[72:73], v[64:65]
    v_mov_b64 v[74:75], v[64:65]
    v_mov_b64 v[76:77], v[64:65]
    v_mov_b64 v[78:79], v[64:65]
    v_add_f32 v136, v136, v64
    v_add_f32 v137, v137, v64
    v_add_f32 v138, v138, v64
    v_add_f32 v139, v139, v64
    v_add_f32 v140, v140, v64
    v_add_f32 v141, v141, v64
    v_add_f32 v142, v142, v64
    v_add_f32 v143, v143, v64
    v_add_f32 v144, v144, v64
    v_add_f32 v145, v145, v64
    v_add_f32 v146, v146, v64
    v_add_f32 v147, v147, v64
    v_add_f32 v148, v148, v64
    v_add_f32 v149, v149, v64
    v_add_f32 v150, v150, v64
    v_add_f32 v151, v151, v64
    s_cmp_eq_u32 s63, 0
    s_cbranch_scc1 AP77
AR78:
    v_exp_f32 v136, v136
    v_exp_f32 v137, v137
    s_cmp_eq_u32 s64, 1
    v_exp_f32 v138, v138
    s_waitcnt lgkmcnt(0)
    v_exp_f32 v139, v139
    v_exp_f32 v140, v140
    v_exp_f32 v141, v141
    v_mfma_f32_32x32x16_bf16 v[152:167], v[176:179], v[200:203], v[64:79]
    ds_read_b128 v[192:195], v10 offset:30720
    v_exp_f32 v142, v142
    v_exp_f32 v143, v143
    v_exp_f32 v144, v144
    v_mfma_f32_32x32x16_bf16 v[152:167], v[180:183], v[204:207], v[152:167]
    ds_read_b128 v[196:199], v10 offset:31744
    v_exp_f32 v145, v145
    v_exp_f32 v146, v146
    v_exp_f32 v147, v147
    v_smfmac_f32_16x16x64_bf16 v[128:131], v[28:31], v[136:143], v17
    s_cbranch_scc1 YP79
YR80:
    ds_read_b128 v[168:171], v8 offset:24576
    v_exp_f32 v148, v148
    v_smfmac_f32_32x32x32_bf16 v[112:127], v[184:187], v[136:143], v17
    ds_read_b128 v[172:175], v8 offset:25600
    v_exp_f32 v149, v149
    v_exp_f32 v150, v150
    v_exp_f32 v151, v151
    v_exp_f32 v152, v152
    v_exp_f32 v153, v153
    v_smfmac_f32_16x16x64_bf16 v[128:131], v[28:31], v[144:151], v17
    s_cmp_eq_u32 s64, 2
    v_exp_f32 v154, v154
    v_smfmac_f32_32x32x32_bf16 v[112:127], v[188:191], v[144:151], v17
    s_waitcnt lgkmcnt(0)
    v_exp_f32 v155, v155
    v_exp_f32 v156, v156
    v_exp_f32 v157, v157
    v_mfma_f32_32x32x16_bf16 v[136:151], v[168:171], v[200:203], v[64:79]
    ds_read_b128 v[184:187], v10 offset:26624
    v_exp_f32 v158, v158
    v_exp_f32 v159, v159
    v_exp_f32 v160, v160
    v_mfma_f32_32x32x16_bf16 v[136:151], v[172:175], v[204:207], v[136:151]
    ds_read_b128 v[188:191], v10 offset:27648
    v_exp_f32 v161, v161
    v_exp_f32 v162, v162
    v_exp_f32 v163, v163
    v_smfmac_f32_16x16x64_bf16 v[128:131], v[28:31], v[152:159], v17
    s_cbranch_scc1 YP84
YR85:
    ds_read_b128 v[176:179], v8 offset:20480
    v_exp_f32 v164, v164
    v_smfmac_f32_32x32x32_bf16 v[112:127], v[192:195], v[152:159], v17
    ds_read_b128 v[180:183], v8 offset:21504
    v_exp_f32 v165, v165
    v_exp_f32 v166, v166
    v_exp_f32 v167, v167
    v_exp_f32 v136, v136
    v_exp_f32 v137, v137
    v_smfmac_f32_16x16x64_bf16 v[128:131], v[28:31], v[160:167], v17
    s_cmp_eq_u32 s64, 3
    v_exp_f32 v138, v138
    v_smfmac_f32_32x32x32_bf16 v[112:127], v[196:199], v[160:167], v17
    s_waitcnt lgkmcnt(0)
    v_exp_f32 v139, v139
    v_exp_f32 v140, v140
    v_exp_f32 v141, v141
    v_mfma_f32_32x32x16_bf16 v[152:167], v[176:179], v[200:203], v[64:79]
    ds_read_b128 v[192:195], v10 offset:22528
    v_exp_f32 v142, v142
    v_exp_f32 v143, v143
    v_exp_f32 v144, v144
    v_mfma_f32_32x32x16_bf16 v[152:167], v[180:183], v[204:207], v[152:167]
    ds_read_b128 v[196:199], v10 offset:23552
    v_exp_f32 v145, v145
    v_exp_f32 v146, v146
    v_exp_f32 v147, v147
    v_smfmac_f32_16x16x64_bf16 v[128:131], v[28:31], v[136:143], v17
    s_cbranch_scc1 YP89
YR90:
    ds_read_b128 v[168:171], v8 offset:16384
    v_exp_f32 v148, v148
    v_smfmac_f32_32x32x32_bf16 v[112:127], v[184:187], v[136:143], v17
    ds_read_b128 v[172:175], v8 offset:17408
    v_exp_f32 v149, v149
    v_exp_f32 v150, v150
    v_exp_f32 v151, v151
    v_exp_f32 v152, v152
    v_exp_f32 v153, v153
    v_smfmac_f32_16x16x64_bf16 v[128:131], v[28:31], v[144:151], v17
    s_cmp_eq_u32 s64, 4
    v_exp_f32 v154, v154
    v_smfmac_f32_32x32x32_bf16 v[112:127], v[188:191], v[144:151], v17
    s_waitcnt lgkmcnt(0)
    v_exp_f32 v155, v155
    v_exp_f32 v156, v156
    v_exp_f32 v157, v157
    v_mfma_f32_32x32x16_bf16 v[136:151], v[168:171], v[200:203], v[64:79]
    ds_read_b128 v[184:187], v10 offset:18432
    v_exp_f32 v158, v158
    v_exp_f32 v159, v159
    v_exp_f32 v160, v160
    v_mfma_f32_32x32x16_bf16 v[136:151], v[172:175], v[204:207], v[136:151]
    ds_read_b128 v[188:191], v10 offset:19456
    s_waitcnt vmcnt(0)
    v_exp_f32 v161, v161
    v_exp_f32 v162, v162
    v_exp_f32 v163, v163
    v_smfmac_f32_16x16x64_bf16 v[128:131], v[28:31], v[152:159], v17
    s_cbranch_scc1 YP94
YR95:
    ds_read_b128 v[176:179], v8 offset:12288
    v_exp_f32 v164, v164
    v_smfmac_f32_32x32x32_bf16 v[112:127], v[192:195], v[152:159], v17
    ds_read_b128 v[180:183], v8 offset:13312
    v_exp_f32 v165, v165
    v_exp_f32 v166, v166
    v_exp_f32 v167, v167
    v_exp_f32 v136, v136
    v_exp_f32 v137, v137
    v_smfmac_f32_16x16x64_bf16 v[128:131], v[28:31], v[160:167], v17
    s_cmp_eq_u32 s64, 5
    v_exp_f32 v138, v138
    v_smfmac_f32_32x32x32_bf16 v[112:127], v[196:199], v[160:167], v17
    s_waitcnt lgkmcnt(0)
    v_exp_f32 v139, v139
    v_exp_f32 v140, v140
    v_exp_f32 v141, v141
    v_mfma_f32_32x32x16_bf16 v[152:167], v[176:179], v[200:203], v[64:79]
    ds_read_b128 v[192:195], v10 offset:14336
    v_exp_f32 v142, v142
    v_exp_f32 v143, v143
    v_exp_f32 v144, v144
    v_mfma_f32_32x32x16_bf16 v[152:167], v[180:183], v[204:207], v[152:167]
    ds_read_b128 v[196:199], v10 offset:15360
    v_exp_f32 v145, v145
    v_exp_f32 v146, v146
    v_exp_f32 v147, v147
    v_smfmac_f32_16x16x64_bf16 v[128:131], v[28:31], v[136:143], v17
    s_cbranch_scc1 YP97
YR98:
    ds_read_b128 v[168:171], v8 offset:8192
    v_exp_f32 v148, v148
    v_smfmac_f32_32x32x32_bf16 v[112:127], v[184:187], v[136:143], v17
    ds_read_b128 v[172:175], v8 offset:9216
    v_exp_f32 v149, v149
    v_exp_f32 v150, v150
    v_exp_f32 v151, v151
    v_exp_f32 v152, v152
    v_exp_f32 v153, v153
    v_smfmac_f32_16x16x64_bf16 v[128:131], v[28:31], v[144:151], v17
    s_cmp_eq_u32 s64, 6
    v_exp_f32 v154, v154
    v_smfmac_f32_32x32x32_bf16 v[112:127], v[188:191], v[144:151], v17
    s_waitcnt lgkmcnt(0)
    v_exp_f32 v155, v155
    v_exp_f32 v156, v156
    v_exp_f32 v157, v157
    v_mfma_f32_32x32x16_bf16 v[136:151], v[168:171], v[200:203], v[64:79]
    ds_read_b128 v[184:187], v10 offset:10240
    v_exp_f32 v158, v158
    v_exp_f32 v159, v159
    v_exp_f32 v160, v160
    v_mfma_f32_32x32x16_bf16 v[136:151], v[172:175], v[204:207], v[136:151]
    ds_read_b128 v[188:191], v10 offset:11264
    v_exp_f32 v161, v161
    v_exp_f32 v162, v162
    v_exp_f32 v163, v163
    v_smfmac_f32_16x16x64_bf16 v[128:131], v[28:31], v[152:159], v17
    s_cbranch_scc1 YP100
YR101:
    ds_read_b128 v[176:179], v8 offset:4096
    v_exp_f32 v164, v164
    v_smfmac_f32_32x32x32_bf16 v[112:127], v[192:195], v[152:159], v17
    ds_read_b128 v[180:183], v8 offset:5120
    v_exp_f32 v165, v165
    v_exp_f32 v166, v166
    v_exp_f32 v167, v167
    v_exp_f32 v136, v136
    v_exp_f32 v137, v137
    v_smfmac_f32_16x16x64_bf16 v[128:131], v[28:31], v[160:167], v17
    s_cmp_eq_u32 s64, 7
    v_exp_f32 v138, v138
    v_smfmac_f32_32x32x32_bf16 v[112:127], v[196:199], v[160:167], v17
    s_waitcnt lgkmcnt(0)
    v_exp_f32 v139, v139
    v_exp_f32 v140, v140
    v_exp_f32 v141, v141
    v_mfma_f32_32x32x16_bf16 v[152:167], v[176:179], v[200:203], v[64:79]
    ds_read_b128 v[192:195], v10 offset:6144
    v_exp_f32 v142, v142
    v_exp_f32 v143, v143
    v_exp_f32 v144, v144
    v_mfma_f32_32x32x16_bf16 v[152:167], v[180:183], v[204:207], v[152:167]
    ds_read_b128 v[196:199], v10 offset:7168
    v_exp_f32 v145, v145
    v_exp_f32 v146, v146
    v_exp_f32 v147, v147
    v_smfmac_f32_16x16x64_bf16 v[128:131], v[28:31], v[136:143], v17
    s_cbranch_scc1 YP103
YR104:
    ds_read_b128 v[168:171], v8 offset:0
    v_exp_f32 v148, v148
    v_smfmac_f32_32x32x32_bf16 v[112:127], v[184:187], v[136:143], v17
    ds_read_b128 v[172:175], v8 offset:1024
    v_exp_f32 v149, v149
    v_exp_f32 v150, v150
    v_exp_f32 v151, v151
    v_exp_f32 v152, v152
    v_exp_f32 v153, v153
    v_smfmac_f32_16x16x64_bf16 v[128:131], v[28:31], v[144:151], v17
    v_exp_f32 v154, v154
    v_smfmac_f32_32x32x32_bf16 v[112:127], v[188:191], v[144:151], v17
    s_waitcnt lgkmcnt(0)
    v_min_f32 v48, v64, -v32
    v_min_f32 v49, v64, -v33
    v_min_f32 v50, v64, -v34
    v_min_f32 v51, v64, -v35
    v_min_f32 v52, v64, -v36
    v_min_f32 v53, v64, -v37
    v_min_f32 v54, v64, -v38
    v_min_f32 v55, v64, -v39
    v_min_f32 v56, v64, -v40
    v_min_f32 v57, v64, -v41
    v_min_f32 v58, v64, -v42
    v_min_f32 v59, v64, -v43
    v_min_f32 v60, v64, -v44
    v_min_f32 v61, v64, -v45
    v_min_f32 v62, v64, -v46
    v_min_f32 v63, v64, -v47
    v_exp_f32 v155, v155
    v_exp_f32 v156, v156
    v_exp_f32 v157, v157
    v_mfma_f32_32x32x16_bf16 v[136:151], v[168:171], v[200:203], v[48:63]
    ds_read_b128 v[184:187], v10 offset:2048
    v_exp_f32 v158, v158
    v_exp_f32 v159, v159
    v_exp_f32 v160, v160
    v_mfma_f32_32x32x16_bf16 v[136:151], v[172:175], v[204:207], v[136:151]
    ds_read_b128 v[188:191], v10 offset:3072
    v_exp_f32 v161, v161
    v_exp_f32 v162, v162
    v_exp_f32 v163, v163
    v_smfmac_f32_16x16x64_bf16 v[128:131], v[28:31], v[152:159], v17
    s_nop 0
    v_exp_f32 v164, v164
    v_smfmac_f32_32x32x32_bf16 v[112:127], v[192:195], v[152:159], v17
    s_nop 0
    s_cmp_lt_u32 s20, 4
    s_cbranch_scc1 YB106
    s_mov_b64 exec, s[94:95]
    buffer_load_dwordx2 v[14:15], v5, s[16:19], s58 offen sc1
    s_mov_b64 exec, -1
YB106:
    v_exp_f32 v165, v165
    v_exp_f32 v166, v166
    v_exp_f32 v167, v167
    v_exp_f32 v136, v136
    v_exp_f32 v137, v137
    v_smfmac_f32_16x16x64_bf16 v[128:131], v[28:31], v[160:167], v17
    v_exp_f32 v138, v138
    v_smfmac_f32_32x32x32_bf16 v[112:127], v[196:199], v[160:167], v17
    s_waitcnt lgkmcnt(0)
    v_exp_f32 v139, v139
    v_exp_f32 v140, v140
    v_exp_f32 v141, v141
    v_exp_f32 v142, v142
    v_exp_f32 v143, v143
    v_exp_f32 v144, v144
    v_exp_f32 v145, v145
    v_exp_f32 v146, v146
    v_exp_f32 v147, v147
    v_smfmac_f32_16x16x64_bf16 v[128:131], v[28:31], v[136:143], v17
    v_exp_f32 v148, v148
    v_smfmac_f32_32x32x32_bf16 v[112:127], v[184:187], v[136:143], v17
    s_cmp_lt_u32 s20, 4
    s_cbranch_scc1 YB107
    s_waitcnt vmcnt(0)
    v_cmp_eq_u64 vcc, v[6:7], v[14:15]
    s_and_b64 vcc, vcc, s[94:95]
    s_cmp_eq_u64 vcc, s[94:95]
    s_cbranch_scc0 FC108
FD109:
    s_and_b32 s31, s21, 4
    s_xor_b32 s31, s31, 0
    s_lshl_b32 s31, s31, 15
    s_add_u32 s31, s31, s54
    s_add_u32 s31, s31, s56
    s_add_u32 m0, s56, 0
    s_nop 0
    buffer_load_dwordx4 v3, s[16:19], s31 offen offset:0 sc1 lds
    buffer_load_dwordx4 v3, s[16:19], s31 offen offset:1024 sc1 lds
    buffer_load_dwordx4 v3, s[16:19], s31 offen offset:2048 sc1 lds
    buffer_load_dwordx4 v3, s[16:19], s31 offen offset:3072 sc1 lds
    s_add_u32 m0, s56, 4096
    s_add_u32 s31, s31, 4096
    buffer_load_dwordx4 v3, s[16:19], s31 offen offset:0 sc1 lds
    buffer_load_dwordx4 v3, s[16:19], s31 offen offset:1024 sc1 lds
    buffer_load_dwordx4 v3, s[16:19], s31 offen offset:2048 sc1 lds
    buffer_load_dwordx4 v3, s[16:19], s31 offen offset:3072 sc1 lds
    s_add_u32 m0, s74, 131072
    s_xor_b32 s31, s79, 0x800
    buffer_load_dwordx4 v3, s[16:19], s31 offen offset:0 sc1 lds
    buffer_load_dwordx4 v3, s[16:19], s31 offen offset:1024 sc1 lds
    buffer_load_dwordx4 v3, s[16:19], s31 offen offset:2048 sc1 lds
    buffer_load_dwordx4 v3, s[16:19], s31 offen offset:3072 sc1 lds
    s_lshr_b32 s31, s74, 3
    s_add_u32 m0, s31, 147456
    s_mov_b32 exec_hi, 0
    buffer_load_dwordx4 v3, s[16:19], s96 offen offset:0 sc1 lds
    s_mov_b32 exec_hi, -1
YB107:
    v_exp_f32 v149, v149
    v_exp_f32 v150, v150
    v_exp_f32 v151, v151
    s_nop 1
    v_smfmac_f32_16x16x64_bf16 v[128:131], v[28:31], v[144:151], v17
    v_smfmac_f32_32x32x32_bf16 v[112:127], v[188:191], v[144:151], v17
    s_nop 11
    v_rcp_f32 v22, v128
    v_cmp_gt_f32 s[4:5], s78, v128
    v_maximum3_f32 v23, abs(v112), abs(v113), 0
    v_maximum3_f32 v23, abs(v114), abs(v115), v23
    v_maximum3_f32 v23, abs(v116), abs(v117), v23
    v_maximum3_f32 v23, abs(v118), abs(v119), v23
    v_maximum3_f32 v23, abs(v120), abs(v121), v23
    v_maximum3_f32 v23, abs(v122), abs(v123), v23
    v_maximum3_f32 v23, abs(v124), abs(v125), v23
    v_maximum3_f32 v23, abs(v126), abs(v127), v23
    v_cmp_gt_f32 s[6:7], s77, v23
    v_cmp_lt_f32 vcc, s76, v23
    s_and_b64 s[4:5], s[4:5], s[6:7]
    s_and_b64 s[4:5], s[4:5], vcc
    s_cmp_eq_u64 s[4:5], -1
    s_cbranch_scc0 FB110
RT111:
    v_mul_f32 v112, v22, v112
    v_mul_f32 v113, v22, v113
    v_mul_f32 v114, v22, v114
    v_mul_f32 v115, v22, v115
    v_mul_f32 v116, v22, v116
    v_mul_f32 v117, v22, v117
    v_mul_f32 v118, v22, v118
    v_mul_f32 v119, v22, v119
    v_mul_f32 v120, v22, v120
    v_mul_f32 v121, v22, v121
    v_mul_f32 v122, v22, v122
    v_mul_f32 v123, v22, v123
    v_mul_f32 v124, v22, v124
    v_mul_f32 v125, v22, v125
    v_mul_f32 v126, v22, v126
    v_mul_f32 v127, v22, v127
    v_cvt_pk_bf16_f32 v152, v112, v113
    v_cvt_pk_bf16_f32 v153, v114, v115
    v_cvt_pk_bf16_f32 v154, v116, v117
    v_cvt_pk_bf16_f32 v155, v118, v119
    v_cvt_pk_bf16_f32 v156, v120, v121
    v_cvt_pk_bf16_f32 v157, v122, v123
    v_cvt_pk_bf16_f32 v158, v124, v125
    v_cvt_pk_bf16_f32 v159, v126, v127
    buffer_store_dwordx4 v[152:155], v18, s[16:19], s85 offen offset:0 sc1
    buffer_store_dwordx4 v[156:159], v18, s[16:19], s85 offen offset:512 sc1
    s_setprio 0
    s_lshl_b32 s25, s29, 14
    v_add_u32 v8, s25, v16
    v_add_u32 v10, s25, v3
    s_lshr_b32 s25, s81, 3
    s_add_u32 s25, s25, 147456
    v_lshl_add_u32 v26, v2, 2, s25
    v_xor_b32 v14, 0x100, v26
    v_mov_b64 v[96:97], 0
    v_mov_b64 v[98:99], 0
    v_mov_b64 v[100:101], 0
    v_mov_b64 v[102:103], 0
    v_mov_b64 v[104:105], 0
    v_mov_b64 v[106:107], 0
    v_mov_b64 v[108:109], 0
    v_mov_b64 v[110:111], 0
    v_mov_b64 v[112:113], 0
    v_mov_b64 v[114:115], 0
    v_mov_b64 v[116:117], 0
    v_mov_b64 v[118:119], 0
    v_mov_b64 v[120:121], 0
    v_mov_b64 v[122:123], 0
    v_mov_b64 v[124:125], 0
    v_mov_b64 v[126:127], 0
    v_mov_b64 v[128:129], 0
    v_mov_b64 v[130:131], 0
    v_mov_b64 v[132:133], 0
    v_mov_b64 v[134:135], 0
    s_add_u32 s25, s81, 131072
    v_add_u32 v12, s25, v3
    v_xor_b32 v13, 0x800, v12
    s_cmp_lt_u32 s20, 4
    s_cbranch_scc1 YB114
    s_waitcnt vmcnt(0)
YB114:
    s_barrier
    ds_read_b128 v[80:83], v12 offset:0
    ds_read_b128 v[84:87], v12 offset:1024
    ds_read_b128 v[88:91], v13 offset:0
    ds_read_b128 v[92:95], v13 offset:1024
    ds_read_b128 v[168:171], v8 offset:0
    ds_read_b128 v[172:175], v8 offset:1024
    ds_read_b128 v[184:187], v10 offset:2048
    ds_read_b128 v[188:191], v10 offset:3072
    ds_read_b32 v64, v26
    ds_read_b32 v48, v14
    s_waitcnt lgkmcnt(0)
    s_mov_b32 exec_lo, s88
    s_mov_b32 exec_hi, 0
    buffer_load_dwordx2 v[14:15], v5, s[16:19], s58 offen sc1
    s_mov_b64 exec, -1
    v_mov_b32 v65, v64
    v_mov_b64 v[66:67], v[64:65]
    v_mov_b64 v[68:69], v[64:65]
    v_mov_b64 v[70:71], v[64:65]
    v_mov_b64 v[72:73], v[64:65]
    v_mov_b64 v[74:75], v[64:65]
    v_mov_b64 v[76:77], v[64:65]
    v_mov_b64 v[78:79], v[64:65]
    v_mov_b32 v49, v48
    v_mov_b64 v[50:51], v[48:49]
    v_mfma_f32_32x32x16_bf16 v[136:151], v[168:171], v[80:83], v[64:79]
    v_mfma_f32_32x32x16_bf16 v[136:151], v[172:175], v[84:87], v[136:151]
    v_mov_b64 v[52:53], v[48:49]
    v_mov_b64 v[54:55], v[48:49]
    v_mov_b64 v[56:57], v[48:49]
    v_mov_b64 v[58:59], v[48:49]
    v_mov_b64 v[60:61], v[48:49]
    v_mov_b64 v[62:63], v[48:49]
    s_nop 5
YS0:
    v_exp_f32 v136, v136
    v_exp_f32 v137, v137
    s_waitcnt lgkmcnt(0)
    v_exp_f32 v138, v138
    ds_read_b128 v[176:179], v8 offset:4096
    v_exp_f32 v139, v139
    v_exp_f32 v140, v140
    v_exp_f32 v141, v141
    v_mfma_f32_32x32x16_bf16 v[152:167], v[168:171], v[88:91], v[48:63]
    ds_read_b128 v[180:183], v8 offset:5120
    v_exp_f32 v142, v142
    v_exp_f32 v143, v143
    v_exp_f32 v144, v144
    v_mfma_f32_32x32x16_bf16 v[152:167], v[172:175], v[92:95], v[152:167]
    s_setprio 2
    v_exp_f32 v145, v145
    v_exp_f32 v146, v146
    v_exp_f32 v147, v147
    v_smfmac_f32_16x16x64_bf16 v[128:131], v[28:31], v[136:143], v17
    s_nop 0
    v_exp_f32 v148, v148
    v_smfmac_f32_32x32x32_bf16 v[96:111], v[184:187], v[136:143], v17
    s_nop 0
    v_exp_f32 v149, v149
    v_exp_f32 v150, v150
    v_exp_f32 v151, v151
YS1:
    v_exp_f32 v152, v152
    v_exp_f32 v153, v153
    v_smfmac_f32_16x16x64_bf16 v[128:131], v[28:31], v[144:151], v17
    s_waitcnt lgkmcnt(0)
    v_exp_f32 v154, v154
    v_smfmac_f32_32x32x32_bf16 v[96:111], v[188:191], v[144:151], v17
    ds_read_b128 v[192:195], v10 offset:6144
    v_exp_f32 v155, v155
    v_exp_f32 v156, v156
    v_exp_f32 v157, v157
    v_mfma_f32_32x32x16_bf16 v[136:151], v[176:179], v[80:83], v[64:79]
    ds_read_b128 v[196:199], v10 offset:7168
    s_waitcnt vmcnt(0)
    s_mov_b64 exec, 0xff
    buffer_store_dwordx4 v[6:9], v3, s[16:19], s86 offen sc1
    s_mov_b64 exec, -1
    v_cmp_eq_u64 vcc, v[6:7], v[14:15]
    s_and_b32 s27, vcc_lo, s88
    s_cmp_eq_u32 s27, s88
    s_cbranch_scc0 FC116
FD117:
    v_exp_f32 v158, v158
    v_exp_f32 v159, v159
    v_exp_f32 v160, v160
    v_mfma_f32_32x32x16_bf16 v[136:151], v[180:183], v[84:87], v[136:151]
    s_and_b32 s31, s21, 4
    s_xor_b32 s31, s31, 1
    s_lshl_b32 s31, s31, 15
    v_exp_f32 v161, v161
    v_exp_f32 v162, v162
    v_exp_f32 v163, v163
    v_smfmac_f32_16x16x64_bf16 v[132:135], v[28:31], v[152:159], v17
    s_add_u32 s31, s31, s54
    s_add_u32 s31, s31, s57
    s_add_u32 m0, s57, 32768
    v_exp_f32 v164, v164
    v_smfmac_f32_32x32x32_bf16 v[112:127], v[184:187], v[152:159], v17
    buffer_load_dwordx4 v3, s[16:19], s31 offen offset:0 sc1 lds
    v_exp_f32 v165, v165
    v_exp_f32 v166, v166
    v_exp_f32 v167, v167
YS2:
    v_exp_f32 v136, v136
    v_exp_f32 v137, v137
    v_smfmac_f32_16x16x64_bf16 v[132:135], v[28:31], v[160:167], v17
    s_waitcnt lgkmcnt(0)
    v_exp_f32 v138, v138
    v_smfmac_f32_32x32x32_bf16 v[112:127], v[188:191], v[160:167], v17
    ds_read_b128 v[168:171], v8 offset:8192
    buffer_load_dwordx4 v3, s[16:19], s31 offen offset:1024 sc1 lds
    v_exp_f32 v139, v139
    v_exp_f32 v140, v140
    v_exp_f32 v141, v141
    v_mfma_f32_32x32x16_bf16 v[152:167], v[176:179], v[88:91], v[48:63]
    ds_read_b128 v[172:175], v8 offset:9216
    v_exp_f32 v142, v142
    v_exp_f32 v143, v143
    v_exp_f32 v144, v144
    v_mfma_f32_32x32x16_bf16 v[152:167], v[180:183], v[92:95], v[152:167]
    s_setprio 1
    v_exp_f32 v145, v145
    v_exp_f32 v146, v146
    v_exp_f32 v147, v147
    v_smfmac_f32_16x16x64_bf16 v[128:131], v[28:31], v[136:143], v17
    s_nop 0
    v_exp_f32 v148, v148
    v_smfmac_f32_32x32x32_bf16 v[96:111], v[192:195], v[136:143], v17
    buffer_load_dwordx4 v3, s[16:19], s31 offen offset:2048 sc1 lds
    v_exp_f32 v149, v149
    v_exp_f32 v150, v150
    v_exp_f32 v151, v151
YS3:
    v_exp_f32 v152, v152
    v_exp_f32 v153, v153
    v_smfmac_f32_16x16x64_bf16 v[128:131], v[28:31], v[144:151], v17
    s_waitcnt lgkmcnt(0)
    v_exp_f32 v154, v154
    v_smfmac_f32_32x32x32_bf16 v[96:111], v[196:199], v[144:151], v17
    ds_read_b128 v[184:187], v10 offset:10240
    buffer_load_dwordx4 v3, s[16:19], s31 offen offset:3072 sc1 lds
    v_exp_f32 v155, v155
    v_exp_f32 v156, v156
    v_exp_f32 v157, v157
    v_mfma_f32_32x32x16_bf16 v[136:151], v[168:171], v[80:83], v[64:79]
    ds_read_b128 v[188:191], v10 offset:11264
    v_exp_f32 v158, v158
    v_exp_f32 v159, v159
    v_exp_f32 v160, v160
    v_mfma_f32_32x32x16_bf16 v[136:151], v[172:175], v[84:87], v[136:151]
    s_nop 0
    v_exp_f32 v161, v161
    v_exp_f32 v162, v162
    v_exp_f32 v163, v163
    v_smfmac_f32_16x16x64_bf16 v[132:135], v[28:31], v[152:159], v17
    s_nop 0
    v_exp_f32 v164, v164
    v_smfmac_f32_32x32x32_bf16 v[112:127], v[192:195], v[152:159], v17
    s_nop 0
    v_exp_f32 v165, v165
    v_exp_f32 v166, v166
    v_exp_f32 v167, v167
YS4:
    v_exp_f32 v136, v136
    v_exp_f32 v137, v137
    v_smfmac_f32_16x16x64_bf16 v[132:135], v[28:31], v[160:167], v17
    s_waitcnt lgkmcnt(0)
    v_exp_f32 v138, v138
    v_smfmac_f32_32x32x32_bf16 v[112:127], v[196:199], v[160:167], v17
    ds_read_b128 v[176:179], v8 offset:12288
    v_exp_f32 v139, v139
    v_exp_f32 v140, v140
    v_exp_f32 v141, v141
    v_mfma_f32_32x32x16_bf16 v[152:167], v[168:171], v[88:91], v[48:63]
    ds_read_b128 v[180:183], v8 offset:13312
    v_exp_f32 v142, v142
    v_exp_f32 v143, v143
    v_exp_f32 v144, v144
    v_mfma_f32_32x32x16_bf16 v[152:167], v[172:175], v[92:95], v[152:167]
    s_setprio 0
    v_exp_f32 v145, v145
    v_exp_f32 v146, v146
    v_exp_f32 v147, v147
    v_smfmac_f32_16x16x64_bf16 v[128:131], v[28:31], v[136:143], v17
    s_nop 0
    v_exp_f32 v148, v148
    v_smfmac_f32_32x32x32_bf16 v[96:111], v[184:187], v[136:143], v17
    s_mov_b32 exec_lo, s89
    s_mov_b32 exec_hi, 0
    buffer_load_dwordx2 v[14:15], v5, s[16:19], s58 offen sc1
    s_mov_b64 exec, -1
    v_exp_f32 v149, v149
    v_exp_f32 v150, v150
    v_exp_f32 v151, v151
YS5:
    v_exp_f32 v152, v152
    v_exp_f32 v153, v153
    v_smfmac_f32_16x16x64_bf16 v[128:131], v[28:31], v[144:151], v17
    s_waitcnt lgkmcnt(0)
    v_exp_f32 v154, v154
    v_smfmac_f32_32x32x32_bf16 v[96:111], v[188:191], v[144:151], v17
    ds_read_b128 v[192:195], v10 offset:14336
    v_exp_f32 v155, v155
    v_exp_f32 v156, v156
    v_exp_f32 v157, v157
    v_mfma_f32_32x32x16_bf16 v[136:151], v[176:179], v[80:83], v[64:79]
    ds_read_b128 v[196:199], v10 offset:15360
    v_exp_f32 v158, v158
    v_exp_f32 v159, v159
    v_exp_f32 v160, v160
    v_mfma_f32_32x32x16_bf16 v[136:151], v[180:183], v[84:87], v[136:151]
    s_nop 0
    v_exp_f32 v161, v161
    v_exp_f32 v162, v162
    v_exp_f32 v163, v163
    v_smfmac_f32_16x16x64_bf16 v[132:135], v[28:31], v[152:159], v17
    s_nop 0
    v_exp_f32 v164, v164
    v_smfmac_f32_32x32x32_bf16 v[112:127], v[184:187], v[152:159], v17
    s_nop 0
    v_exp_f32 v165, v165
    v_exp_f32 v166, v166
    v_exp_f32 v167, v167
YS6:
    v_exp_f32 v136, v136
    v_exp_f32 v137, v137
    v_smfmac_f32_16x16x64_bf16 v[132:135], v[28:31], v[160:167], v17
    s_waitcnt vmcnt(1) lgkmcnt(0)
    s_barrier
    v_exp_f32 v138, v138
    v_smfmac_f32_32x32x32_bf16 v[112:127], v[188:191], v[160:167], v17
    ds_read_b128 v[168:171], v8 offset:32768
    v_exp_f32 v139, v139
    v_exp_f32 v140, v140
    v_exp_f32 v141, v141
    v_mfma_f32_32x32x16_bf16 v[152:167], v[176:179], v[88:91], v[48:63]
    ds_read_b128 v[172:175], v8 offset:33792
    s_waitcnt vmcnt(0)
    v_cmp_eq_u64 vcc, v[6:7], v[14:15]
    s_and_b32 s27, vcc_lo, s89
    s_cmp_eq_u32 s27, s89
    s_cbranch_scc0 FC118
FD119:
    v_exp_f32 v142, v142
    v_exp_f32 v143, v143
    v_exp_f32 v144, v144
    v_mfma_f32_32x32x16_bf16 v[152:167], v[180:183], v[92:95], v[152:167]
    s_and_b32 s31, s21, 4
    s_xor_b32 s31, s31, 2
    s_lshl_b32 s31, s31, 15
    s_setprio 3
    v_exp_f32 v145, v145
    v_exp_f32 v146, v146
    v_exp_f32 v147, v147
    v_smfmac_f32_16x16x64_bf16 v[128:131], v[28:31], v[136:143], v17
    s_add_u32 s31, s31, s54
    s_add_u32 s31, s31, s57
    s_add_u32 m0, s57, 0
    v_exp_f32 v148, v148
    v_smfmac_f32_32x32x32_bf16 v[96:111], v[192:195], v[136:143], v17
    buffer_load_dwordx4 v3, s[16:19], s31 offen offset:0 sc1 lds
    v_exp_f32 v149, v149
    v_exp_f32 v150, v150
    v_exp_f32 v151, v151
YS7:
    v_exp_f32 v152, v152
    v_exp_f32 v153, v153
    v_smfmac_f32_16x16x64_bf16 v[128:131], v[28:31], v[144:151], v17
    s_waitcnt lgkmcnt(0)
    v_exp_f32 v154, v154
    v_smfmac_f32_32x32x32_bf16 v[96:111], v[196:199], v[144:151], v17
    ds_read_b128 v[184:187], v10 offset:34816
    v_exp_f32 v155, v155
    v_exp_f32 v156, v156
    v_exp_f32 v157, v157
    v_mfma_f32_32x32x16_bf16 v[136:151], v[168:171], v[80:83], v[64:79]
    ds_read_b128 v[188:191], v10 offset:35840
    v_exp_f32 v158, v158
    v_exp_f32 v159, v159
    v_exp_f32 v160, v160
    v_mfma_f32_32x32x16_bf16 v[136:151], v[172:175], v[84:87], v[136:151]
    s_nop 0
    v_exp_f32 v161, v161
    v_exp_f32 v162, v162
    v_exp_f32 v163, v163
    v_smfmac_f32_16x16x64_bf16 v[132:135], v[28:31], v[152:159], v17
    s_nop 0
    v_exp_f32 v164, v164
    v_smfmac_f32_32x32x32_bf16 v[112:127], v[192:195], v[152:159], v17
    buffer_load_dwordx4 v3, s[16:19], s31 offen offset:1024 sc1 lds
    v_exp_f32 v165, v165
    v_exp_f32 v166, v166
    v_exp_f32 v167, v167
YS8:
    v_exp_f32 v136, v136
    v_exp_f32 v137, v137
    v_smfmac_f32_16x16x64_bf16 v[132:135], v[28:31], v[160:167], v17
    s_waitcnt lgkmcnt(0)
    v_exp_f32 v138, v138
    v_smfmac_f32_32x32x32_bf16 v[112:127], v[196:199], v[160:167], v17
    ds_read_b128 v[176:179], v8 offset:36864
    s_cmp_lt_u32 s20, 4
    s_cbranch_scc1 YB120
    buffer_store_dwordx4 v[216:219], v4, s[16:19], s34 offen offset:256 sc1
    buffer_store_dwordx4 v[220:223], v4, s[16:19], s34 offen offset:0 sc1
    buffer_store_dwordx4 v[224:227], v4, s[16:19], s35 offen offset:256 sc1
YB120:
    v_exp_f32 v139, v139
    v_exp_f32 v140, v140
    v_exp_f32 v141, v141
    v_mfma_f32_32x32x16_bf16 v[152:167], v[168:171], v[88:91], v[48:63]
    ds_read_b128 v[180:183], v8 offset:37888
    v_exp_f32 v142, v142
    v_exp_f32 v143, v143
    v_exp_f32 v144, v144
    v_mfma_f32_32x32x16_bf16 v[152:167], v[172:175], v[92:95], v[152:167]
    s_setprio 2
    v_exp_f32 v145, v145
    v_exp_f32 v146, v146
    v_exp_f32 v147, v147
    v_smfmac_f32_16x16x64_bf16 v[128:131], v[28:31], v[136:143], v17
    s_nop 0
    v_exp_f32 v148, v148
    v_smfmac_f32_32x32x32_bf16 v[96:111], v[184:187], v[136:143], v17
    buffer_load_dwordx4 v3, s[16:19], s31 offen offset:2048 sc1 lds
    v_exp_f32 v149, v149
    v_exp_f32 v150, v150
    v_exp_f32 v151, v151
YS9:
    v_exp_f32 v152, v152
    v_exp_f32 v153, v153
    v_smfmac_f32_16x16x64_bf16 v[128:131], v[28:31], v[144:151], v17
    s_waitcnt lgkmcnt(0)
    v_exp_f32 v154, v154
    v_smfmac_f32_32x32x32_bf16 v[96:111], v[188:191], v[144:151], v17
    ds_read_b128 v[192:195], v10 offset:38912
    v_exp_f32 v155, v155
    v_exp_f32 v156, v156
    v_exp_f32 v157, v157
    v_mfma_f32_32x32x16_bf16 v[136:151], v[176:179], v[80:83], v[64:79]
    ds_read_b128 v[196:199], v10 offset:39936
    v_exp_f32 v158, v158
    v_exp_f32 v159, v159
    v_exp_f32 v160, v160
    v_mfma_f32_32x32x16_bf16 v[136:151], v[180:183], v[84:87], v[136:151]
    s_nop 0
    v_exp_f32 v161, v161
    v_exp_f32 v162, v162
    v_exp_f32 v163, v163
    v_smfmac_f32_16x16x64_bf16 v[132:135], v[28:31], v[152:159], v17
    s_nop 0
    v_exp_f32 v164, v164
    v_smfmac_f32_32x32x32_bf16 v[112:127], v[184:187], v[152:159], v17
    buffer_load_dwordx4 v3, s[16:19], s31 offen offset:3072 sc1 lds
    v_exp_f32 v165, v165
    v_exp_f32 v166, v166
    v_exp_f32 v167, v167
YS10:
    v_exp_f32 v136, v136
    v_exp_f32 v137, v137
    v_smfmac_f32_16x16x64_bf16 v[132:135], v[28:31], v[160:167], v17
    s_waitcnt lgkmcnt(0)
    v_exp_f32 v138, v138
    v_smfmac_f32_32x32x32_bf16 v[112:127], v[188:191], v[160:167], v17
    ds_read_b128 v[168:171], v8 offset:40960
    v_exp_f32 v139, v139
    v_exp_f32 v140, v140
    v_exp_f32 v141, v141
    v_mfma_f32_32x32x16_bf16 v[152:167], v[176:179], v[88:91], v[48:63]
    ds_read_b128 v[172:175], v8 offset:41984
    v_exp_f32 v142, v142
    v_exp_f32 v143, v143
    v_exp_f32 v144, v144
    v_mfma_f32_32x32x16_bf16 v[152:167], v[180:183], v[92:95], v[152:167]
    s_setprio 1
    v_exp_f32 v145, v145
    v_exp_f32 v146, v146
    v_exp_f32 v147, v147
    v_smfmac_f32_16x16x64_bf16 v[128:131], v[28:31], v[136:143], v17
    s_nop 0
    v_exp_f32 v148, v148
    v_smfmac_f32_32x32x32_bf16 v[96:111], v[192:195], v[136:143], v17
    s_nop 0
    v_exp_f32 v149, v149
    v_exp_f32 v150, v150
    v_exp_f32 v151, v151
YS11:
    v_exp_f32 v152, v152
    v_exp_f32 v153, v153
    v_smfmac_f32_16x16x64_bf16 v[128:131], v[28:31], v[144:151], v17
    s_waitcnt lgkmcnt(0)
    v_exp_f32 v154, v154
    v_smfmac_f32_32x32x32_bf16 v[96:111], v[196:199], v[144:151], v17
    ds_read_b128 v[184:187], v10 offset:43008
    s_cmp_lt_u32 s20, 4
    s_cbranch_scc1 YB121
    buffer_store_dwordx4 v[228:231], v4, s[16:19], s35 offen offset:0 sc1
    buffer_store_dwordx4 v[232:235], v4, s[16:19], s35 offen offset:2048 sc1
    buffer_store_dwordx4 v[236:239], v4, s[16:19], s35 offen offset:2304 sc1
YB121:
    v_exp_f32 v155, v155
    v_exp_f32 v156, v156
    v_exp_f32 v157, v157
    v_mfma_f32_32x32x16_bf16 v[136:151], v[168:171], v[80:83], v[64:79]
    ds_read_b128 v[188:191], v10 offset:44032
    v_exp_f32 v158, v158
    v_exp_f32 v159, v159
    v_exp_f32 v160, v160
    v_mfma_f32_32x32x16_bf16 v[136:151], v[172:175], v[84:87], v[136:151]
    s_nop 0
    v_exp_f32 v161, v161
    v_exp_f32 v162, v162
    v_exp_f32 v163, v163
    v_smfmac_f32_16x16x64_bf16 v[132:135], v[28:31], v[152:159], v17
    s_nop 0
    v_exp_f32 v164, v164
    v_smfmac_f32_32x32x32_bf16 v[112:127], v[192:195], v[152:159], v17
    s_mov_b32 exec_lo, s3
    s_mov_b32 exec_hi, 0
    buffer_load_dwordx2 v[14:15], v5, s[16:19], s58 offen sc1
    s_mov_b64 exec, -1
    v_exp_f32 v165, v165
    v_exp_f32 v166, v166
    v_exp_f32 v167, v167
YS12:
    v_exp_f32 v136, v136
    v_exp_f32 v137, v137
    v_smfmac_f32_16x16x64_bf16 v[132:135], v[28:31], v[160:167], v17
    s_waitcnt lgkmcnt(0)
    v_exp_f32 v138, v138
    v_smfmac_f32_32x32x32_bf16 v[112:127], v[196:199], v[160:167], v17
    ds_read_b128 v[176:179], v8 offset:45056
    v_exp_f32 v139, v139
    v_exp_f32 v140, v140
    v_exp_f32 v141, v141
    v_mfma_f32_32x32x16_bf16 v[152:167], v[168:171], v[88:91], v[48:63]
    ds_read_b128 v[180:183], v8 offset:46080
    v_exp_f32 v142, v142
    v_exp_f32 v143, v143
    v_exp_f32 v144, v144
    v_mfma_f32_32x32x16_bf16 v[152:167], v[172:175], v[92:95], v[152:167]
    s_setprio 0
    v_exp_f32 v145, v145
    v_exp_f32 v146, v146
    v_exp_f32 v147, v147
    v_smfmac_f32_16x16x64_bf16 v[128:131], v[28:31], v[136:143], v17
    s_nop 0
    v_exp_f32 v148, v148
    v_smfmac_f32_32x32x32_bf16 v[96:111], v[184:187], v[136:143], v17
    s_nop 0
    v_exp_f32 v149, v149
    v_exp_f32 v150, v150
    v_exp_f32 v151, v151
YS13:
    v_exp_f32 v152, v152
    v_exp_f32 v153, v153
    v_smfmac_f32_16x16x64_bf16 v[128:131], v[28:31], v[144:151], v17
    s_waitcnt lgkmcnt(0)
    v_exp_f32 v154, v154
    v_smfmac_f32_32x32x32_bf16 v[96:111], v[188:191], v[144:151], v17
    ds_read_b128 v[192:195], v10 offset:47104
    v_exp_f32 v155, v155
    v_exp_f32 v156, v156
    v_exp_f32 v157, v157
    v_mfma_f32_32x32x16_bf16 v[136:151], v[176:179], v[80:83], v[64:79]
    ds_read_b128 v[196:199], v10 offset:48128
    v_exp_f32 v158, v158
    v_exp_f32 v159, v159
    v_exp_f32 v160, v160
    v_mfma_f32_32x32x16_bf16 v[136:151], v[180:183], v[84:87], v[136:151]
    s_nop 0
    v_exp_f32 v161, v161
    v_exp_f32 v162, v162
    v_exp_f32 v163, v163
    v_smfmac_f32_16x16x64_bf16 v[132:135], v[28:31], v[152:159], v17
    s_nop 0
    v_exp_f32 v164, v164
    v_smfmac_f32_32x32x32_bf16 v[112:127], v[184:187], v[152:159], v17
    s_nop 0
    v_exp_f32 v165, v165
    v_exp_f32 v166, v166
    v_exp_f32 v167, v167
YS14:
    v_exp_f32 v136, v136
    v_exp_f32 v137, v137
    v_smfmac_f32_16x16x64_bf16 v[132:135], v[28:31], v[160:167], v17
    s_waitcnt vmcnt(1) lgkmcnt(0)
    s_barrier
    v_exp_f32 v138, v138
    v_smfmac_f32_32x32x32_bf16 v[112:127], v[188:191], v[160:167], v17
    ds_read_b128 v[168:171], v8 offset:0
    v_exp_f32 v139, v139
    v_exp_f32 v140, v140
    v_exp_f32 v141, v141
    v_mfma_f32_32x32x16_bf16 v[152:167], v[176:179], v[88:91], v[48:63]
    ds_read_b128 v[172:175], v8 offset:1024
    s_waitcnt vmcnt(0)
    v_cmp_eq_u64 vcc, v[6:7], v[14:15]
    s_and_b32 s27, vcc_lo, s3
    s_cmp_eq_u32 s27, s3
    s_cbranch_scc0 FC122
FD123:
    v_exp_f32 v142, v142
    v_exp_f32 v143, v143
    v_exp_f32 v144, v144
    v_mfma_f32_32x32x16_bf16 v[152:167], v[180:183], v[92:95], v[152:167]
    s_and_b32 s31, s21, 4
    s_xor_b32 s31, s31, 3
    s_lshl_b32 s31, s31, 15
    s_setprio 3
    v_exp_f32 v145, v145
    v_exp_f32 v146, v146
    v_exp_f32 v147, v147
    v_smfmac_f32_16x16x64_bf16 v[128:131], v[28:31], v[136:143], v17
    s_add_u32 s31, s31, s54
    s_add_u32 s31, s31, s57
    s_add_u32 m0, s57, 32768
    v_exp_f32 v148, v148
    v_smfmac_f32_32x32x32_bf16 v[96:111], v[192:195], v[136:143], v17
    buffer_load_dwordx4 v3, s[16:19], s31 offen offset:0 sc1 lds
    v_exp_f32 v149, v149
    v_exp_f32 v150, v150
    v_exp_f32 v151, v151
YS15:
    v_exp_f32 v152, v152
    v_exp_f32 v153, v153
    v_smfmac_f32_16x16x64_bf16 v[128:131], v[28:31], v[144:151], v17
    s_waitcnt lgkmcnt(0)
    v_exp_f32 v154, v154
    v_smfmac_f32_32x32x32_bf16 v[96:111], v[196:199], v[144:151], v17
    ds_read_b128 v[184:187], v10 offset:2048
    v_exp_f32 v155, v155
    v_exp_f32 v156, v156
    v_exp_f32 v157, v157
    v_mfma_f32_32x32x16_bf16 v[136:151], v[168:171], v[80:83], v[64:79]
    ds_read_b128 v[188:191], v10 offset:3072
    v_exp_f32 v158, v158
    v_exp_f32 v159, v159
    v_exp_f32 v160, v160
    v_mfma_f32_32x32x16_bf16 v[136:151], v[172:175], v[84:87], v[136:151]
    s_nop 0
    v_exp_f32 v161, v161
    v_exp_f32 v162, v162
    v_exp_f32 v163, v163
    v_smfmac_f32_16x16x64_bf16 v[132:135], v[28:31], v[152:159], v17
    s_nop 0
    v_exp_f32 v164, v164
    v_smfmac_f32_32x32x32_bf16 v[112:127], v[192:195], v[152:159], v17
    buffer_load_dwordx4 v3, s[16:19], s31 offen offset:1024 sc1 lds
    v_exp_f32 v165, v165
    v_exp_f32 v166, v166
    v_exp_f32 v167, v167
YS16:
    v_exp_f32 v136, v136
    v_exp_f32 v137, v137
    v_smfmac_f32_16x16x64_bf16 v[132:135], v[28:31], v[160:167], v17
    s_waitcnt lgkmcnt(0)
    v_exp_f32 v138, v138
    v_smfmac_f32_32x32x32_bf16 v[112:127], v[196:199], v[160:167], v17
    ds_read_b128 v[176:179], v8 offset:4096
    s_cmp_lt_u32 s20, 4
    s_cbranch_scc1 YB124
    buffer_store_dwordx4 v[240:243], v4, s[16:19], s44 offen offset:2048 sc1
    buffer_store_dwordx4 v[244:247], v4, s[16:19], s44 offen offset:2304 sc1
    buffer_store_dwordx4 v[248:251], v4, s[16:19], s44 offen offset:256 sc1
YB124:
    v_exp_f32 v139, v139
    v_exp_f32 v140, v140
    v_exp_f32 v141, v141
    v_mfma_f32_32x32x16_bf16 v[152:167], v[168:171], v[88:91], v[48:63]
    ds_read_b128 v[180:183], v8 offset:5120
    v_exp_f32 v142, v142
    v_exp_f32 v143, v143
    v_exp_f32 v144, v144
    v_mfma_f32_32x32x16_bf16 v[152:167], v[172:175], v[92:95], v[152:167]
    s_setprio 2
    v_exp_f32 v145, v145
    v_exp_f32 v146, v146
    v_exp_f32 v147, v147
    v_smfmac_f32_16x16x64_bf16 v[128:131], v[28:31], v[136:143], v17
    s_nop 0
    v_exp_f32 v148, v148
    v_smfmac_f32_32x32x32_bf16 v[96:111], v[184:187], v[136:143], v17
    buffer_load_dwordx4 v3, s[16:19], s31 offen offset:2048 sc1 lds
    v_exp_f32 v149, v149
    v_exp_f32 v150, v150
    v_exp_f32 v151, v151
YS17:
    v_exp_f32 v152, v152
    v_exp_f32 v153, v153
    v_smfmac_f32_16x16x64_bf16 v[128:131], v[28:31], v[144:151], v17
    s_waitcnt lgkmcnt(0)
    v_exp_f32 v154, v154
    v_smfmac_f32_32x32x32_bf16 v[96:111], v[188:191], v[144:151], v17
    ds_read_b128 v[192:195], v10 offset:6144
    v_exp_f32 v155, v155
    v_exp_f32 v156, v156
    v_exp_f32 v157, v157
    v_mfma_f32_32x32x16_bf16 v[136:151], v[176:179], v[80:83], v[64:79]
    ds_read_b128 v[196:199], v10 offset:7168
    v_exp_f32 v158, v158
    v_exp_f32 v159, v159
    v_exp_f32 v160, v160
    v_mfma_f32_32x32x16_bf16 v[136:151], v[180:183], v[84:87], v[136:151]
    s_nop 0
    v_exp_f32 v161, v161
    v_exp_f32 v162, v162
    v_exp_f32 v163, v163
    v_smfmac_f32_16x16x64_bf16 v[132:135], v[28:31], v[152:159], v17
    s_nop 0
    v_exp_f32 v164, v164
    v_smfmac_f32_32x32x32_bf16 v[112:127], v[184:187], v[152:159], v17
    buffer_load_dwordx4 v3, s[16:19], s31 offen offset:3072 sc1 lds
    v_exp_f32 v165, v165
    v_exp_f32 v166, v166
    v_exp_f32 v167, v167
YS18:
    v_exp_f32 v136, v136
    v_exp_f32 v137, v137
    v_smfmac_f32_16x16x64_bf16 v[132:135], v[28:31], v[160:167], v17
    s_waitcnt lgkmcnt(0)
    v_exp_f32 v138, v138
    v_smfmac_f32_32x32x32_bf16 v[112:127], v[188:191], v[160:167], v17
    ds_read_b128 v[168:171], v8 offset:8192
    v_exp_f32 v139, v139
    v_exp_f32 v140, v140
    v_exp_f32 v141, v141
    v_mfma_f32_32x32x16_bf16 v[152:167], v[176:179], v[88:91], v[48:63]
    ds_read_b128 v[172:175], v8 offset:9216
    v_exp_f32 v142, v142
    v_exp_f32 v143, v143
    v_exp_f32 v144, v144
    v_mfma_f32_32x32x16_bf16 v[152:167], v[180:183], v[92:95], v[152:167]
    s_setprio 1
    v_exp_f32 v145, v145
    v_exp_f32 v146, v146
    v_exp_f32 v147, v147
    v_smfmac_f32_16x16x64_bf16 v[128:131], v[28:31], v[136:143], v17
    s_nop 0
    v_exp_f32 v148, v148
    v_smfmac_f32_32x32x32_bf16 v[96:111], v[192:195], v[136:143], v17
    s_nop 0
    v_exp_f32 v149, v149
    v_exp_f32 v150, v150
    v_exp_f32 v151, v151
YS19:
    v_exp_f32 v152, v152
    v_exp_f32 v153, v153
    v_smfmac_f32_16x16x64_bf16 v[128:131], v[28:31], v[144:151], v17
    s_waitcnt lgkmcnt(0)
    v_exp_f32 v154, v154
    v_smfmac_f32_32x32x32_bf16 v[96:111], v[196:199], v[144:151], v17
    ds_read_b128 v[184:187], v10 offset:10240
    s_cmp_lt_u32 s20, 4
    s_cbranch_scc1 YB125
    buffer_store_dwordx4 v[252:255], v4, s[16:19], s44 offen offset:0 sc1
    buffer_store_dwordx4 v[208:211], v4, s[16:19], s34 offen offset:2304 sc1
    buffer_store_dwordx4 v[212:215], v4, s[16:19], s34 offen offset:2048 sc1
YB125:
    v_exp_f32 v155, v155
    v_exp_f32 v156, v156
    v_exp_f32 v157, v157
    v_mfma_f32_32x32x16_bf16 v[136:151], v[168:171], v[80:83], v[64:79]
    ds_read_b128 v[188:191], v10 offset:11264
    v_exp_f32 v158, v158
    v_exp_f32 v159, v159
    v_exp_f32 v160, v160
    v_mfma_f32_32x32x16_bf16 v[136:151], v[172:175], v[84:87], v[136:151]
    s_nop 0
    v_exp_f32 v161, v161
    v_exp_f32 v162, v162
    v_exp_f32 v163, v163
    v_smfmac_f32_16x16x64_bf16 v[132:135], v[28:31], v[152:159], v17
    s_nop 0
    v_exp_f32 v164, v164
    v_smfmac_f32_32x32x32_bf16 v[112:127], v[192:195], v[152:159], v17
    s_nop 0
    v_exp_f32 v165, v165
    v_exp_f32 v166, v166
    v_exp_f32 v167, v167
YS20:
    v_exp_f32 v136, v136
    v_exp_f32 v137, v137
    v_smfmac_f32_16x16x64_bf16 v[132:135], v[28:31], v[160:167], v17
    s_waitcnt lgkmcnt(0)
    v_exp_f32 v138, v138
    v_smfmac_f32_32x32x32_bf16 v[112:127], v[196:199], v[160:167], v17
    ds_read_b128 v[176:179], v8 offset:12288
    v_exp_f32 v139, v139
    v_exp_f32 v140, v140
    v_exp_f32 v141, v141
    v_mfma_f32_32x32x16_bf16 v[152:167], v[168:171], v[88:91], v[48:63]
    ds_read_b128 v[180:183], v8 offset:13312
    v_exp_f32 v142, v142
    v_exp_f32 v143, v143
    v_exp_f32 v144, v144
    v_mfma_f32_32x32x16_bf16 v[152:167], v[172:175], v[92:95], v[152:167]
    s_setprio 0
    v_exp_f32 v145, v145
    v_exp_f32 v146, v146
    v_exp_f32 v147, v147
    v_smfmac_f32_16x16x64_bf16 v[128:131], v[28:31], v[136:143], v17
    s_nop 0
    v_exp_f32 v148, v148
    v_smfmac_f32_32x32x32_bf16 v[96:111], v[184:187], v[136:143], v17
    s_mov_b32 exec_lo, s61
    s_mov_b32 exec_hi, 0
    buffer_load_dwordx2 v[14:15], v5, s[16:19], s58 offen sc1
    s_mov_b64 exec, -1
    v_exp_f32 v149, v149
    v_exp_f32 v150, v150
    v_exp_f32 v151, v151
YS21:
    v_exp_f32 v152, v152
    v_exp_f32 v153, v153
    v_smfmac_f32_16x16x64_bf16 v[128:131], v[28:31], v[144:151], v17
    s_waitcnt lgkmcnt(0)
    v_exp_f32 v154, v154
    v_smfmac_f32_32x32x32_bf16 v[96:111], v[188:191], v[144:151], v17
    ds_read_b128 v[192:195], v10 offset:14336
    v_exp_f32 v155, v155
    v_exp_f32 v156, v156
    v_exp_f32 v157, v157
    v_mfma_f32_32x32x16_bf16 v[136:151], v[176:179], v[80:83], v[64:79]
    ds_read_b128 v[196:199], v10 offset:15360
    v_exp_f32 v158, v158
    v_exp_f32 v159, v159
    v_exp_f32 v160, v160
    v_mfma_f32_32x32x16_bf16 v[136:151], v[180:183], v[84:87], v[136:151]
    s_nop 0
    v_exp_f32 v161, v161
    v_exp_f32 v162, v162
    v_exp_f32 v163, v163
    v_smfmac_f32_16x16x64_bf16 v[132:135], v[28:31], v[152:159], v17
    s_nop 0
    v_exp_f32 v164, v164
    v_smfmac_f32_32x32x32_bf16 v[112:127], v[184:187], v[152:159], v17
    s_nop 0
    v_exp_f32 v165, v165
    v_exp_f32 v166, v166
    v_exp_f32 v167, v167
YS22:
    v_exp_f32 v136, v136
    v_exp_f32 v137, v137
    v_smfmac_f32_16x16x64_bf16 v[132:135], v[28:31], v[160:167], v17
    s_waitcnt vmcnt(1) lgkmcnt(0)
    s_barrier
    v_exp_f32 v138, v138
    v_smfmac_f32_32x32x32_bf16 v[112:127], v[188:191], v[160:167], v17
    ds_read_b128 v[168:171], v8 offset:32768
    v_exp_f32 v139, v139
    v_exp_f32 v140, v140
    v_exp_f32 v141, v141
    v_mfma_f32_32x32x16_bf16 v[152:167], v[176:179], v[88:91], v[48:63]
    ds_read_b128 v[172:175], v8 offset:33792
    s_waitcnt vmcnt(0)
    v_cmp_eq_u64 vcc, v[6:7], v[14:15]
    s_and_b32 s27, vcc_lo, s61
    s_cmp_eq_u32 s27, s61
    s_cbranch_scc0 FC126
FD127:
    v_exp_f32 v142, v142
    v_exp_f32 v143, v143
    v_exp_f32 v144, v144
    v_mfma_f32_32x32x16_bf16 v[152:167], v[180:183], v[92:95], v[152:167]
    s_and_b32 s31, s21, 4
    s_xor_b32 s31, s31, 4
    s_lshl_b32 s31, s31, 15
    s_setprio 3
    v_exp_f32 v145, v145
    v_exp_f32 v146, v146
    v_exp_f32 v147, v147
    v_smfmac_f32_16x16x64_bf16 v[128:131], v[28:31], v[136:143], v17
    s_add_u32 s31, s31, s54
    s_add_u32 s31, s31, s57
    s_add_u32 m0, s57, 0
    v_exp_f32 v148, v148
    v_smfmac_f32_32x32x32_bf16 v[96:111], v[192:195], v[136:143], v17
    buffer_load_dwordx4 v3, s[16:19], s31 offen offset:0 sc1 lds
    v_exp_f32 v149, v149
    v_exp_f32 v150, v150
    v_exp_f32 v151, v151
YS23:
    v_exp_f32 v152, v152
    v_exp_f32 v153, v153
    v_smfmac_f32_16x16x64_bf16 v[128:131], v[28:31], v[144:151], v17
    s_waitcnt lgkmcnt(0)
    v_exp_f32 v154, v154
    v_smfmac_f32_32x32x32_bf16 v[96:111], v[196:199], v[144:151], v17
    ds_read_b128 v[184:187], v10 offset:34816
    v_exp_f32 v155, v155
    v_exp_f32 v156, v156
    v_exp_f32 v157, v157
    v_mfma_f32_32x32x16_bf16 v[136:151], v[168:171], v[80:83], v[64:79]
    ds_read_b128 v[188:191], v10 offset:35840
    s_waitcnt vmcnt(1)
    s_cmp_eq_u32 s29, 1
    s_cselect_b64 exec, 0xff, 0
    buffer_store_dwordx4 v[6:9], v3, s[16:19], s45 offen sc1
    s_mov_b64 exec, -1
    v_exp_f32 v158, v158
    v_exp_f32 v159, v159
    v_exp_f32 v160, v160
    v_mfma_f32_32x32x16_bf16 v[136:151], v[172:175], v[84:87], v[136:151]
    s_nop 0
    v_exp_f32 v161, v161
    v_exp_f32 v162, v162
    v_exp_f32 v163, v163
    v_smfmac_f32_16x16x64_bf16 v[132:135], v[28:31], v[152:159], v17
    s_nop 0
    v_exp_f32 v164, v164
    v_smfmac_f32_32x32x32_bf16 v[112:127], v[192:195], v[152:159], v17
    buffer_load_dwordx4 v3, s[16:19], s31 offen offset:1024 sc1 lds
    v_exp_f32 v165, v165
    v_exp_f32 v166, v166
    v_exp_f32 v167, v167
YS24:
    v_exp_f32 v136, v136
    v_exp_f32 v137, v137
    v_smfmac_f32_16x16x64_bf16 v[132:135], v[28:31], v[160:167], v17
    s_waitcnt lgkmcnt(0)
    v_exp_f32 v138, v138
    v_smfmac_f32_32x32x32_bf16 v[112:127], v[196:199], v[160:167], v17
    ds_read_b128 v[176:179], v8 offset:36864
    v_exp_f32 v139, v139
    v_exp_f32 v140, v140
    v_exp_f32 v141, v141
    v_mfma_f32_32x32x16_bf16 v[152:167], v[168:171], v[88:91], v[48:63]
    ds_read_b128 v[180:183], v8 offset:37888
    v_exp_f32 v142, v142
    v_exp_f32 v143, v143
    v_exp_f32 v144, v144
    v_mfma_f32_32x32x16_bf16 v[152:167], v[172:175], v[92:95], v[152:167]
    s_setprio 2
    v_exp_f32 v145, v145
    v_exp_f32 v146, v146
    v_exp_f32 v147, v147
    v_smfmac_f32_16x16x64_bf16 v[128:131], v[28:31], v[136:143], v17
    s_nop 0
    v_exp_f32 v148, v148
    v_smfmac_f32_32x32x32_bf16 v[96:111], v[184:187], v[136:143], v17
    buffer_load_dwordx4 v3, s[16:19], s31 offen offset:2048 sc1 lds
    v_exp_f32 v149, v149
    v_exp_f32 v150, v150
    v_exp_f32 v151, v151
YS25:
    v_exp_f32 v152, v152
    v_exp_f32 v153, v153
    v_smfmac_f32_16x16x64_bf16 v[128:131], v[28:31], v[144:151], v17
    s_waitcnt lgkmcnt(0)
    v_exp_f32 v154, v154
    v_smfmac_f32_32x32x32_bf16 v[96:111], v[188:191], v[144:151], v17
    ds_read_b128 v[192:195], v10 offset:38912
    v_exp_f32 v155, v155
    v_exp_f32 v156, v156
    v_exp_f32 v157, v157
    v_mfma_f32_32x32x16_bf16 v[136:151], v[176:179], v[80:83], v[64:79]
    ds_read_b128 v[196:199], v10 offset:39936
    v_exp_f32 v158, v158
    v_exp_f32 v159, v159
    v_exp_f32 v160, v160
    v_mfma_f32_32x32x16_bf16 v[136:151], v[180:183], v[84:87], v[136:151]
    s_nop 0
    v_exp_f32 v161, v161
    v_exp_f32 v162, v162
    v_exp_f32 v163, v163
    v_smfmac_f32_16x16x64_bf16 v[132:135], v[28:31], v[152:159], v17
    s_nop 0
    v_exp_f32 v164, v164
    v_smfmac_f32_32x32x32_bf16 v[112:127], v[184:187], v[152:159], v17
    buffer_load_dwordx4 v3, s[16:19], s31 offen offset:3072 sc1 lds
    v_exp_f32 v165, v165
    v_exp_f32 v166, v166
    v_exp_f32 v167, v167
YS26:
    v_exp_f32 v136, v136
    v_exp_f32 v137, v137
    v_smfmac_f32_16x16x64_bf16 v[132:135], v[28:31], v[160:167], v17
    s_waitcnt lgkmcnt(0)
    v_exp_f32 v138, v138
    v_smfmac_f32_32x32x32_bf16 v[112:127], v[188:191], v[160:167], v17
    ds_read_b128 v[168:171], v8 offset:40960
    v_exp_f32 v139, v139
    v_exp_f32 v140, v140
    v_exp_f32 v141, v141
    v_mfma_f32_32x32x16_bf16 v[152:167], v[176:179], v[88:91], v[48:63]
    ds_read_b128 v[172:175], v8 offset:41984
    v_exp_f32 v142, v142
    v_exp_f32 v143, v143
    v_exp_f32 v144, v144
    v_mfma_f32_32x32x16_bf16 v[152:167], v[180:183], v[92:95], v[152:167]
    s_mov_b32 s51, 0
    s_setprio 1
    v_exp_f32 v145, v145
    v_exp_f32 v146, v146
    v_exp_f32 v147, v147
    v_smfmac_f32_16x16x64_bf16 v[128:131], v[28:31], v[136:143], v17
    s_nop 0
    v_exp_f32 v148, v148
    v_smfmac_f32_32x32x32_bf16 v[96:111], v[192:195], v[136:143], v17
    buffer_load_dword v27, v21, s[36:39], s51 offen
    v_exp_f32 v149, v149
    v_exp_f32 v150, v150
    v_exp_f32 v151, v151
YS27:
    v_exp_f32 v152, v152
    v_exp_f32 v153, v153
    v_smfmac_f32_16x16x64_bf16 v[128:131], v[28:31], v[144:151], v17
    s_waitcnt lgkmcnt(0)
    v_exp_f32 v154, v154
    v_smfmac_f32_32x32x32_bf16 v[96:111], v[196:199], v[144:151], v17
    ds_read_b128 v[184:187], v10 offset:43008
    v_exp_f32 v155, v155
    v_exp_f32 v156, v156
    v_exp_f32 v157, v157
    v_mfma_f32_32x32x16_bf16 v[136:151], v[168:171], v[80:83], v[64:79]
    ds_read_b128 v[188:191], v10 offset:44032
    v_exp_f32 v158, v158
    v_exp_f32 v159, v159
    v_exp_f32 v160, v160
    v_mfma_f32_32x32x16_bf16 v[136:151], v[172:175], v[84:87], v[136:151]
    s_nop 0
    v_exp_f32 v161, v161
    v_exp_f32 v162, v162
    v_exp_f32 v163, v163
    v_smfmac_f32_16x16x64_bf16 v[132:135], v[28:31], v[152:159], v17
    s_nop 0
    v_exp_f32 v164, v164
    v_smfmac_f32_32x32x32_bf16 v[112:127], v[192:195], v[152:159], v17
    s_nop 0
    v_exp_f32 v165, v165
    v_exp_f32 v166, v166
    v_exp_f32 v167, v167
YS28:
    v_exp_f32 v136, v136
    v_exp_f32 v137, v137
    v_smfmac_f32_16x16x64_bf16 v[132:135], v[28:31], v[160:167], v17
    s_waitcnt lgkmcnt(0)
    v_exp_f32 v138, v138
    v_smfmac_f32_32x32x32_bf16 v[112:127], v[196:199], v[160:167], v17
    ds_read_b128 v[176:179], v8 offset:45056
    v_exp_f32 v139, v139
    v_exp_f32 v140, v140
    v_exp_f32 v141, v141
    v_mfma_f32_32x32x16_bf16 v[152:167], v[168:171], v[88:91], v[48:63]
    ds_read_b128 v[180:183], v8 offset:46080
    v_exp_f32 v142, v142
    v_exp_f32 v143, v143
    v_exp_f32 v144, v144
    v_mfma_f32_32x32x16_bf16 v[152:167], v[172:175], v[92:95], v[152:167]
    s_setprio 0
    v_exp_f32 v145, v145
    v_exp_f32 v146, v146
    v_exp_f32 v147, v147
    v_smfmac_f32_16x16x64_bf16 v[128:131], v[28:31], v[136:143], v17
    s_nop 0
    v_exp_f32 v148, v148
    v_smfmac_f32_32x32x32_bf16 v[96:111], v[184:187], v[136:143], v17
    s_nop 0
    v_exp_f32 v149, v149
    v_exp_f32 v150, v150
    v_exp_f32 v151, v151
YS29:
    v_exp_f32 v152, v152
    v_exp_f32 v153, v153
    v_smfmac_f32_16x16x64_bf16 v[128:131], v[28:31], v[144:151], v17
    s_waitcnt lgkmcnt(0)
    v_exp_f32 v154, v154
    v_smfmac_f32_32x32x32_bf16 v[96:111], v[188:191], v[144:151], v17
    ds_read_b128 v[192:195], v10 offset:47104
    v_exp_f32 v155, v155
    v_exp_f32 v156, v156
    v_exp_f32 v157, v157
    v_mfma_f32_32x32x16_bf16 v[136:151], v[176:179], v[80:83], v[64:79]
    ds_read_b128 v[196:199], v10 offset:48128
    v_exp_f32 v158, v158
    v_exp_f32 v159, v159
    v_exp_f32 v160, v160
    v_mfma_f32_32x32x16_bf16 v[136:151], v[180:183], v[84:87], v[136:151]
    s_nop 0
    v_exp_f32 v161, v161
    v_exp_f32 v162, v162
    v_exp_f32 v163, v163
    v_smfmac_f32_16x16x64_bf16 v[132:135], v[28:31], v[152:159], v17
    s_nop 0
    v_exp_f32 v164, v164
    v_smfmac_f32_32x32x32_bf16 v[112:127], v[184:187], v[152:159], v17
    s_nop 0
    v_exp_f32 v165, v165
    v_exp_f32 v166, v166
    v_exp_f32 v167, v167
YS30:
    v_exp_f32 v136, v136
    v_exp_f32 v137, v137
    v_smfmac_f32_16x16x64_bf16 v[132:135], v[28:31], v[160:167], v17
    s_waitcnt vmcnt(1) lgkmcnt(0)
    s_barrier
    v_exp_f32 v138, v138
    v_smfmac_f32_32x32x32_bf16 v[112:127], v[188:191], v[160:167], v17
    ds_read_b128 v[168:171], v8 offset:0
    v_exp_f32 v139, v139
    v_exp_f32 v140, v140
    v_exp_f32 v141, v141
    v_mfma_f32_32x32x16_bf16 v[152:167], v[176:179], v[88:91], v[48:63]
    ds_read_b128 v[172:175], v8 offset:1024
    v_exp_f32 v142, v142
    v_exp_f32 v143, v143
    v_exp_f32 v144, v144
    v_mfma_f32_32x32x16_bf16 v[152:167], v[180:183], v[92:95], v[152:167]
    s_and_b32 s31, s21, 4
    s_xor_b32 s31, s31, 5
    s_lshl_b32 s31, s31, 15
    s_setprio 3
    v_exp_f32 v145, v145
    v_exp_f32 v146, v146
    v_exp_f32 v147, v147
    v_smfmac_f32_16x16x64_bf16 v[128:131], v[28:31], v[136:143], v17
    s_add_u32 s31, s31, s54
    s_add_u32 s31, s31, s57
    s_add_u32 m0, s57, 32768
    v_exp_f32 v148, v148
    v_smfmac_f32_32x32x32_bf16 v[96:111], v[192:195], v[136:143], v17
    buffer_load_dwordx4 v3, s[16:19], s31 offen offset:0 sc1 lds
    v_exp_f32 v149, v149
    v_exp_f32 v150, v150
    v_exp_f32 v151, v151
YS31:
    v_exp_f32 v152, v152
    v_exp_f32 v153, v153
    v_smfmac_f32_16x16x64_bf16 v[128:131], v[28:31], v[144:151], v17
    s_waitcnt lgkmcnt(0)
    v_exp_f32 v154, v154
    v_smfmac_f32_32x32x32_bf16 v[96:111], v[196:199], v[144:151], v17
    ds_read_b128 v[184:187], v10 offset:2048
    v_exp_f32 v155, v155
    v_exp_f32 v156, v156
    v_exp_f32 v157, v157
    v_mfma_f32_32x32x16_bf16 v[136:151], v[168:171], v[80:83], v[64:79]
    ds_read_b128 v[188:191], v10 offset:3072
    v_exp_f32 v158, v158
    v_exp_f32 v159, v159
    v_exp_f32 v160, v160
    v_mfma_f32_32x32x16_bf16 v[136:151], v[172:175], v[84:87], v[136:151]
    s_nop 0
    v_exp_f32 v161, v161
    v_exp_f32 v162, v162
    v_exp_f32 v163, v163
    v_smfmac_f32_16x16x64_bf16 v[132:135], v[28:31], v[152:159], v17
    s_nop 0
    v_exp_f32 v164, v164
    v_smfmac_f32_32x32x32_bf16 v[112:127], v[192:195], v[152:159], v17
    buffer_load_dwordx4 v3, s[16:19], s31 offen offset:1024 sc1 lds
    v_exp_f32 v165, v165
    v_exp_f32 v166, v166
    v_exp_f32 v167, v167
YS32:
    v_exp_f32 v136, v136
    v_exp_f32 v137, v137
    v_smfmac_f32_16x16x64_bf16 v[132:135], v[28:31], v[160:167], v17
    s_waitcnt lgkmcnt(0)
    v_exp_f32 v138, v138
    v_smfmac_f32_32x32x32_bf16 v[112:127], v[196:199], v[160:167], v17
    ds_read_b128 v[176:179], v8 offset:4096
    v_exp_f32 v139, v139
    v_exp_f32 v140, v140
    v_exp_f32 v141, v141
    v_mfma_f32_32x32x16_bf16 v[152:167], v[168:171], v[88:91], v[48:63]
    ds_read_b128 v[180:183], v8 offset:5120
    v_exp_f32 v142, v142
    v_exp_f32 v143, v143
    v_exp_f32 v144, v144
    v_mfma_f32_32x32x16_bf16 v[152:167], v[172:175], v[92:95], v[152:167]
    s_setprio 2
    v_exp_f32 v145, v145
    v_exp_f32 v146, v146
    v_exp_f32 v147, v147
    v_smfmac_f32_16x16x64_bf16 v[128:131], v[28:31], v[136:143], v17
    s_nop 0
    v_exp_f32 v148, v148
    v_smfmac_f32_32x32x32_bf16 v[96:111], v[184:187], v[136:143], v17
    buffer_load_dwordx4 v3, s[16:19], s31 offen offset:2048 sc1 lds
    v_exp_f32 v149, v149
    v_exp_f32 v150, v150
    v_exp_f32 v151, v151
YS33:
    v_exp_f32 v152, v152
    v_exp_f32 v153, v153
    v_smfmac_f32_16x16x64_bf16 v[128:131], v[28:31], v[144:151], v17
    s_waitcnt lgkmcnt(0)
    v_exp_f32 v154, v154
    v_smfmac_f32_32x32x32_bf16 v[96:111], v[188:191], v[144:151], v17
    ds_read_b128 v[192:195], v10 offset:6144
    v_exp_f32 v155, v155
    v_exp_f32 v156, v156
    v_exp_f32 v157, v157
    v_mfma_f32_32x32x16_bf16 v[136:151], v[176:179], v[80:83], v[64:79]
    ds_read_b128 v[196:199], v10 offset:7168
    v_exp_f32 v158, v158
    v_exp_f32 v159, v159
    v_exp_f32 v160, v160
    v_mfma_f32_32x32x16_bf16 v[136:151], v[180:183], v[84:87], v[136:151]
    s_nop 0
    v_exp_f32 v161, v161
    v_exp_f32 v162, v162
    v_exp_f32 v163, v163
    v_smfmac_f32_16x16x64_bf16 v[132:135], v[28:31], v[152:159], v17
    s_nop 0
    v_exp_f32 v164, v164
    v_smfmac_f32_32x32x32_bf16 v[112:127], v[184:187], v[152:159], v17
    buffer_load_dwordx4 v3, s[16:19], s31 offen offset:3072 sc1 lds
    v_exp_f32 v165, v165
    v_exp_f32 v166, v166
    v_exp_f32 v167, v167
YS34:
    v_exp_f32 v136, v136
    v_exp_f32 v137, v137
    v_smfmac_f32_16x16x64_bf16 v[132:135], v[28:31], v[160:167], v17
    s_waitcnt lgkmcnt(0)
    v_exp_f32 v138, v138
    v_smfmac_f32_32x32x32_bf16 v[112:127], v[188:191], v[160:167], v17
    ds_read_b128 v[168:171], v8 offset:8192
    v_exp_f32 v139, v139
    v_exp_f32 v140, v140
    v_exp_f32 v141, v141
    v_mfma_f32_32x32x16_bf16 v[152:167], v[176:179], v[88:91], v[48:63]
    ds_read_b128 v[172:175], v8 offset:9216
    v_exp_f32 v142, v142
    v_exp_f32 v143, v143
    v_exp_f32 v144, v144
    v_mfma_f32_32x32x16_bf16 v[152:167], v[180:183], v[92:95], v[152:167]
    s_setprio 1
    v_exp_f32 v145, v145
    v_exp_f32 v146, v146
    v_exp_f32 v147, v147
    v_smfmac_f32_16x16x64_bf16 v[128:131], v[28:31], v[136:143], v17
    s_nop 0
    v_exp_f32 v148, v148
    v_smfmac_f32_32x32x32_bf16 v[96:111], v[192:195], v[136:143], v17
    s_nop 0
    v_exp_f32 v149, v149
    v_exp_f32 v150, v150
    v_exp_f32 v151, v151
YS35:
    v_exp_f32 v152, v152
    v_exp_f32 v153, v153
    v_smfmac_f32_16x16x64_bf16 v[128:131], v[28:31], v[144:151], v17
    s_waitcnt lgkmcnt(0)
    v_exp_f32 v154, v154
    v_smfmac_f32_32x32x32_bf16 v[96:111], v[196:199], v[144:151], v17
    ds_read_b128 v[184:187], v10 offset:10240
    v_exp_f32 v155, v155
    v_exp_f32 v156, v156
    v_exp_f32 v157, v157
    v_mfma_f32_32x32x16_bf16 v[136:151], v[168:171], v[80:83], v[64:79]
    ds_read_b128 v[188:191], v10 offset:11264
    v_exp_f32 v158, v158
    v_exp_f32 v159, v159
    v_exp_f32 v160, v160
    v_mfma_f32_32x32x16_bf16 v[136:151], v[172:175], v[84:87], v[136:151]
    s_getpc_b64 s[4:5]
PC115:
    s_add_u32 s4, s4, OUTC-PC115
    s_addc_u32 s5, s5, 0
    s_andn2_b32 s51, s2, 7
    s_add_u32 s51, s51, s20
    v_exp_f32 v161, v161
    v_exp_f32 v162, v162
    v_exp_f32 v163, v163
    v_smfmac_f32_16x16x64_bf16 v[132:135], v[28:31], v[152:159], v17
    s_lshl_b32 s51, s51, 6
    s_min_u32 s51, s51, CODE_END-OUTC-64
    v_mov_b32 v22, s51
    v_exp_f32 v164, v164
    v_smfmac_f32_32x32x32_bf16 v[112:127], v[192:195], v[152:159], v17
    global_load_dword v27, v22, s[4:5]
    v_exp_f32 v165, v165
    v_exp_f32 v166, v166
    v_exp_f32 v167, v167
YS36:
    v_exp_f32 v136, v136
    v_exp_f32 v137, v137
    v_smfmac_f32_16x16x64_bf16 v[132:135], v[28:31], v[160:167], v17
    s_waitcnt lgkmcnt(0)
    v_exp_f32 v138, v138
    v_smfmac_f32_32x32x32_bf16 v[112:127], v[196:199], v[160:167], v17
    ds_read_b128 v[176:179], v8 offset:12288
    v_exp_f32 v139, v139
    v_exp_f32 v140, v140
    v_exp_f32 v141, v141
    v_mfma_f32_32x32x16_bf16 v[152:167], v[168:171], v[88:91], v[48:63]
    ds_read_b128 v[180:183], v8 offset:13312
    v_exp_f32 v142, v142
    v_exp_f32 v143, v143
    v_exp_f32 v144, v144
    v_mfma_f32_32x32x16_bf16 v[152:167], v[172:175], v[92:95], v[152:167]
    s_setprio 0
    v_exp_f32 v145, v145
    v_exp_f32 v146, v146
    v_exp_f32 v147, v147
    v_smfmac_f32_16x16x64_bf16 v[128:131], v[28:31], v[136:143], v17
    s_nop 0
    v_exp_f32 v148, v148
    v_smfmac_f32_32x32x32_bf16 v[96:111], v[184:187], v[136:143], v17
    s_mov_b32 exec_lo, s71
    s_mov_b32 exec_hi, 0
    buffer_load_dwordx2 v[14:15], v5, s[16:19], s70 offen sc1
    s_mov_b64 exec, -1
    v_exp_f32 v149, v149
    v_exp_f32 v150, v150
    v_exp_f32 v151, v151
YS37:
    v_exp_f32 v152, v152
    v_exp_f32 v153, v153
    v_smfmac_f32_16x16x64_bf16 v[128:131], v[28:31], v[144:151], v17
    s_waitcnt lgkmcnt(0)
    v_exp_f32 v154, v154
    v_smfmac_f32_32x32x32_bf16 v[96:111], v[188:191], v[144:151], v17
    ds_read_b128 v[192:195], v10 offset:14336
    v_exp_f32 v155, v155
    v_exp_f32 v156, v156
    v_exp_f32 v157, v157
    v_mfma_f32_32x32x16_bf16 v[136:151], v[176:179], v[80:83], v[64:79]
    ds_read_b128 v[196:199], v10 offset:15360
    v_exp_f32 v158, v158
    v_exp_f32 v159, v159
    v_exp_f32 v160, v160
    v_mfma_f32_32x32x16_bf16 v[136:151], v[180:183], v[84:87], v[136:151]
    s_nop 0
    v_exp_f32 v161, v161
    v_exp_f32 v162, v162
    v_exp_f32 v163, v163
    v_smfmac_f32_16x16x64_bf16 v[132:135], v[28:31], v[152:159], v17
    s_nop 0
    v_exp_f32 v164, v164
    v_smfmac_f32_32x32x32_bf16 v[112:127], v[184:187], v[152:159], v17
    s_nop 0
    v_exp_f32 v165, v165
    v_exp_f32 v166, v166
    v_exp_f32 v167, v167
YS38:
    v_exp_f32 v136, v136
    v_exp_f32 v137, v137
    v_smfmac_f32_16x16x64_bf16 v[132:135], v[28:31], v[160:167], v17
    s_waitcnt vmcnt(2) lgkmcnt(0)
    s_barrier
    v_exp_f32 v138, v138
    v_smfmac_f32_32x32x32_bf16 v[112:127], v[188:191], v[160:167], v17
    ds_read_b128 v[168:171], v8 offset:32768
    v_exp_f32 v139, v139
    v_exp_f32 v140, v140
    v_exp_f32 v141, v141
    v_mfma_f32_32x32x16_bf16 v[152:167], v[176:179], v[88:91], v[48:63]
    ds_read_b128 v[172:175], v8 offset:33792
    s_waitcnt vmcnt(0)
    v_cmp_eq_u64 vcc, v[6:7], v[14:15]
    s_and_b32 s27, vcc_lo, s71
    s_cmp_eq_u32 s27, s71
    s_cbranch_scc0 FC128
FD129:
    v_exp_f32 v142, v142
    v_exp_f32 v143, v143
    v_exp_f32 v144, v144
    v_mfma_f32_32x32x16_bf16 v[152:167], v[180:183], v[92:95], v[152:167]
    s_and_b32 s31, s21, 4
    s_xor_b32 s31, s31, 6
    s_lshl_b32 s31, s31, 15
    s_setprio 3
    v_exp_f32 v145, v145
    v_exp_f32 v146, v146
    v_exp_f32 v147, v147
    v_smfmac_f32_16x16x64_bf16 v[128:131], v[28:31], v[136:143], v17
    s_add_u32 s31, s31, s54
    s_add_u32 s31, s31, s57
    s_add_u32 m0, s57, 0
    v_exp_f32 v148, v148
    v_smfmac_f32_32x32x32_bf16 v[96:111], v[192:195], v[136:143], v17
    buffer_load_dwordx4 v3, s[16:19], s31 offen offset:0 sc1 lds
    v_exp_f32 v149, v149
    v_exp_f32 v150, v150
    v_exp_f32 v151, v151
YS39:
    v_exp_f32 v152, v152
    v_exp_f32 v153, v153
    v_smfmac_f32_16x16x64_bf16 v[128:131], v[28:31], v[144:151], v17
    s_waitcnt lgkmcnt(0)
    v_exp_f32 v154, v154
    v_smfmac_f32_32x32x32_bf16 v[96:111], v[196:199], v[144:151], v17
    ds_read_b128 v[184:187], v10 offset:34816
    v_exp_f32 v155, v155
    v_exp_f32 v156, v156
    v_exp_f32 v157, v157
    v_mfma_f32_32x32x16_bf16 v[136:151], v[168:171], v[80:83], v[64:79]
    ds_read_b128 v[188:191], v10 offset:35840
    v_exp_f32 v158, v158
    v_exp_f32 v159, v159
    v_exp_f32 v160, v160
    v_mfma_f32_32x32x16_bf16 v[136:151], v[172:175], v[84:87], v[136:151]
    s_nop 0
    v_exp_f32 v161, v161
    v_exp_f32 v162, v162
    v_exp_f32 v163, v163
    v_smfmac_f32_16x16x64_bf16 v[132:135], v[28:31], v[152:159], v17
    s_nop 0
    v_exp_f32 v164, v164
    v_smfmac_f32_32x32x32_bf16 v[112:127], v[192:195], v[152:159], v17
    buffer_load_dwordx4 v3, s[16:19], s31 offen offset:1024 sc1 lds
    v_exp_f32 v165, v165
    v_exp_f32 v166, v166
    v_exp_f32 v167, v167
YS40:
    v_exp_f32 v136, v136
    v_exp_f32 v137, v137
    v_smfmac_f32_16x16x64_bf16 v[132:135], v[28:31], v[160:167], v17
    s_waitcnt lgkmcnt(0)
    v_exp_f32 v138, v138
    v_smfmac_f32_32x32x32_bf16 v[112:127], v[196:199], v[160:167], v17
    ds_read_b128 v[176:179], v8 offset:36864
    v_exp_f32 v139, v139
    v_exp_f32 v140, v140
    v_exp_f32 v141, v141
    v_mfma_f32_32x32x16_bf16 v[152:167], v[168:171], v[88:91], v[48:63]
    ds_read_b128 v[180:183], v8 offset:37888
    v_exp_f32 v142, v142
    v_exp_f32 v143, v143
    v_exp_f32 v144, v144
    v_mfma_f32_32x32x16_bf16 v[152:167], v[172:175], v[92:95], v[152:167]
    s_setprio 2
    v_exp_f32 v145, v145
    v_exp_f32 v146, v146
    v_exp_f32 v147, v147
    v_smfmac_f32_16x16x64_bf16 v[128:131], v[28:31], v[136:143], v17
    s_nop 0
    v_exp_f32 v148, v148
    v_smfmac_f32_32x32x32_bf16 v[96:111], v[184:187], v[136:143], v17
    buffer_load_dwordx4 v3, s[16:19], s31 offen offset:2048 sc1 lds
    v_exp_f32 v149, v149
    v_exp_f32 v150, v150
    v_exp_f32 v151, v151
YS41:
    v_exp_f32 v152, v152
    v_exp_f32 v153, v153
    v_smfmac_f32_16x16x64_bf16 v[128:131], v[28:31], v[144:151], v17
    s_waitcnt lgkmcnt(0)
    v_exp_f32 v154, v154
    v_smfmac_f32_32x32x32_bf16 v[96:111], v[188:191], v[144:151], v17
    ds_read_b128 v[192:195], v10 offset:38912
    s_and_b32 s51, s21, 3
    s_lshl_b32 s51, s51, 1
    s_add_u32 s51, s51, s29
    s_lshl_b32 s51, s51, 12
    s_add_u32 s51, s51, s75
    s_add_u32 s51, s51, s69
    v_lshlrev_b32 v22, 2, v3
    buffer_load_dword v27, v22, s[16:19], s51 offen sc1
    v_exp_f32 v155, v155
    v_exp_f32 v156, v156
    v_exp_f32 v157, v157
    v_mfma_f32_32x32x16_bf16 v[136:151], v[176:179], v[80:83], v[64:79]
    ds_read_b128 v[196:199], v10 offset:39936
    v_exp_f32 v158, v158
    v_exp_f32 v159, v159
    v_exp_f32 v160, v160
    v_mfma_f32_32x32x16_bf16 v[136:151], v[180:183], v[84:87], v[136:151]
    s_nop 0
    v_exp_f32 v161, v161
    v_exp_f32 v162, v162
    v_exp_f32 v163, v163
    v_smfmac_f32_16x16x64_bf16 v[132:135], v[28:31], v[152:159], v17
    s_nop 0
    v_exp_f32 v164, v164
    v_smfmac_f32_32x32x32_bf16 v[112:127], v[184:187], v[152:159], v17
    buffer_load_dwordx4 v3, s[16:19], s31 offen offset:3072 sc1 lds
    v_exp_f32 v165, v165
    v_exp_f32 v166, v166
    v_exp_f32 v167, v167
YS42:
    v_exp_f32 v136, v136
    v_exp_f32 v137, v137
    v_smfmac_f32_16x16x64_bf16 v[132:135], v[28:31], v[160:167], v17
    s_waitcnt lgkmcnt(0)
    v_exp_f32 v138, v138
    v_smfmac_f32_32x32x32_bf16 v[112:127], v[188:191], v[160:167], v17
    ds_read_b128 v[168:171], v8 offset:40960
    v_exp_f32 v139, v139
    v_exp_f32 v140, v140
    v_exp_f32 v141, v141
    v_mfma_f32_32x32x16_bf16 v[152:167], v[176:179], v[88:91], v[48:63]
    ds_read_b128 v[172:175], v8 offset:41984
    v_exp_f32 v142, v142
    v_exp_f32 v143, v143
    v_exp_f32 v144, v144
    v_mfma_f32_32x32x16_bf16 v[152:167], v[180:183], v[92:95], v[152:167]
    s_add_u32 m0, s81, 81920
    s_xor_b32 s31, s73, 0
    s_setprio 1
    v_exp_f32 v145, v145
    v_exp_f32 v146, v146
    v_exp_f32 v147, v147
    v_smfmac_f32_16x16x64_bf16 v[128:131], v[28:31], v[136:143], v17
    s_add_u32 s31, s31, s82
    v_exp_f32 v148, v148
    v_smfmac_f32_32x32x32_bf16 v[96:111], v[192:195], v[136:143], v17
    buffer_load_dwordx4 v19, s[36:39], s31 offen offset:0 lds
    v_exp_f32 v149, v149
    v_exp_f32 v150, v150
    v_exp_f32 v151, v151
YS43:
    v_exp_f32 v152, v152
    v_exp_f32 v153, v153
    v_smfmac_f32_16x16x64_bf16 v[128:131], v[28:31], v[144:151], v17
    s_waitcnt lgkmcnt(0)
    v_exp_f32 v154, v154
    v_smfmac_f32_32x32x32_bf16 v[96:111], v[196:199], v[144:151], v17
    ds_read_b128 v[184:187], v10 offset:43008
    v_exp_f32 v155, v155
    v_exp_f32 v156, v156
    v_exp_f32 v157, v157
    v_mfma_f32_32x32x16_bf16 v[136:151], v[168:171], v[80:83], v[64:79]
    ds_read_b128 v[188:191], v10 offset:44032
    v_exp_f32 v158, v158
    v_exp_f32 v159, v159
    v_exp_f32 v160, v160
    v_mfma_f32_32x32x16_bf16 v[136:151], v[172:175], v[84:87], v[136:151]
    s_nop 0
    v_exp_f32 v161, v161
    v_exp_f32 v162, v162
    v_exp_f32 v163, v163
    v_smfmac_f32_16x16x64_bf16 v[132:135], v[28:31], v[152:159], v17
    s_nop 0
    v_exp_f32 v164, v164
    v_smfmac_f32_32x32x32_bf16 v[112:127], v[192:195], v[152:159], v17
    buffer_load_dwordx4 v20, s[36:39], s31 offen offset:1024 lds
    v_exp_f32 v165, v165
    v_exp_f32 v166, v166
    v_exp_f32 v167, v167
YS44:
    v_exp_f32 v136, v136
    v_exp_f32 v137, v137
    v_smfmac_f32_16x16x64_bf16 v[132:135], v[28:31], v[160:167], v17
    s_waitcnt lgkmcnt(0)
    v_exp_f32 v138, v138
    v_smfmac_f32_32x32x32_bf16 v[112:127], v[196:199], v[160:167], v17
    ds_read_b128 v[176:179], v8 offset:45056
    v_exp_f32 v139, v139
    v_exp_f32 v140, v140
    v_exp_f32 v141, v141
    v_mfma_f32_32x32x16_bf16 v[152:167], v[168:171], v[88:91], v[48:63]
    ds_read_b128 v[180:183], v8 offset:46080
    v_exp_f32 v142, v142
    v_exp_f32 v143, v143
    v_exp_f32 v144, v144
    v_mfma_f32_32x32x16_bf16 v[152:167], v[172:175], v[92:95], v[152:167]
    s_add_u32 m0, s81, 65536
    s_xor_b32 s31, s75, 0
    s_setprio 0
    v_exp_f32 v145, v145
    v_exp_f32 v146, v146
    v_exp_f32 v147, v147
    v_smfmac_f32_16x16x64_bf16 v[128:131], v[28:31], v[136:143], v17
    s_add_u32 s31, s31, s83
    v_exp_f32 v148, v148
    v_smfmac_f32_32x32x32_bf16 v[96:111], v[184:187], v[136:143], v17
    buffer_load_dwordx4 v3, s[16:19], s31 offen offset:0 sc1 lds
    v_exp_f32 v149, v149
    v_exp_f32 v150, v150
    v_exp_f32 v151, v151
YS45:
    v_exp_f32 v152, v152
    v_exp_f32 v153, v153
    v_smfmac_f32_16x16x64_bf16 v[128:131], v[28:31], v[144:151], v17
    s_waitcnt lgkmcnt(0)
    v_exp_f32 v154, v154
    v_smfmac_f32_32x32x32_bf16 v[96:111], v[188:191], v[144:151], v17
    ds_read_b128 v[192:195], v10 offset:47104
    v_exp_f32 v155, v155
    v_exp_f32 v156, v156
    v_exp_f32 v157, v157
    v_mfma_f32_32x32x16_bf16 v[136:151], v[176:179], v[80:83], v[64:79]
    ds_read_b128 v[196:199], v10 offset:48128
    v_exp_f32 v158, v158
    v_exp_f32 v159, v159
    v_exp_f32 v160, v160
    v_mfma_f32_32x32x16_bf16 v[136:151], v[180:183], v[84:87], v[136:151]
    s_nop 0
    v_exp_f32 v161, v161
    v_exp_f32 v162, v162
    v_exp_f32 v163, v163
    v_smfmac_f32_16x16x64_bf16 v[132:135], v[28:31], v[152:159], v17
    s_nop 0
    v_exp_f32 v164, v164
    v_smfmac_f32_32x32x32_bf16 v[112:127], v[184:187], v[152:159], v17
    buffer_load_dwordx4 v3, s[16:19], s31 offen offset:1024 sc1 lds
    v_exp_f32 v165, v165
    v_exp_f32 v166, v166
    v_exp_f32 v167, v167
YS46:
    v_exp_f32 v136, v136
    v_exp_f32 v137, v137
    v_smfmac_f32_16x16x64_bf16 v[132:135], v[28:31], v[160:167], v17
    s_waitcnt vmcnt(4) lgkmcnt(0)
    s_barrier
    v_exp_f32 v138, v138
    v_smfmac_f32_32x32x32_bf16 v[112:127], v[188:191], v[160:167], v17
    ds_read_b128 v[168:171], v8 offset:0
    v_exp_f32 v139, v139
    v_exp_f32 v140, v140
    v_exp_f32 v141, v141
    v_mfma_f32_32x32x16_bf16 v[152:167], v[176:179], v[88:91], v[48:63]
    ds_read_b128 v[172:175], v8 offset:1024
    v_exp_f32 v142, v142
    v_exp_f32 v143, v143
    v_exp_f32 v144, v144
    v_mfma_f32_32x32x16_bf16 v[152:167], v[180:183], v[92:95], v[152:167]
    s_and_b32 s31, s21, 4
    s_xor_b32 s31, s31, 7
    s_lshl_b32 s31, s31, 15
    s_setprio 3
    v_exp_f32 v145, v145
    v_exp_f32 v146, v146
    v_exp_f32 v147, v147
    v_smfmac_f32_16x16x64_bf16 v[128:131], v[28:31], v[136:143], v17
    s_add_u32 s31, s31, s54
    s_add_u32 s31, s31, s57
    s_add_u32 m0, s57, 32768
    v_exp_f32 v148, v148
    v_smfmac_f32_32x32x32_bf16 v[96:111], v[192:195], v[136:143], v17
    buffer_load_dwordx4 v3, s[16:19], s31 offen offset:0 sc1 lds
    v_exp_f32 v149, v149
    v_exp_f32 v150, v150
    v_exp_f32 v151, v151
YS47:
    v_exp_f32 v152, v152
    v_exp_f32 v153, v153
    v_smfmac_f32_16x16x64_bf16 v[128:131], v[28:31], v[144:151], v17
    s_waitcnt lgkmcnt(0)
    v_exp_f32 v154, v154
    v_smfmac_f32_32x32x32_bf16 v[96:111], v[196:199], v[144:151], v17
    ds_read_b128 v[184:187], v10 offset:2048
    v_exp_f32 v155, v155
    v_exp_f32 v156, v156
    v_exp_f32 v157, v157
    v_mfma_f32_32x32x16_bf16 v[136:151], v[168:171], v[80:83], v[64:79]
    ds_read_b128 v[188:191], v10 offset:3072
    v_exp_f32 v158, v158
    v_exp_f32 v159, v159
    v_exp_f32 v160, v160
    v_mfma_f32_32x32x16_bf16 v[136:151], v[172:175], v[84:87], v[136:151]
    s_nop 0
    v_exp_f32 v161, v161
    v_exp_f32 v162, v162
    v_exp_f32 v163, v163
    v_smfmac_f32_16x16x64_bf16 v[132:135], v[28:31], v[152:159], v17
    s_nop 0
    v_exp_f32 v164, v164
    v_smfmac_f32_32x32x32_bf16 v[112:127], v[192:195], v[152:159], v17
    buffer_load_dwordx4 v3, s[16:19], s31 offen offset:1024 sc1 lds
    v_exp_f32 v165, v165
    v_exp_f32 v166, v166
    v_exp_f32 v167, v167
YS48:
    v_exp_f32 v136, v136
    v_exp_f32 v137, v137
    v_smfmac_f32_16x16x64_bf16 v[132:135], v[28:31], v[160:167], v17
    s_waitcnt lgkmcnt(0)
    v_exp_f32 v138, v138
    v_smfmac_f32_32x32x32_bf16 v[112:127], v[196:199], v[160:167], v17
    ds_read_b128 v[176:179], v8 offset:4096
    v_exp_f32 v139, v139
    v_exp_f32 v140, v140
    v_exp_f32 v141, v141
    v_mfma_f32_32x32x16_bf16 v[152:167], v[168:171], v[88:91], v[48:63]
    ds_read_b128 v[180:183], v8 offset:5120
    v_exp_f32 v142, v142
    v_exp_f32 v143, v143
    v_exp_f32 v144, v144
    v_mfma_f32_32x32x16_bf16 v[152:167], v[172:175], v[92:95], v[152:167]
    s_setprio 2
    v_exp_f32 v145, v145
    v_exp_f32 v146, v146
    v_exp_f32 v147, v147
    v_smfmac_f32_16x16x64_bf16 v[128:131], v[28:31], v[136:143], v17
    s_nop 0
    v_exp_f32 v148, v148
    v_smfmac_f32_32x32x32_bf16 v[96:111], v[184:187], v[136:143], v17
    buffer_load_dwordx4 v3, s[16:19], s31 offen offset:2048 sc1 lds
    v_exp_f32 v149, v149
    v_exp_f32 v150, v150
    v_exp_f32 v151, v151
YS49:
    v_exp_f32 v152, v152
    v_exp_f32 v153, v153
    v_smfmac_f32_16x16x64_bf16 v[128:131], v[28:31], v[144:151], v17
    s_waitcnt lgkmcnt(0)
    v_exp_f32 v154, v154
    v_smfmac_f32_32x32x32_bf16 v[96:111], v[188:191], v[144:151], v17
    ds_read_b128 v[192:195], v10 offset:6144
    v_exp_f32 v155, v155
    v_exp_f32 v156, v156
    v_exp_f32 v157, v157
    v_mfma_f32_32x32x16_bf16 v[136:151], v[176:179], v[80:83], v[64:79]
    ds_read_b128 v[196:199], v10 offset:7168
    v_exp_f32 v158, v158
    v_exp_f32 v159, v159
    v_exp_f32 v160, v160
    v_mfma_f32_32x32x16_bf16 v[136:151], v[180:183], v[84:87], v[136:151]
    s_nop 0
    v_exp_f32 v161, v161
    v_exp_f32 v162, v162
    v_exp_f32 v163, v163
    v_smfmac_f32_16x16x64_bf16 v[132:135], v[28:31], v[152:159], v17
    s_nop 0
    v_exp_f32 v164, v164
    v_smfmac_f32_32x32x32_bf16 v[112:127], v[184:187], v[152:159], v17
    buffer_load_dwordx4 v3, s[16:19], s31 offen offset:3072 sc1 lds
    v_exp_f32 v165, v165
    v_exp_f32 v166, v166
    v_exp_f32 v167, v167
YS50:
    v_exp_f32 v136, v136
    v_exp_f32 v137, v137
    v_smfmac_f32_16x16x64_bf16 v[132:135], v[28:31], v[160:167], v17
    s_waitcnt lgkmcnt(0)
    v_exp_f32 v138, v138
    v_smfmac_f32_32x32x32_bf16 v[112:127], v[188:191], v[160:167], v17
    ds_read_b128 v[168:171], v8 offset:8192
    v_exp_f32 v139, v139
    v_exp_f32 v140, v140
    v_exp_f32 v141, v141
    v_mfma_f32_32x32x16_bf16 v[152:167], v[176:179], v[88:91], v[48:63]
    ds_read_b128 v[172:175], v8 offset:9216
    v_exp_f32 v142, v142
    v_exp_f32 v143, v143
    v_exp_f32 v144, v144
    v_mfma_f32_32x32x16_bf16 v[152:167], v[180:183], v[92:95], v[152:167]
    s_add_u32 m0, s81, 114688
    s_xor_b32 s31, s73, 262144
    s_setprio 1
    v_exp_f32 v145, v145
    v_exp_f32 v146, v146
    v_exp_f32 v147, v147
    v_smfmac_f32_16x16x64_bf16 v[128:131], v[28:31], v[136:143], v17
    s_add_u32 s31, s31, s82
    v_exp_f32 v148, v148
    v_smfmac_f32_32x32x32_bf16 v[96:111], v[192:195], v[136:143], v17
    buffer_load_dwordx4 v19, s[36:39], s31 offen offset:0 lds
    v_exp_f32 v149, v149
    v_exp_f32 v150, v150
    v_exp_f32 v151, v151
YS51:
    v_exp_f32 v152, v152
    v_exp_f32 v153, v153
    v_smfmac_f32_16x16x64_bf16 v[128:131], v[28:31], v[144:151], v17
    s_waitcnt lgkmcnt(0)
    v_exp_f32 v154, v154
    v_smfmac_f32_32x32x32_bf16 v[96:111], v[196:199], v[144:151], v17
    ds_read_b128 v[184:187], v10 offset:10240
    v_exp_f32 v155, v155
    v_exp_f32 v156, v156
    v_exp_f32 v157, v157
    v_mfma_f32_32x32x16_bf16 v[136:151], v[168:171], v[80:83], v[64:79]
    ds_read_b128 v[188:191], v10 offset:11264
    v_exp_f32 v158, v158
    v_exp_f32 v159, v159
    v_exp_f32 v160, v160
    v_mfma_f32_32x32x16_bf16 v[136:151], v[172:175], v[84:87], v[136:151]
    s_nop 0
    v_exp_f32 v161, v161
    v_exp_f32 v162, v162
    v_exp_f32 v163, v163
    v_smfmac_f32_16x16x64_bf16 v[132:135], v[28:31], v[152:159], v17
    s_nop 0
    v_exp_f32 v164, v164
    v_smfmac_f32_32x32x32_bf16 v[112:127], v[192:195], v[152:159], v17
    buffer_load_dwordx4 v20, s[36:39], s31 offen offset:1024 lds
    v_exp_f32 v165, v165
    v_exp_f32 v166, v166
    v_exp_f32 v167, v167
YS52:
    v_exp_f32 v136, v136
    v_exp_f32 v137, v137
    v_smfmac_f32_16x16x64_bf16 v[132:135], v[28:31], v[160:167], v17
    s_waitcnt lgkmcnt(0)
    v_exp_f32 v138, v138
    v_smfmac_f32_32x32x32_bf16 v[112:127], v[196:199], v[160:167], v17
    ds_read_b128 v[176:179], v8 offset:12288
    v_exp_f32 v139, v139
    v_exp_f32 v140, v140
    v_exp_f32 v141, v141
    v_mfma_f32_32x32x16_bf16 v[152:167], v[168:171], v[88:91], v[48:63]
    ds_read_b128 v[180:183], v8 offset:13312
    v_exp_f32 v142, v142
    v_exp_f32 v143, v143
    v_exp_f32 v144, v144
    v_mfma_f32_32x32x16_bf16 v[152:167], v[172:175], v[92:95], v[152:167]
    s_add_u32 m0, s81, 98304
    s_xor_b32 s31, s75, 4096
    s_setprio 0
    v_exp_f32 v145, v145
    v_exp_f32 v146, v146
    v_exp_f32 v147, v147
    v_smfmac_f32_16x16x64_bf16 v[128:131], v[28:31], v[136:143], v17
    s_add_u32 s31, s31, s83
    v_exp_f32 v148, v148
    v_smfmac_f32_32x32x32_bf16 v[96:111], v[184:187], v[136:143], v17
    buffer_load_dwordx4 v3, s[16:19], s31 offen offset:0 sc1 lds
    v_exp_f32 v149, v149
    v_exp_f32 v150, v150
    v_exp_f32 v151, v151
YS53:
    v_exp_f32 v152, v152
    v_exp_f32 v153, v153
    v_smfmac_f32_16x16x64_bf16 v[128:131], v[28:31], v[144:151], v17
    s_waitcnt lgkmcnt(0)
    v_exp_f32 v154, v154
    v_smfmac_f32_32x32x32_bf16 v[96:111], v[188:191], v[144:151], v17
    ds_read_b128 v[192:195], v10 offset:14336
    v_exp_f32 v155, v155
    v_exp_f32 v156, v156
    v_exp_f32 v157, v157
    v_mfma_f32_32x32x16_bf16 v[136:151], v[176:179], v[80:83], v[64:79]
    ds_read_b128 v[196:199], v10 offset:15360
    v_exp_f32 v158, v158
    v_exp_f32 v159, v159
    v_exp_f32 v160, v160
    v_mfma_f32_32x32x16_bf16 v[136:151], v[180:183], v[84:87], v[136:151]
    s_nop 0
    v_exp_f32 v161, v161
    v_exp_f32 v162, v162
    v_exp_f32 v163, v163
    v_smfmac_f32_16x16x64_bf16 v[132:135], v[28:31], v[152:159], v17
    s_nop 0
    v_exp_f32 v164, v164
    v_smfmac_f32_32x32x32_bf16 v[112:127], v[184:187], v[152:159], v17
    buffer_load_dwordx4 v3, s[16:19], s31 offen offset:1024 sc1 lds
    v_exp_f32 v165, v165
    v_exp_f32 v166, v166
    v_exp_f32 v167, v167
YS54:
    v_exp_f32 v136, v136
    v_exp_f32 v137, v137
    v_smfmac_f32_16x16x64_bf16 v[132:135], v[28:31], v[160:167], v17
    s_waitcnt vmcnt(4) lgkmcnt(0)
    s_barrier
    v_exp_f32 v138, v138
    v_smfmac_f32_32x32x32_bf16 v[112:127], v[188:191], v[160:167], v17
    ds_read_b128 v[168:171], v8 offset:32768
    v_exp_f32 v139, v139
    v_exp_f32 v140, v140
    v_exp_f32 v141, v141
    v_mfma_f32_32x32x16_bf16 v[152:167], v[176:179], v[88:91], v[48:63]
    ds_read_b128 v[172:175], v8 offset:33792
    v_exp_f32 v142, v142
    v_exp_f32 v143, v143
    v_exp_f32 v144, v144
    v_mfma_f32_32x32x16_bf16 v[152:167], v[180:183], v[92:95], v[152:167]
    s_add_u32 m0, s81, 147456
    s_xor_b32 s31, s73, 524288
    s_setprio 3
    v_exp_f32 v145, v145
    v_exp_f32 v146, v146
    v_exp_f32 v147, v147
    v_smfmac_f32_16x16x64_bf16 v[128:131], v[28:31], v[136:143], v17
    s_add_u32 s31, s31, s82
    v_exp_f32 v148, v148
    v_smfmac_f32_32x32x32_bf16 v[96:111], v[192:195], v[136:143], v17
    buffer_load_dwordx4 v19, s[36:39], s31 offen offset:0 lds
    v_exp_f32 v149, v149
    v_exp_f32 v150, v150
    v_exp_f32 v151, v151
YS55:
    v_exp_f32 v152, v152
    v_exp_f32 v153, v153
    v_smfmac_f32_16x16x64_bf16 v[128:131], v[28:31], v[144:151], v17
    s_waitcnt lgkmcnt(0)
    v_exp_f32 v154, v154
    v_smfmac_f32_32x32x32_bf16 v[96:111], v[196:199], v[144:151], v17
    ds_read_b128 v[184:187], v10 offset:34816
    v_exp_f32 v155, v155
    v_exp_f32 v156, v156
    v_exp_f32 v157, v157
    v_mfma_f32_32x32x16_bf16 v[136:151], v[168:171], v[80:83], v[64:79]
    ds_read_b128 v[188:191], v10 offset:35840
    v_exp_f32 v158, v158
    v_exp_f32 v159, v159
    v_exp_f32 v160, v160
    v_mfma_f32_32x32x16_bf16 v[136:151], v[172:175], v[84:87], v[136:151]
    s_nop 0
    v_exp_f32 v161, v161
    v_exp_f32 v162, v162
    v_exp_f32 v163, v163
    v_smfmac_f32_16x16x64_bf16 v[132:135], v[28:31], v[152:159], v17
    s_nop 0
    v_exp_f32 v164, v164
    v_smfmac_f32_32x32x32_bf16 v[112:127], v[192:195], v[152:159], v17
    buffer_load_dwordx4 v20, s[36:39], s31 offen offset:1024 lds
    v_exp_f32 v165, v165
    v_exp_f32 v166, v166
    v_exp_f32 v167, v167
YS56:
    v_exp_f32 v136, v136
    v_exp_f32 v137, v137
    v_smfmac_f32_16x16x64_bf16 v[132:135], v[28:31], v[160:167], v17
    s_waitcnt lgkmcnt(0)
    v_exp_f32 v138, v138
    v_smfmac_f32_32x32x32_bf16 v[112:127], v[196:199], v[160:167], v17
    ds_read_b128 v[176:179], v8 offset:36864
    v_exp_f32 v139, v139
    v_exp_f32 v140, v140
    v_exp_f32 v141, v141
    v_mfma_f32_32x32x16_bf16 v[152:167], v[168:171], v[88:91], v[48:63]
    ds_read_b128 v[180:183], v8 offset:37888
    v_exp_f32 v142, v142
    v_exp_f32 v143, v143
    v_exp_f32 v144, v144
    v_mfma_f32_32x32x16_bf16 v[152:167], v[172:175], v[92:95], v[152:167]
    s_add_u32 m0, s81, 131072
    s_xor_b32 s31, s75, 8192
    s_setprio 3
    v_exp_f32 v145, v145
    v_exp_f32 v146, v146
    v_exp_f32 v147, v147
    v_smfmac_f32_16x16x64_bf16 v[128:131], v[28:31], v[136:143], v17
    s_add_u32 s31, s31, s83
    v_exp_f32 v148, v148
    v_smfmac_f32_32x32x32_bf16 v[96:111], v[184:187], v[136:143], v17
    buffer_load_dwordx4 v3, s[16:19], s31 offen offset:0 sc1 lds
    v_exp_f32 v149, v149
    v_exp_f32 v150, v150
    v_exp_f32 v151, v151
YS57:
    v_exp_f32 v152, v152
    v_exp_f32 v153, v153
    v_smfmac_f32_16x16x64_bf16 v[128:131], v[28:31], v[144:151], v17
    s_waitcnt lgkmcnt(0)
    v_exp_f32 v154, v154
    v_smfmac_f32_32x32x32_bf16 v[96:111], v[188:191], v[144:151], v17
    ds_read_b128 v[192:195], v10 offset:38912
    v_exp_f32 v155, v155
    v_exp_f32 v156, v156
    v_exp_f32 v157, v157
    v_mfma_f32_32x32x16_bf16 v[136:151], v[176:179], v[80:83], v[64:79]
    ds_read_b128 v[196:199], v10 offset:39936
    v_exp_f32 v158, v158
    v_exp_f32 v159, v159
    v_exp_f32 v160, v160
    v_mfma_f32_32x32x16_bf16 v[136:151], v[180:183], v[84:87], v[136:151]
    s_nop 0
    v_exp_f32 v161, v161
    v_exp_f32 v162, v162
    v_exp_f32 v163, v163
    v_smfmac_f32_16x16x64_bf16 v[132:135], v[28:31], v[152:159], v17
    s_nop 0
    v_exp_f32 v164, v164
    v_smfmac_f32_32x32x32_bf16 v[112:127], v[184:187], v[152:159], v17
    buffer_load_dwordx4 v3, s[16:19], s31 offen offset:1024 sc1 lds
    v_exp_f32 v165, v165
    v_exp_f32 v166, v166
    v_exp_f32 v167, v167
YS58:
    v_exp_f32 v136, v136
    v_exp_f32 v137, v137
    v_smfmac_f32_16x16x64_bf16 v[132:135], v[28:31], v[160:167], v17
    s_waitcnt lgkmcnt(0)
    v_exp_f32 v138, v138
    v_smfmac_f32_32x32x32_bf16 v[112:127], v[188:191], v[160:167], v17
    ds_read_b128 v[168:171], v8 offset:40960
    v_exp_f32 v139, v139
    v_exp_f32 v140, v140
    v_exp_f32 v141, v141
    v_mfma_f32_32x32x16_bf16 v[152:167], v[176:179], v[88:91], v[48:63]
    ds_read_b128 v[172:175], v8 offset:41984
    v_exp_f32 v142, v142
    v_exp_f32 v143, v143
    v_exp_f32 v144, v144
    v_mfma_f32_32x32x16_bf16 v[152:167], v[180:183], v[92:95], v[152:167]
    s_add_u32 m0, s81, 16384
    s_xor_b32 s31, s73, 786432
    s_setprio 2
    v_exp_f32 v145, v145
    v_exp_f32 v146, v146
    v_exp_f32 v147, v147
    v_smfmac_f32_16x16x64_bf16 v[128:131], v[28:31], v[136:143], v17
    s_add_u32 s31, s31, s82
    v_exp_f32 v148, v148
    v_smfmac_f32_32x32x32_bf16 v[96:111], v[192:195], v[136:143], v17
    buffer_load_dwordx4 v19, s[36:39], s31 offen offset:0 lds
    v_exp_f32 v149, v149
    v_exp_f32 v150, v150
    v_exp_f32 v151, v151
YS59:
    v_exp_f32 v152, v152
    v_exp_f32 v153, v153
    v_smfmac_f32_16x16x64_bf16 v[128:131], v[28:31], v[144:151], v17
    s_waitcnt lgkmcnt(0)
    v_exp_f32 v154, v154
    v_smfmac_f32_32x32x32_bf16 v[96:111], v[196:199], v[144:151], v17
    ds_read_b128 v[184:187], v10 offset:43008
    v_exp_f32 v155, v155
    v_exp_f32 v156, v156
    v_exp_f32 v157, v157
    v_mfma_f32_32x32x16_bf16 v[136:151], v[168:171], v[80:83], v[64:79]
    ds_read_b128 v[188:191], v10 offset:44032
    v_exp_f32 v158, v158
    v_exp_f32 v159, v159
    v_exp_f32 v160, v160
    v_mfma_f32_32x32x16_bf16 v[136:151], v[172:175], v[84:87], v[136:151]
    s_nop 0
    v_exp_f32 v161, v161
    v_exp_f32 v162, v162
    v_exp_f32 v163, v163
    v_smfmac_f32_16x16x64_bf16 v[132:135], v[28:31], v[152:159], v17
    s_nop 0
    v_exp_f32 v164, v164
    v_smfmac_f32_32x32x32_bf16 v[112:127], v[192:195], v[152:159], v17
    buffer_load_dwordx4 v20, s[36:39], s31 offen offset:1024 lds
    v_exp_f32 v165, v165
    v_exp_f32 v166, v166
    v_exp_f32 v167, v167
YS60:
    v_exp_f32 v136, v136
    v_exp_f32 v137, v137
    v_smfmac_f32_16x16x64_bf16 v[132:135], v[28:31], v[160:167], v17
    s_waitcnt lgkmcnt(0)
    v_exp_f32 v138, v138
    v_smfmac_f32_32x32x32_bf16 v[112:127], v[196:199], v[160:167], v17
    ds_read_b128 v[176:179], v8 offset:45056
    v_exp_f32 v139, v139
    v_exp_f32 v140, v140
    v_exp_f32 v141, v141
    v_mfma_f32_32x32x16_bf16 v[152:167], v[168:171], v[88:91], v[48:63]
    ds_read_b128 v[180:183], v8 offset:46080
    v_exp_f32 v142, v142
    v_exp_f32 v143, v143
    v_exp_f32 v144, v144
    v_mfma_f32_32x32x16_bf16 v[152:167], v[172:175], v[92:95], v[152:167]
    s_add_u32 m0, s81, 0
    s_xor_b32 s31, s75, 12288
    s_setprio 1
    v_exp_f32 v145, v145
    v_exp_f32 v146, v146
    v_exp_f32 v147, v147
    v_smfmac_f32_16x16x64_bf16 v[128:131], v[28:31], v[136:143], v17
    s_add_u32 s31, s31, s83
    v_exp_f32 v148, v148
    v_smfmac_f32_32x32x32_bf16 v[96:111], v[184:187], v[136:143], v17
    buffer_load_dwordx4 v3, s[16:19], s31 offen offset:0 sc1 lds
    v_exp_f32 v149, v149
    v_exp_f32 v150, v150
    v_exp_f32 v151, v151
YS61:
    v_exp_f32 v152, v152
    v_exp_f32 v153, v153
    v_smfmac_f32_16x16x64_bf16 v[128:131], v[28:31], v[144:151], v17
    s_waitcnt lgkmcnt(0)
    v_exp_f32 v154, v154
    v_smfmac_f32_32x32x32_bf16 v[96:111], v[188:191], v[144:151], v17
    ds_read_b128 v[192:195], v10 offset:47104
    v_exp_f32 v155, v155
    v_exp_f32 v156, v156
    v_exp_f32 v157, v157
    v_mfma_f32_32x32x16_bf16 v[136:151], v[176:179], v[80:83], v[64:79]
    ds_read_b128 v[196:199], v10 offset:48128
    v_exp_f32 v158, v158
    v_exp_f32 v159, v159
    v_exp_f32 v160, v160
    v_mfma_f32_32x32x16_bf16 v[136:151], v[180:183], v[84:87], v[136:151]
    s_nop 0
    v_exp_f32 v161, v161
    v_exp_f32 v162, v162
    v_exp_f32 v163, v163
    v_smfmac_f32_16x16x64_bf16 v[132:135], v[28:31], v[152:159], v17
    s_nop 0
    v_exp_f32 v164, v164
    v_smfmac_f32_32x32x32_bf16 v[112:127], v[184:187], v[152:159], v17
    s_nop 0
    v_exp_f32 v165, v165
    v_exp_f32 v166, v166
    v_exp_f32 v167, v167
YS62:
    v_exp_f32 v136, v136
    v_exp_f32 v137, v137
    v_smfmac_f32_16x16x64_bf16 v[132:135], v[28:31], v[160:167], v17
    s_waitcnt lgkmcnt(0)
    s_barrier
    v_exp_f32 v138, v138
    v_smfmac_f32_32x32x32_bf16 v[112:127], v[188:191], v[160:167], v17
    v_exp_f32 v139, v139
    v_exp_f32 v140, v140
    v_exp_f32 v141, v141
    v_mfma_f32_32x32x16_bf16 v[152:167], v[176:179], v[88:91], v[48:63]
    v_exp_f32 v142, v142
    v_exp_f32 v143, v143
    v_exp_f32 v144, v144
    v_mfma_f32_32x32x16_bf16 v[152:167], v[180:183], v[92:95], v[152:167]
    s_setprio 1
    v_exp_f32 v145, v145
    v_exp_f32 v146, v146
    v_exp_f32 v147, v147
    v_smfmac_f32_16x16x64_bf16 v[128:131], v[28:31], v[136:143], v17
    s_nop 0
    v_exp_f32 v148, v148
    v_smfmac_f32_32x32x32_bf16 v[96:111], v[192:195], v[136:143], v17
    s_nop 0
    v_exp_f32 v149, v149
    v_exp_f32 v150, v150
    v_exp_f32 v151, v151
YS63:
    v_exp_f32 v152, v152
    v_exp_f32 v153, v153
    v_smfmac_f32_16x16x64_bf16 v[128:131], v[28:31], v[144:151], v17
    s_waitcnt lgkmcnt(0)
    v_exp_f32 v154, v154
    v_smfmac_f32_32x32x32_bf16 v[96:111], v[196:199], v[144:151], v17
    v_exp_f32 v155, v155
    v_exp_f32 v156, v156
    v_exp_f32 v157, v157
    v_exp_f32 v158, v158
    v_exp_f32 v159, v159
    v_exp_f32 v160, v160
    s_nop 0
    v_exp_f32 v161, v161
    v_exp_f32 v162, v162
    v_exp_f32 v163, v163
    v_smfmac_f32_16x16x64_bf16 v[132:135], v[28:31], v[152:159], v17
    s_nop 0
    v_exp_f32 v164, v164
    v_smfmac_f32_32x32x32_bf16 v[112:127], v[192:195], v[152:159], v17
    s_nop 0
    v_exp_f32 v165, v165
    v_exp_f32 v166, v166
    v_exp_f32 v167, v167
YS64:
    s_add_u32 s25, s57, 32768
    s_setprio 0
    v_smfmac_f32_16x16x64_bf16 v[132:135], v[28:31], v[160:167], v17
    v_smfmac_f32_32x32x32_bf16 v[112:127], v[196:199], v[160:167], v17
    v_add_u32 v24, s25, v3
    v_xor_b32 v25, 0x4000, v24
    s_add_u32 s25, s81, 1024
    s_nop 0
    v_lshl_add_u32 v26, v2, 2, s25
    v_xor_b32 v22, 0x800, v26
    s_nop 5
    ds_write_b32 v26, v132
    ds_write_b128 v24, v[112:115] offset:0
    ds_write_b128 v24, v[116:119] offset:1024
    ds_write_b128 v24, v[120:123] offset:2048
    ds_write_b128 v24, v[124:127] offset:3072
    s_cmp_ge_u32 s20, 4
    s_cbranch_scc1 OB134
    s_branch VP131
VR130:
    s_branch VP133
VR132:
OB134:
    s_waitcnt vmcnt(0) lgkmcnt(0)
    s_barrier
    ds_read_b32 v132, v22
    ds_read_b128 v[112:115], v25 offset:0
    ds_read_b128 v[116:119], v25 offset:1024
    ds_read_b128 v[120:123], v25 offset:2048
    ds_read_b128 v[124:127], v25 offset:3072
    s_cmp_lt_u32 s20, 4
    s_cbranch_scc1 YB135
    s_setprio 1
YB135:
    s_waitcnt lgkmcnt(0)
    s_barrier
    v_add_f32 v128, v128, v132
    v_add_f32 v96, v96, v112
    v_add_f32 v97, v97, v113
    v_add_f32 v98, v98, v114
    v_add_f32 v99, v99, v115
    v_add_f32 v100, v100, v116
    v_add_f32 v101, v101, v117
    v_add_f32 v102, v102, v118
    v_add_f32 v103, v103, v119
    v_add_f32 v104, v104, v120
    v_add_f32 v105, v105, v121
    v_add_f32 v106, v106, v122
    v_add_f32 v107, v107, v123
    v_add_f32 v108, v108, v124
    v_add_f32 v109, v109, v125
    v_add_f32 v110, v110, v126
    v_add_f32 v111, v111, v127
    v_rcp_f32 v22, v128
    v_cmp_gt_f32 s[4:5], s78, v128
    v_maximum3_f32 v23, abs(v96), abs(v97), 0
    v_maximum3_f32 v23, abs(v98), abs(v99), v23
    v_maximum3_f32 v23, abs(v100), abs(v101), v23
    v_maximum3_f32 v23, abs(v102), abs(v103), v23
    v_maximum3_f32 v23, abs(v104), abs(v105), v23
    v_maximum3_f32 v23, abs(v106), abs(v107), v23
    v_maximum3_f32 v23, abs(v108), abs(v109), v23
    v_maximum3_f32 v23, abs(v110), abs(v111), v23
    v_cmp_gt_f32 s[6:7], s77, v23
    v_cmp_lt_f32 vcc, s76, v23
    s_and_b64 s[4:5], s[4:5], s[6:7]
    s_and_b64 s[4:5], s[4:5], vcc
    s_cmp_eq_u64 s[4:5], -1
    s_cbranch_scc0 FB136
RT137:
    v_mul_f32 v96, v22, v96
    v_mul_f32 v97, v22, v97
    v_mul_f32 v98, v22, v98
    v_mul_f32 v99, v22, v99
    v_mul_f32 v100, v22, v100
    v_mul_f32 v101, v22, v101
    v_mul_f32 v102, v22, v102
    v_mul_f32 v103, v22, v103
    v_mul_f32 v104, v22, v104
    v_mul_f32 v105, v22, v105
    v_mul_f32 v106, v22, v106
    v_mul_f32 v107, v22, v107
    v_mul_f32 v108, v22, v108
    v_mul_f32 v109, v22, v109
    v_mul_f32 v110, v22, v110
    v_mul_f32 v111, v22, v111
    v_cvt_pk_bf16_f32 v88, v96, v97
    v_cvt_pk_bf16_f32 v89, v98, v99
    v_cvt_pk_bf16_f32 v90, v100, v101
    v_cvt_pk_bf16_f32 v91, v102, v103
    v_cvt_pk_bf16_f32 v92, v104, v105
    v_cvt_pk_bf16_f32 v93, v106, v107
    v_cvt_pk_bf16_f32 v94, v108, v109
    v_cvt_pk_bf16_f32 v95, v110, v111
    buffer_store_dwordx4 v[88:91], v18, s[16:19], s65 offen offset:0 sc1
    buffer_store_dwordx4 v[92:95], v18, s[16:19], s65 offen offset:512 sc1
    s_cmp_ge_u32 s20, 4
    s_cbranch_scc1 OUTC
    s_branch OUTLY
YEND:
.p2align 12
VP34:
    s_branch VR33
VP131:
    s_branch VR130
OUTC:
    v_add_u32 v8, 65536, v11
    v_xor_b32 v12, 81920, v9
    v_xor_b32 v13, 81952, v9
    v_xor_b32 v14, 81984, v9
    v_xor_b32 v15, 82016, v9
    ds_read_b128 v[96:99], v8 offset:0
    ds_read_b64_tr_b16 v[128:129], v12 offset:0
    ds_read_b64_tr_b16 v[130:131], v12 offset:2048
    ds_read_b64_tr_b16 v[132:133], v13 offset:0
    ds_read_b64_tr_b16 v[134:135], v13 offset:2048
    ds_read_b64_tr_b16 v[136:137], v14 offset:0
    ds_read_b64_tr_b16 v[138:139], v14 offset:2048
    ds_read_b64_tr_b16 v[140:141], v15 offset:0
    ds_read_b64_tr_b16 v[142:143], v15 offset:2048
    ds_read_b128 v[100:103], v8 offset:1024
    ds_read_b128 v[104:107], v8 offset:4096
    ds_read_b128 v[108:111], v8 offset:5120
    v_add_u32 v10, 131072, v11
    v_add_u32 v27, s74, v3
    v_xor_b32 v16, 147456, v9
    v_xor_b32 v17, 147488, v9
    v_xor_b32 v18, 147520, v9
    v_xor_b32 v19, 147552, v9
    v_xor_b32 v20, 16384, v9
    v_xor_b32 v21, 16416, v9
    v_xor_b32 v22, 16448, v9
    v_xor_b32 v23, 16480, v9
    s_mov_b32 s26, 2
    s_waitcnt lgkmcnt(0)
    v_mfma_f32_16x16x32_bf16 v[28:31], v[128:131], v[96:99], 0
    ds_read_b128 v[112:115], v8 offset:2048
    v_mfma_f32_16x16x32_bf16 v[44:47], v[128:131], v[100:103], 0
    ds_read_b64_tr_b16 v[144:145], v12 offset:8192
    v_mfma_f32_16x16x32_bf16 v[48:51], v[132:135], v[100:103], 0
    ds_read_b64_tr_b16 v[146:147], v12 offset:10240
    v_mfma_f32_16x16x32_bf16 v[32:35], v[132:135], v[96:99], 0
    ds_read_b64_tr_b16 v[148:149], v13 offset:8192
    v_mfma_f32_16x16x32_bf16 v[36:39], v[136:139], v[96:99], 0
    ds_read_b64_tr_b16 v[150:151], v13 offset:10240
    v_mfma_f32_16x16x32_bf16 v[52:55], v[136:139], v[100:103], 0
    ds_read_b64_tr_b16 v[152:153], v14 offset:8192
    v_mfma_f32_16x16x32_bf16 v[56:59], v[140:143], v[100:103], 0
    ds_read_b64_tr_b16 v[154:155], v14 offset:10240
    v_mfma_f32_16x16x32_bf16 v[40:43], v[140:143], v[96:99], 0
    ds_read_b64_tr_b16 v[156:157], v15 offset:8192
    v_and_b32 v25, 15, v2
    v_mfma_f32_16x16x32_bf16 v[72:75], v[140:143], v[104:107], 0
    ds_read_b64_tr_b16 v[158:159], v15 offset:10240
    v_bfe_u32 v24, v2, 4, 1
    v_mfma_f32_16x16x32_bf16 v[88:91], v[140:143], v[108:111], 0
    ds_read_b128 v[116:119], v8 offset:3072
    v_lshrrev_b32 v26, 5, v2
    v_mfma_f32_16x16x32_bf16 v[84:87], v[136:139], v[108:111], 0
    ds_read_b128 v[120:123], v8 offset:6144
    v_lshl_add_u32 v24, v24, 1, v26
    v_mfma_f32_16x16x32_bf16 v[68:71], v[136:139], v[104:107], 0
    ds_read_b128 v[124:127], v8 offset:7168
    v_and_b32 v26, 7, v2
    v_mfma_f32_16x16x32_bf16 v[64:67], v[132:135], v[104:107], 0
    v_xor_b32 v24, v24, v26
    v_mfma_f32_16x16x32_bf16 v[80:83], v[132:135], v[108:111], 0
    v_lshlrev_b32 v24, 4, v24
    v_mfma_f32_16x16x32_bf16 v[76:79], v[128:131], v[108:111], 0
    v_lshl_add_u32 v24, v25, 7, v24
    v_mfma_f32_16x16x32_bf16 v[60:63], v[128:131], v[104:107], 0
    v_add_u32 v24, s56, v24
    s_waitcnt lgkmcnt(0)
    s_waitcnt vmcnt(0)
    s_barrier
    v_mfma_f32_16x16x32_bf16 v[28:31], v[144:147], v[112:115], v[28:31]
    ds_read_b128 v[96:99], v8 offset:32768
    v_mfma_f32_16x16x32_bf16 v[44:47], v[144:147], v[116:119], v[44:47]
    ds_read_b64_tr_b16 v[128:129], v12 offset:32768
    v_mfma_f32_16x16x32_bf16 v[48:51], v[148:151], v[116:119], v[48:51]
    ds_read_b64_tr_b16 v[130:131], v12 offset:34816
    v_mfma_f32_16x16x32_bf16 v[32:35], v[148:151], v[112:115], v[32:35]
    ds_read_b64_tr_b16 v[132:133], v13 offset:32768
    v_mfma_f32_16x16x32_bf16 v[36:39], v[152:155], v[112:115], v[36:39]
    ds_read_b64_tr_b16 v[134:135], v13 offset:34816
    v_mfma_f32_16x16x32_bf16 v[52:55], v[152:155], v[116:119], v[52:55]
    ds_read_b64_tr_b16 v[136:137], v14 offset:32768
    v_mfma_f32_16x16x32_bf16 v[56:59], v[156:159], v[116:119], v[56:59]
    ds_read_b64_tr_b16 v[138:139], v14 offset:34816
    v_mfma_f32_16x16x32_bf16 v[40:43], v[156:159], v[112:115], v[40:43]
    ds_read_b64_tr_b16 v[140:141], v15 offset:32768
    v_lshrrev_b32 v25, 3, v2
    v_mfma_f32_16x16x32_bf16 v[72:75], v[156:159], v[120:123], v[72:75]
    ds_read_b64_tr_b16 v[142:143], v15 offset:34816
    v_xor_b32 v9, v26, v25
    v_mfma_f32_16x16x32_bf16 v[88:91], v[156:159], v[124:127], v[88:91]
    ds_read_b128 v[100:103], v8 offset:33792
    v_lshlrev_b32 v9, 4, v9
    v_mfma_f32_16x16x32_bf16 v[84:87], v[152:155], v[124:127], v[84:87]
    ds_read_b128 v[104:107], v8 offset:36864
    v_lshl_add_u32 v9, v25, 7, v9
    v_mfma_f32_16x16x32_bf16 v[68:71], v[152:155], v[120:123], v[68:71]
    ds_read_b128 v[108:111], v8 offset:37888
    v_add_u32 v9, s56, v9
    v_mfma_f32_16x16x32_bf16 v[64:67], v[148:151], v[120:123], v[64:67]
    v_lshlrev_b32 v26, 4, v26
    v_mfma_f32_16x16x32_bf16 v[80:83], v[148:151], v[124:127], v[80:83]
    v_lshl_add_u32 v26, v25, 12, v26
    v_mfma_f32_16x16x32_bf16 v[76:79], v[144:147], v[124:127], v[76:79]
    v_xor_b32 v25, 64, v24
    v_mfma_f32_16x16x32_bf16 v[60:63], v[144:147], v[120:123], v[60:63]
OLOOP:
    s_waitcnt lgkmcnt(0)
    v_mfma_f32_16x16x32_bf16 v[28:31], v[128:131], v[96:99], v[28:31]
    ds_read_b128 v[112:115], v8 offset:34816
    v_mfma_f32_16x16x32_bf16 v[44:47], v[128:131], v[100:103], v[44:47]
    ds_read_b64_tr_b16 v[144:145], v12 offset:40960
    v_mfma_f32_16x16x32_bf16 v[48:51], v[132:135], v[100:103], v[48:51]
    ds_read_b64_tr_b16 v[146:147], v12 offset:43008
    v_mfma_f32_16x16x32_bf16 v[32:35], v[132:135], v[96:99], v[32:35]
    ds_read_b64_tr_b16 v[148:149], v13 offset:40960
    v_mfma_f32_16x16x32_bf16 v[36:39], v[136:139], v[96:99], v[36:39]
    ds_read_b64_tr_b16 v[150:151], v13 offset:43008
    v_mfma_f32_16x16x32_bf16 v[52:55], v[136:139], v[100:103], v[52:55]
    ds_read_b64_tr_b16 v[152:153], v14 offset:40960
    v_mfma_f32_16x16x32_bf16 v[56:59], v[140:143], v[100:103], v[56:59]
    ds_read_b64_tr_b16 v[154:155], v14 offset:43008
    v_mfma_f32_16x16x32_bf16 v[40:43], v[140:143], v[96:99], v[40:43]
    ds_read_b64_tr_b16 v[156:157], v15 offset:40960
    v_mfma_f32_16x16x32_bf16 v[72:75], v[140:143], v[104:107], v[72:75]
    ds_read_b64_tr_b16 v[158:159], v15 offset:43008
    v_mfma_f32_16x16x32_bf16 v[88:91], v[140:143], v[108:111], v[88:91]
    ds_read_b128 v[116:119], v8 offset:35840
    v_mfma_f32_16x16x32_bf16 v[84:87], v[136:139], v[108:111], v[84:87]
    ds_read_b128 v[120:123], v8 offset:38912
    v_mfma_f32_16x16x32_bf16 v[68:71], v[136:139], v[104:107], v[68:71]
    ds_read_b128 v[124:127], v8 offset:39936
    v_mfma_f32_16x16x32_bf16 v[64:67], v[132:135], v[104:107], v[64:67]
    v_mfma_f32_16x16x32_bf16 v[80:83], v[132:135], v[108:111], v[80:83]
    v_mfma_f32_16x16x32_bf16 v[76:79], v[128:131], v[108:111], v[76:79]
    v_mfma_f32_16x16x32_bf16 v[60:63], v[128:131], v[104:107], v[60:63]
    s_waitcnt lgkmcnt(0)
    s_waitcnt vmcnt(2)
    s_barrier
    v_mfma_f32_16x16x32_bf16 v[28:31], v[144:147], v[112:115], v[28:31]
    ds_read_b128 v[96:99], v10 offset:0
    v_mfma_f32_16x16x32_bf16 v[44:47], v[144:147], v[116:119], v[44:47]
    ds_read_b64_tr_b16 v[128:129], v16 offset:0
    v_mfma_f32_16x16x32_bf16 v[48:51], v[148:151], v[116:119], v[48:51]
    ds_read_b64_tr_b16 v[130:131], v16 offset:2048
    v_mfma_f32_16x16x32_bf16 v[32:35], v[148:151], v[112:115], v[32:35]
    ds_read_b64_tr_b16 v[132:133], v17 offset:0
    v_mfma_f32_16x16x32_bf16 v[36:39], v[152:155], v[112:115], v[36:39]
    ds_read_b64_tr_b16 v[134:135], v17 offset:2048
    v_mfma_f32_16x16x32_bf16 v[52:55], v[152:155], v[116:119], v[52:55]
    ds_read_b64_tr_b16 v[136:137], v18 offset:0
    v_mfma_f32_16x16x32_bf16 v[56:59], v[156:159], v[116:119], v[56:59]
    ds_read_b64_tr_b16 v[138:139], v18 offset:2048
    v_mfma_f32_16x16x32_bf16 v[40:43], v[156:159], v[112:115], v[40:43]
    ds_read_b64_tr_b16 v[140:141], v19 offset:0
    v_mfma_f32_16x16x32_bf16 v[72:75], v[156:159], v[120:123], v[72:75]
    ds_read_b64_tr_b16 v[142:143], v19 offset:2048
    v_mfma_f32_16x16x32_bf16 v[88:91], v[156:159], v[124:127], v[88:91]
    ds_read_b128 v[100:103], v10 offset:1024
    v_mfma_f32_16x16x32_bf16 v[84:87], v[152:155], v[124:127], v[84:87]
    ds_read_b128 v[104:107], v10 offset:4096
    v_mfma_f32_16x16x32_bf16 v[68:71], v[152:155], v[120:123], v[68:71]
    ds_read_b128 v[108:111], v10 offset:5120
    v_mfma_f32_16x16x32_bf16 v[64:67], v[148:151], v[120:123], v[64:67]
    v_mfma_f32_16x16x32_bf16 v[80:83], v[148:151], v[124:127], v[80:83]
    v_mfma_f32_16x16x32_bf16 v[76:79], v[144:147], v[124:127], v[76:79]
    v_mfma_f32_16x16x32_bf16 v[60:63], v[144:147], v[120:123], v[60:63]
    s_waitcnt lgkmcnt(0)
    v_mfma_f32_16x16x32_bf16 v[28:31], v[128:131], v[96:99], v[28:31]
    ds_read_b128 v[112:115], v10 offset:2048
    v_mfma_f32_16x16x32_bf16 v[44:47], v[128:131], v[100:103], v[44:47]
    ds_read_b64_tr_b16 v[144:145], v16 offset:8192
    v_mfma_f32_16x16x32_bf16 v[48:51], v[132:135], v[100:103], v[48:51]
    ds_read_b64_tr_b16 v[146:147], v16 offset:10240
    v_mfma_f32_16x16x32_bf16 v[32:35], v[132:135], v[96:99], v[32:35]
    ds_read_b64_tr_b16 v[148:149], v17 offset:8192
    v_mfma_f32_16x16x32_bf16 v[36:39], v[136:139], v[96:99], v[36:39]
    ds_read_b64_tr_b16 v[150:151], v17 offset:10240
    v_mfma_f32_16x16x32_bf16 v[52:55], v[136:139], v[100:103], v[52:55]
    ds_read_b64_tr_b16 v[152:153], v18 offset:8192
    v_mfma_f32_16x16x32_bf16 v[56:59], v[140:143], v[100:103], v[56:59]
    ds_read_b64_tr_b16 v[154:155], v18 offset:10240
    v_mfma_f32_16x16x32_bf16 v[40:43], v[140:143], v[96:99], v[40:43]
    ds_read_b64_tr_b16 v[156:157], v19 offset:8192
    v_mfma_f32_16x16x32_bf16 v[72:75], v[140:143], v[104:107], v[72:75]
    ds_read_b64_tr_b16 v[158:159], v19 offset:10240
    v_mfma_f32_16x16x32_bf16 v[88:91], v[140:143], v[108:111], v[88:91]
    ds_read_b128 v[116:119], v10 offset:3072
    v_mfma_f32_16x16x32_bf16 v[84:87], v[136:139], v[108:111], v[84:87]
    ds_read_b128 v[120:123], v10 offset:6144
    v_mfma_f32_16x16x32_bf16 v[68:71], v[136:139], v[104:107], v[68:71]
    ds_read_b128 v[124:127], v10 offset:7168
    v_mfma_f32_16x16x32_bf16 v[64:67], v[132:135], v[104:107], v[64:67]
    v_mfma_f32_16x16x32_bf16 v[80:83], v[132:135], v[108:111], v[80:83]
    v_mfma_f32_16x16x32_bf16 v[76:79], v[128:131], v[108:111], v[76:79]
    v_mfma_f32_16x16x32_bf16 v[60:63], v[128:131], v[104:107], v[60:63]
    s_waitcnt lgkmcnt(0)
    s_barrier
    v_mfma_f32_16x16x32_bf16 v[28:31], v[144:147], v[112:115], v[28:31]
    ds_read_b128 v[96:99], v11 offset:0
    v_mfma_f32_16x16x32_bf16 v[44:47], v[144:147], v[116:119], v[44:47]
    ds_read_b64_tr_b16 v[128:129], v20 offset:0
    v_mfma_f32_16x16x32_bf16 v[48:51], v[148:151], v[116:119], v[48:51]
    ds_read_b64_tr_b16 v[130:131], v20 offset:2048
    v_mfma_f32_16x16x32_bf16 v[32:35], v[148:151], v[112:115], v[32:35]
    ds_read_b64_tr_b16 v[132:133], v21 offset:0
    v_mfma_f32_16x16x32_bf16 v[36:39], v[152:155], v[112:115], v[36:39]
    ds_read_b64_tr_b16 v[134:135], v21 offset:2048
    v_mfma_f32_16x16x32_bf16 v[52:55], v[152:155], v[116:119], v[52:55]
    ds_read_b64_tr_b16 v[136:137], v22 offset:0
    v_mfma_f32_16x16x32_bf16 v[56:59], v[156:159], v[116:119], v[56:59]
    ds_read_b64_tr_b16 v[138:139], v22 offset:2048
    v_mfma_f32_16x16x32_bf16 v[40:43], v[156:159], v[112:115], v[40:43]
    ds_read_b64_tr_b16 v[140:141], v23 offset:0
    v_mfma_f32_16x16x32_bf16 v[72:75], v[156:159], v[120:123], v[72:75]
    ds_read_b64_tr_b16 v[142:143], v23 offset:2048
    v_mfma_f32_16x16x32_bf16 v[88:91], v[156:159], v[124:127], v[88:91]
    ds_read_b128 v[100:103], v11 offset:1024
    v_mfma_f32_16x16x32_bf16 v[84:87], v[152:155], v[124:127], v[84:87]
    ds_read_b128 v[104:107], v11 offset:4096
    v_mfma_f32_16x16x32_bf16 v[68:71], v[152:155], v[120:123], v[68:71]
    ds_read_b128 v[108:111], v11 offset:5120
    v_mfma_f32_16x16x32_bf16 v[64:67], v[148:151], v[120:123], v[64:67]
    v_mfma_f32_16x16x32_bf16 v[80:83], v[148:151], v[124:127], v[80:83]
    v_mfma_f32_16x16x32_bf16 v[76:79], v[144:147], v[124:127], v[76:79]
    v_mfma_f32_16x16x32_bf16 v[60:63], v[144:147], v[120:123], v[60:63]
    s_waitcnt lgkmcnt(0)
    v_mfma_f32_16x16x32_bf16 v[28:31], v[128:131], v[96:99], v[28:31]
    ds_read_b128 v[112:115], v11 offset:2048
    v_mfma_f32_16x16x32_bf16 v[44:47], v[128:131], v[100:103], v[44:47]
    ds_read_b64_tr_b16 v[144:145], v20 offset:8192
    v_mfma_f32_16x16x32_bf16 v[48:51], v[132:135], v[100:103], v[48:51]
    ds_read_b64_tr_b16 v[146:147], v20 offset:10240
    v_mfma_f32_16x16x32_bf16 v[32:35], v[132:135], v[96:99], v[32:35]
    ds_read_b64_tr_b16 v[148:149], v21 offset:8192
    v_mfma_f32_16x16x32_bf16 v[36:39], v[136:139], v[96:99], v[36:39]
    ds_read_b64_tr_b16 v[150:151], v21 offset:10240
    v_mfma_f32_16x16x32_bf16 v[52:55], v[136:139], v[100:103], v[52:55]
    ds_read_b64_tr_b16 v[152:153], v22 offset:8192
    v_mfma_f32_16x16x32_bf16 v[56:59], v[140:143], v[100:103], v[56:59]
    ds_read_b64_tr_b16 v[154:155], v22 offset:10240
    v_mfma_f32_16x16x32_bf16 v[40:43], v[140:143], v[96:99], v[40:43]
    ds_read_b64_tr_b16 v[156:157], v23 offset:8192
    v_mfma_f32_16x16x32_bf16 v[72:75], v[140:143], v[104:107], v[72:75]
    ds_read_b64_tr_b16 v[158:159], v23 offset:10240
    v_mfma_f32_16x16x32_bf16 v[88:91], v[140:143], v[108:111], v[88:91]
    ds_read_b128 v[116:119], v11 offset:3072
    v_mfma_f32_16x16x32_bf16 v[84:87], v[136:139], v[108:111], v[84:87]
    ds_read_b128 v[120:123], v11 offset:6144
    v_mfma_f32_16x16x32_bf16 v[68:71], v[136:139], v[104:107], v[68:71]
    ds_read_b128 v[124:127], v11 offset:7168
    v_mfma_f32_16x16x32_bf16 v[64:67], v[132:135], v[104:107], v[64:67]
    v_mfma_f32_16x16x32_bf16 v[80:83], v[132:135], v[108:111], v[80:83]
    v_mfma_f32_16x16x32_bf16 v[76:79], v[128:131], v[108:111], v[76:79]
    v_mfma_f32_16x16x32_bf16 v[60:63], v[128:131], v[104:107], v[60:63]
    s_waitcnt lgkmcnt(0)
    s_barrier
    v_mfma_f32_16x16x32_bf16 v[28:31], v[144:147], v[112:115], v[28:31]
    ds_read_b128 v[96:99], v11 offset:32768
    v_mfma_f32_16x16x32_bf16 v[44:47], v[144:147], v[116:119], v[44:47]
    ds_read_b64_tr_b16 v[128:129], v20 offset:32768
    v_mfma_f32_16x16x32_bf16 v[48:51], v[148:151], v[116:119], v[48:51]
    ds_read_b64_tr_b16 v[130:131], v20 offset:34816
    v_mfma_f32_16x16x32_bf16 v[32:35], v[148:151], v[112:115], v[32:35]
    ds_read_b64_tr_b16 v[132:133], v21 offset:32768
    v_mfma_f32_16x16x32_bf16 v[36:39], v[152:155], v[112:115], v[36:39]
    ds_read_b64_tr_b16 v[134:135], v21 offset:34816
    v_mfma_f32_16x16x32_bf16 v[52:55], v[152:155], v[116:119], v[52:55]
    ds_read_b64_tr_b16 v[136:137], v22 offset:32768
    v_mfma_f32_16x16x32_bf16 v[56:59], v[156:159], v[116:119], v[56:59]
    ds_read_b64_tr_b16 v[138:139], v22 offset:34816
    v_mfma_f32_16x16x32_bf16 v[40:43], v[156:159], v[112:115], v[40:43]
    ds_read_b64_tr_b16 v[140:141], v23 offset:32768
    v_mfma_f32_16x16x32_bf16 v[72:75], v[156:159], v[120:123], v[72:75]
    ds_read_b64_tr_b16 v[142:143], v23 offset:34816
    v_mfma_f32_16x16x32_bf16 v[88:91], v[156:159], v[124:127], v[88:91]
    ds_read_b128 v[100:103], v11 offset:33792
    v_mfma_f32_16x16x32_bf16 v[84:87], v[152:155], v[124:127], v[84:87]
    ds_read_b128 v[104:107], v11 offset:36864
    v_mfma_f32_16x16x32_bf16 v[68:71], v[152:155], v[120:123], v[68:71]
    ds_read_b128 v[108:111], v11 offset:37888
    v_mfma_f32_16x16x32_bf16 v[64:67], v[148:151], v[120:123], v[64:67]
    v_mfma_f32_16x16x32_bf16 v[80:83], v[148:151], v[124:127], v[80:83]
    v_mfma_f32_16x16x32_bf16 v[76:79], v[144:147], v[124:127], v[76:79]
    v_mfma_f32_16x16x32_bf16 v[60:63], v[144:147], v[120:123], v[60:63]
    s_waitcnt lgkmcnt(0)
    v_mfma_f32_16x16x32_bf16 v[28:31], v[128:131], v[96:99], v[28:31]
    ds_read_b128 v[112:115], v11 offset:34816
    v_mfma_f32_16x16x32_bf16 v[44:47], v[128:131], v[100:103], v[44:47]
    ds_read_b64_tr_b16 v[144:145], v20 offset:40960
    v_mfma_f32_16x16x32_bf16 v[48:51], v[132:135], v[100:103], v[48:51]
    ds_read_b64_tr_b16 v[146:147], v20 offset:43008
    v_mfma_f32_16x16x32_bf16 v[32:35], v[132:135], v[96:99], v[32:35]
    ds_read_b64_tr_b16 v[148:149], v21 offset:40960
    v_mfma_f32_16x16x32_bf16 v[36:39], v[136:139], v[96:99], v[36:39]
    ds_read_b64_tr_b16 v[150:151], v21 offset:43008
    v_mfma_f32_16x16x32_bf16 v[52:55], v[136:139], v[100:103], v[52:55]
    ds_read_b64_tr_b16 v[152:153], v22 offset:40960
    v_mfma_f32_16x16x32_bf16 v[56:59], v[140:143], v[100:103], v[56:59]
    ds_read_b64_tr_b16 v[154:155], v22 offset:43008
    v_mfma_f32_16x16x32_bf16 v[40:43], v[140:143], v[96:99], v[40:43]
    ds_read_b64_tr_b16 v[156:157], v23 offset:40960
    v_mfma_f32_16x16x32_bf16 v[72:75], v[140:143], v[104:107], v[72:75]
    ds_read_b64_tr_b16 v[158:159], v23 offset:43008
    v_mfma_f32_16x16x32_bf16 v[88:91], v[140:143], v[108:111], v[88:91]
    ds_read_b128 v[116:119], v11 offset:35840
    v_mfma_f32_16x16x32_bf16 v[84:87], v[136:139], v[108:111], v[84:87]
    ds_read_b128 v[120:123], v11 offset:38912
    v_mfma_f32_16x16x32_bf16 v[68:71], v[136:139], v[104:107], v[68:71]
    ds_read_b128 v[124:127], v11 offset:39936
    v_mfma_f32_16x16x32_bf16 v[64:67], v[132:135], v[104:107], v[64:67]
    v_mfma_f32_16x16x32_bf16 v[80:83], v[132:135], v[108:111], v[80:83]
    v_mfma_f32_16x16x32_bf16 v[76:79], v[128:131], v[108:111], v[76:79]
    v_mfma_f32_16x16x32_bf16 v[60:63], v[128:131], v[104:107], v[60:63]
    s_waitcnt lgkmcnt(0)
    s_barrier
    v_mfma_f32_16x16x32_bf16 v[28:31], v[144:147], v[112:115], v[28:31]
    ds_read_b128 v[96:99], v8 offset:0
    v_mfma_f32_16x16x32_bf16 v[44:47], v[144:147], v[116:119], v[44:47]
    ds_read_b64_tr_b16 v[128:129], v12 offset:0
    v_mfma_f32_16x16x32_bf16 v[48:51], v[148:151], v[116:119], v[48:51]
    ds_read_b64_tr_b16 v[130:131], v12 offset:2048
    v_mfma_f32_16x16x32_bf16 v[32:35], v[148:151], v[112:115], v[32:35]
    ds_read_b64_tr_b16 v[132:133], v13 offset:0
    v_mfma_f32_16x16x32_bf16 v[36:39], v[152:155], v[112:115], v[36:39]
    ds_read_b64_tr_b16 v[134:135], v13 offset:2048
    v_mfma_f32_16x16x32_bf16 v[52:55], v[152:155], v[116:119], v[52:55]
    ds_read_b64_tr_b16 v[136:137], v14 offset:0
    v_mfma_f32_16x16x32_bf16 v[56:59], v[156:159], v[116:119], v[56:59]
    ds_read_b64_tr_b16 v[138:139], v14 offset:2048
    v_mfma_f32_16x16x32_bf16 v[40:43], v[156:159], v[112:115], v[40:43]
    ds_read_b64_tr_b16 v[140:141], v15 offset:0
    v_mfma_f32_16x16x32_bf16 v[72:75], v[156:159], v[120:123], v[72:75]
    ds_read_b64_tr_b16 v[142:143], v15 offset:2048
    v_mfma_f32_16x16x32_bf16 v[88:91], v[156:159], v[124:127], v[88:91]
    ds_read_b128 v[100:103], v8 offset:1024
    v_mfma_f32_16x16x32_bf16 v[84:87], v[152:155], v[124:127], v[84:87]
    ds_read_b128 v[104:107], v8 offset:4096
    v_mfma_f32_16x16x32_bf16 v[68:71], v[152:155], v[120:123], v[68:71]
    ds_read_b128 v[108:111], v8 offset:5120
    v_mfma_f32_16x16x32_bf16 v[64:67], v[148:151], v[120:123], v[64:67]
    v_mfma_f32_16x16x32_bf16 v[80:83], v[148:151], v[124:127], v[80:83]
    v_mfma_f32_16x16x32_bf16 v[76:79], v[144:147], v[124:127], v[76:79]
    v_mfma_f32_16x16x32_bf16 v[60:63], v[144:147], v[120:123], v[60:63]
    s_waitcnt lgkmcnt(0)
    v_mfma_f32_16x16x32_bf16 v[28:31], v[128:131], v[96:99], v[28:31]
    ds_read_b128 v[112:115], v8 offset:2048
    v_mfma_f32_16x16x32_bf16 v[44:47], v[128:131], v[100:103], v[44:47]
    ds_read_b64_tr_b16 v[144:145], v12 offset:8192
    v_mfma_f32_16x16x32_bf16 v[48:51], v[132:135], v[100:103], v[48:51]
    ds_read_b64_tr_b16 v[146:147], v12 offset:10240
    v_mfma_f32_16x16x32_bf16 v[32:35], v[132:135], v[96:99], v[32:35]
    ds_read_b64_tr_b16 v[148:149], v13 offset:8192
    v_mfma_f32_16x16x32_bf16 v[36:39], v[136:139], v[96:99], v[36:39]
    ds_read_b64_tr_b16 v[150:151], v13 offset:10240
    v_mfma_f32_16x16x32_bf16 v[52:55], v[136:139], v[100:103], v[52:55]
    ds_read_b64_tr_b16 v[152:153], v14 offset:8192
    v_mfma_f32_16x16x32_bf16 v[56:59], v[140:143], v[100:103], v[56:59]
    ds_read_b64_tr_b16 v[154:155], v14 offset:10240
    v_mfma_f32_16x16x32_bf16 v[40:43], v[140:143], v[96:99], v[40:43]
    ds_read_b64_tr_b16 v[156:157], v15 offset:8192
    v_mfma_f32_16x16x32_bf16 v[72:75], v[140:143], v[104:107], v[72:75]
    ds_read_b64_tr_b16 v[158:159], v15 offset:10240
    v_mfma_f32_16x16x32_bf16 v[88:91], v[140:143], v[108:111], v[88:91]
    ds_read_b128 v[116:119], v8 offset:3072
    v_mfma_f32_16x16x32_bf16 v[84:87], v[136:139], v[108:111], v[84:87]
    ds_read_b128 v[120:123], v8 offset:6144
    v_mfma_f32_16x16x32_bf16 v[68:71], v[136:139], v[104:107], v[68:71]
    ds_read_b128 v[124:127], v8 offset:7168
    v_mfma_f32_16x16x32_bf16 v[64:67], v[132:135], v[104:107], v[64:67]
    v_mfma_f32_16x16x32_bf16 v[80:83], v[132:135], v[108:111], v[80:83]
    s_sub_u32 s26, s26, 1
    v_mfma_f32_16x16x32_bf16 v[76:79], v[128:131], v[108:111], v[76:79]
    v_mfma_f32_16x16x32_bf16 v[60:63], v[128:131], v[104:107], v[60:63]
    s_cbranch_scc1 OFIN
    s_waitcnt lgkmcnt(0)
    s_barrier
    v_mfma_f32_16x16x32_bf16 v[28:31], v[144:147], v[112:115], v[28:31]
    ds_read_b128 v[96:99], v8 offset:32768
    v_mfma_f32_16x16x32_bf16 v[44:47], v[144:147], v[116:119], v[44:47]
    ds_read_b64_tr_b16 v[128:129], v12 offset:32768
    v_mfma_f32_16x16x32_bf16 v[48:51], v[148:151], v[116:119], v[48:51]
    ds_read_b64_tr_b16 v[130:131], v12 offset:34816
    v_mfma_f32_16x16x32_bf16 v[32:35], v[148:151], v[112:115], v[32:35]
    ds_read_b64_tr_b16 v[132:133], v13 offset:32768
    v_mfma_f32_16x16x32_bf16 v[36:39], v[152:155], v[112:115], v[36:39]
    ds_read_b64_tr_b16 v[134:135], v13 offset:34816
    v_mfma_f32_16x16x32_bf16 v[52:55], v[152:155], v[116:119], v[52:55]
    ds_read_b64_tr_b16 v[136:137], v14 offset:32768
    v_mfma_f32_16x16x32_bf16 v[56:59], v[156:159], v[116:119], v[56:59]
    ds_read_b64_tr_b16 v[138:139], v14 offset:34816
    v_mfma_f32_16x16x32_bf16 v[40:43], v[156:159], v[112:115], v[40:43]
    ds_read_b64_tr_b16 v[140:141], v15 offset:32768
    v_mfma_f32_16x16x32_bf16 v[72:75], v[156:159], v[120:123], v[72:75]
    ds_read_b64_tr_b16 v[142:143], v15 offset:34816
    v_mfma_f32_16x16x32_bf16 v[88:91], v[156:159], v[124:127], v[88:91]
    ds_read_b128 v[100:103], v8 offset:33792
    v_mfma_f32_16x16x32_bf16 v[84:87], v[152:155], v[124:127], v[84:87]
    ds_read_b128 v[104:107], v8 offset:36864
    v_mfma_f32_16x16x32_bf16 v[68:71], v[152:155], v[120:123], v[68:71]
    ds_read_b128 v[108:111], v8 offset:37888
    v_mfma_f32_16x16x32_bf16 v[64:67], v[148:151], v[120:123], v[64:67]
    v_mfma_f32_16x16x32_bf16 v[80:83], v[148:151], v[124:127], v[80:83]
    v_mfma_f32_16x16x32_bf16 v[76:79], v[144:147], v[124:127], v[76:79]
    v_mfma_f32_16x16x32_bf16 v[60:63], v[144:147], v[120:123], v[60:63]
    s_branch OLOOP
OFIN:
    s_waitcnt lgkmcnt(0)
    v_mfma_f32_16x16x32_bf16 v[28:31], v[144:147], v[112:115], v[28:31]
    v_mfma_f32_16x16x32_bf16 v[32:35], v[148:151], v[112:115], v[32:35]
    v_mfma_f32_16x16x32_bf16 v[36:39], v[152:155], v[112:115], v[36:39]
    v_mfma_f32_16x16x32_bf16 v[40:43], v[156:159], v[112:115], v[40:43]
    v_mfma_f32_16x16x32_bf16 v[56:59], v[156:159], v[116:119], v[56:59]
    v_mfma_f32_16x16x32_bf16 v[52:55], v[152:155], v[116:119], v[52:55]
    v_mfma_f32_16x16x32_bf16 v[48:51], v[148:151], v[116:119], v[48:51]
    v_mfma_f32_16x16x32_bf16 v[44:47], v[144:147], v[116:119], v[44:47]
    v_mfma_f32_16x16x32_bf16 v[60:63], v[144:147], v[120:123], v[60:63]
    v_mfma_f32_16x16x32_bf16 v[64:67], v[148:151], v[120:123], v[64:67]
    v_mfma_f32_16x16x32_bf16 v[68:71], v[152:155], v[120:123], v[68:71]
    v_mfma_f32_16x16x32_bf16 v[72:75], v[156:159], v[120:123], v[72:75]
    v_cvt_pk_bf16_f32 v28, v28, v29
    v_cvt_pk_bf16_f32 v29, v30, v31
    v_cvt_pk_bf16_f32 v30, v32, v33
    v_mfma_f32_16x16x32_bf16 v[88:91], v[156:159], v[124:127], v[88:91]
    v_cvt_pk_bf16_f32 v31, v34, v35
    v_cvt_pk_bf16_f32 v36, v36, v37
    v_cvt_pk_bf16_f32 v37, v38, v39
    v_mfma_f32_16x16x32_bf16 v[84:87], v[152:155], v[124:127], v[84:87]
    v_cvt_pk_bf16_f32 v38, v40, v41
    v_cvt_pk_bf16_f32 v39, v42, v43
    v_permlane16_swap_b32 v28, v30
    v_mfma_f32_16x16x32_bf16 v[80:83], v[148:151], v[124:127], v[80:83]
    v_permlane16_swap_b32 v29, v31
    s_nop 0
    v_permlane16_swap_b32 v36, v38
    v_mfma_f32_16x16x32_bf16 v[76:79], v[144:147], v[124:127], v[76:79]
    v_permlane16_swap_b32 v37, v39
    ds_write_b128 v24, v[28:31] offset:0
    ds_write_b128 v25, v[36:39] offset:0
    ds_read_b128 v[96:99], v9 offset:0
    ds_read_b128 v[100:103], v9 offset:1024
    v_cvt_pk_bf16_f32 v44, v44, v45
    v_cvt_pk_bf16_f32 v45, v46, v47
    v_cvt_pk_bf16_f32 v46, v48, v49
    v_cvt_pk_bf16_f32 v47, v50, v51
    v_cvt_pk_bf16_f32 v52, v52, v53
    v_cvt_pk_bf16_f32 v53, v54, v55
    v_cvt_pk_bf16_f32 v54, v56, v57
    v_cvt_pk_bf16_f32 v55, v58, v59
    v_permlane16_swap_b32 v44, v46
    v_permlane16_swap_b32 v45, v47
    s_nop 0
    v_permlane16_swap_b32 v52, v54
    v_permlane16_swap_b32 v53, v55
    ds_write_b128 v24, v[44:47] offset:2048
    ds_write_b128 v25, v[52:55] offset:2048
    ds_read_b128 v[104:107], v9 offset:2048
    ds_read_b128 v[108:111], v9 offset:3072
    s_waitcnt lgkmcnt(4)
    s_add_u32 s25, s84, 0
    buffer_store_dwordx4 v[96:99], v26, s[40:43], s25 offen sc1
    s_add_u32 s25, s84, 32768
    buffer_store_dwordx4 v[100:103], v26, s[40:43], s25 offen sc1
    v_cvt_pk_bf16_f32 v60, v60, v61
    v_cvt_pk_bf16_f32 v61, v62, v63
    v_cvt_pk_bf16_f32 v62, v64, v65
    v_cvt_pk_bf16_f32 v63, v66, v67
    v_cvt_pk_bf16_f32 v68, v68, v69
    v_cvt_pk_bf16_f32 v69, v70, v71
    v_cvt_pk_bf16_f32 v70, v72, v73
    v_cvt_pk_bf16_f32 v71, v74, v75
    v_permlane16_swap_b32 v60, v62
    v_permlane16_swap_b32 v61, v63
    s_nop 0
    v_permlane16_swap_b32 v68, v70
    v_permlane16_swap_b32 v69, v71
    ds_write_b128 v24, v[60:63] offset:4096
    ds_write_b128 v25, v[68:71] offset:4096
    ds_read_b128 v[112:115], v9 offset:4096
    ds_read_b128 v[116:119], v9 offset:5120
    s_waitcnt lgkmcnt(4)
    s_add_u32 s25, s84, 65536
    buffer_store_dwordx4 v[104:107], v26, s[40:43], s25 offen sc1
    s_add_u32 s25, s84, 98304
    buffer_store_dwordx4 v[108:111], v26, s[40:43], s25 offen sc1
    v_cvt_pk_bf16_f32 v76, v76, v77
    v_cvt_pk_bf16_f32 v77, v78, v79
    v_cvt_pk_bf16_f32 v78, v80, v81
    v_cvt_pk_bf16_f32 v79, v82, v83
    v_cvt_pk_bf16_f32 v84, v84, v85
    v_cvt_pk_bf16_f32 v85, v86, v87
    v_cvt_pk_bf16_f32 v86, v88, v89
    v_cvt_pk_bf16_f32 v87, v90, v91
    v_permlane16_swap_b32 v76, v78
    v_permlane16_swap_b32 v77, v79
    s_nop 0
    v_permlane16_swap_b32 v84, v86
    v_permlane16_swap_b32 v85, v87
    ds_write_b128 v24, v[76:79] offset:6144
    ds_write_b128 v25, v[84:87] offset:6144
    ds_read_b128 v[120:123], v9 offset:6144
    ds_read_b128 v[124:127], v9 offset:7168
    s_waitcnt lgkmcnt(4)
    s_add_u32 s25, s84, 131072
    buffer_store_dwordx4 v[112:115], v26, s[40:43], s25 offen sc1
    s_add_u32 s25, s84, 163840
    buffer_store_dwordx4 v[116:119], v26, s[40:43], s25 offen sc1
    s_waitcnt lgkmcnt(0)
    s_add_u32 s25, s84, 196608
    buffer_store_dwordx4 v[120:123], v26, s[40:43], s25 offen sc1
    s_add_u32 s25, s84, 229376
    buffer_store_dwordx4 v[124:127], v26, s[40:43], s25 offen sc1
    s_endpgm
.p2align 12
VP36:
    s_branch VR35
OUTL0:
    s_add_u32 m0, s74, 16384
    s_xor_b32 s31, s73, 786432
    buffer_load_dwordx4 v19, s[36:39], s31 offen offset:0 lds
    buffer_load_dwordx4 v20, s[36:39], s31 offen offset:1024 lds
    s_add_u32 s31, s31, 14336
    buffer_load_dwordx4 v19, s[36:39], s31 offen offset:2048 lds
    buffer_load_dwordx4 v20, s[36:39], s31 offen offset:3072 lds
    s_add_u32 m0, s74, 0
    s_xor_b32 s31, s75, 12288
    s_add_u32 s31, s31, s69
    buffer_load_dwordx4 v3, s[16:19], s31 offen offset:0 sc1 lds
    buffer_load_dwordx4 v3, s[16:19], s31 offen offset:1024 sc1 lds
    s_waitcnt vmcnt(10)
    s_barrier
    s_waitcnt vmcnt(6)
    s_mov_b64 exec, 0xff
    buffer_store_dwordx4 v[6:9], v3, s[16:19], s66 offen sc1
    s_mov_b64 exec, -1
    s_mov_b64 exec, 0xff
    buffer_store_dwordx4 v[6:9], v3, s[16:19], s51 offen sc1
    s_mov_b64 exec, -1
    buffer_load_dwordx4 v3, s[16:19], s31 offen offset:2048 sc1 lds
    buffer_load_dwordx4 v3, s[16:19], s31 offen offset:3072 sc1 lds
    s_add_u32 m0, s74, 32768
    s_xor_b32 s31, s75, 16384
    s_add_u32 s31, s31, s69
    buffer_load_dwordx4 v3, s[16:19], s31 offen offset:0 sc1 lds
    buffer_load_dwordx4 v3, s[16:19], s31 offen offset:1024 sc1 lds
    buffer_load_dwordx4 v3, s[16:19], s31 offen offset:2048 sc1 lds
    buffer_load_dwordx4 v3, s[16:19], s31 offen offset:3072 sc1 lds
    s_add_u32 m0, s74, 81920
    s_xor_b32 s31, s73, 1310720
    buffer_load_dwordx4 v19, s[36:39], s31 offen offset:0 lds
    s_waitcnt vmcnt(17)
    s_barrier
    buffer_load_dwordx4 v20, s[36:39], s31 offen offset:1024 lds
    s_add_u32 s31, s31, 14336
    buffer_load_dwordx4 v19, s[36:39], s31 offen offset:2048 lds
    buffer_load_dwordx4 v20, s[36:39], s31 offen offset:3072 lds
    s_add_u32 m0, s74, 65536
    s_xor_b32 s31, s75, 20480
    s_add_u32 s31, s31, s69
    buffer_load_dwordx4 v3, s[16:19], s31 offen offset:0 sc1 lds
    buffer_load_dwordx4 v3, s[16:19], s31 offen offset:1024 sc1 lds
    buffer_load_dwordx4 v3, s[16:19], s31 offen offset:2048 sc1 lds
    buffer_load_dwordx4 v3, s[16:19], s31 offen offset:3072 sc1 lds
    s_add_u32 m0, s74, 114688
    s_xor_b32 s31, s73, 1572864
    buffer_load_dwordx4 v19, s[36:39], s31 offen offset:0 lds
    s_waitcnt vmcnt(13)
    s_barrier
    buffer_load_dwordx4 v20, s[36:39], s31 offen offset:1024 lds
    s_add_u32 s31, s31, 14336
    buffer_load_dwordx4 v19, s[36:39], s31 offen offset:2048 lds
    buffer_load_dwordx4 v20, s[36:39], s31 offen offset:3072 lds
    s_add_u32 m0, s74, 98304
    s_xor_b32 s31, s75, 24576
    s_add_u32 s31, s31, s69
    buffer_load_dwordx4 v3, s[16:19], s31 offen offset:0 sc1 lds
    buffer_load_dwordx4 v3, s[16:19], s31 offen offset:1024 sc1 lds
    buffer_load_dwordx4 v3, s[16:19], s31 offen offset:2048 sc1 lds
    buffer_load_dwordx4 v3, s[16:19], s31 offen offset:3072 sc1 lds
    s_add_u32 m0, s74, 147456
    s_xor_b32 s31, s73, 1835008
    buffer_load_dwordx4 v19, s[36:39], s31 offen offset:0 lds
    s_waitcnt vmcnt(17)
    s_barrier
    buffer_load_dwordx4 v20, s[36:39], s31 offen offset:1024 lds
    s_add_u32 s31, s31, 14336
    buffer_load_dwordx4 v19, s[36:39], s31 offen offset:2048 lds
    buffer_load_dwordx4 v20, s[36:39], s31 offen offset:3072 lds
    s_mov_b32 exec_lo, s72
    s_mov_b32 exec_hi, 0
    buffer_load_dwordx2 v[14:15], v5, s[16:19], s70 offen sc1
    s_mov_b64 exec, -1
    s_add_u32 m0, s74, 131072
    s_xor_b32 s31, s75, 28672
    s_add_u32 s31, s31, s69
    buffer_load_dwordx4 v3, s[16:19], s31 offen offset:0 sc1 lds
    buffer_load_dwordx4 v3, s[16:19], s31 offen offset:1024 sc1 lds
    buffer_load_dwordx4 v3, s[16:19], s31 offen offset:2048 sc1 lds
    buffer_load_dwordx4 v3, s[16:19], s31 offen offset:3072 sc1 lds
    s_waitcnt vmcnt(17)
    s_barrier
    s_branch OUTL
.p2align 6
VP133:
    s_branch VR132
OUTLY:
    s_xor_b32 s51, s66, 4096
    s_add_u32 m0, s74, 0
    s_xor_b32 s31, s75, 12288
    s_add_u32 s31, s31, s69
    buffer_load_dwordx4 v3, s[16:19], s31 offen offset:1024 sc1 lds
    buffer_load_dwordx4 v3, s[16:19], s31 offen offset:3072 sc1 lds
    s_add_u32 m0, s74, 49152
    s_xor_b32 s31, s73, 1048576
    buffer_load_dwordx4 v19, s[36:39], s31 offen offset:0 lds
    buffer_load_dwordx4 v20, s[36:39], s31 offen offset:1024 lds
    s_add_u32 s31, s31, 14336
    buffer_load_dwordx4 v19, s[36:39], s31 offen offset:2048 lds
    buffer_load_dwordx4 v20, s[36:39], s31 offen offset:3072 lds
    s_add_u32 m0, s74, 32768
    s_xor_b32 s31, s75, 16384
    s_add_u32 s31, s31, s69
    buffer_load_dwordx4 v3, s[16:19], s31 offen offset:0 sc1 lds
    s_waitcnt vmcnt(11)
    s_barrier
    s_waitcnt vmcnt(7)
    s_mov_b64 exec, 0xff
    buffer_store_dwordx4 v[6:9], v3, s[16:19], s66 offen sc1
    s_mov_b64 exec, -1
    s_mov_b64 exec, 0xff
    buffer_store_dwordx4 v[6:9], v3, s[16:19], s51 offen sc1
    s_mov_b64 exec, -1
    buffer_load_dwordx4 v3, s[16:19], s31 offen offset:1024 sc1 lds
    buffer_load_dwordx4 v3, s[16:19], s31 offen offset:2048 sc1 lds
    buffer_load_dwordx4 v3, s[16:19], s31 offen offset:3072 sc1 lds
    s_add_u32 m0, s74, 81920
    s_xor_b32 s31, s73, 1310720
    buffer_load_dwordx4 v19, s[36:39], s31 offen offset:0 lds
    buffer_load_dwordx4 v20, s[36:39], s31 offen offset:1024 lds
    s_add_u32 s31, s31, 14336
    buffer_load_dwordx4 v19, s[36:39], s31 offen offset:2048 lds
    buffer_load_dwordx4 v20, s[36:39], s31 offen offset:3072 lds
    s_waitcnt vmcnt(18)
    s_barrier
    s_add_u32 m0, s74, 65536
    s_xor_b32 s31, s75, 20480
    s_add_u32 s31, s31, s69
    buffer_load_dwordx4 v3, s[16:19], s31 offen offset:0 sc1 lds
    buffer_load_dwordx4 v3, s[16:19], s31 offen offset:1024 sc1 lds
    buffer_load_dwordx4 v3, s[16:19], s31 offen offset:2048 sc1 lds
    buffer_load_dwordx4 v3, s[16:19], s31 offen offset:3072 sc1 lds
    s_add_u32 m0, s74, 114688
    s_xor_b32 s31, s73, 1572864
    buffer_load_dwordx4 v19, s[36:39], s31 offen offset:0 lds
    buffer_load_dwordx4 v20, s[36:39], s31 offen offset:1024 lds
    s_add_u32 s31, s31, 14336
    buffer_load_dwordx4 v19, s[36:39], s31 offen offset:2048 lds
    s_waitcnt vmcnt(21)
    s_barrier
    buffer_load_dwordx4 v20, s[36:39], s31 offen offset:3072 lds
    s_add_u32 m0, s74, 98304
    s_xor_b32 s31, s75, 24576
    s_add_u32 s31, s31, s69
    buffer_load_dwordx4 v3, s[16:19], s31 offen offset:0 sc1 lds
    buffer_load_dwordx4 v3, s[16:19], s31 offen offset:1024 sc1 lds
    buffer_load_dwordx4 v3, s[16:19], s31 offen offset:2048 sc1 lds
    buffer_load_dwordx4 v3, s[16:19], s31 offen offset:3072 sc1 lds
    s_add_u32 m0, s74, 147456
    s_xor_b32 s31, s73, 1835008
    buffer_load_dwordx4 v19, s[36:39], s31 offen offset:0 lds
    buffer_load_dwordx4 v20, s[36:39], s31 offen offset:1024 lds
    s_waitcnt vmcnt(18)
    s_barrier
    s_add_u32 s31, s31, 14336
    buffer_load_dwordx4 v19, s[36:39], s31 offen offset:2048 lds
    buffer_load_dwordx4 v20, s[36:39], s31 offen offset:3072 lds
    s_mov_b32 exec_lo, s72
    s_mov_b32 exec_hi, 0
    buffer_load_dwordx2 v[14:15], v5, s[16:19], s70 offen sc1
    s_mov_b64 exec, -1
    s_add_u32 m0, s74, 131072
    s_xor_b32 s31, s75, 28672
    s_add_u32 s31, s31, s69
    buffer_load_dwordx4 v3, s[16:19], s31 offen offset:0 sc1 lds
    buffer_load_dwordx4 v3, s[16:19], s31 offen offset:1024 sc1 lds
    buffer_load_dwordx4 v3, s[16:19], s31 offen offset:2048 sc1 lds
    buffer_load_dwordx4 v3, s[16:19], s31 offen offset:3072 sc1 lds
    s_waitcnt vmcnt(17)
    s_barrier
OUTL:
    s_waitcnt vmcnt(4)
    v_cmp_eq_u64 vcc, v[6:7], v[14:15]
    s_and_b32 s27, vcc_lo, s72
    s_cmp_eq_u32 s27, s72
    s_cbranch_scc0 LV140
    s_add_u32 m0, s74, 16384
    s_xor_b32 s31, s73, 65536
    buffer_load_dwordx4 v19, s[36:39], s31 offen offset:0 lds
    buffer_load_dwordx4 v20, s[36:39], s31 offen offset:1024 lds
    s_add_u32 s31, s31, 14336
    buffer_load_dwordx4 v19, s[36:39], s31 offen offset:2048 lds
    buffer_load_dwordx4 v20, s[36:39], s31 offen offset:3072 lds
    s_add_u32 m0, s74, 0
    s_xor_b32 s31, s75, 32768
    s_add_u32 s31, s31, s69
    buffer_load_dwordx4 v3, s[16:19], s31 offen offset:0 sc1 lds
    buffer_load_dwordx4 v3, s[16:19], s31 offen offset:1024 sc1 lds
    buffer_load_dwordx4 v3, s[16:19], s31 offen offset:2048 sc1 lds
    s_barrier
    buffer_load_dwordx4 v3, s[16:19], s31 offen offset:3072 sc1 lds
    s_add_u32 m0, s74, 49152
    s_xor_b32 s31, s73, 327680
    buffer_load_dwordx4 v19, s[36:39], s31 offen offset:0 lds
    buffer_load_dwordx4 v20, s[36:39], s31 offen offset:1024 lds
    s_add_u32 s31, s31, 14336
    buffer_load_dwordx4 v19, s[36:39], s31 offen offset:2048 lds
    buffer_load_dwordx4 v20, s[36:39], s31 offen offset:3072 lds
    s_add_u32 m0, s74, 32768
    s_xor_b32 s31, s75, 36864
    s_add_u32 s31, s31, s69
    buffer_load_dwordx4 v3, s[16:19], s31 offen offset:0 sc1 lds
    buffer_load_dwordx4 v3, s[16:19], s31 offen offset:1024 sc1 lds
    s_waitcnt vmcnt(14)
    s_barrier
    buffer_load_dwordx4 v3, s[16:19], s31 offen offset:2048 sc1 lds
    buffer_load_dwordx4 v3, s[16:19], s31 offen offset:3072 sc1 lds
    s_add_u32 m0, s74, 81920
    s_xor_b32 s31, s73, 589824
    buffer_load_dwordx4 v19, s[36:39], s31 offen offset:0 lds
    buffer_load_dwordx4 v20, s[36:39], s31 offen offset:1024 lds
    s_add_u32 s31, s31, 14336
    buffer_load_dwordx4 v19, s[36:39], s31 offen offset:2048 lds
    buffer_load_dwordx4 v20, s[36:39], s31 offen offset:3072 lds
    s_add_u32 m0, s74, 65536
    s_xor_b32 s31, s75, 40960
    s_add_u32 s31, s31, s69
    buffer_load_dwordx4 v3, s[16:19], s31 offen offset:0 sc1 lds
    s_waitcnt vmcnt(13)
    s_barrier
    buffer_load_dwordx4 v3, s[16:19], s31 offen offset:1024 sc1 lds
    buffer_load_dwordx4 v3, s[16:19], s31 offen offset:2048 sc1 lds
    buffer_load_dwordx4 v3, s[16:19], s31 offen offset:3072 sc1 lds
    s_add_u32 m0, s74, 114688
    s_xor_b32 s31, s73, 851968
    buffer_load_dwordx4 v19, s[36:39], s31 offen offset:0 lds
    buffer_load_dwordx4 v20, s[36:39], s31 offen offset:1024 lds
    s_add_u32 s31, s31, 14336
    buffer_load_dwordx4 v19, s[36:39], s31 offen offset:2048 lds
    buffer_load_dwordx4 v20, s[36:39], s31 offen offset:3072 lds
    s_waitcnt vmcnt(12)
    s_barrier
    s_add_u32 m0, s74, 98304
    s_xor_b32 s31, s75, 45056
    s_add_u32 s31, s31, s69
    buffer_load_dwordx4 v3, s[16:19], s31 offen offset:0 sc1 lds
    buffer_load_dwordx4 v3, s[16:19], s31 offen offset:1024 sc1 lds
    buffer_load_dwordx4 v3, s[16:19], s31 offen offset:2048 sc1 lds
    buffer_load_dwordx4 v3, s[16:19], s31 offen offset:3072 sc1 lds
    s_add_u32 m0, s74, 147456
    s_xor_b32 s31, s73, 1114112
    buffer_load_dwordx4 v19, s[36:39], s31 offen offset:0 lds
    buffer_load_dwordx4 v20, s[36:39], s31 offen offset:1024 lds
    s_add_u32 s31, s31, 14336
    buffer_load_dwordx4 v19, s[36:39], s31 offen offset:2048 lds
    s_waitcnt vmcnt(11)
    s_barrier
    buffer_load_dwordx4 v20, s[36:39], s31 offen offset:3072 lds
    s_add_u32 m0, s74, 131072
    s_xor_b32 s31, s75, 49152
    s_add_u32 s31, s31, s69
    buffer_load_dwordx4 v3, s[16:19], s31 offen offset:0 sc1 lds
    buffer_load_dwordx4 v3, s[16:19], s31 offen offset:1024 sc1 lds
    buffer_load_dwordx4 v3, s[16:19], s31 offen offset:2048 sc1 lds
    buffer_load_dwordx4 v3, s[16:19], s31 offen offset:3072 sc1 lds
    s_add_u32 m0, s74, 16384
    s_xor_b32 s31, s73, 1376256
    buffer_load_dwordx4 v19, s[36:39], s31 offen offset:0 lds
    buffer_load_dwordx4 v20, s[36:39], s31 offen offset:1024 lds
    s_waitcnt vmcnt(10)
    s_barrier
    s_add_u32 s31, s31, 14336
    buffer_load_dwordx4 v19, s[36:39], s31 offen offset:2048 lds
    buffer_load_dwordx4 v20, s[36:39], s31 offen offset:3072 lds
    s_add_u32 m0, s74, 0
    s_xor_b32 s31, s75, 53248
    s_add_u32 s31, s31, s69
    buffer_load_dwordx4 v3, s[16:19], s31 offen offset:0 sc1 lds
    buffer_load_dwordx4 v3, s[16:19], s31 offen offset:1024 sc1 lds
    buffer_load_dwordx4 v3, s[16:19], s31 offen offset:2048 sc1 lds
    buffer_load_dwordx4 v3, s[16:19], s31 offen offset:3072 sc1 lds
    s_add_u32 m0, s74, 49152
    s_xor_b32 s31, s73, 1638400
    buffer_load_dwordx4 v19, s[36:39], s31 offen offset:0 lds
    s_waitcnt vmcnt(9)
    s_barrier
    buffer_load_dwordx4 v20, s[36:39], s31 offen offset:1024 lds
    s_add_u32 s31, s31, 14336
    buffer_load_dwordx4 v19, s[36:39], s31 offen offset:2048 lds
    buffer_load_dwordx4 v20, s[36:39], s31 offen offset:3072 lds
    s_add_u32 m0, s74, 32768
    s_xor_b32 s31, s75, 57344
    s_add_u32 s31, s31, s69
    buffer_load_dwordx4 v3, s[16:19], s31 offen offset:0 sc1 lds
    buffer_load_dwordx4 v3, s[16:19], s31 offen offset:1024 sc1 lds
    buffer_load_dwordx4 v3, s[16:19], s31 offen offset:2048 sc1 lds
    buffer_load_dwordx4 v3, s[16:19], s31 offen offset:3072 sc1 lds
    s_waitcnt vmcnt(8)
    s_barrier
    s_add_u32 m0, s74, 81920
    s_xor_b32 s31, s73, 1900544
    buffer_load_dwordx4 v19, s[36:39], s31 offen offset:0 lds
    buffer_load_dwordx4 v20, s[36:39], s31 offen offset:1024 lds
    s_add_u32 s31, s31, 14336
    buffer_load_dwordx4 v19, s[36:39], s31 offen offset:2048 lds
    buffer_load_dwordx4 v20, s[36:39], s31 offen offset:3072 lds
    s_add_u32 m0, s74, 65536
    s_xor_b32 s31, s75, 61440
    s_add_u32 s31, s31, s69
    buffer_load_dwordx4 v3, s[16:19], s31 offen offset:0 sc1 lds
    buffer_load_dwordx4 v3, s[16:19], s31 offen offset:1024 sc1 lds
    buffer_load_dwordx4 v3, s[16:19], s31 offen offset:2048 sc1 lds
    s_waitcnt vmcnt(7)
    s_barrier
    buffer_load_dwordx4 v3, s[16:19], s31 offen offset:3072 sc1 lds
    s_waitcnt vmcnt(0)
    s_barrier
    s_branch LEND
LV140:
    s_add_u32 m0, s74, 16384
    s_xor_b32 s31, s73, 65536
    buffer_load_dwordx4 v19, s[36:39], s31 offen offset:0 lds
    buffer_load_dwordx4 v20, s[36:39], s31 offen offset:1024 lds
    s_add_u32 s31, s31, 14336
    buffer_load_dwordx4 v19, s[36:39], s31 offen offset:2048 lds
    buffer_load_dwordx4 v20, s[36:39], s31 offen offset:3072 lds
    s_mov_b32 exec_lo, s72
    s_mov_b32 exec_hi, 0
    buffer_load_dwordx2 v[14:15], v5, s[16:19], s70 offen sc1
    s_mov_b64 exec, -1
    s_add_u32 m0, s74, 49152
    s_xor_b32 s31, s73, 327680
    buffer_load_dwordx4 v19, s[36:39], s31 offen offset:0 lds
    buffer_load_dwordx4 v20, s[36:39], s31 offen offset:1024 lds
    s_add_u32 s31, s31, 14336
    buffer_load_dwordx4 v19, s[36:39], s31 offen offset:2048 lds
    buffer_load_dwordx4 v20, s[36:39], s31 offen offset:3072 lds
    s_barrier
    s_waitcnt vmcnt(4)
    v_cmp_eq_u64 vcc, v[6:7], v[14:15]
    s_and_b32 s27, vcc_lo, s72
    s_cmp_eq_u32 s27, s72
    s_cbranch_scc0 LW141
    s_add_u32 m0, s74, 0
    s_xor_b32 s31, s75, 32768
    s_add_u32 s31, s31, s69
    buffer_load_dwordx4 v3, s[16:19], s31 offen offset:0 sc1 lds
    buffer_load_dwordx4 v3, s[16:19], s31 offen offset:1024 sc1 lds
    buffer_load_dwordx4 v3, s[16:19], s31 offen offset:2048 sc1 lds
    buffer_load_dwordx4 v3, s[16:19], s31 offen offset:3072 sc1 lds
    s_add_u32 m0, s74, 32768
    s_xor_b32 s31, s75, 36864
    s_add_u32 s31, s31, s69
    buffer_load_dwordx4 v3, s[16:19], s31 offen offset:0 sc1 lds
    buffer_load_dwordx4 v3, s[16:19], s31 offen offset:1024 sc1 lds
    buffer_load_dwordx4 v3, s[16:19], s31 offen offset:2048 sc1 lds
    s_barrier
    buffer_load_dwordx4 v3, s[16:19], s31 offen offset:3072 sc1 lds
    s_add_u32 m0, s74, 81920
    s_xor_b32 s31, s73, 589824
    buffer_load_dwordx4 v19, s[36:39], s31 offen offset:0 lds
    buffer_load_dwordx4 v20, s[36:39], s31 offen offset:1024 lds
    s_add_u32 s31, s31, 14336
    buffer_load_dwordx4 v19, s[36:39], s31 offen offset:2048 lds
    buffer_load_dwordx4 v20, s[36:39], s31 offen offset:3072 lds
    s_add_u32 m0, s74, 65536
    s_xor_b32 s31, s75, 40960
    s_add_u32 s31, s31, s69
    buffer_load_dwordx4 v3, s[16:19], s31 offen offset:0 sc1 lds
    buffer_load_dwordx4 v3, s[16:19], s31 offen offset:1024 sc1 lds
    s_waitcnt vmcnt(10)
    s_barrier
    buffer_load_dwordx4 v3, s[16:19], s31 offen offset:2048 sc1 lds
    buffer_load_dwordx4 v3, s[16:19], s31 offen offset:3072 sc1 lds
    s_add_u32 m0, s74, 114688
    s_xor_b32 s31, s73, 851968
    buffer_load_dwordx4 v19, s[36:39], s31 offen offset:0 lds
    buffer_load_dwordx4 v20, s[36:39], s31 offen offset:1024 lds
    s_add_u32 s31, s31, 14336
    buffer_load_dwordx4 v19, s[36:39], s31 offen offset:2048 lds
    buffer_load_dwordx4 v20, s[36:39], s31 offen offset:3072 lds
    s_add_u32 m0, s74, 98304
    s_xor_b32 s31, s75, 45056
    s_add_u32 s31, s31, s69
    buffer_load_dwordx4 v3, s[16:19], s31 offen offset:0 sc1 lds
    s_waitcnt vmcnt(13)
    s_barrier
    buffer_load_dwordx4 v3, s[16:19], s31 offen offset:1024 sc1 lds
    buffer_load_dwordx4 v3, s[16:19], s31 offen offset:2048 sc1 lds
    buffer_load_dwordx4 v3, s[16:19], s31 offen offset:3072 sc1 lds
    s_add_u32 m0, s74, 147456
    s_xor_b32 s31, s73, 1114112
    buffer_load_dwordx4 v19, s[36:39], s31 offen offset:0 lds
    buffer_load_dwordx4 v20, s[36:39], s31 offen offset:1024 lds
    s_add_u32 s31, s31, 14336
    buffer_load_dwordx4 v19, s[36:39], s31 offen offset:2048 lds
    buffer_load_dwordx4 v20, s[36:39], s31 offen offset:3072 lds
    s_waitcnt vmcnt(12)
    s_barrier
    s_add_u32 m0, s74, 131072
    s_xor_b32 s31, s75, 49152
    s_add_u32 s31, s31, s69
    buffer_load_dwordx4 v3, s[16:19], s31 offen offset:0 sc1 lds
    buffer_load_dwordx4 v3, s[16:19], s31 offen offset:1024 sc1 lds
    buffer_load_dwordx4 v3, s[16:19], s31 offen offset:2048 sc1 lds
    buffer_load_dwordx4 v3, s[16:19], s31 offen offset:3072 sc1 lds
    s_add_u32 m0, s74, 16384
    s_xor_b32 s31, s73, 1376256
    buffer_load_dwordx4 v19, s[36:39], s31 offen offset:0 lds
    buffer_load_dwordx4 v20, s[36:39], s31 offen offset:1024 lds
    s_add_u32 s31, s31, 14336
    buffer_load_dwordx4 v19, s[36:39], s31 offen offset:2048 lds
    s_waitcnt vmcnt(11)
    s_barrier
    buffer_load_dwordx4 v20, s[36:39], s31 offen offset:3072 lds
    s_add_u32 m0, s74, 0
    s_xor_b32 s31, s75, 53248
    s_add_u32 s31, s31, s69
    buffer_load_dwordx4 v3, s[16:19], s31 offen offset:0 sc1 lds
    buffer_load_dwordx4 v3, s[16:19], s31 offen offset:1024 sc1 lds
    buffer_load_dwordx4 v3, s[16:19], s31 offen offset:2048 sc1 lds
    buffer_load_dwordx4 v3, s[16:19], s31 offen offset:3072 sc1 lds
    s_add_u32 m0, s74, 49152
    s_xor_b32 s31, s73, 1638400
    buffer_load_dwordx4 v19, s[36:39], s31 offen offset:0 lds
    buffer_load_dwordx4 v20, s[36:39], s31 offen offset:1024 lds
    s_waitcnt vmcnt(10)
    s_barrier
    s_add_u32 s31, s31, 14336
    buffer_load_dwordx4 v19, s[36:39], s31 offen offset:2048 lds
    buffer_load_dwordx4 v20, s[36:39], s31 offen offset:3072 lds
    s_add_u32 m0, s74, 32768
    s_xor_b32 s31, s75, 57344
    s_add_u32 s31, s31, s69
    buffer_load_dwordx4 v3, s[16:19], s31 offen offset:0 sc1 lds
    buffer_load_dwordx4 v3, s[16:19], s31 offen offset:1024 sc1 lds
    buffer_load_dwordx4 v3, s[16:19], s31 offen offset:2048 sc1 lds
    buffer_load_dwordx4 v3, s[16:19], s31 offen offset:3072 sc1 lds
    s_add_u32 m0, s74, 81920
    s_xor_b32 s31, s73, 1900544
    buffer_load_dwordx4 v19, s[36:39], s31 offen offset:0 lds
    s_waitcnt vmcnt(9)
    s_barrier
    buffer_load_dwordx4 v20, s[36:39], s31 offen offset:1024 lds
    s_add_u32 s31, s31, 14336
    buffer_load_dwordx4 v19, s[36:39], s31 offen offset:2048 lds
    buffer_load_dwordx4 v20, s[36:39], s31 offen offset:3072 lds
    s_add_u32 m0, s74, 65536
    s_xor_b32 s31, s75, 61440
    s_add_u32 s31, s31, s69
    buffer_load_dwordx4 v3, s[16:19], s31 offen offset:0 sc1 lds
    buffer_load_dwordx4 v3, s[16:19], s31 offen offset:1024 sc1 lds
    buffer_load_dwordx4 v3, s[16:19], s31 offen offset:2048 sc1 lds
    buffer_load_dwordx4 v3, s[16:19], s31 offen offset:3072 sc1 lds
    s_waitcnt vmcnt(8)
    s_barrier
    s_waitcnt vmcnt(0)
    s_barrier
    s_branch LEND
LW141:
    s_add_u32 m0, s74, 81920
    s_xor_b32 s31, s73, 589824
    buffer_load_dwordx4 v19, s[36:39], s31 offen offset:0 lds
    buffer_load_dwordx4 v20, s[36:39], s31 offen offset:1024 lds
    s_add_u32 s31, s31, 14336
    buffer_load_dwordx4 v19, s[36:39], s31 offen offset:2048 lds
    buffer_load_dwordx4 v20, s[36:39], s31 offen offset:3072 lds
    s_mov_b32 exec_lo, s72
    s_mov_b32 exec_hi, 0
    buffer_load_dwordx2 v[14:15], v5, s[16:19], s70 offen sc1
    s_mov_b64 exec, -1
    s_barrier
    s_waitcnt vmcnt(0)
    v_cmp_eq_u64 vcc, v[6:7], v[14:15]
    s_and_b32 s27, vcc_lo, s72
    s_cmp_eq_u32 s27, s72
    s_cbranch_scc0 FC142
FD143:
    s_add_u32 m0, s74, 0
    s_xor_b32 s31, s75, 32768
    s_add_u32 s31, s31, s69
    buffer_load_dwordx4 v3, s[16:19], s31 offen offset:0 sc1 lds
    buffer_load_dwordx4 v3, s[16:19], s31 offen offset:1024 sc1 lds
    buffer_load_dwordx4 v3, s[16:19], s31 offen offset:2048 sc1 lds
    buffer_load_dwordx4 v3, s[16:19], s31 offen offset:3072 sc1 lds
    s_add_u32 m0, s74, 32768
    s_xor_b32 s31, s75, 36864
    s_add_u32 s31, s31, s69
    buffer_load_dwordx4 v3, s[16:19], s31 offen offset:0 sc1 lds
    buffer_load_dwordx4 v3, s[16:19], s31 offen offset:1024 sc1 lds
    buffer_load_dwordx4 v3, s[16:19], s31 offen offset:2048 sc1 lds
    buffer_load_dwordx4 v3, s[16:19], s31 offen offset:3072 sc1 lds
    s_waitcnt vmcnt(4)
    s_barrier
    s_add_u32 m0, s74, 65536
    s_xor_b32 s31, s75, 40960
    s_add_u32 s31, s31, s69
    buffer_load_dwordx4 v3, s[16:19], s31 offen offset:0 sc1 lds
    buffer_load_dwordx4 v3, s[16:19], s31 offen offset:1024 sc1 lds
    buffer_load_dwordx4 v3, s[16:19], s31 offen offset:2048 sc1 lds
    buffer_load_dwordx4 v3, s[16:19], s31 offen offset:3072 sc1 lds
    s_add_u32 m0, s74, 114688
    s_xor_b32 s31, s73, 851968
    buffer_load_dwordx4 v19, s[36:39], s31 offen offset:0 lds
    buffer_load_dwordx4 v20, s[36:39], s31 offen offset:1024 lds
    s_add_u32 s31, s31, 14336
    buffer_load_dwordx4 v19, s[36:39], s31 offen offset:2048 lds
    buffer_load_dwordx4 v20, s[36:39], s31 offen offset:3072 lds
    s_waitcnt vmcnt(8)
    s_barrier
    s_add_u32 m0, s74, 98304
    s_xor_b32 s31, s75, 45056
    s_add_u32 s31, s31, s69
    buffer_load_dwordx4 v3, s[16:19], s31 offen offset:0 sc1 lds
    buffer_load_dwordx4 v3, s[16:19], s31 offen offset:1024 sc1 lds
    buffer_load_dwordx4 v3, s[16:19], s31 offen offset:2048 sc1 lds
    buffer_load_dwordx4 v3, s[16:19], s31 offen offset:3072 sc1 lds
    s_add_u32 m0, s74, 147456
    s_xor_b32 s31, s73, 1114112
    buffer_load_dwordx4 v19, s[36:39], s31 offen offset:0 lds
    buffer_load_dwordx4 v20, s[36:39], s31 offen offset:1024 lds
    s_add_u32 s31, s31, 14336
    buffer_load_dwordx4 v19, s[36:39], s31 offen offset:2048 lds
    buffer_load_dwordx4 v20, s[36:39], s31 offen offset:3072 lds
    s_waitcnt vmcnt(12)
    s_barrier
    s_add_u32 m0, s74, 131072
    s_xor_b32 s31, s75, 49152
    s_add_u32 s31, s31, s69
    buffer_load_dwordx4 v3, s[16:19], s31 offen offset:0 sc1 lds
    buffer_load_dwordx4 v3, s[16:19], s31 offen offset:1024 sc1 lds
    buffer_load_dwordx4 v3, s[16:19], s31 offen offset:2048 sc1 lds
    buffer_load_dwordx4 v3, s[16:19], s31 offen offset:3072 sc1 lds
    s_add_u32 m0, s74, 16384
    s_xor_b32 s31, s73, 1376256
    buffer_load_dwordx4 v19, s[36:39], s31 offen offset:0 lds
    buffer_load_dwordx4 v20, s[36:39], s31 offen offset:1024 lds
    s_add_u32 s31, s31, 14336
    buffer_load_dwordx4 v19, s[36:39], s31 offen offset:2048 lds
    buffer_load_dwordx4 v20, s[36:39], s31 offen offset:3072 lds
    s_waitcnt vmcnt(12)
    s_barrier
    s_add_u32 m0, s74, 0
    s_xor_b32 s31, s75, 53248
    s_add_u32 s31, s31, s69
    buffer_load_dwordx4 v3, s[16:19], s31 offen offset:0 sc1 lds
    buffer_load_dwordx4 v3, s[16:19], s31 offen offset:1024 sc1 lds
    buffer_load_dwordx4 v3, s[16:19], s31 offen offset:2048 sc1 lds
    buffer_load_dwordx4 v3, s[16:19], s31 offen offset:3072 sc1 lds
    s_add_u32 m0, s74, 49152
    s_xor_b32 s31, s73, 1638400
    buffer_load_dwordx4 v19, s[36:39], s31 offen offset:0 lds
    buffer_load_dwordx4 v20, s[36:39], s31 offen offset:1024 lds
    s_add_u32 s31, s31, 14336
    buffer_load_dwordx4 v19, s[36:39], s31 offen offset:2048 lds
    buffer_load_dwordx4 v20, s[36:39], s31 offen offset:3072 lds
    s_waitcnt vmcnt(12)
    s_barrier
    s_add_u32 m0, s74, 32768
    s_xor_b32 s31, s75, 57344
    s_add_u32 s31, s31, s69
    buffer_load_dwordx4 v3, s[16:19], s31 offen offset:0 sc1 lds
    buffer_load_dwordx4 v3, s[16:19], s31 offen offset:1024 sc1 lds
    buffer_load_dwordx4 v3, s[16:19], s31 offen offset:2048 sc1 lds
    buffer_load_dwordx4 v3, s[16:19], s31 offen offset:3072 sc1 lds
    s_add_u32 m0, s74, 81920
    s_xor_b32 s31, s73, 1900544
    buffer_load_dwordx4 v19, s[36:39], s31 offen offset:0 lds
    buffer_load_dwordx4 v20, s[36:39], s31 offen offset:1024 lds
    s_add_u32 s31, s31, 14336
    buffer_load_dwordx4 v19, s[36:39], s31 offen offset:2048 lds
    buffer_load_dwordx4 v20, s[36:39], s31 offen offset:3072 lds
    s_waitcnt vmcnt(12)
    s_barrier
    s_add_u32 m0, s74, 65536
    s_xor_b32 s31, s75, 61440
    s_add_u32 s31, s31, s69
    buffer_load_dwordx4 v3, s[16:19], s31 offen offset:0 sc1 lds
    buffer_load_dwordx4 v3, s[16:19], s31 offen offset:1024 sc1 lds
    buffer_load_dwordx4 v3, s[16:19], s31 offen offset:2048 sc1 lds
    buffer_load_dwordx4 v3, s[16:19], s31 offen offset:3072 sc1 lds
    s_waitcnt vmcnt(8)
    s_barrier
    s_waitcnt vmcnt(0)
    s_barrier
LEND:
    s_endpgm
END:
    s_endpgm
.p2align 10
VP66:
    s_branch VR65
YHOT:
FC71:
    s_mov_b32 s30, 0
FC71x:
    s_andn2_b32 s27, s62, s27
    s_mov_b32 exec_lo, s27
    s_mov_b32 exec_hi, 0
    buffer_load_dwordx2 v[14:15], v5, s[16:19], s59 offen sc1
    s_mov_b64 exec, -1
    s_waitcnt vmcnt(0)
    v_cmp_eq_u64 vcc, v[6:7], v[14:15]
    s_and_b32 s27, vcc_lo, s62
    s_cmp_eq_u32 s27, s62
    s_cbranch_scc1 FD72
    s_add_u32 s30, s30, 1
    s_cmp_lt_u32 s30, 1048576
    s_cbranch_scc1 FC71x
    s_branch FD72
YP79:
    s_waitcnt vmcnt(0)
    s_barrier
    s_cmp_eq_u32 s21, 0
    s_cbranch_scc1 YZ81
    v_cmp_eq_u64 vcc, v[6:7], v[14:15]
    s_and_b32 s27, vcc_lo, s60
    s_cmp_eq_u32 s27, s60
    s_cbranch_scc0 FC82
FD83:
    s_mov_b32 m0, 77824
    s_add_u32 s51, s31, 12288
    buffer_load_dwordx4 v3, s[16:19], s51 offen offset:0 sc1 lds
    buffer_load_dwordx4 v3, s[16:19], s51 offen offset:1024 sc1 lds
    buffer_load_dwordx4 v3, s[16:19], s51 offen offset:2048 sc1 lds
    buffer_load_dwordx4 v3, s[16:19], s51 offen offset:3072 sc1 lds
    s_mov_b32 m0, 73728
    s_add_u32 s51, s31, 8192
    buffer_load_dwordx4 v3, s[16:19], s51 offen offset:0 sc1 lds
    buffer_load_dwordx4 v3, s[16:19], s51 offen offset:1024 sc1 lds
    buffer_load_dwordx4 v3, s[16:19], s51 offen offset:2048 sc1 lds
    buffer_load_dwordx4 v3, s[16:19], s51 offen offset:3072 sc1 lds
    s_mov_b32 m0, 69632
    s_add_u32 s51, s31, 4096
    buffer_load_dwordx4 v3, s[16:19], s51 offen offset:0 sc1 lds
    buffer_load_dwordx4 v3, s[16:19], s51 offen offset:1024 sc1 lds
    buffer_load_dwordx4 v3, s[16:19], s51 offen offset:2048 sc1 lds
    buffer_load_dwordx4 v3, s[16:19], s51 offen offset:3072 sc1 lds
    s_branch YR80
YP84:
    s_waitcnt vmcnt(0)
    s_barrier
    s_cmp_eq_u32 s21, 0
    s_cbranch_scc1 YZ86
    v_cmp_eq_u64 vcc, v[6:7], v[14:15]
    s_and_b32 s27, vcc_lo, s60
    s_cmp_eq_u32 s27, s60
    s_cbranch_scc0 FC87
FD88:
    s_mov_b32 m0, 77824
    s_add_u32 s51, s31, 12288
    buffer_load_dwordx4 v3, s[16:19], s51 offen offset:0 sc1 lds
    buffer_load_dwordx4 v3, s[16:19], s51 offen offset:1024 sc1 lds
    buffer_load_dwordx4 v3, s[16:19], s51 offen offset:2048 sc1 lds
    buffer_load_dwordx4 v3, s[16:19], s51 offen offset:3072 sc1 lds
    s_mov_b32 m0, 73728
    s_add_u32 s51, s31, 8192
    buffer_load_dwordx4 v3, s[16:19], s51 offen offset:0 sc1 lds
    buffer_load_dwordx4 v3, s[16:19], s51 offen offset:1024 sc1 lds
    buffer_load_dwordx4 v3, s[16:19], s51 offen offset:2048 sc1 lds
    buffer_load_dwordx4 v3, s[16:19], s51 offen offset:3072 sc1 lds
    s_branch YR85
YP89:
    s_waitcnt vmcnt(0)
    s_barrier
    s_cmp_eq_u32 s21, 0
    s_cbranch_scc1 YZ91
    v_cmp_eq_u64 vcc, v[6:7], v[14:15]
    s_and_b32 s27, vcc_lo, s60
    s_cmp_eq_u32 s27, s60
    s_cbranch_scc0 FC92
FD93:
    s_mov_b32 m0, 77824
    s_add_u32 s51, s31, 12288
    buffer_load_dwordx4 v3, s[16:19], s51 offen offset:0 sc1 lds
    buffer_load_dwordx4 v3, s[16:19], s51 offen offset:1024 sc1 lds
    buffer_load_dwordx4 v3, s[16:19], s51 offen offset:2048 sc1 lds
    buffer_load_dwordx4 v3, s[16:19], s51 offen offset:3072 sc1 lds
    s_branch YR90
YP94:
    s_barrier
    s_setprio 1
    s_cmp_lg_u32 s21, 0
    s_cbranch_scc1 YR95
    s_branch YZ96
YP97:
    s_barrier
    s_setprio 1
    s_cmp_lg_u32 s21, 0
    s_cbranch_scc1 YR98
    s_branch YZ99
YP100:
    s_barrier
    s_setprio 1
    s_cmp_lg_u32 s21, 0
    s_cbranch_scc1 YR101
    s_branch YZ102
YP103:
    s_barrier
    s_setprio 1
    s_cmp_lg_u32 s21, 0
    s_cbranch_scc1 YR104
    s_branch YZ105
FC108:
    s_mov_b32 s30, 0
FC108x:
    s_mov_b64 exec, s[94:95]
    buffer_load_dwordx2 v[14:15], v5, s[16:19], s58 offen sc1
    s_mov_b64 exec, -1
    s_waitcnt vmcnt(0)
    v_cmp_eq_u64 vcc, v[6:7], v[14:15]
    s_and_b64 vcc, vcc, s[94:95]
    s_cmp_eq_u64 vcc, s[94:95]
    s_cbranch_scc1 FD109
    s_add_u32 s30, s30, 1
    s_cmp_lt_u32 s30, 1048576
    s_cbranch_scc1 FC108x
    s_branch FD109
DC1:
    s_mov_b32 s30, 0
DC1x:
    global_load_dwordx2 v[6:7], v26, s[6:7] sc1
    s_waitcnt vmcnt(0)
    v_cmp_eq_u32 vcc, 1, v7
    s_cmp_eq_u64 vcc, -1
    s_cbranch_scc1 DD2
    s_add_u32 s30, s30, 1
    s_cmp_lt_u32 s30, 1048576
    s_cbranch_scc1 DC1x
    s_branch DD2
DC10:
    s_mov_b32 s30, 0
DC10x:
    global_load_dwordx2 v[6:7], v26, s[6:7] sc1
    s_waitcnt vmcnt(0)
    v_cmp_eq_u32 vcc, 1, v7
    s_cmp_eq_u64 vcc, -1
    s_cbranch_scc1 DD11
    s_add_u32 s30, s30, 1
    s_cmp_lt_u32 s30, 1048576
    s_cbranch_scc1 DC10x
    s_branch DD11
FC22:
    s_mov_b32 s30, 0
FC22x:
    s_andn2_b32 s27, s88, s27
    s_mov_b32 exec_lo, s27
    s_mov_b32 exec_hi, 0
    buffer_load_dwordx2 v[14:15], v5, s[16:19], s58 offen sc1
    s_mov_b64 exec, -1
    s_waitcnt vmcnt(0)
    v_cmp_eq_u64 vcc, v[6:7], v[14:15]
    s_and_b32 s27, vcc_lo, s88
    s_cmp_eq_u32 s27, s88
    s_cbranch_scc1 FD23
    s_add_u32 s30, s30, 1
    s_cmp_lt_u32 s30, 1048576
    s_cbranch_scc1 FC22x
    s_branch FD23
FC24:
    s_mov_b32 s30, 0
FC24x:
    s_andn2_b32 s27, s89, s27
    s_mov_b32 exec_lo, s27
    s_mov_b32 exec_hi, 0
    buffer_load_dwordx2 v[14:15], v5, s[16:19], s58 offen sc1
    s_mov_b64 exec, -1
    s_waitcnt vmcnt(0)
    v_cmp_eq_u64 vcc, v[6:7], v[14:15]
    s_and_b32 s27, vcc_lo, s89
    s_cmp_eq_u32 s27, s89
    s_cbranch_scc1 FD25
    s_add_u32 s30, s30, 1
    s_cmp_lt_u32 s30, 1048576
    s_cbranch_scc1 FC24x
    s_branch FD25
FC27:
    s_mov_b32 s30, 0
FC27x:
    s_andn2_b32 s27, s3, s27
    s_mov_b32 exec_lo, s27
    s_mov_b32 exec_hi, 0
    buffer_load_dwordx2 v[14:15], v5, s[16:19], s58 offen sc1
    s_mov_b64 exec, -1
    s_waitcnt vmcnt(0)
    v_cmp_eq_u64 vcc, v[6:7], v[14:15]
    s_and_b32 s27, vcc_lo, s3
    s_cmp_eq_u32 s27, s3
    s_cbranch_scc1 FD28
    s_add_u32 s30, s30, 1
    s_cmp_lt_u32 s30, 1048576
    s_cbranch_scc1 FC27x
    s_branch FD28
FC29:
    s_mov_b32 s30, 0
FC29x:
    s_andn2_b32 s27, s61, s27
    s_mov_b32 exec_lo, s27
    s_mov_b32 exec_hi, 0
    buffer_load_dwordx2 v[14:15], v5, s[16:19], s58 offen sc1
    s_mov_b64 exec, -1
    s_waitcnt vmcnt(0)
    v_cmp_eq_u64 vcc, v[6:7], v[14:15]
    s_and_b32 s27, vcc_lo, s61
    s_cmp_eq_u32 s27, s61
    s_cbranch_scc1 FD30
    s_add_u32 s30, s30, 1
    s_cmp_lt_u32 s30, 1048576
    s_cbranch_scc1 FC29x
    s_branch FD30
FC31:
    s_mov_b32 s30, 0
FC31x:
    s_andn2_b32 s27, s62, s27
    s_mov_b32 exec_lo, s27
    s_mov_b32 exec_hi, 0
    buffer_load_dwordx2 v[14:15], v5, s[16:19], s59 offen sc1
    s_mov_b64 exec, -1
    s_waitcnt vmcnt(0)
    v_cmp_eq_u64 vcc, v[6:7], v[14:15]
    s_and_b32 s27, vcc_lo, s62
    s_cmp_eq_u32 s27, s62
    s_cbranch_scc1 FD32
    s_add_u32 s30, s30, 1
    s_cmp_lt_u32 s30, 1048576
    s_cbranch_scc1 FC31x
    s_branch FD32
FB38:
    s_mov_b32 s47, 64
    v_mov_b32 v26, 0xff800000
    v_mov_b32 v23, 0
    s_mov_b32 s46, 0
FL40:
    s_lshl_b32 s25, s46, 12
    s_add_u32 s25, s25, s54
    s_mov_b32 s48, 0
    s_mov_b32 s49, 1904214016
    buffer_load_dwordx4 v[168:171], v16, s[16:19], s25 offen offset:0 sc1
    buffer_load_dwordx4 v[172:175], v16, s[16:19], s25 offen offset:1024 sc1
    v_mov_b32 v25, s49
    v_fma_f32 v64, v32, s48, v25
    v_min_f32 v64, v64, v23
    v_fma_f32 v65, v33, s48, v25
    v_min_f32 v65, v65, v23
    v_fma_f32 v66, v34, s48, v25
    v_min_f32 v66, v66, v23
    v_fma_f32 v67, v35, s48, v25
    v_min_f32 v67, v67, v23
    v_fma_f32 v68, v36, s48, v25
    v_min_f32 v68, v68, v23
    v_fma_f32 v69, v37, s48, v25
    v_min_f32 v69, v69, v23
    v_fma_f32 v70, v38, s48, v25
    v_min_f32 v70, v70, v23
    v_fma_f32 v71, v39, s48, v25
    v_min_f32 v71, v71, v23
    v_fma_f32 v72, v40, s48, v25
    v_min_f32 v72, v72, v23
    v_fma_f32 v73, v41, s48, v25
    v_min_f32 v73, v73, v23
    v_fma_f32 v74, v42, s48, v25
    v_min_f32 v74, v74, v23
    v_fma_f32 v75, v43, s48, v25
    v_min_f32 v75, v75, v23
    v_fma_f32 v76, v44, s48, v25
    v_min_f32 v76, v76, v23
    v_fma_f32 v77, v45, s48, v25
    v_min_f32 v77, v77, v23
    v_fma_f32 v78, v46, s48, v25
    v_min_f32 v78, v78, v23
    v_fma_f32 v79, v47, s48, v25
    v_min_f32 v79, v79, v23
    s_waitcnt vmcnt(0)
    s_nop 0
    v_mfma_f32_32x32x16_bf16 v[136:151], v[168:171], v[80:83], v[64:79]
    v_mfma_f32_32x32x16_bf16 v[136:151], v[172:175], v[84:87], v[136:151]
    s_nop 11
    v_max3_f32 v26, v26, v136, v137
    v_max3_f32 v26, v26, v138, v139
    v_max3_f32 v26, v26, v140, v141
    v_max3_f32 v26, v26, v142, v143
    v_max3_f32 v26, v26, v144, v145
    v_max3_f32 v26, v26, v146, v147
    v_max3_f32 v26, v26, v148, v149
    v_max3_f32 v26, v26, v150, v151
    s_add_u32 s46, s46, 1
    s_cmp_lt_u32 s46, s47
    s_cbranch_scc1 FL40
    v_mov_b32 v24, v26
    s_nop 1
    v_permlane32_swap_b32 v24, v26
    s_nop 1
    v_max_f32 v26, v26, v24
    v_sub_f32 v23, 0, v26
    v_mov_b64 v[96:97], 0
    v_mov_b64 v[98:99], 0
    v_mov_b64 v[100:101], 0
    v_mov_b64 v[102:103], 0
    v_mov_b64 v[104:105], 0
    v_mov_b64 v[106:107], 0
    v_mov_b64 v[108:109], 0
    v_mov_b64 v[110:111], 0
    v_mov_b64 v[128:129], 0
    v_mov_b64 v[130:131], 0
    s_mov_b32 s46, 0
FL41:
    s_lshl_b32 s25, s46, 12
    s_add_u32 s25, s25, s54
    s_mov_b32 s48, 0
    s_mov_b32 s49, 1904214016
    buffer_load_dwordx4 v[168:171], v16, s[16:19], s25 offen offset:0 sc1
    buffer_load_dwordx4 v[172:175], v16, s[16:19], s25 offen offset:1024 sc1
    buffer_load_dwordx4 v[184:187], v3, s[16:19], s25 offen offset:2048 sc1
    buffer_load_dwordx4 v[188:191], v3, s[16:19], s25 offen offset:3072 sc1
    v_mov_b32 v25, s49
    v_fma_f32 v64, v32, s48, v25
    v_min_f32 v64, v64, v23
    v_fma_f32 v65, v33, s48, v25
    v_min_f32 v65, v65, v23
    v_fma_f32 v66, v34, s48, v25
    v_min_f32 v66, v66, v23
    v_fma_f32 v67, v35, s48, v25
    v_min_f32 v67, v67, v23
    v_fma_f32 v68, v36, s48, v25
    v_min_f32 v68, v68, v23
    v_fma_f32 v69, v37, s48, v25
    v_min_f32 v69, v69, v23
    v_fma_f32 v70, v38, s48, v25
    v_min_f32 v70, v70, v23
    v_fma_f32 v71, v39, s48, v25
    v_min_f32 v71, v71, v23
    v_fma_f32 v72, v40, s48, v25
    v_min_f32 v72, v72, v23
    v_fma_f32 v73, v41, s48, v25
    v_min_f32 v73, v73, v23
    v_fma_f32 v74, v42, s48, v25
    v_min_f32 v74, v74, v23
    v_fma_f32 v75, v43, s48, v25
    v_min_f32 v75, v75, v23
    v_fma_f32 v76, v44, s48, v25
    v_min_f32 v76, v76, v23
    v_fma_f32 v77, v45, s48, v25
    v_min_f32 v77, v77, v23
    v_fma_f32 v78, v46, s48, v25
    v_min_f32 v78, v78, v23
    v_fma_f32 v79, v47, s48, v25
    v_min_f32 v79, v79, v23
    s_waitcnt vmcnt(0)
    s_nop 0
    v_mfma_f32_32x32x16_bf16 v[136:151], v[168:171], v[80:83], v[64:79]
    v_mfma_f32_32x32x16_bf16 v[136:151], v[172:175], v[84:87], v[136:151]
    s_nop 11
    v_exp_f32 v136, v136
    v_exp_f32 v137, v137
    v_exp_f32 v138, v138
    v_exp_f32 v139, v139
    v_exp_f32 v140, v140
    v_exp_f32 v141, v141
    v_exp_f32 v142, v142
    v_exp_f32 v143, v143
    v_exp_f32 v144, v144
    v_exp_f32 v145, v145
    v_exp_f32 v146, v146
    v_exp_f32 v147, v147
    v_exp_f32 v148, v148
    v_exp_f32 v149, v149
    v_exp_f32 v150, v150
    v_exp_f32 v151, v151
    s_nop 1
    v_smfmac_f32_16x16x64_bf16 v[128:131], v[28:31], v[136:143], v17
    v_smfmac_f32_32x32x32_bf16 v[96:111], v[184:187], v[136:143], v17
    v_smfmac_f32_16x16x64_bf16 v[128:131], v[28:31], v[144:151], v17
    v_smfmac_f32_32x32x32_bf16 v[96:111], v[188:191], v[144:151], v17
    s_add_u32 s46, s46, 1
    s_cmp_lt_u32 s46, s47
    s_cbranch_scc1 FL41
    s_nop 11
    v_rcp_f32 v22, v128
    s_nop 0
    s_branch RT39
AP43:
    s_nop 7
    v_mov_b32 v64, 4219469824
    v_mov_b32 v65, v64
    v_mov_b64 v[66:67], v[64:65]
    v_mov_b64 v[68:69], v[64:65]
    v_mov_b64 v[70:71], v[64:65]
    v_mov_b64 v[72:73], v[64:65]
    v_mov_b64 v[74:75], v[64:65]
    v_mov_b64 v[76:77], v[64:65]
    v_mov_b64 v[78:79], v[64:65]
    s_branch AR44
AP45:
    s_nop 7
    v_mov_b32 v64, 4219469824
    v_mov_b32 v65, v64
    v_mov_b64 v[66:67], v[64:65]
    v_mov_b64 v[68:69], v[64:65]
    v_mov_b64 v[70:71], v[64:65]
    v_mov_b64 v[72:73], v[64:65]
    v_mov_b64 v[74:75], v[64:65]
    v_mov_b64 v[76:77], v[64:65]
    v_mov_b64 v[78:79], v[64:65]
    s_branch AR46
AP47:
    s_nop 7
    v_mov_b32 v64, 4219469824
    v_mov_b32 v65, v64
    v_mov_b64 v[66:67], v[64:65]
    v_mov_b64 v[68:69], v[64:65]
    v_mov_b64 v[70:71], v[64:65]
    v_mov_b64 v[72:73], v[64:65]
    v_mov_b64 v[74:75], v[64:65]
    v_mov_b64 v[76:77], v[64:65]
    v_mov_b64 v[78:79], v[64:65]
    s_branch AR48
AP49:
    s_nop 7
    v_mov_b32 v64, 4219469824
    v_mov_b32 v65, v64
    v_mov_b64 v[66:67], v[64:65]
    v_mov_b64 v[68:69], v[64:65]
    v_mov_b64 v[70:71], v[64:65]
    v_mov_b64 v[72:73], v[64:65]
    v_mov_b64 v[74:75], v[64:65]
    v_mov_b64 v[76:77], v[64:65]
    v_mov_b64 v[78:79], v[64:65]
    s_branch AR50
AP51:
    s_nop 7
    v_mov_b32 v64, 4219469824
    v_mov_b32 v65, v64
    v_mov_b64 v[66:67], v[64:65]
    v_mov_b64 v[68:69], v[64:65]
    v_mov_b64 v[70:71], v[64:65]
    v_mov_b64 v[72:73], v[64:65]
    v_mov_b64 v[74:75], v[64:65]
    v_mov_b64 v[76:77], v[64:65]
    v_mov_b64 v[78:79], v[64:65]
    s_branch AR52
AP53:
    s_nop 7
    v_mov_b32 v64, 4219469824
    v_mov_b32 v65, v64
    v_mov_b64 v[66:67], v[64:65]
    v_mov_b64 v[68:69], v[64:65]
    v_mov_b64 v[70:71], v[64:65]
    v_mov_b64 v[72:73], v[64:65]
    v_mov_b64 v[74:75], v[64:65]
    v_mov_b64 v[76:77], v[64:65]
    v_mov_b64 v[78:79], v[64:65]
    s_branch AR54
AP55:
    s_nop 7
    v_mov_b32 v64, 4219469824
    v_mov_b32 v65, v64
    v_mov_b64 v[66:67], v[64:65]
    v_mov_b64 v[68:69], v[64:65]
    v_mov_b64 v[70:71], v[64:65]
    v_mov_b64 v[72:73], v[64:65]
    v_mov_b64 v[74:75], v[64:65]
    v_mov_b64 v[76:77], v[64:65]
    v_mov_b64 v[78:79], v[64:65]
    s_branch AR56
FC57:
    s_mov_b32 s30, 0
FC57x:
    s_andn2_b32 s27, s71, s27
    s_mov_b32 exec_lo, s27
    s_mov_b32 exec_hi, 0
    buffer_load_dwordx2 v[14:15], v5, s[16:19], s70 offen sc1
    s_mov_b64 exec, -1
    s_waitcnt vmcnt(0)
    v_cmp_eq_u64 vcc, v[6:7], v[14:15]
    s_and_b32 s27, vcc_lo, s71
    s_cmp_eq_u32 s27, s71
    s_cbranch_scc1 FD58
    s_add_u32 s30, s30, 1
    s_cmp_lt_u32 s30, 1048576
    s_cbranch_scc1 FC57x
    s_branch FD58
AP59:
    s_nop 7
    v_mov_b32 v64, 4219469824
    v_mov_b32 v65, v64
    v_mov_b64 v[66:67], v[64:65]
    v_mov_b64 v[68:69], v[64:65]
    v_mov_b64 v[70:71], v[64:65]
    v_mov_b64 v[72:73], v[64:65]
    v_mov_b64 v[74:75], v[64:65]
    v_mov_b64 v[76:77], v[64:65]
    v_mov_b64 v[78:79], v[64:65]
    s_branch AR60
FB61:
    s_min_u32 s47, s63, 8
    s_add_u32 s47, s47, 1
    v_mov_b32 v26, 0xff800000
    v_mov_b32 v23, 0
    s_mov_b32 s46, 0
FL63:
    s_sub_u32 s25, s63, s46
    s_lshl_b32 s25, s25, 12
    s_add_u32 s25, s25, s55
    s_mov_b32 s48, 0
    s_mov_b32 s49, 1904214016
    s_cmp_eq_u32 s46, 0
    s_cselect_b32 s48, 1.0, s48
    s_cselect_b32 s49, 0, s49
    s_cmp_eq_u32 s46, 8
    s_cselect_b32 s48, -1.0, s48
    s_cselect_b32 s49, 0, s49
    buffer_load_dwordx4 v[168:171], v16, s[16:19], s25 offen offset:0 sc1
    buffer_load_dwordx4 v[172:175], v16, s[16:19], s25 offen offset:1024 sc1
    v_mov_b32 v25, s49
    v_fma_f32 v64, v32, s48, v25
    v_min_f32 v64, v64, v23
    v_fma_f32 v65, v33, s48, v25
    v_min_f32 v65, v65, v23
    v_fma_f32 v66, v34, s48, v25
    v_min_f32 v66, v66, v23
    v_fma_f32 v67, v35, s48, v25
    v_min_f32 v67, v67, v23
    v_fma_f32 v68, v36, s48, v25
    v_min_f32 v68, v68, v23
    v_fma_f32 v69, v37, s48, v25
    v_min_f32 v69, v69, v23
    v_fma_f32 v70, v38, s48, v25
    v_min_f32 v70, v70, v23
    v_fma_f32 v71, v39, s48, v25
    v_min_f32 v71, v71, v23
    v_fma_f32 v72, v40, s48, v25
    v_min_f32 v72, v72, v23
    v_fma_f32 v73, v41, s48, v25
    v_min_f32 v73, v73, v23
    v_fma_f32 v74, v42, s48, v25
    v_min_f32 v74, v74, v23
    v_fma_f32 v75, v43, s48, v25
    v_min_f32 v75, v75, v23
    v_fma_f32 v76, v44, s48, v25
    v_min_f32 v76, v76, v23
    v_fma_f32 v77, v45, s48, v25
    v_min_f32 v77, v77, v23
    v_fma_f32 v78, v46, s48, v25
    v_min_f32 v78, v78, v23
    v_fma_f32 v79, v47, s48, v25
    v_min_f32 v79, v79, v23
    s_waitcnt vmcnt(0)
    s_nop 0
    v_mfma_f32_32x32x16_bf16 v[136:151], v[168:171], v[200:203], v[64:79]
    v_mfma_f32_32x32x16_bf16 v[136:151], v[172:175], v[204:207], v[136:151]
    s_nop 11
    v_max3_f32 v26, v26, v136, v137
    v_max3_f32 v26, v26, v138, v139
    v_max3_f32 v26, v26, v140, v141
    v_max3_f32 v26, v26, v142, v143
    v_max3_f32 v26, v26, v144, v145
    v_max3_f32 v26, v26, v146, v147
    v_max3_f32 v26, v26, v148, v149
    v_max3_f32 v26, v26, v150, v151
    s_add_u32 s46, s46, 1
    s_cmp_lt_u32 s46, s47
    s_cbranch_scc1 FL63
    v_mov_b32 v24, v26
    s_nop 1
    v_permlane32_swap_b32 v24, v26
    s_nop 1
    v_max_f32 v26, v26, v24
    v_sub_f32 v23, 0, v26
    v_mov_b64 v[112:113], 0
    v_mov_b64 v[114:115], 0
    v_mov_b64 v[116:117], 0
    v_mov_b64 v[118:119], 0
    v_mov_b64 v[120:121], 0
    v_mov_b64 v[122:123], 0
    v_mov_b64 v[124:125], 0
    v_mov_b64 v[126:127], 0
    v_mov_b64 v[128:129], 0
    v_mov_b64 v[130:131], 0
    s_mov_b32 s46, 0
FL64:
    s_sub_u32 s25, s63, s46
    s_lshl_b32 s25, s25, 12
    s_add_u32 s25, s25, s55
    s_mov_b32 s48, 0
    s_mov_b32 s49, 1904214016
    s_cmp_eq_u32 s46, 0
    s_cselect_b32 s48, 1.0, s48
    s_cselect_b32 s49, 0, s49
    s_cmp_eq_u32 s46, 8
    s_cselect_b32 s48, -1.0, s48
    s_cselect_b32 s49, 0, s49
    buffer_load_dwordx4 v[168:171], v16, s[16:19], s25 offen offset:0 sc1
    buffer_load_dwordx4 v[172:175], v16, s[16:19], s25 offen offset:1024 sc1
    buffer_load_dwordx4 v[184:187], v3, s[16:19], s25 offen offset:2048 sc1
    buffer_load_dwordx4 v[188:191], v3, s[16:19], s25 offen offset:3072 sc1
    v_mov_b32 v25, s49
    v_fma_f32 v64, v32, s48, v25
    v_min_f32 v64, v64, v23
    v_fma_f32 v65, v33, s48, v25
    v_min_f32 v65, v65, v23
    v_fma_f32 v66, v34, s48, v25
    v_min_f32 v66, v66, v23
    v_fma_f32 v67, v35, s48, v25
    v_min_f32 v67, v67, v23
    v_fma_f32 v68, v36, s48, v25
    v_min_f32 v68, v68, v23
    v_fma_f32 v69, v37, s48, v25
    v_min_f32 v69, v69, v23
    v_fma_f32 v70, v38, s48, v25
    v_min_f32 v70, v70, v23
    v_fma_f32 v71, v39, s48, v25
    v_min_f32 v71, v71, v23
    v_fma_f32 v72, v40, s48, v25
    v_min_f32 v72, v72, v23
    v_fma_f32 v73, v41, s48, v25
    v_min_f32 v73, v73, v23
    v_fma_f32 v74, v42, s48, v25
    v_min_f32 v74, v74, v23
    v_fma_f32 v75, v43, s48, v25
    v_min_f32 v75, v75, v23
    v_fma_f32 v76, v44, s48, v25
    v_min_f32 v76, v76, v23
    v_fma_f32 v77, v45, s48, v25
    v_min_f32 v77, v77, v23
    v_fma_f32 v78, v46, s48, v25
    v_min_f32 v78, v78, v23
    v_fma_f32 v79, v47, s48, v25
    v_min_f32 v79, v79, v23
    s_waitcnt vmcnt(0)
    s_nop 0
    v_mfma_f32_32x32x16_bf16 v[136:151], v[168:171], v[200:203], v[64:79]
    v_mfma_f32_32x32x16_bf16 v[136:151], v[172:175], v[204:207], v[136:151]
    s_nop 11
    v_exp_f32 v136, v136
    v_exp_f32 v137, v137
    v_exp_f32 v138, v138
    v_exp_f32 v139, v139
    v_exp_f32 v140, v140
    v_exp_f32 v141, v141
    v_exp_f32 v142, v142
    v_exp_f32 v143, v143
    v_exp_f32 v144, v144
    v_exp_f32 v145, v145
    v_exp_f32 v146, v146
    v_exp_f32 v147, v147
    v_exp_f32 v148, v148
    v_exp_f32 v149, v149
    v_exp_f32 v150, v150
    v_exp_f32 v151, v151
    s_nop 1
    v_smfmac_f32_16x16x64_bf16 v[128:131], v[28:31], v[136:143], v17
    v_smfmac_f32_32x32x32_bf16 v[112:127], v[184:187], v[136:143], v17
    v_smfmac_f32_16x16x64_bf16 v[128:131], v[28:31], v[144:151], v17
    v_smfmac_f32_32x32x32_bf16 v[112:127], v[188:191], v[144:151], v17
    s_add_u32 s46, s46, 1
    s_cmp_lt_u32 s46, s47
    s_cbranch_scc1 FL64
    s_nop 11
    v_rcp_f32 v22, v128
    s_nop 0
    s_branch RT62
FC74:
    s_mov_b32 s30, 0
FC74x:
    s_mov_b32 exec_lo, s60
    s_mov_b32 exec_hi, 0
    buffer_load_dwordx2 v[14:15], v5, s[16:19], s59 offen sc1
    s_mov_b64 exec, -1
    s_waitcnt vmcnt(0)
    v_cmp_eq_u64 vcc, v[6:7], v[14:15]
    s_and_b32 s27, vcc_lo, s60
    s_cmp_eq_u32 s27, s60
    s_cbranch_scc1 FD75
    s_add_u32 s30, s30, 1
    s_cmp_lt_u32 s30, 1048576
    s_cbranch_scc1 FC74x
    s_branch FD75
AP77:
    v_mov_b32 v64, 4219469824
    v_mov_b32 v65, v64
    v_mov_b64 v[66:67], v[64:65]
    v_mov_b64 v[68:69], v[64:65]
    v_mov_b64 v[70:71], v[64:65]
    v_mov_b64 v[72:73], v[64:65]
    v_mov_b64 v[74:75], v[64:65]
    v_mov_b64 v[76:77], v[64:65]
    v_mov_b64 v[78:79], v[64:65]
    s_branch AR78
FC82:
    s_mov_b32 s30, 0
FC82x:
    s_mov_b32 exec_lo, s60
    s_mov_b32 exec_hi, 0
    buffer_load_dwordx2 v[14:15], v5, s[16:19], s59 offen sc1
    s_mov_b64 exec, -1
    s_waitcnt vmcnt(0)
    v_cmp_eq_u64 vcc, v[6:7], v[14:15]
    s_and_b32 s27, vcc_lo, s60
    s_cmp_eq_u32 s27, s60
    s_cbranch_scc1 FD83
    s_add_u32 s30, s30, 1
    s_cmp_lt_u32 s30, 1048576
    s_cbranch_scc1 FC82x
    s_branch FD83
YZ81:
    v_mov_b32 v64, 4219469824
    v_mov_b32 v65, v64
    v_mov_b64 v[66:67], v[64:65]
    v_mov_b64 v[68:69], v[64:65]
    v_mov_b64 v[70:71], v[64:65]
    v_mov_b64 v[72:73], v[64:65]
    v_mov_b64 v[74:75], v[64:65]
    v_mov_b64 v[76:77], v[64:65]
    v_mov_b64 v[78:79], v[64:65]
    s_branch YR80
FC87:
    s_mov_b32 s30, 0
FC87x:
    s_mov_b32 exec_lo, s60
    s_mov_b32 exec_hi, 0
    buffer_load_dwordx2 v[14:15], v5, s[16:19], s59 offen sc1
    s_mov_b64 exec, -1
    s_waitcnt vmcnt(0)
    v_cmp_eq_u64 vcc, v[6:7], v[14:15]
    s_and_b32 s27, vcc_lo, s60
    s_cmp_eq_u32 s27, s60
    s_cbranch_scc1 FD88
    s_add_u32 s30, s30, 1
    s_cmp_lt_u32 s30, 1048576
    s_cbranch_scc1 FC87x
    s_branch FD88
YZ86:
    v_mov_b32 v64, 4219469824
    v_mov_b32 v65, v64
    v_mov_b64 v[66:67], v[64:65]
    v_mov_b64 v[68:69], v[64:65]
    v_mov_b64 v[70:71], v[64:65]
    v_mov_b64 v[72:73], v[64:65]
    v_mov_b64 v[74:75], v[64:65]
    v_mov_b64 v[76:77], v[64:65]
    v_mov_b64 v[78:79], v[64:65]
    s_branch YR85
FC92:
    s_mov_b32 s30, 0
FC92x:
    s_mov_b32 exec_lo, s60
    s_mov_b32 exec_hi, 0
    buffer_load_dwordx2 v[14:15], v5, s[16:19], s59 offen sc1
    s_mov_b64 exec, -1
    s_waitcnt vmcnt(0)
    v_cmp_eq_u64 vcc, v[6:7], v[14:15]
    s_and_b32 s27, vcc_lo, s60
    s_cmp_eq_u32 s27, s60
    s_cbranch_scc1 FD93
    s_add_u32 s30, s30, 1
    s_cmp_lt_u32 s30, 1048576
    s_cbranch_scc1 FC92x
    s_branch FD93
YZ91:
    v_mov_b32 v64, 4219469824
    v_mov_b32 v65, v64
    v_mov_b64 v[66:67], v[64:65]
    v_mov_b64 v[68:69], v[64:65]
    v_mov_b64 v[70:71], v[64:65]
    v_mov_b64 v[72:73], v[64:65]
    v_mov_b64 v[74:75], v[64:65]
    v_mov_b64 v[76:77], v[64:65]
    v_mov_b64 v[78:79], v[64:65]
    s_branch YR90
YZ96:
    v_mov_b32 v64, 4219469824
    v_mov_b32 v65, v64
    v_mov_b64 v[66:67], v[64:65]
    v_mov_b64 v[68:69], v[64:65]
    v_mov_b64 v[70:71], v[64:65]
    v_mov_b64 v[72:73], v[64:65]
    v_mov_b64 v[74:75], v[64:65]
    v_mov_b64 v[76:77], v[64:65]
    v_mov_b64 v[78:79], v[64:65]
    s_branch YR95
YZ99:
    v_mov_b32 v64, 4219469824
    v_mov_b32 v65, v64
    v_mov_b64 v[66:67], v[64:65]
    v_mov_b64 v[68:69], v[64:65]
    v_mov_b64 v[70:71], v[64:65]
    v_mov_b64 v[72:73], v[64:65]
    v_mov_b64 v[74:75], v[64:65]
    v_mov_b64 v[76:77], v[64:65]
    v_mov_b64 v[78:79], v[64:65]
    s_branch YR98
YZ102:
    v_mov_b32 v64, 4219469824
    v_mov_b32 v65, v64
    v_mov_b64 v[66:67], v[64:65]
    v_mov_b64 v[68:69], v[64:65]
    v_mov_b64 v[70:71], v[64:65]
    v_mov_b64 v[72:73], v[64:65]
    v_mov_b64 v[74:75], v[64:65]
    v_mov_b64 v[76:77], v[64:65]
    v_mov_b64 v[78:79], v[64:65]
    s_branch YR101
YZ105:
    v_mov_b32 v64, 4219469824
    v_mov_b32 v65, v64
    v_mov_b64 v[66:67], v[64:65]
    v_mov_b64 v[68:69], v[64:65]
    v_mov_b64 v[70:71], v[64:65]
    v_mov_b64 v[72:73], v[64:65]
    v_mov_b64 v[74:75], v[64:65]
    v_mov_b64 v[76:77], v[64:65]
    v_mov_b64 v[78:79], v[64:65]
    s_branch YR104
FB110:
    s_min_u32 s47, s63, 8
    s_add_u32 s47, s47, 1
    v_mov_b32 v26, 0xff800000
    v_mov_b32 v23, 0
    s_mov_b32 s46, 0
FL112:
    s_sub_u32 s25, s63, s46
    s_lshl_b32 s25, s25, 12
    s_add_u32 s25, s25, s55
    s_mov_b32 s48, 0
    s_mov_b32 s49, 1904214016
    s_cmp_eq_u32 s46, 0
    s_cselect_b32 s48, 1.0, s48
    s_cselect_b32 s49, 0, s49
    s_cmp_eq_u32 s46, 8
    s_cselect_b32 s48, -1.0, s48
    s_cselect_b32 s49, 0, s49
    buffer_load_dwordx4 v[168:171], v16, s[16:19], s25 offen offset:0 sc1
    buffer_load_dwordx4 v[172:175], v16, s[16:19], s25 offen offset:1024 sc1
    v_mov_b32 v25, s49
    v_fma_f32 v64, v32, s48, v25
    v_min_f32 v64, v64, v23
    v_fma_f32 v65, v33, s48, v25
    v_min_f32 v65, v65, v23
    v_fma_f32 v66, v34, s48, v25
    v_min_f32 v66, v66, v23
    v_fma_f32 v67, v35, s48, v25
    v_min_f32 v67, v67, v23
    v_fma_f32 v68, v36, s48, v25
    v_min_f32 v68, v68, v23
    v_fma_f32 v69, v37, s48, v25
    v_min_f32 v69, v69, v23
    v_fma_f32 v70, v38, s48, v25
    v_min_f32 v70, v70, v23
    v_fma_f32 v71, v39, s48, v25
    v_min_f32 v71, v71, v23
    v_fma_f32 v72, v40, s48, v25
    v_min_f32 v72, v72, v23
    v_fma_f32 v73, v41, s48, v25
    v_min_f32 v73, v73, v23
    v_fma_f32 v74, v42, s48, v25
    v_min_f32 v74, v74, v23
    v_fma_f32 v75, v43, s48, v25
    v_min_f32 v75, v75, v23
    v_fma_f32 v76, v44, s48, v25
    v_min_f32 v76, v76, v23
    v_fma_f32 v77, v45, s48, v25
    v_min_f32 v77, v77, v23
    v_fma_f32 v78, v46, s48, v25
    v_min_f32 v78, v78, v23
    v_fma_f32 v79, v47, s48, v25
    v_min_f32 v79, v79, v23
    s_waitcnt vmcnt(0)
    s_nop 0
    v_mfma_f32_32x32x16_bf16 v[136:151], v[168:171], v[200:203], v[64:79]
    v_mfma_f32_32x32x16_bf16 v[136:151], v[172:175], v[204:207], v[136:151]
    s_nop 11
    v_max3_f32 v26, v26, v136, v137
    v_max3_f32 v26, v26, v138, v139
    v_max3_f32 v26, v26, v140, v141
    v_max3_f32 v26, v26, v142, v143
    v_max3_f32 v26, v26, v144, v145
    v_max3_f32 v26, v26, v146, v147
    v_max3_f32 v26, v26, v148, v149
    v_max3_f32 v26, v26, v150, v151
    s_add_u32 s46, s46, 1
    s_cmp_lt_u32 s46, s47
    s_cbranch_scc1 FL112
    v_mov_b32 v24, v26
    s_nop 1
    v_permlane32_swap_b32 v24, v26
    s_nop 1
    v_max_f32 v26, v26, v24
    v_sub_f32 v23, 0, v26
    v_mov_b64 v[112:113], 0
    v_mov_b64 v[114:115], 0
    v_mov_b64 v[116:117], 0
    v_mov_b64 v[118:119], 0
    v_mov_b64 v[120:121], 0
    v_mov_b64 v[122:123], 0
    v_mov_b64 v[124:125], 0
    v_mov_b64 v[126:127], 0
    v_mov_b64 v[128:129], 0
    v_mov_b64 v[130:131], 0
    s_mov_b32 s46, 0
FL113:
    s_sub_u32 s25, s63, s46
    s_lshl_b32 s25, s25, 12
    s_add_u32 s25, s25, s55
    s_mov_b32 s48, 0
    s_mov_b32 s49, 1904214016
    s_cmp_eq_u32 s46, 0
    s_cselect_b32 s48, 1.0, s48
    s_cselect_b32 s49, 0, s49
    s_cmp_eq_u32 s46, 8
    s_cselect_b32 s48, -1.0, s48
    s_cselect_b32 s49, 0, s49
    buffer_load_dwordx4 v[168:171], v16, s[16:19], s25 offen offset:0 sc1
    buffer_load_dwordx4 v[172:175], v16, s[16:19], s25 offen offset:1024 sc1
    buffer_load_dwordx4 v[184:187], v3, s[16:19], s25 offen offset:2048 sc1
    buffer_load_dwordx4 v[188:191], v3, s[16:19], s25 offen offset:3072 sc1
    v_mov_b32 v25, s49
    v_fma_f32 v64, v32, s48, v25
    v_min_f32 v64, v64, v23
    v_fma_f32 v65, v33, s48, v25
    v_min_f32 v65, v65, v23
    v_fma_f32 v66, v34, s48, v25
    v_min_f32 v66, v66, v23
    v_fma_f32 v67, v35, s48, v25
    v_min_f32 v67, v67, v23
    v_fma_f32 v68, v36, s48, v25
    v_min_f32 v68, v68, v23
    v_fma_f32 v69, v37, s48, v25
    v_min_f32 v69, v69, v23
    v_fma_f32 v70, v38, s48, v25
    v_min_f32 v70, v70, v23
    v_fma_f32 v71, v39, s48, v25
    v_min_f32 v71, v71, v23
    v_fma_f32 v72, v40, s48, v25
    v_min_f32 v72, v72, v23
    v_fma_f32 v73, v41, s48, v25
    v_min_f32 v73, v73, v23
    v_fma_f32 v74, v42, s48, v25
    v_min_f32 v74, v74, v23
    v_fma_f32 v75, v43, s48, v25
    v_min_f32 v75, v75, v23
    v_fma_f32 v76, v44, s48, v25
    v_min_f32 v76, v76, v23
    v_fma_f32 v77, v45, s48, v25
    v_min_f32 v77, v77, v23
    v_fma_f32 v78, v46, s48, v25
    v_min_f32 v78, v78, v23
    v_fma_f32 v79, v47, s48, v25
    v_min_f32 v79, v79, v23
    s_waitcnt vmcnt(0)
    s_nop 0
    v_mfma_f32_32x32x16_bf16 v[136:151], v[168:171], v[200:203], v[64:79]
    v_mfma_f32_32x32x16_bf16 v[136:151], v[172:175], v[204:207], v[136:151]
    s_nop 11
    v_exp_f32 v136, v136
    v_exp_f32 v137, v137
    v_exp_f32 v138, v138
    v_exp_f32 v139, v139
    v_exp_f32 v140, v140
    v_exp_f32 v141, v141
    v_exp_f32 v142, v142
    v_exp_f32 v143, v143
    v_exp_f32 v144, v144
    v_exp_f32 v145, v145
    v_exp_f32 v146, v146
    v_exp_f32 v147, v147
    v_exp_f32 v148, v148
    v_exp_f32 v149, v149
    v_exp_f32 v150, v150
    v_exp_f32 v151, v151
    s_nop 1
    v_smfmac_f32_16x16x64_bf16 v[128:131], v[28:31], v[136:143], v17
    v_smfmac_f32_32x32x32_bf16 v[112:127], v[184:187], v[136:143], v17
    v_smfmac_f32_16x16x64_bf16 v[128:131], v[28:31], v[144:151], v17
    v_smfmac_f32_32x32x32_bf16 v[112:127], v[188:191], v[144:151], v17
    s_add_u32 s46, s46, 1
    s_cmp_lt_u32 s46, s47
    s_cbranch_scc1 FL113
    s_nop 11
    v_rcp_f32 v22, v128
    s_nop 0
    s_branch RT111
FC116:
    s_mov_b32 s30, 0
FC116x:
    s_andn2_b32 s27, s88, s27
    s_mov_b32 exec_lo, s27
    s_mov_b32 exec_hi, 0
    buffer_load_dwordx2 v[14:15], v5, s[16:19], s58 offen sc1
    s_mov_b64 exec, -1
    s_waitcnt vmcnt(0)
    v_cmp_eq_u64 vcc, v[6:7], v[14:15]
    s_and_b32 s27, vcc_lo, s88
    s_cmp_eq_u32 s27, s88
    s_cbranch_scc1 FD117
    s_add_u32 s30, s30, 1
    s_cmp_lt_u32 s30, 1048576
    s_cbranch_scc1 FC116x
    s_branch FD117
FC118:
    s_mov_b32 s30, 0
FC118x:
    s_andn2_b32 s27, s89, s27
    s_mov_b32 exec_lo, s27
    s_mov_b32 exec_hi, 0
    buffer_load_dwordx2 v[14:15], v5, s[16:19], s58 offen sc1
    s_mov_b64 exec, -1
    s_waitcnt vmcnt(0)
    v_cmp_eq_u64 vcc, v[6:7], v[14:15]
    s_and_b32 s27, vcc_lo, s89
    s_cmp_eq_u32 s27, s89
    s_cbranch_scc1 FD119
    s_add_u32 s30, s30, 1
    s_cmp_lt_u32 s30, 1048576
    s_cbranch_scc1 FC118x
    s_branch FD119
FC122:
    s_mov_b32 s30, 0
FC122x:
    s_andn2_b32 s27, s3, s27
    s_mov_b32 exec_lo, s27
    s_mov_b32 exec_hi, 0
    buffer_load_dwordx2 v[14:15], v5, s[16:19], s58 offen sc1
    s_mov_b64 exec, -1
    s_waitcnt vmcnt(0)
    v_cmp_eq_u64 vcc, v[6:7], v[14:15]
    s_and_b32 s27, vcc_lo, s3
    s_cmp_eq_u32 s27, s3
    s_cbranch_scc1 FD123
    s_add_u32 s30, s30, 1
    s_cmp_lt_u32 s30, 1048576
    s_cbranch_scc1 FC122x
    s_branch FD123
FC126:
    s_mov_b32 s30, 0
FC126x:
    s_andn2_b32 s27, s61, s27
    s_mov_b32 exec_lo, s27
    s_mov_b32 exec_hi, 0
    buffer_load_dwordx2 v[14:15], v5, s[16:19], s58 offen sc1
    s_mov_b64 exec, -1
    s_waitcnt vmcnt(0)
    v_cmp_eq_u64 vcc, v[6:7], v[14:15]
    s_and_b32 s27, vcc_lo, s61
    s_cmp_eq_u32 s27, s61
    s_cbranch_scc1 FD127
    s_add_u32 s30, s30, 1
    s_cmp_lt_u32 s30, 1048576
    s_cbranch_scc1 FC126x
    s_branch FD127
FC128:
    s_mov_b32 s30, 0
FC128x:
    s_andn2_b32 s27, s71, s27
    s_mov_b32 exec_lo, s27
    s_mov_b32 exec_hi, 0
    buffer_load_dwordx2 v[14:15], v5, s[16:19], s70 offen sc1
    s_mov_b64 exec, -1
    s_waitcnt vmcnt(0)
    v_cmp_eq_u64 vcc, v[6:7], v[14:15]
    s_and_b32 s27, vcc_lo, s71
    s_cmp_eq_u32 s27, s71
    s_cbranch_scc1 FD129
    s_add_u32 s30, s30, 1
    s_cmp_lt_u32 s30, 1048576
    s_cbranch_scc1 FC128x
    s_branch FD129
FB136:
    s_mov_b32 s47, 64
    v_mov_b32 v26, 0xff800000
    v_mov_b32 v23, 0
    s_mov_b32 s46, 0
FL138:
    s_lshl_b32 s25, s46, 12
    s_add_u32 s25, s25, s54
    s_mov_b32 s48, 0
    s_mov_b32 s49, 1904214016
    buffer_load_dwordx4 v[168:171], v16, s[16:19], s25 offen offset:0 sc1
    buffer_load_dwordx4 v[172:175], v16, s[16:19], s25 offen offset:1024 sc1
    v_mov_b32 v25, s49
    v_fma_f32 v64, v32, s48, v25
    v_min_f32 v64, v64, v23
    v_fma_f32 v65, v33, s48, v25
    v_min_f32 v65, v65, v23
    v_fma_f32 v66, v34, s48, v25
    v_min_f32 v66, v66, v23
    v_fma_f32 v67, v35, s48, v25
    v_min_f32 v67, v67, v23
    v_fma_f32 v68, v36, s48, v25
    v_min_f32 v68, v68, v23
    v_fma_f32 v69, v37, s48, v25
    v_min_f32 v69, v69, v23
    v_fma_f32 v70, v38, s48, v25
    v_min_f32 v70, v70, v23
    v_fma_f32 v71, v39, s48, v25
    v_min_f32 v71, v71, v23
    v_fma_f32 v72, v40, s48, v25
    v_min_f32 v72, v72, v23
    v_fma_f32 v73, v41, s48, v25
    v_min_f32 v73, v73, v23
    v_fma_f32 v74, v42, s48, v25
    v_min_f32 v74, v74, v23
    v_fma_f32 v75, v43, s48, v25
    v_min_f32 v75, v75, v23
    v_fma_f32 v76, v44, s48, v25
    v_min_f32 v76, v76, v23
    v_fma_f32 v77, v45, s48, v25
    v_min_f32 v77, v77, v23
    v_fma_f32 v78, v46, s48, v25
    v_min_f32 v78, v78, v23
    v_fma_f32 v79, v47, s48, v25
    v_min_f32 v79, v79, v23
    s_waitcnt vmcnt(0)
    s_nop 0
    v_mfma_f32_32x32x16_bf16 v[136:151], v[168:171], v[80:83], v[64:79]
    v_mfma_f32_32x32x16_bf16 v[136:151], v[172:175], v[84:87], v[136:151]
    s_nop 11
    v_max3_f32 v26, v26, v136, v137
    v_max3_f32 v26, v26, v138, v139
    v_max3_f32 v26, v26, v140, v141
    v_max3_f32 v26, v26, v142, v143
    v_max3_f32 v26, v26, v144, v145
    v_max3_f32 v26, v26, v146, v147
    v_max3_f32 v26, v26, v148, v149
    v_max3_f32 v26, v26, v150, v151
    s_add_u32 s46, s46, 1
    s_cmp_lt_u32 s46, s47
    s_cbranch_scc1 FL138
    v_mov_b32 v24, v26
    s_nop 1
    v_permlane32_swap_b32 v24, v26
    s_nop 1
    v_max_f32 v26, v26, v24
    v_sub_f32 v23, 0, v26
    v_mov_b64 v[96:97], 0
    v_mov_b64 v[98:99], 0
    v_mov_b64 v[100:101], 0
    v_mov_b64 v[102:103], 0
    v_mov_b64 v[104:105], 0
    v_mov_b64 v[106:107], 0
    v_mov_b64 v[108:109], 0
    v_mov_b64 v[110:111], 0
    v_mov_b64 v[128:129], 0
    v_mov_b64 v[130:131], 0
    s_mov_b32 s46, 0
FL139:
    s_lshl_b32 s25, s46, 12
    s_add_u32 s25, s25, s54
    s_mov_b32 s48, 0
    s_mov_b32 s49, 1904214016
    buffer_load_dwordx4 v[168:171], v16, s[16:19], s25 offen offset:0 sc1
    buffer_load_dwordx4 v[172:175], v16, s[16:19], s25 offen offset:1024 sc1
    buffer_load_dwordx4 v[184:187], v3, s[16:19], s25 offen offset:2048 sc1
    buffer_load_dwordx4 v[188:191], v3, s[16:19], s25 offen offset:3072 sc1
    v_mov_b32 v25, s49
    v_fma_f32 v64, v32, s48, v25
    v_min_f32 v64, v64, v23
    v_fma_f32 v65, v33, s48, v25
    v_min_f32 v65, v65, v23
    v_fma_f32 v66, v34, s48, v25
    v_min_f32 v66, v66, v23
    v_fma_f32 v67, v35, s48, v25
    v_min_f32 v67, v67, v23
    v_fma_f32 v68, v36, s48, v25
    v_min_f32 v68, v68, v23
    v_fma_f32 v69, v37, s48, v25
    v_min_f32 v69, v69, v23
    v_fma_f32 v70, v38, s48, v25
    v_min_f32 v70, v70, v23
    v_fma_f32 v71, v39, s48, v25
    v_min_f32 v71, v71, v23
    v_fma_f32 v72, v40, s48, v25
    v_min_f32 v72, v72, v23
    v_fma_f32 v73, v41, s48, v25
    v_min_f32 v73, v73, v23
    v_fma_f32 v74, v42, s48, v25
    v_min_f32 v74, v74, v23
    v_fma_f32 v75, v43, s48, v25
    v_min_f32 v75, v75, v23
    v_fma_f32 v76, v44, s48, v25
    v_min_f32 v76, v76, v23
    v_fma_f32 v77, v45, s48, v25
    v_min_f32 v77, v77, v23
    v_fma_f32 v78, v46, s48, v25
    v_min_f32 v78, v78, v23
    v_fma_f32 v79, v47, s48, v25
    v_min_f32 v79, v79, v23
    s_waitcnt vmcnt(0)
    s_nop 0
    v_mfma_f32_32x32x16_bf16 v[136:151], v[168:171], v[80:83], v[64:79]
    v_mfma_f32_32x32x16_bf16 v[136:151], v[172:175], v[84:87], v[136:151]
    s_nop 11
    v_exp_f32 v136, v136
    v_exp_f32 v137, v137
    v_exp_f32 v138, v138
    v_exp_f32 v139, v139
    v_exp_f32 v140, v140
    v_exp_f32 v141, v141
    v_exp_f32 v142, v142
    v_exp_f32 v143, v143
    v_exp_f32 v144, v144
    v_exp_f32 v145, v145
    v_exp_f32 v146, v146
    v_exp_f32 v147, v147
    v_exp_f32 v148, v148
    v_exp_f32 v149, v149
    v_exp_f32 v150, v150
    v_exp_f32 v151, v151
    s_nop 1
    v_smfmac_f32_16x16x64_bf16 v[128:131], v[28:31], v[136:143], v17
    v_smfmac_f32_32x32x32_bf16 v[96:111], v[184:187], v[136:143], v17
    v_smfmac_f32_16x16x64_bf16 v[128:131], v[28:31], v[144:151], v17
    v_smfmac_f32_32x32x32_bf16 v[96:111], v[188:191], v[144:151], v17
    s_add_u32 s46, s46, 1
    s_cmp_lt_u32 s46, s47
    s_cbranch_scc1 FL139
    s_nop 11
    v_rcp_f32 v22, v128
    s_nop 0
    s_branch RT137
FC142:
    s_mov_b32 s30, 0
FC142x:
    s_andn2_b32 s27, s72, s27
    s_mov_b32 exec_lo, s27
    s_mov_b32 exec_hi, 0
    buffer_load_dwordx2 v[14:15], v5, s[16:19], s70 offen sc1
    s_mov_b64 exec, -1
    s_waitcnt vmcnt(0)
    v_cmp_eq_u64 vcc, v[6:7], v[14:15]
    s_and_b32 s27, vcc_lo, s72
    s_cmp_eq_u32 s27, s72
    s_cbranch_scc1 FD143
    s_add_u32 s30, s30, 1
    s_cmp_lt_u32 s30, 1048576
    s_cbranch_scc1 FC142x
    s_branch FD143
CODE_END:
    s_endpgm
.section .rodata,"a"
.p2align 6
.amdhsa_kernel concat_heads__sliding_block__softmax_full_mha__prompt_kernel
  .amdhsa_next_free_vgpr 256
  .amdhsa_next_free_sgpr 102
  .amdhsa_accum_offset 256
  .amdhsa_group_segment_fixed_size 0
  .amdhsa_kernarg_size 72
  .amdhsa_user_sgpr_count 2
  .amdhsa_user_sgpr_kernarg_segment_ptr 1
  .amdhsa_system_sgpr_workgroup_id_x 1
.end_amdhsa_kernel
```
